```python
import torch

def _softmax(x, axis=-1):
    return torch.softmax(x, dim=axis)

def _gelu(x):
    return torch.nn.functional.gelu(x, approximate='tanh')

def _silu(x):
    return torch.nn.functional.silu(x)

def _sigmoid(x):
    return torch.sigmoid(x)

def _layernorm(x, axis=-1, eps=1e-05):
    m = x.mean(dim=axis, keepdim=True)
    v = x.var(dim=axis, keepdim=True, unbiased=False)
    return (x - m) / torch.sqrt(v + eps)

def _scatter_add(tgt, idx, src, axis=0):
    return tgt.clone().index_add_(axis, idx, src)

def _segment_sum(src, seg, n):
    out = torch.zeros((n,) + src.shape[1:], dtype=src.dtype)
    return out.index_add_(0, seg, src)

def _pad(x, pw):
    flat = tuple((v for pair in reversed(pw) for v in pair))
    return torch.nn.functional.pad(x, flat)
kernel_name = 'sequential_preLN__memory_aug_recurrent_mem_tr__mixer_token_mlp__prompt'

def setup_inputs():

    _w = lambda a: (lambda t: t.to(torch.bfloat16) if t.is_floating_point() else t)(torch.as_tensor(a))

    def _A_setup():
        B, S, Dm = (1, 2048, 448)
        H, Dh = (16, 256)
        M, seg = (8, 32)
        seg = min(seg, S)
        S = S // seg * seg
        return {'x': _w((lambda *s: torch.randn(*s, dtype=torch.bfloat16) * 0.05)(B, S, Dm)), 'mem0': _w((lambda *s: torch.randn(*s, dtype=torch.bfloat16) * 0.2)(B, M, Dm)), 'Wq': _w((lambda *s: torch.randn(*s, dtype=torch.bfloat16) * 1.6)(Dm, H, Dh) * Dm ** (-0.5)), 'Wk': _w((lambda *s: torch.randn(*s, dtype=torch.bfloat16) * 1.6)(Dm, H, Dh) * Dm ** (-0.5)), 'Wv': _w((lambda *s: torch.randn(*s, dtype=torch.bfloat16) * 0.2)(Dm, H, Dh) * Dm ** (-0.5)), 'Wo': _w((lambda *s: torch.randn(*s, dtype=torch.bfloat16) * 0.2)(H, Dh, Dm) * (H * Dh) ** (-0.5)), 'seg_len': seg}
    _A_in = _A_setup()

    def _B_setup():
        B, S, D, F = (1, 2048, 448, 1792)
        return {'x': _w((lambda *s: torch.randn(*s, dtype=torch.bfloat16) * 0.05)(B, S, D)), 'w1': _w((lambda *s: torch.randn(*s, dtype=torch.bfloat16) * 0.4)(S, F) * S ** (-0.5)), 'b1': _w((lambda *s: torch.randn(*s, dtype=torch.bfloat16) * 3.2)(F) * 0.02), 'w2': _w((lambda *s: torch.randn(*s, dtype=torch.bfloat16) * 0.4)(F, S) * F ** (-0.5)), 'b2': _w((lambda *s: torch.randn(*s, dtype=torch.bfloat16) * 1.6)(S) * 0.02)}
    _B_in = _B_setup()
    return {'A_x': _A_in['x'], 'A_mem0': _A_in['mem0'], 'A_Wq': _A_in['Wq'], 'A_Wk': _A_in['Wk'], 'A_Wv': _A_in['Wv'], 'A_Wo': _A_in['Wo'], 'A_seg_len': _A_in['seg_len'], 'B_x': _B_in['x'], 'B_w1': _B_in['w1'], 'B_b1': _B_in['b1'], 'B_w2': _B_in['w2'], 'B_b2': _B_in['b2']}

def reference(A_x, A_mem0, A_Wq, A_Wk, A_Wv, A_Wo, A_seg_len, B_x, B_w1, B_b1, B_w2, B_b2):

    def _A_ref(x, mem0, Wq, Wk, Wv, Wo, seg_len):
        B, S, Dm = x.shape
        H, Dh = (Wq.shape[1], Wq.shape[2])
        M = mem0.shape[1]
        scale = Dh ** (-0.5)
        n_seg = S // seg_len
        L = M + seg_len
        idx = torch.arange(L)
        mask = (idx[:, None] < M) | (idx[:, None] >= idx[None, :])
        mem = mem0
        outs = []
        for s in range(n_seg):
            xs = x[:, s * seg_len:(s + 1) * seg_len, :].clone()
            h = torch.concatenate([mem, xs], axis=1)
            q = torch.einsum('btd,dhe->bhte', h, Wq)
            k = torch.einsum('btd,dhe->bhte', h, Wk)
            v = torch.einsum('btd,dhe->bhte', h, Wv)
            scores = torch.einsum('bhqe,bhke->bhqk', q, k) * scale
            scores = torch.where(mask[None, None], scores, -1000000000.0)
            p = _softmax(scores, axis=-1)
            o = torch.einsum('bhqk,bhke->bhqe', p, v)
            o = torch.einsum('bhte,hed->btd', o, Wo)
            mem = o[:, :M, :].clone()
            outs.append(o[:, M:, :])
        return torch.concatenate(outs, axis=1)

    def _B_ref(x, w1, b1, w2, b2):
        B, S, D = x.shape
        h = _layernorm(x, axis=-1)
        u = torch.einsum('bsd,sf->bdf', h, w1) + b1
        u = _gelu(u)
        y = torch.einsum('bdf,fs->bds', u, w2) + b2
        return (lambda x, *d: x.permute(*d))(y, 0, 2, 1)
    x = A_x
    h = x + _A_ref(_layernorm(x, axis=-1), A_mem0, A_Wq, A_Wk, A_Wv, A_Wo, A_seg_len)
    h2 = h + _B_ref(_layernorm(h, axis=-1), B_w1, B_b1, B_w2, B_b2)
    return h2
```

```asm
; @launch grid=(256,1,1) block=(256,1,1) lds=135232
.amdgcn_target "amdgcn-amd-amdhsa--gfx950"
.text
.globl sequential_preLN__memory_aug_recurrent_mem_tr__mixer_token_mlp__prompt_kernel
.p2align 8
.type sequential_preLN__memory_aug_recurrent_mem_tr__mixer_token_mlp__prompt_kernel,@function
sequential_preLN__memory_aug_recurrent_mem_tr__mixer_token_mlp__prompt_kernel:

  s_cmp_ge_u32 s2, 256
  s_cbranch_scc1 L_sequential_preLN__memory_aug_recurrent_mem_tr__mixer_token_mlp__prompt_kernel_end
  s_load_dwordx2 s[6:7], s[0:1], 104
  s_load_dwordx2 s[70:71], s[0:1], 0
  s_load_dwordx2 s[4:5], s[0:1], 112
  s_load_dwordx2 s[10:11], s[0:1], 0
  s_load_dwordx2 s[12:13], s[0:1], 8
  s_load_dwordx2 s[14:15], s[0:1], 16
  s_load_dwordx2 s[16:17], s[0:1], 24
  s_load_dwordx2 s[18:19], s[0:1], 32
  s_load_dwordx2 s[20:21], s[0:1], 40
  s_getreg_b32 s68, hwreg(HW_REG_XCC_ID)
  s_and_b32 s68, s68, 7
  v_lshrrev_b32 v1, 6, v0
  s_nop 0
  v_readfirstlane_b32 s8, v1
  s_waitcnt lgkmcnt(0)
  s_add_u32 s86, s4, 61517824
  s_addc_u32 s87, s5, 0
  v_cmp_eq_u32 vcc, 0, v0
  s_and_saveexec_b64 s[22:23], vcc
  s_cbranch_execz L_rk_1
  s_lshl_b32 s24, s68, 5
  v_mov_b32 v1, s24
  v_mov_b32 v2, 1
  global_atomic_add v191, v1, v2, s[6:7] sc0 sc1
  s_cmp_lg_u32 s2, 0
  s_cbranch_scc1 L_n0_2
  s_memrealtime s[24:25]
  s_waitcnt lgkmcnt(0)
  s_or_b32 s24, s24, 1
  v_mov_b32 v2, s24
  v_mov_b32 v1, 8
  global_store_dword v1, v2, s[6:7] sc1
L_n0_2:
L_rk_1:
  s_mov_b64 exec, s[22:23]
  s_mov_b32 s9, s2
  s_lshl_b32 s24, s9, 8
  v_add_u32 v2, s24, v0
  v_lshlrev_b32 v3, 4, v2
  s_add_u32 s26, s14, 0
  s_addc_u32 s27, s15, 0
  global_load_dwordx4 v[8:11], v3, s[26:27]
  s_add_u32 s26, s14, 1048576
  s_addc_u32 s27, s15, 0
  global_load_dwordx4 v[8:11], v3, s[26:27]
  s_add_u32 s26, s14, 2097152
  s_addc_u32 s27, s15, 0
  global_load_dwordx4 v[8:11], v3, s[26:27]
  s_add_u32 s26, s14, 3145728
  s_addc_u32 s27, s15, 0
  v_min_u32 v12, 524272, v3
  global_load_dwordx4 v[8:11], v12, s[26:27]
  s_add_u32 s26, s16, 0
  s_addc_u32 s27, s17, 0
  global_load_dwordx4 v[8:11], v3, s[26:27]
  s_add_u32 s26, s16, 1048576
  s_addc_u32 s27, s17, 0
  global_load_dwordx4 v[8:11], v3, s[26:27]
  s_add_u32 s26, s16, 2097152
  s_addc_u32 s27, s17, 0
  global_load_dwordx4 v[8:11], v3, s[26:27]
  s_add_u32 s26, s16, 3145728
  s_addc_u32 s27, s17, 0
  v_min_u32 v12, 524272, v3
  global_load_dwordx4 v[8:11], v12, s[26:27]
  s_add_u32 s26, s18, 0
  s_addc_u32 s27, s19, 0
  global_load_dwordx4 v[8:11], v3, s[26:27]
  s_add_u32 s26, s18, 1048576
  s_addc_u32 s27, s19, 0
  global_load_dwordx4 v[8:11], v3, s[26:27]
  s_add_u32 s26, s18, 2097152
  s_addc_u32 s27, s19, 0
  global_load_dwordx4 v[8:11], v3, s[26:27]
  s_add_u32 s26, s18, 3145728
  s_addc_u32 s27, s19, 0
  v_min_u32 v12, 524272, v3
  global_load_dwordx4 v[8:11], v12, s[26:27]
  s_add_u32 s26, s20, 0
  s_addc_u32 s27, s21, 0
  global_load_dwordx4 v[8:11], v3, s[26:27]
  s_add_u32 s26, s20, 1048576
  s_addc_u32 s27, s21, 0
  global_load_dwordx4 v[8:11], v3, s[26:27]
  s_add_u32 s26, s20, 2097152
  s_addc_u32 s27, s21, 0
  global_load_dwordx4 v[8:11], v3, s[26:27]
  s_add_u32 s26, s20, 3145728
  s_addc_u32 s27, s21, 0
  v_min_u32 v12, 524272, v3
  global_load_dwordx4 v[8:11], v12, s[26:27]
  s_add_u32 s26, s10, 0
  s_addc_u32 s27, s11, 0
  global_load_dwordx4 v[8:11], v3, s[26:27]
  s_add_u32 s26, s10, 1048576
  s_addc_u32 s27, s11, 0
  v_min_u32 v12, 786416, v3
  global_load_dwordx4 v[8:11], v12, s[26:27]
  v_mov_b32 v179, 8
  global_load_dword v179, v179, s[6:7] sc1
  s_cmp_ge_u32 s9, 224
  s_cbranch_scc1 L_sequential_preLN__memory_aug_recurrent_mem_tr__mixer_token_mlp__prompt_kernel_p1ln
  s_and_b32 s24, s9, 7
  s_lshr_b32 s25, s9, 3
  s_mul_i32 s33, s25, 9363
  s_lshr_b32 s33, s33, 16
  s_mul_i32 s34, s33, 7
  s_sub_u32 s34, s25, s34
  s_lshl_b32 s24, s24, 2
  s_add_u32 s33, s33, s24
  s_lshr_b32 s32, s33, 4
  s_and_b32 s33, s33, 15
  v_and_b32 v183, 63, v0
  v_lshlrev_b32 v180, 4, v183
  v_and_b32 v184, 15, v0
  v_bfe_u32 v185, v0, 4, 2
  v_bfe_u32 v183, v0, 5, 1
  v_lshlrev_b32 v181, 13, v183
  v_mul_u32_u24 v186, 528, v183
  v_and_b32 v183, 31, v0
  v_lshl_add_u32 v181, v183, 4, v181
  v_lshl_add_u32 v186, v183, 4, v186
  s_mul_i32 s24, s8, 16896
  s_add_u32 s24, s24, 0
  v_add_u32 v186, s24, v186
  v_lshrrev_b32 v187, 2, v184
  v_lshlrev_b32 v187, 3, v187
  v_and_b32 v183, 3, v184
  v_add_u32 v187, v187, v183
  v_mul_u32_u24 v187, 528, v187
  v_lshl_add_u32 v187, v185, 4, v187
  v_add_u32 v187, s24, v187
  s_cmp_eq_u32 s32, 0
  s_cselect_b32 s36, s14, s18
  s_cselect_b32 s37, s15, s19
  s_lshl_b32 s24, s33, 9
  s_add_u32 s36, s36, s24
  s_addc_u32 s37, s37, 0
  s_cmp_eq_u32 s32, 0
  s_mov_b32 s26, 6422528
  s_cselect_b32 s26, 0, s26
  s_mov_b32 s40, 0x3db8aa3b
  s_cselect_b32 s40, s40, 1.0
  s_mul_i32 s24, s33, 401408
  s_add_u32 s26, s26, s24
  s_mul_i32 s24, s34, 57344
  s_add_u32 s26, s26, s24
  s_add_u32 s38, s4, s26
  s_addc_u32 s39, s5, 0
  s_cmp_eq_u32 s32, 1
  s_cbranch_scc1 L_foldB_4
  v_lshrrev_b32 v183, 5, v0
  v_and_b32 v182, 31, v0
  v_lshlrev_b32 v168, 13, v183
  v_lshl_add_u32 v168, v182, 4, v168
  v_mul_u32_u24 v169, 528, v183
  v_lshl_add_u32 v169, v182, 4, v169
  v_add_u32 v169, 67584, v169
  s_lshl_b32 s24, s34, 19
  s_lshl_b32 s25, s33, 9
  s_add_u32 s24, s24, s25
  s_add_u32 s26, s16, s24
  s_addc_u32 s27, s17, 0
  global_load_dwordx4 v[8:11], v168, s[26:27]
  s_add_u32 s26, s26, 65536
  s_addc_u32 s27, s27, 0
  global_load_dwordx4 v[12:15], v168, s[26:27]
  s_add_u32 s26, s26, 65536
  s_addc_u32 s27, s27, 0
  global_load_dwordx4 v[16:19], v168, s[26:27]
  s_add_u32 s26, s26, 65536
  s_addc_u32 s27, s27, 0
  global_load_dwordx4 v[20:23], v168, s[26:27]
  s_add_u32 s26, s26, 65536
  s_addc_u32 s27, s27, 0
  global_load_dwordx4 v[24:27], v168, s[26:27]
  s_add_u32 s26, s26, 65536
  s_addc_u32 s27, s27, 0
  global_load_dwordx4 v[28:31], v168, s[26:27]
  s_add_u32 s26, s26, 65536
  s_addc_u32 s27, s27, 0
  global_load_dwordx4 v[32:35], v168, s[26:27]
  s_add_u32 s26, s26, 65536
  s_addc_u32 s27, s27, 0
  global_load_dwordx4 v[36:39], v168, s[26:27]
  s_add_u32 s26, s26, 65536
  s_addc_u32 s27, s27, 0
  s_branch L_foldj_5
L_foldB_4:
  s_mul_i32 s24, s33, 229376
  s_lshl_b32 s25, s34, 7
  s_add_u32 s24, s24, s25
  s_add_u32 s26, s20, s24
  s_addc_u32 s27, s21, 0
  v_lshrrev_b32 v183, 3, v0
  v_and_b32 v182, 7, v0
  v_mul_u32_u24 v168, 896, v183
  v_lshl_add_u32 v168, v182, 4, v168
  v_mul_u32_u24 v169, 144, v183
  v_lshl_add_u32 v169, v182, 4, v169
  v_add_u32 v169, 67584, v169
  global_load_dwordx4 v[8:11], v168, s[26:27]
  s_add_u32 s26, s26, 28672
  s_addc_u32 s27, s27, 0
  global_load_dwordx4 v[12:15], v168, s[26:27]
  s_add_u32 s26, s26, 28672
  s_addc_u32 s27, s27, 0
  global_load_dwordx4 v[16:19], v168, s[26:27]
  s_add_u32 s26, s26, 28672
  s_addc_u32 s27, s27, 0
  global_load_dwordx4 v[20:23], v168, s[26:27]
  s_add_u32 s26, s26, 28672
  s_addc_u32 s27, s27, 0
  global_load_dwordx4 v[24:27], v168, s[26:27]
  s_add_u32 s26, s26, 28672
  s_addc_u32 s27, s27, 0
  global_load_dwordx4 v[28:31], v168, s[26:27]
  s_add_u32 s26, s26, 28672
  s_addc_u32 s27, s27, 0
  global_load_dwordx4 v[32:35], v168, s[26:27]
  s_add_u32 s26, s26, 28672
  s_addc_u32 s27, s27, 0
  global_load_dwordx4 v[36:39], v168, s[26:27]
  s_add_u32 s26, s26, 28672
  s_addc_u32 s27, s27, 0
L_foldj_5:
  s_lshl_b32 s24, s8, 18
  s_add_u32 s42, s36, s24
  s_addc_u32 s43, s37, 0
  s_mov_b32 s30, s42
  s_mov_b32 s31, s43
  global_load_dwordx4 a[0:3], v181, s[30:31]
  s_add_u32 s30, s30, 16384
  s_addc_u32 s31, s31, 0
  global_load_dwordx4 a[4:7], v181, s[30:31]
  s_add_u32 s30, s30, 16384
  s_addc_u32 s31, s31, 0
  global_load_dwordx4 a[8:11], v181, s[30:31]
  s_add_u32 s30, s30, 16384
  s_addc_u32 s31, s31, 0
  global_load_dwordx4 a[12:15], v181, s[30:31]
  s_add_u32 s30, s30, 16384
  s_addc_u32 s31, s31, 0
  global_load_dwordx4 a[16:19], v181, s[30:31]
  s_add_u32 s30, s30, 16384
  s_addc_u32 s31, s31, 0
  global_load_dwordx4 a[20:23], v181, s[30:31]
  s_add_u32 s30, s30, 16384
  s_addc_u32 s31, s31, 0
  global_load_dwordx4 a[24:27], v181, s[30:31]
  s_add_u32 s30, s30, 16384
  s_addc_u32 s31, s31, 0
  global_load_dwordx4 a[28:31], v181, s[30:31]
  s_add_u32 s30, s30, 16384
  s_addc_u32 s31, s31, 0
  global_load_dwordx4 a[32:35], v181, s[30:31]
  s_add_u32 s30, s30, 16384
  s_addc_u32 s31, s31, 0
  global_load_dwordx4 a[36:39], v181, s[30:31]
  s_add_u32 s30, s30, 16384
  s_addc_u32 s31, s31, 0
  global_load_dwordx4 a[40:43], v181, s[30:31]
  s_add_u32 s30, s30, 16384
  s_addc_u32 s31, s31, 0
  global_load_dwordx4 a[44:47], v181, s[30:31]
  s_add_u32 s30, s30, 16384
  s_addc_u32 s31, s31, 0
  global_load_dwordx4 a[48:51], v181, s[30:31]
  s_add_u32 s30, s30, 16384
  s_addc_u32 s31, s31, 0
  global_load_dwordx4 a[52:55], v181, s[30:31]
  s_add_u32 s30, s30, 16384
  s_addc_u32 s31, s31, 0
  global_load_dwordx4 a[56:59], v181, s[30:31]
  s_add_u32 s30, s30, 16384
  s_addc_u32 s31, s31, 0
  global_load_dwordx4 a[60:63], v181, s[30:31]
  s_add_u32 s42, s42, 1048576
  s_addc_u32 s43, s43, 0
  s_mov_b32 s30, s42
  s_mov_b32 s31, s43
  global_load_dwordx4 a[64:67], v181, s[30:31]
  s_add_u32 s30, s30, 16384
  s_addc_u32 s31, s31, 0
  global_load_dwordx4 a[68:71], v181, s[30:31]
  s_add_u32 s30, s30, 16384
  s_addc_u32 s31, s31, 0
  global_load_dwordx4 a[72:75], v181, s[30:31]
  s_add_u32 s30, s30, 16384
  s_addc_u32 s31, s31, 0
  global_load_dwordx4 a[76:79], v181, s[30:31]
  s_add_u32 s30, s30, 16384
  s_addc_u32 s31, s31, 0
  global_load_dwordx4 a[80:83], v181, s[30:31]
  s_add_u32 s30, s30, 16384
  s_addc_u32 s31, s31, 0
  global_load_dwordx4 a[84:87], v181, s[30:31]
  s_add_u32 s30, s30, 16384
  s_addc_u32 s31, s31, 0
  global_load_dwordx4 a[88:91], v181, s[30:31]
  s_add_u32 s30, s30, 16384
  s_addc_u32 s31, s31, 0
  global_load_dwordx4 a[92:95], v181, s[30:31]
  s_add_u32 s30, s30, 16384
  s_addc_u32 s31, s31, 0
  global_load_dwordx4 a[96:99], v181, s[30:31]
  s_add_u32 s30, s30, 16384
  s_addc_u32 s31, s31, 0
  global_load_dwordx4 a[100:103], v181, s[30:31]
  s_add_u32 s30, s30, 16384
  s_addc_u32 s31, s31, 0
  global_load_dwordx4 a[104:107], v181, s[30:31]
  s_add_u32 s30, s30, 16384
  s_addc_u32 s31, s31, 0
  global_load_dwordx4 a[108:111], v181, s[30:31]
  s_add_u32 s30, s30, 16384
  s_addc_u32 s31, s31, 0
  global_load_dwordx4 a[112:115], v181, s[30:31]
  s_add_u32 s30, s30, 16384
  s_addc_u32 s31, s31, 0
  global_load_dwordx4 a[116:119], v181, s[30:31]
  s_add_u32 s30, s30, 16384
  s_addc_u32 s31, s31, 0
  global_load_dwordx4 a[120:123], v181, s[30:31]
  s_add_u32 s30, s30, 16384
  s_addc_u32 s31, s31, 0
  global_load_dwordx4 a[124:127], v181, s[30:31]
  s_add_u32 s42, s42, 1048576
  s_addc_u32 s43, s43, 0
  s_mov_b32 s30, s42
  s_mov_b32 s31, s43
  global_load_dwordx4 a[128:131], v181, s[30:31]
  s_add_u32 s30, s30, 16384
  s_addc_u32 s31, s31, 0
  global_load_dwordx4 a[132:135], v181, s[30:31]
  s_add_u32 s30, s30, 16384
  s_addc_u32 s31, s31, 0
  global_load_dwordx4 a[136:139], v181, s[30:31]
  s_add_u32 s30, s30, 16384
  s_addc_u32 s31, s31, 0
  global_load_dwordx4 a[140:143], v181, s[30:31]
  s_add_u32 s30, s30, 16384
  s_addc_u32 s31, s31, 0
  global_load_dwordx4 a[144:147], v181, s[30:31]
  s_add_u32 s30, s30, 16384
  s_addc_u32 s31, s31, 0
  global_load_dwordx4 a[148:151], v181, s[30:31]
  s_add_u32 s30, s30, 16384
  s_addc_u32 s31, s31, 0
  global_load_dwordx4 a[152:155], v181, s[30:31]
  s_add_u32 s30, s30, 16384
  s_addc_u32 s31, s31, 0
  global_load_dwordx4 a[156:159], v181, s[30:31]
  s_add_u32 s30, s30, 16384
  s_addc_u32 s31, s31, 0
  global_load_dwordx4 a[160:163], v181, s[30:31]
  s_add_u32 s30, s30, 16384
  s_addc_u32 s31, s31, 0
  global_load_dwordx4 a[164:167], v181, s[30:31]
  s_add_u32 s30, s30, 16384
  s_addc_u32 s31, s31, 0
  global_load_dwordx4 a[168:171], v181, s[30:31]
  s_add_u32 s30, s30, 16384
  s_addc_u32 s31, s31, 0
  global_load_dwordx4 a[172:175], v181, s[30:31]
  s_add_u32 s30, s30, 16384
  s_addc_u32 s31, s31, 0
  global_load_dwordx4 a[176:179], v181, s[30:31]
  s_add_u32 s30, s30, 16384
  s_addc_u32 s31, s31, 0
  global_load_dwordx4 a[180:183], v181, s[30:31]
  s_add_u32 s30, s30, 16384
  s_addc_u32 s31, s31, 0
  global_load_dwordx4 a[184:187], v181, s[30:31]
  s_add_u32 s30, s30, 16384
  s_addc_u32 s31, s31, 0
  global_load_dwordx4 a[188:191], v181, s[30:31]
  s_add_u32 s42, s42, 1048576
  s_addc_u32 s43, s43, 0
  s_cmp_ge_u32 s8, 2
  s_cbranch_scc1 L_no4_6
  s_mov_b32 s30, s42
  s_mov_b32 s31, s43
  global_load_dwordx4 a[192:195], v181, s[30:31]
  s_add_u32 s30, s30, 16384
  s_addc_u32 s31, s31, 0
  global_load_dwordx4 a[196:199], v181, s[30:31]
  s_add_u32 s30, s30, 16384
  s_addc_u32 s31, s31, 0
  global_load_dwordx4 a[200:203], v181, s[30:31]
  s_add_u32 s30, s30, 16384
  s_addc_u32 s31, s31, 0
  global_load_dwordx4 a[204:207], v181, s[30:31]
  s_add_u32 s30, s30, 16384
  s_addc_u32 s31, s31, 0
  global_load_dwordx4 a[208:211], v181, s[30:31]
  s_add_u32 s30, s30, 16384
  s_addc_u32 s31, s31, 0
  global_load_dwordx4 a[212:215], v181, s[30:31]
  s_add_u32 s30, s30, 16384
  s_addc_u32 s31, s31, 0
  global_load_dwordx4 a[216:219], v181, s[30:31]
  s_add_u32 s30, s30, 16384
  s_addc_u32 s31, s31, 0
  global_load_dwordx4 a[220:223], v181, s[30:31]
  s_add_u32 s30, s30, 16384
  s_addc_u32 s31, s31, 0
  global_load_dwordx4 a[224:227], v181, s[30:31]
  s_add_u32 s30, s30, 16384
  s_addc_u32 s31, s31, 0
  global_load_dwordx4 a[228:231], v181, s[30:31]
  s_add_u32 s30, s30, 16384
  s_addc_u32 s31, s31, 0
  global_load_dwordx4 a[232:235], v181, s[30:31]
  s_add_u32 s30, s30, 16384
  s_addc_u32 s31, s31, 0
  global_load_dwordx4 a[236:239], v181, s[30:31]
  s_add_u32 s30, s30, 16384
  s_addc_u32 s31, s31, 0
  global_load_dwordx4 a[240:243], v181, s[30:31]
  s_add_u32 s30, s30, 16384
  s_addc_u32 s31, s31, 0
  global_load_dwordx4 a[244:247], v181, s[30:31]
  s_add_u32 s30, s30, 16384
  s_addc_u32 s31, s31, 0
  global_load_dwordx4 a[248:251], v181, s[30:31]
  s_add_u32 s30, s30, 16384
  s_addc_u32 s31, s31, 0
  global_load_dwordx4 a[252:255], v181, s[30:31]
  s_waitcnt vmcnt(63)
L_no4_6:
  s_waitcnt vmcnt(48)
  s_cmp_eq_u32 s32, 1
  s_cbranch_scc1 L_foldB2_7
  ds_write_b128 v169, v[8:11] offset:0
  ds_write_b128 v169, v[12:15] offset:4224
  ds_write_b128 v169, v[16:19] offset:8448
  ds_write_b128 v169, v[20:23] offset:12672
  ds_write_b128 v169, v[24:27] offset:16896
  ds_write_b128 v169, v[28:31] offset:21120
  ds_write_b128 v169, v[32:35] offset:25344
  ds_write_b128 v169, v[36:39] offset:29568
  s_waitcnt lgkmcnt(0)
  s_barrier
  v_mul_u32_u24 v182, 528, v184
  v_lshl_add_u32 v182, v185, 4, v182
  v_add_u32 v182, 67584, v182
  ds_read_b128 v[8:11], v182 offset:0
  ds_read_b128 v[12:15], v182 offset:64
  ds_read_b128 v[16:19], v182 offset:128
  ds_read_b128 v[20:23], v182 offset:192
  ds_read_b128 v[24:27], v182 offset:256
  ds_read_b128 v[28:31], v182 offset:320
  ds_read_b128 v[32:35], v182 offset:384
  ds_read_b128 v[36:39], v182 offset:448
  s_waitcnt lgkmcnt(0)
  ds_read_b128 v[40:43], v182 offset:8448
  ds_read_b128 v[44:47], v182 offset:8512
  ds_read_b128 v[48:51], v182 offset:8576
  ds_read_b128 v[52:55], v182 offset:8640
  ds_read_b128 v[56:59], v182 offset:8704
  ds_read_b128 v[60:63], v182 offset:8768
  ds_read_b128 v[64:67], v182 offset:8832
  ds_read_b128 v[68:71], v182 offset:8896
  s_waitcnt lgkmcnt(0)
  ds_read_b128 v[72:75], v182 offset:16896
  ds_read_b128 v[76:79], v182 offset:16960
  ds_read_b128 v[80:83], v182 offset:17024
  ds_read_b128 v[84:87], v182 offset:17088
  ds_read_b128 v[88:91], v182 offset:17152
  ds_read_b128 v[92:95], v182 offset:17216
  ds_read_b128 v[96:99], v182 offset:17280
  ds_read_b128 v[100:103], v182 offset:17344
  s_waitcnt lgkmcnt(0)
  ds_read_b128 v[104:107], v182 offset:25344
  ds_read_b128 v[108:111], v182 offset:25408
  ds_read_b128 v[112:115], v182 offset:25472
  ds_read_b128 v[116:119], v182 offset:25536
  ds_read_b128 v[120:123], v182 offset:25600
  ds_read_b128 v[124:127], v182 offset:25664
  ds_read_b128 v[128:131], v182 offset:25728
  ds_read_b128 v[132:135], v182 offset:25792
  s_waitcnt lgkmcnt(0)
  s_branch L_foldj2_8
L_foldB2_7:
  ds_write_b128 v169, v[8:11] offset:0
  ds_write_b128 v169, v[12:15] offset:4608
  ds_write_b128 v169, v[16:19] offset:9216
  ds_write_b128 v169, v[20:23] offset:13824
  ds_write_b128 v169, v[24:27] offset:18432
  ds_write_b128 v169, v[28:31] offset:23040
  ds_write_b128 v169, v[32:35] offset:27648
  ds_write_b128 v169, v[36:39] offset:32256
  s_waitcnt lgkmcnt(0)
  s_barrier
  v_bfe_u32 v183, v0, 2, 2
  v_lshl_add_u32 v183, v185, 3, v183
  v_mul_u32_u24 v182, 144, v183
  v_and_b32 v183, 3, v0
  v_lshl_add_u32 v182, v183, 3, v182
  v_add_u32 v182, 67584, v182
  ds_read_b64_tr_b16 v[8:9], v182 offset:0
  ds_read_b64_tr_b16 v[10:11], v182 offset:576
  ds_read_b64_tr_b16 v[12:13], v182 offset:4608
  ds_read_b64_tr_b16 v[14:15], v182 offset:5184
  ds_read_b64_tr_b16 v[16:17], v182 offset:9216
  ds_read_b64_tr_b16 v[18:19], v182 offset:9792
  ds_read_b64_tr_b16 v[20:21], v182 offset:13824
  ds_read_b64_tr_b16 v[22:23], v182 offset:14400
  ds_read_b64_tr_b16 v[24:25], v182 offset:18432
  ds_read_b64_tr_b16 v[26:27], v182 offset:19008
  ds_read_b64_tr_b16 v[28:29], v182 offset:23040
  ds_read_b64_tr_b16 v[30:31], v182 offset:23616
  ds_read_b64_tr_b16 v[32:33], v182 offset:27648
  ds_read_b64_tr_b16 v[34:35], v182 offset:28224
  ds_read_b64_tr_b16 v[36:37], v182 offset:32256
  ds_read_b64_tr_b16 v[38:39], v182 offset:32832
  s_waitcnt lgkmcnt(0)
  ds_read_b64_tr_b16 v[40:41], v182 offset:32
  ds_read_b64_tr_b16 v[42:43], v182 offset:608
  ds_read_b64_tr_b16 v[44:45], v182 offset:4640
  ds_read_b64_tr_b16 v[46:47], v182 offset:5216
  ds_read_b64_tr_b16 v[48:49], v182 offset:9248
  ds_read_b64_tr_b16 v[50:51], v182 offset:9824
  ds_read_b64_tr_b16 v[52:53], v182 offset:13856
  ds_read_b64_tr_b16 v[54:55], v182 offset:14432
  ds_read_b64_tr_b16 v[56:57], v182 offset:18464
  ds_read_b64_tr_b16 v[58:59], v182 offset:19040
  ds_read_b64_tr_b16 v[60:61], v182 offset:23072
  ds_read_b64_tr_b16 v[62:63], v182 offset:23648
  ds_read_b64_tr_b16 v[64:65], v182 offset:27680
  ds_read_b64_tr_b16 v[66:67], v182 offset:28256
  ds_read_b64_tr_b16 v[68:69], v182 offset:32288
  ds_read_b64_tr_b16 v[70:71], v182 offset:32864
  s_waitcnt lgkmcnt(0)
  ds_read_b64_tr_b16 v[72:73], v182 offset:64
  ds_read_b64_tr_b16 v[74:75], v182 offset:640
  ds_read_b64_tr_b16 v[76:77], v182 offset:4672
  ds_read_b64_tr_b16 v[78:79], v182 offset:5248
  ds_read_b64_tr_b16 v[80:81], v182 offset:9280
  ds_read_b64_tr_b16 v[82:83], v182 offset:9856
  ds_read_b64_tr_b16 v[84:85], v182 offset:13888
  ds_read_b64_tr_b16 v[86:87], v182 offset:14464
  ds_read_b64_tr_b16 v[88:89], v182 offset:18496
  ds_read_b64_tr_b16 v[90:91], v182 offset:19072
  ds_read_b64_tr_b16 v[92:93], v182 offset:23104
  ds_read_b64_tr_b16 v[94:95], v182 offset:23680
  ds_read_b64_tr_b16 v[96:97], v182 offset:27712
  ds_read_b64_tr_b16 v[98:99], v182 offset:28288
  ds_read_b64_tr_b16 v[100:101], v182 offset:32320
  ds_read_b64_tr_b16 v[102:103], v182 offset:32896
  s_waitcnt lgkmcnt(0)
  ds_read_b64_tr_b16 v[104:105], v182 offset:96
  ds_read_b64_tr_b16 v[106:107], v182 offset:672
  ds_read_b64_tr_b16 v[108:109], v182 offset:4704
  ds_read_b64_tr_b16 v[110:111], v182 offset:5280
  ds_read_b64_tr_b16 v[112:113], v182 offset:9312
  ds_read_b64_tr_b16 v[114:115], v182 offset:9888
  ds_read_b64_tr_b16 v[116:117], v182 offset:13920
  ds_read_b64_tr_b16 v[118:119], v182 offset:14496
  ds_read_b64_tr_b16 v[120:121], v182 offset:18528
  ds_read_b64_tr_b16 v[122:123], v182 offset:19104
  ds_read_b64_tr_b16 v[124:125], v182 offset:23136
  ds_read_b64_tr_b16 v[126:127], v182 offset:23712
  ds_read_b64_tr_b16 v[128:129], v182 offset:27744
  ds_read_b64_tr_b16 v[130:131], v182 offset:28320
  ds_read_b64_tr_b16 v[132:133], v182 offset:32352
  ds_read_b64_tr_b16 v[134:135], v182 offset:32928
  s_waitcnt lgkmcnt(0)
L_foldj2_8:
  s_barrier
  v_add_u32 v189, 67584, v186
  v_add_u32 v190, 67584, v187
  v_mov_b32 v178, s40
  s_cmp_ge_u32 s8, 2
  s_cbranch_scc1 L_blk3_10
  s_waitcnt vmcnt(48)
  ds_write_b128 v186, a[0:3] offset:0
  ds_write_b128 v186, a[4:7] offset:1056
  ds_write_b128 v186, a[8:11] offset:2112
  ds_write_b128 v186, a[12:15] offset:3168
  ds_write_b128 v186, a[16:19] offset:4224
  ds_write_b128 v186, a[20:23] offset:5280
  ds_write_b128 v186, a[24:27] offset:6336
  ds_write_b128 v186, a[28:31] offset:7392
  ds_write_b128 v186, a[32:35] offset:8448
  ds_write_b128 v186, a[36:39] offset:9504
  ds_write_b128 v186, a[40:43] offset:10560
  ds_write_b128 v186, a[44:47] offset:11616
  ds_write_b128 v186, a[48:51] offset:12672
  ds_write_b128 v186, a[52:55] offset:13728
  ds_write_b128 v186, a[56:59] offset:14784
  ds_write_b128 v186, a[60:63] offset:15840
  ds_read_b128 v[192:195], v187 offset:0
  ds_read_b128 v[224:227], v187 offset:2112
  ds_read_b128 v[196:199], v187 offset:64
  ds_read_b128 v[228:231], v187 offset:2176
  ds_read_b128 v[200:203], v187 offset:128
  ds_read_b128 v[232:235], v187 offset:2240
  ds_read_b128 v[204:207], v187 offset:192
  ds_read_b128 v[236:239], v187 offset:2304
  ds_read_b128 v[208:211], v187 offset:256
  ds_read_b128 v[240:243], v187 offset:2368
  ds_read_b128 v[212:215], v187 offset:320
  ds_read_b128 v[244:247], v187 offset:2432
  ds_read_b128 v[216:219], v187 offset:384
  ds_read_b128 v[248:251], v187 offset:2496
  ds_read_b128 v[220:223], v187 offset:448
  ds_read_b128 v[252:255], v187 offset:2560
  s_lshl_b32 s24, s9, 8
  v_add_u32 v2, s24, v0
  v_mov_b32 v4, -1
  v_mov_b32 v5, -1
  v_mov_b32 v6, -1
  v_mov_b32 v7, -1
  s_add_u32 s26, s4, 48241664
  s_addc_u32 s27, s5, 0
  v_lshlrev_b32 v3, 4, v2
  global_store_dwordx4 v3, v[4:7], s[26:27] sc1
  s_add_u32 s26, s26, 1048576
  s_addc_u32 s27, s27, 0
  v_lshlrev_b32 v3, 4, v2
  global_store_dwordx4 v3, v[4:7], s[26:27] sc1
  s_add_u32 s26, s26, 1048576
  s_addc_u32 s27, s27, 0
  v_lshlrev_b32 v3, 4, v2
  global_store_dwordx4 v3, v[4:7], s[26:27] sc1
  s_add_u32 s26, s26, 1048576
  s_addc_u32 s27, s27, 0
  v_lshlrev_b32 v3, 4, v2
  global_store_dwordx4 v3, v[4:7], s[26:27] sc1
  s_add_u32 s26, s26, 1048576
  s_addc_u32 s27, s27, 0
  v_lshlrev_b32 v3, 4, v2
  global_store_dwordx4 v3, v[4:7], s[26:27] sc1
  s_add_u32 s26, s26, 1048576
  s_addc_u32 s27, s27, 0
  v_lshlrev_b32 v3, 4, v2
  global_store_dwordx4 v3, v[4:7], s[26:27] sc1
  s_add_u32 s26, s26, 1048576
  s_addc_u32 s27, s27, 0
  v_lshlrev_b32 v3, 4, v2
  global_store_dwordx4 v3, v[4:7], s[26:27] sc1
  s_add_u32 s26, s26, 1048576
  s_addc_u32 s27, s27, 0
  v_lshlrev_b32 v3, 4, v2
  global_store_dwordx4 v3, v[4:7], s[26:27] sc1
  s_add_u32 s26, s26, 1048576
  s_addc_u32 s27, s27, 0
  v_lshlrev_b32 v3, 4, v2
  global_store_dwordx4 v3, v[4:7], s[26:27] sc1
  s_add_u32 s26, s26, 1048576
  s_addc_u32 s27, s27, 0
  v_cmp_gt_u32 vcc, 15936, v2
  v_lshlrev_b32 v3, 4, v2
  s_and_saveexec_b64 s[22:23], vcc
  s_cbranch_execz L_nz_11
  global_store_dwordx4 v3, v[4:7], s[26:27] sc1
L_nz_11:
  s_mov_b64 exec, s[22:23]
  s_add_u32 s26, s26, 1048576
  s_addc_u32 s27, s27, 0
  s_waitcnt lgkmcnt(0)
  v_mfma_f32_16x16x32_bf16 v[136:139], v[192:195], v[8:11], 0
  s_waitcnt vmcnt(41)
  ds_write_b128 v189, a[64:67] offset:0
  v_mfma_f32_16x16x32_bf16 v[140:143], v[192:195], v[40:43], 0
  ds_write_b128 v189, a[68:71] offset:1056
  v_mfma_f32_16x16x32_bf16 v[144:147], v[192:195], v[72:75], 0
  ds_write_b128 v189, a[72:75] offset:2112
  v_mfma_f32_16x16x32_bf16 v[148:151], v[192:195], v[104:107], 0
  ds_write_b128 v189, a[76:79] offset:3168
  v_mfma_f32_16x16x32_bf16 v[152:155], v[224:227], v[8:11], 0
  ds_write_b128 v189, a[80:83] offset:4224
  v_mfma_f32_16x16x32_bf16 v[156:159], v[224:227], v[40:43], 0
  ds_write_b128 v189, a[84:87] offset:5280
  v_mfma_f32_16x16x32_bf16 v[160:163], v[224:227], v[72:75], 0
  ds_write_b128 v189, a[88:91] offset:6336
  v_mfma_f32_16x16x32_bf16 v[164:167], v[224:227], v[104:107], 0
  ds_write_b128 v189, a[92:95] offset:7392
  v_mfma_f32_16x16x32_bf16 v[136:139], v[196:199], v[12:15], v[136:139]
  ds_write_b128 v189, a[96:99] offset:8448
  v_mfma_f32_16x16x32_bf16 v[140:143], v[196:199], v[44:47], v[140:143]
  ds_write_b128 v189, a[100:103] offset:9504
  v_mfma_f32_16x16x32_bf16 v[144:147], v[196:199], v[76:79], v[144:147]
  ds_write_b128 v189, a[104:107] offset:10560
  v_mfma_f32_16x16x32_bf16 v[148:151], v[196:199], v[108:111], v[148:151]
  ds_write_b128 v189, a[108:111] offset:11616
  v_mfma_f32_16x16x32_bf16 v[152:155], v[228:231], v[12:15], v[152:155]
  ds_write_b128 v189, a[112:115] offset:12672
  v_mfma_f32_16x16x32_bf16 v[156:159], v[228:231], v[44:47], v[156:159]
  ds_write_b128 v189, a[116:119] offset:13728
  v_mfma_f32_16x16x32_bf16 v[160:163], v[228:231], v[76:79], v[160:163]
  ds_write_b128 v189, a[120:123] offset:14784
  v_mfma_f32_16x16x32_bf16 v[164:167], v[228:231], v[108:111], v[164:167]
  ds_write_b128 v189, a[124:127] offset:15840
  v_mfma_f32_16x16x32_bf16 v[136:139], v[200:203], v[16:19], v[136:139]
  v_mfma_f32_16x16x32_bf16 v[140:143], v[200:203], v[48:51], v[140:143]
  ds_read_b128 v[192:195], v190 offset:0
  v_mfma_f32_16x16x32_bf16 v[144:147], v[200:203], v[80:83], v[144:147]
  v_mfma_f32_16x16x32_bf16 v[148:151], v[200:203], v[112:115], v[148:151]
  v_mfma_f32_16x16x32_bf16 v[152:155], v[232:235], v[16:19], v[152:155]
  v_mfma_f32_16x16x32_bf16 v[156:159], v[232:235], v[48:51], v[156:159]
  ds_read_b128 v[224:227], v190 offset:2112
  v_mfma_f32_16x16x32_bf16 v[160:163], v[232:235], v[80:83], v[160:163]
  v_mfma_f32_16x16x32_bf16 v[164:167], v[232:235], v[112:115], v[164:167]
  v_mfma_f32_16x16x32_bf16 v[136:139], v[204:207], v[20:23], v[136:139]
  v_mfma_f32_16x16x32_bf16 v[140:143], v[204:207], v[52:55], v[140:143]
  ds_read_b128 v[196:199], v190 offset:64
  v_mfma_f32_16x16x32_bf16 v[144:147], v[204:207], v[84:87], v[144:147]
  v_mfma_f32_16x16x32_bf16 v[148:151], v[204:207], v[116:119], v[148:151]
  v_mfma_f32_16x16x32_bf16 v[152:155], v[236:239], v[20:23], v[152:155]
  v_mfma_f32_16x16x32_bf16 v[156:159], v[236:239], v[52:55], v[156:159]
  ds_read_b128 v[228:231], v190 offset:2176
  v_mfma_f32_16x16x32_bf16 v[160:163], v[236:239], v[84:87], v[160:163]
  v_mfma_f32_16x16x32_bf16 v[164:167], v[236:239], v[116:119], v[164:167]
  v_mfma_f32_16x16x32_bf16 v[136:139], v[208:211], v[24:27], v[136:139]
  v_mfma_f32_16x16x32_bf16 v[140:143], v[208:211], v[56:59], v[140:143]
  ds_read_b128 v[200:203], v190 offset:128
  v_mfma_f32_16x16x32_bf16 v[144:147], v[208:211], v[88:91], v[144:147]
  v_mfma_f32_16x16x32_bf16 v[148:151], v[208:211], v[120:123], v[148:151]
  v_mfma_f32_16x16x32_bf16 v[152:155], v[240:243], v[24:27], v[152:155]
  v_mfma_f32_16x16x32_bf16 v[156:159], v[240:243], v[56:59], v[156:159]
  ds_read_b128 v[232:235], v190 offset:2240
  v_mfma_f32_16x16x32_bf16 v[160:163], v[240:243], v[88:91], v[160:163]
  v_mfma_f32_16x16x32_bf16 v[164:167], v[240:243], v[120:123], v[164:167]
  v_mfma_f32_16x16x32_bf16 v[136:139], v[212:215], v[28:31], v[136:139]
  v_mfma_f32_16x16x32_bf16 v[140:143], v[212:215], v[60:63], v[140:143]
  ds_read_b128 v[204:207], v190 offset:192
  v_mfma_f32_16x16x32_bf16 v[144:147], v[212:215], v[92:95], v[144:147]
  v_mfma_f32_16x16x32_bf16 v[148:151], v[212:215], v[124:127], v[148:151]
  v_mfma_f32_16x16x32_bf16 v[152:155], v[244:247], v[28:31], v[152:155]
  v_mfma_f32_16x16x32_bf16 v[156:159], v[244:247], v[60:63], v[156:159]
  ds_read_b128 v[236:239], v190 offset:2304
  v_mfma_f32_16x16x32_bf16 v[160:163], v[244:247], v[92:95], v[160:163]
  v_mfma_f32_16x16x32_bf16 v[164:167], v[244:247], v[124:127], v[164:167]
  v_mfma_f32_16x16x32_bf16 v[136:139], v[216:219], v[32:35], v[136:139]
  v_mfma_f32_16x16x32_bf16 v[140:143], v[216:219], v[64:67], v[140:143]
  ds_read_b128 v[208:211], v190 offset:256
  v_mfma_f32_16x16x32_bf16 v[144:147], v[216:219], v[96:99], v[144:147]
  v_mfma_f32_16x16x32_bf16 v[148:151], v[216:219], v[128:131], v[148:151]
  v_mfma_f32_16x16x32_bf16 v[152:155], v[248:251], v[32:35], v[152:155]
  v_mfma_f32_16x16x32_bf16 v[156:159], v[248:251], v[64:67], v[156:159]
  ds_read_b128 v[240:243], v190 offset:2368
  v_mfma_f32_16x16x32_bf16 v[160:163], v[248:251], v[96:99], v[160:163]
  v_mfma_f32_16x16x32_bf16 v[164:167], v[248:251], v[128:131], v[164:167]
  v_mfma_f32_16x16x32_bf16 v[136:139], v[220:223], v[36:39], v[136:139]
  v_mfma_f32_16x16x32_bf16 v[140:143], v[220:223], v[68:71], v[140:143]
  ds_read_b128 v[212:215], v190 offset:320
  v_mfma_f32_16x16x32_bf16 v[144:147], v[220:223], v[100:103], v[144:147]
  v_mfma_f32_16x16x32_bf16 v[148:151], v[220:223], v[132:135], v[148:151]
  v_mfma_f32_16x16x32_bf16 v[152:155], v[252:255], v[36:39], v[152:155]
  v_mfma_f32_16x16x32_bf16 v[156:159], v[252:255], v[68:71], v[156:159]
  ds_read_b128 v[244:247], v190 offset:2432
  v_mfma_f32_16x16x32_bf16 v[160:163], v[252:255], v[100:103], v[160:163]
  v_mfma_f32_16x16x32_bf16 v[164:167], v[252:255], v[132:135], v[164:167]
  ds_read_b128 v[216:219], v190 offset:384
  ds_read_b128 v[248:251], v190 offset:2496
  ds_read_b128 v[220:223], v190 offset:448
  ds_read_b128 v[252:255], v190 offset:2560
  s_nop 7
  s_add_u32 s24, s8, 0
  s_lshl_b32 s24, s24, 10
  s_add_u32 s26, s38, s24
  s_addc_u32 s27, s39, 0
  v_pk_mul_f32 v[136:137], v[136:137], v[178:179] op_sel_hi:[1,0]
  v_pk_mul_f32 v[152:153], v[152:153], v[178:179] op_sel_hi:[1,0]
  v_pk_mul_f32 v[138:139], v[138:139], v[178:179] op_sel_hi:[1,0]
  v_pk_mul_f32 v[154:155], v[154:155], v[178:179] op_sel_hi:[1,0]
  v_cvt_pk_bf16_f32 v168, v136, v137
  v_cvt_pk_bf16_f32 v169, v138, v139
  v_cvt_pk_bf16_f32 v170, v152, v153
  v_cvt_pk_bf16_f32 v171, v154, v155
  global_store_dwordx4 v180, v[168:171], s[26:27] sc1
  s_add_u32 s26, s26, 14336
  s_addc_u32 s27, s27, 0
  v_pk_mul_f32 v[140:141], v[140:141], v[178:179] op_sel_hi:[1,0]
  v_pk_mul_f32 v[156:157], v[156:157], v[178:179] op_sel_hi:[1,0]
  v_pk_mul_f32 v[142:143], v[142:143], v[178:179] op_sel_hi:[1,0]
  v_pk_mul_f32 v[158:159], v[158:159], v[178:179] op_sel_hi:[1,0]
  v_cvt_pk_bf16_f32 v172, v140, v141
  v_cvt_pk_bf16_f32 v173, v142, v143
  v_cvt_pk_bf16_f32 v174, v156, v157
  v_cvt_pk_bf16_f32 v175, v158, v159
  global_store_dwordx4 v180, v[172:175], s[26:27] sc1
  s_add_u32 s26, s26, 14336
  s_addc_u32 s27, s27, 0
  v_pk_mul_f32 v[144:145], v[144:145], v[178:179] op_sel_hi:[1,0]
  v_pk_mul_f32 v[160:161], v[160:161], v[178:179] op_sel_hi:[1,0]
  v_pk_mul_f32 v[146:147], v[146:147], v[178:179] op_sel_hi:[1,0]
  v_pk_mul_f32 v[162:163], v[162:163], v[178:179] op_sel_hi:[1,0]
  v_cvt_pk_bf16_f32 v168, v144, v145
  v_cvt_pk_bf16_f32 v169, v146, v147
  v_cvt_pk_bf16_f32 v170, v160, v161
  v_cvt_pk_bf16_f32 v171, v162, v163
  global_store_dwordx4 v180, v[168:171], s[26:27] sc1
  s_add_u32 s26, s26, 14336
  s_addc_u32 s27, s27, 0
  v_pk_mul_f32 v[148:149], v[148:149], v[178:179] op_sel_hi:[1,0]
  v_pk_mul_f32 v[164:165], v[164:165], v[178:179] op_sel_hi:[1,0]
  v_pk_mul_f32 v[150:151], v[150:151], v[178:179] op_sel_hi:[1,0]
  v_pk_mul_f32 v[166:167], v[166:167], v[178:179] op_sel_hi:[1,0]
  v_cvt_pk_bf16_f32 v172, v148, v149
  v_cvt_pk_bf16_f32 v173, v150, v151
  v_cvt_pk_bf16_f32 v174, v164, v165
  v_cvt_pk_bf16_f32 v175, v166, v167
  global_store_dwordx4 v180, v[172:175], s[26:27] sc1
  s_waitcnt lgkmcnt(0)
  v_mfma_f32_16x16x32_bf16 v[136:139], v[192:195], v[8:11], 0
  s_waitcnt vmcnt(29)
  ds_write_b128 v186, a[128:131] offset:0
  v_mfma_f32_16x16x32_bf16 v[140:143], v[192:195], v[40:43], 0
  ds_write_b128 v186, a[132:135] offset:1056
  v_mfma_f32_16x16x32_bf16 v[144:147], v[192:195], v[72:75], 0
  ds_write_b128 v186, a[136:139] offset:2112
  v_mfma_f32_16x16x32_bf16 v[148:151], v[192:195], v[104:107], 0
  ds_write_b128 v186, a[140:143] offset:3168
  v_mfma_f32_16x16x32_bf16 v[152:155], v[224:227], v[8:11], 0
  ds_write_b128 v186, a[144:147] offset:4224
  v_mfma_f32_16x16x32_bf16 v[156:159], v[224:227], v[40:43], 0
  ds_write_b128 v186, a[148:151] offset:5280
  v_mfma_f32_16x16x32_bf16 v[160:163], v[224:227], v[72:75], 0
  ds_write_b128 v186, a[152:155] offset:6336
  v_mfma_f32_16x16x32_bf16 v[164:167], v[224:227], v[104:107], 0
  ds_write_b128 v186, a[156:159] offset:7392
  v_mfma_f32_16x16x32_bf16 v[136:139], v[196:199], v[12:15], v[136:139]
  ds_write_b128 v186, a[160:163] offset:8448
  v_mfma_f32_16x16x32_bf16 v[140:143], v[196:199], v[44:47], v[140:143]
  ds_write_b128 v186, a[164:167] offset:9504
  v_mfma_f32_16x16x32_bf16 v[144:147], v[196:199], v[76:79], v[144:147]
  ds_write_b128 v186, a[168:171] offset:10560
  v_mfma_f32_16x16x32_bf16 v[148:151], v[196:199], v[108:111], v[148:151]
  ds_write_b128 v186, a[172:175] offset:11616
  v_mfma_f32_16x16x32_bf16 v[152:155], v[228:231], v[12:15], v[152:155]
  ds_write_b128 v186, a[176:179] offset:12672
  v_mfma_f32_16x16x32_bf16 v[156:159], v[228:231], v[44:47], v[156:159]
  ds_write_b128 v186, a[180:183] offset:13728
  v_mfma_f32_16x16x32_bf16 v[160:163], v[228:231], v[76:79], v[160:163]
  ds_write_b128 v186, a[184:187] offset:14784
  v_mfma_f32_16x16x32_bf16 v[164:167], v[228:231], v[108:111], v[164:167]
  ds_write_b128 v186, a[188:191] offset:15840
  v_mfma_f32_16x16x32_bf16 v[136:139], v[200:203], v[16:19], v[136:139]
  v_mfma_f32_16x16x32_bf16 v[140:143], v[200:203], v[48:51], v[140:143]
  ds_read_b128 v[192:195], v187 offset:0
  v_mfma_f32_16x16x32_bf16 v[144:147], v[200:203], v[80:83], v[144:147]
  v_mfma_f32_16x16x32_bf16 v[148:151], v[200:203], v[112:115], v[148:151]
  v_mfma_f32_16x16x32_bf16 v[152:155], v[232:235], v[16:19], v[152:155]
  v_mfma_f32_16x16x32_bf16 v[156:159], v[232:235], v[48:51], v[156:159]
  ds_read_b128 v[224:227], v187 offset:2112
  v_mfma_f32_16x16x32_bf16 v[160:163], v[232:235], v[80:83], v[160:163]
  v_mfma_f32_16x16x32_bf16 v[164:167], v[232:235], v[112:115], v[164:167]
  v_mfma_f32_16x16x32_bf16 v[136:139], v[204:207], v[20:23], v[136:139]
  v_mfma_f32_16x16x32_bf16 v[140:143], v[204:207], v[52:55], v[140:143]
  ds_read_b128 v[196:199], v187 offset:64
  v_mfma_f32_16x16x32_bf16 v[144:147], v[204:207], v[84:87], v[144:147]
  v_mfma_f32_16x16x32_bf16 v[148:151], v[204:207], v[116:119], v[148:151]
  v_mfma_f32_16x16x32_bf16 v[152:155], v[236:239], v[20:23], v[152:155]
  v_mfma_f32_16x16x32_bf16 v[156:159], v[236:239], v[52:55], v[156:159]
  ds_read_b128 v[228:231], v187 offset:2176
  v_mfma_f32_16x16x32_bf16 v[160:163], v[236:239], v[84:87], v[160:163]
  v_mfma_f32_16x16x32_bf16 v[164:167], v[236:239], v[116:119], v[164:167]
  v_mfma_f32_16x16x32_bf16 v[136:139], v[208:211], v[24:27], v[136:139]
  v_mfma_f32_16x16x32_bf16 v[140:143], v[208:211], v[56:59], v[140:143]
  ds_read_b128 v[200:203], v187 offset:128
  v_mfma_f32_16x16x32_bf16 v[144:147], v[208:211], v[88:91], v[144:147]
  v_mfma_f32_16x16x32_bf16 v[148:151], v[208:211], v[120:123], v[148:151]
  v_mfma_f32_16x16x32_bf16 v[152:155], v[240:243], v[24:27], v[152:155]
  v_mfma_f32_16x16x32_bf16 v[156:159], v[240:243], v[56:59], v[156:159]
  ds_read_b128 v[232:235], v187 offset:2240
  v_mfma_f32_16x16x32_bf16 v[160:163], v[240:243], v[88:91], v[160:163]
  v_mfma_f32_16x16x32_bf16 v[164:167], v[240:243], v[120:123], v[164:167]
  v_mfma_f32_16x16x32_bf16 v[136:139], v[212:215], v[28:31], v[136:139]
  v_mfma_f32_16x16x32_bf16 v[140:143], v[212:215], v[60:63], v[140:143]
  ds_read_b128 v[204:207], v187 offset:192
  v_mfma_f32_16x16x32_bf16 v[144:147], v[212:215], v[92:95], v[144:147]
  v_mfma_f32_16x16x32_bf16 v[148:151], v[212:215], v[124:127], v[148:151]
  v_mfma_f32_16x16x32_bf16 v[152:155], v[244:247], v[28:31], v[152:155]
  v_mfma_f32_16x16x32_bf16 v[156:159], v[244:247], v[60:63], v[156:159]
  ds_read_b128 v[236:239], v187 offset:2304
  v_mfma_f32_16x16x32_bf16 v[160:163], v[244:247], v[92:95], v[160:163]
  v_mfma_f32_16x16x32_bf16 v[164:167], v[244:247], v[124:127], v[164:167]
  v_mfma_f32_16x16x32_bf16 v[136:139], v[216:219], v[32:35], v[136:139]
  v_mfma_f32_16x16x32_bf16 v[140:143], v[216:219], v[64:67], v[140:143]
  ds_read_b128 v[208:211], v187 offset:256
  v_mfma_f32_16x16x32_bf16 v[144:147], v[216:219], v[96:99], v[144:147]
  v_mfma_f32_16x16x32_bf16 v[148:151], v[216:219], v[128:131], v[148:151]
  v_mfma_f32_16x16x32_bf16 v[152:155], v[248:251], v[32:35], v[152:155]
  v_mfma_f32_16x16x32_bf16 v[156:159], v[248:251], v[64:67], v[156:159]
  ds_read_b128 v[240:243], v187 offset:2368
  v_mfma_f32_16x16x32_bf16 v[160:163], v[248:251], v[96:99], v[160:163]
  v_mfma_f32_16x16x32_bf16 v[164:167], v[248:251], v[128:131], v[164:167]
  v_mfma_f32_16x16x32_bf16 v[136:139], v[220:223], v[36:39], v[136:139]
  v_mfma_f32_16x16x32_bf16 v[140:143], v[220:223], v[68:71], v[140:143]
  ds_read_b128 v[212:215], v187 offset:320
  v_mfma_f32_16x16x32_bf16 v[144:147], v[220:223], v[100:103], v[144:147]
  v_mfma_f32_16x16x32_bf16 v[148:151], v[220:223], v[132:135], v[148:151]
  v_mfma_f32_16x16x32_bf16 v[152:155], v[252:255], v[36:39], v[152:155]
  v_mfma_f32_16x16x32_bf16 v[156:159], v[252:255], v[68:71], v[156:159]
  ds_read_b128 v[244:247], v187 offset:2432
  v_mfma_f32_16x16x32_bf16 v[160:163], v[252:255], v[100:103], v[160:163]
  v_mfma_f32_16x16x32_bf16 v[164:167], v[252:255], v[132:135], v[164:167]
  ds_read_b128 v[216:219], v187 offset:384
  ds_read_b128 v[248:251], v187 offset:2496
  ds_read_b128 v[220:223], v187 offset:448
  ds_read_b128 v[252:255], v187 offset:2560
  s_nop 7
  s_add_u32 s24, s8, 4
  s_lshl_b32 s24, s24, 10
  s_add_u32 s26, s38, s24
  s_addc_u32 s27, s39, 0
  v_pk_mul_f32 v[136:137], v[136:137], v[178:179] op_sel_hi:[1,0]
  v_pk_mul_f32 v[152:153], v[152:153], v[178:179] op_sel_hi:[1,0]
  v_pk_mul_f32 v[138:139], v[138:139], v[178:179] op_sel_hi:[1,0]
  v_pk_mul_f32 v[154:155], v[154:155], v[178:179] op_sel_hi:[1,0]
  v_cvt_pk_bf16_f32 v168, v136, v137
  v_cvt_pk_bf16_f32 v169, v138, v139
  v_cvt_pk_bf16_f32 v170, v152, v153
  v_cvt_pk_bf16_f32 v171, v154, v155
  global_store_dwordx4 v180, v[168:171], s[26:27] sc1
  s_add_u32 s26, s26, 14336
  s_addc_u32 s27, s27, 0
  v_pk_mul_f32 v[140:141], v[140:141], v[178:179] op_sel_hi:[1,0]
  v_pk_mul_f32 v[156:157], v[156:157], v[178:179] op_sel_hi:[1,0]
  v_pk_mul_f32 v[142:143], v[142:143], v[178:179] op_sel_hi:[1,0]
  v_pk_mul_f32 v[158:159], v[158:159], v[178:179] op_sel_hi:[1,0]
  v_cvt_pk_bf16_f32 v172, v140, v141
  v_cvt_pk_bf16_f32 v173, v142, v143
  v_cvt_pk_bf16_f32 v174, v156, v157
  v_cvt_pk_bf16_f32 v175, v158, v159
  global_store_dwordx4 v180, v[172:175], s[26:27] sc1
  s_add_u32 s26, s26, 14336
  s_addc_u32 s27, s27, 0
  v_pk_mul_f32 v[144:145], v[144:145], v[178:179] op_sel_hi:[1,0]
  v_pk_mul_f32 v[160:161], v[160:161], v[178:179] op_sel_hi:[1,0]
  v_pk_mul_f32 v[146:147], v[146:147], v[178:179] op_sel_hi:[1,0]
  v_pk_mul_f32 v[162:163], v[162:163], v[178:179] op_sel_hi:[1,0]
  v_cvt_pk_bf16_f32 v168, v144, v145
  v_cvt_pk_bf16_f32 v169, v146, v147
  v_cvt_pk_bf16_f32 v170, v160, v161
  v_cvt_pk_bf16_f32 v171, v162, v163
  global_store_dwordx4 v180, v[168:171], s[26:27] sc1
  s_add_u32 s26, s26, 14336
  s_addc_u32 s27, s27, 0
  v_pk_mul_f32 v[148:149], v[148:149], v[178:179] op_sel_hi:[1,0]
  v_pk_mul_f32 v[164:165], v[164:165], v[178:179] op_sel_hi:[1,0]
  v_pk_mul_f32 v[150:151], v[150:151], v[178:179] op_sel_hi:[1,0]
  v_pk_mul_f32 v[166:167], v[166:167], v[178:179] op_sel_hi:[1,0]
  v_cvt_pk_bf16_f32 v172, v148, v149
  v_cvt_pk_bf16_f32 v173, v150, v151
  v_cvt_pk_bf16_f32 v174, v164, v165
  v_cvt_pk_bf16_f32 v175, v166, v167
  global_store_dwordx4 v180, v[172:175], s[26:27] sc1
  s_waitcnt lgkmcnt(0)
  v_mfma_f32_16x16x32_bf16 v[136:139], v[192:195], v[8:11], 0
  s_waitcnt vmcnt(17)
  ds_write_b128 v189, a[192:195] offset:0
  v_mfma_f32_16x16x32_bf16 v[140:143], v[192:195], v[40:43], 0
  ds_write_b128 v189, a[196:199] offset:1056
  v_mfma_f32_16x16x32_bf16 v[144:147], v[192:195], v[72:75], 0
  ds_write_b128 v189, a[200:203] offset:2112
  v_mfma_f32_16x16x32_bf16 v[148:151], v[192:195], v[104:107], 0
  ds_write_b128 v189, a[204:207] offset:3168
  v_mfma_f32_16x16x32_bf16 v[152:155], v[224:227], v[8:11], 0
  ds_write_b128 v189, a[208:211] offset:4224
  v_mfma_f32_16x16x32_bf16 v[156:159], v[224:227], v[40:43], 0
  ds_write_b128 v189, a[212:215] offset:5280
  v_mfma_f32_16x16x32_bf16 v[160:163], v[224:227], v[72:75], 0
  ds_write_b128 v189, a[216:219] offset:6336
  v_mfma_f32_16x16x32_bf16 v[164:167], v[224:227], v[104:107], 0
  ds_write_b128 v189, a[220:223] offset:7392
  v_mfma_f32_16x16x32_bf16 v[136:139], v[196:199], v[12:15], v[136:139]
  ds_write_b128 v189, a[224:227] offset:8448
  v_mfma_f32_16x16x32_bf16 v[140:143], v[196:199], v[44:47], v[140:143]
  ds_write_b128 v189, a[228:231] offset:9504
  v_mfma_f32_16x16x32_bf16 v[144:147], v[196:199], v[76:79], v[144:147]
  ds_write_b128 v189, a[232:235] offset:10560
  v_mfma_f32_16x16x32_bf16 v[148:151], v[196:199], v[108:111], v[148:151]
  ds_write_b128 v189, a[236:239] offset:11616
  v_mfma_f32_16x16x32_bf16 v[152:155], v[228:231], v[12:15], v[152:155]
  ds_write_b128 v189, a[240:243] offset:12672
  v_mfma_f32_16x16x32_bf16 v[156:159], v[228:231], v[44:47], v[156:159]
  ds_write_b128 v189, a[244:247] offset:13728
  v_mfma_f32_16x16x32_bf16 v[160:163], v[228:231], v[76:79], v[160:163]
  ds_write_b128 v189, a[248:251] offset:14784
  v_mfma_f32_16x16x32_bf16 v[164:167], v[228:231], v[108:111], v[164:167]
  ds_write_b128 v189, a[252:255] offset:15840
  v_mfma_f32_16x16x32_bf16 v[136:139], v[200:203], v[16:19], v[136:139]
  v_mfma_f32_16x16x32_bf16 v[140:143], v[200:203], v[48:51], v[140:143]
  ds_read_b128 v[192:195], v190 offset:0
  v_mfma_f32_16x16x32_bf16 v[144:147], v[200:203], v[80:83], v[144:147]
  v_mfma_f32_16x16x32_bf16 v[148:151], v[200:203], v[112:115], v[148:151]
  v_mfma_f32_16x16x32_bf16 v[152:155], v[232:235], v[16:19], v[152:155]
  v_mfma_f32_16x16x32_bf16 v[156:159], v[232:235], v[48:51], v[156:159]
  ds_read_b128 v[224:227], v190 offset:2112
  v_mfma_f32_16x16x32_bf16 v[160:163], v[232:235], v[80:83], v[160:163]
  v_mfma_f32_16x16x32_bf16 v[164:167], v[232:235], v[112:115], v[164:167]
  v_mfma_f32_16x16x32_bf16 v[136:139], v[204:207], v[20:23], v[136:139]
  v_mfma_f32_16x16x32_bf16 v[140:143], v[204:207], v[52:55], v[140:143]
  ds_read_b128 v[196:199], v190 offset:64
  v_mfma_f32_16x16x32_bf16 v[144:147], v[204:207], v[84:87], v[144:147]
  v_mfma_f32_16x16x32_bf16 v[148:151], v[204:207], v[116:119], v[148:151]
  v_mfma_f32_16x16x32_bf16 v[152:155], v[236:239], v[20:23], v[152:155]
  v_mfma_f32_16x16x32_bf16 v[156:159], v[236:239], v[52:55], v[156:159]
  ds_read_b128 v[228:231], v190 offset:2176
  v_mfma_f32_16x16x32_bf16 v[160:163], v[236:239], v[84:87], v[160:163]
  v_mfma_f32_16x16x32_bf16 v[164:167], v[236:239], v[116:119], v[164:167]
  v_mfma_f32_16x16x32_bf16 v[136:139], v[208:211], v[24:27], v[136:139]
  v_mfma_f32_16x16x32_bf16 v[140:143], v[208:211], v[56:59], v[140:143]
  ds_read_b128 v[200:203], v190 offset:128
  v_mfma_f32_16x16x32_bf16 v[144:147], v[208:211], v[88:91], v[144:147]
  v_mfma_f32_16x16x32_bf16 v[148:151], v[208:211], v[120:123], v[148:151]
  v_mfma_f32_16x16x32_bf16 v[152:155], v[240:243], v[24:27], v[152:155]
  v_mfma_f32_16x16x32_bf16 v[156:159], v[240:243], v[56:59], v[156:159]
  ds_read_b128 v[232:235], v190 offset:2240
  v_mfma_f32_16x16x32_bf16 v[160:163], v[240:243], v[88:91], v[160:163]
  v_mfma_f32_16x16x32_bf16 v[164:167], v[240:243], v[120:123], v[164:167]
  v_mfma_f32_16x16x32_bf16 v[136:139], v[212:215], v[28:31], v[136:139]
  v_mfma_f32_16x16x32_bf16 v[140:143], v[212:215], v[60:63], v[140:143]
  ds_read_b128 v[204:207], v190 offset:192
  v_mfma_f32_16x16x32_bf16 v[144:147], v[212:215], v[92:95], v[144:147]
  v_mfma_f32_16x16x32_bf16 v[148:151], v[212:215], v[124:127], v[148:151]
  v_mfma_f32_16x16x32_bf16 v[152:155], v[244:247], v[28:31], v[152:155]
  v_mfma_f32_16x16x32_bf16 v[156:159], v[244:247], v[60:63], v[156:159]
  ds_read_b128 v[236:239], v190 offset:2304
  v_mfma_f32_16x16x32_bf16 v[160:163], v[244:247], v[92:95], v[160:163]
  v_mfma_f32_16x16x32_bf16 v[164:167], v[244:247], v[124:127], v[164:167]
  v_mfma_f32_16x16x32_bf16 v[136:139], v[216:219], v[32:35], v[136:139]
  v_mfma_f32_16x16x32_bf16 v[140:143], v[216:219], v[64:67], v[140:143]
  ds_read_b128 v[208:211], v190 offset:256
  v_mfma_f32_16x16x32_bf16 v[144:147], v[216:219], v[96:99], v[144:147]
  v_mfma_f32_16x16x32_bf16 v[148:151], v[216:219], v[128:131], v[148:151]
  v_mfma_f32_16x16x32_bf16 v[152:155], v[248:251], v[32:35], v[152:155]
  v_mfma_f32_16x16x32_bf16 v[156:159], v[248:251], v[64:67], v[156:159]
  ds_read_b128 v[240:243], v190 offset:2368
  v_mfma_f32_16x16x32_bf16 v[160:163], v[248:251], v[96:99], v[160:163]
  v_mfma_f32_16x16x32_bf16 v[164:167], v[248:251], v[128:131], v[164:167]
  v_mfma_f32_16x16x32_bf16 v[136:139], v[220:223], v[36:39], v[136:139]
  v_mfma_f32_16x16x32_bf16 v[140:143], v[220:223], v[68:71], v[140:143]
  ds_read_b128 v[212:215], v190 offset:320
  v_mfma_f32_16x16x32_bf16 v[144:147], v[220:223], v[100:103], v[144:147]
  v_mfma_f32_16x16x32_bf16 v[148:151], v[220:223], v[132:135], v[148:151]
  v_mfma_f32_16x16x32_bf16 v[152:155], v[252:255], v[36:39], v[152:155]
  v_mfma_f32_16x16x32_bf16 v[156:159], v[252:255], v[68:71], v[156:159]
  ds_read_b128 v[244:247], v190 offset:2432
  v_mfma_f32_16x16x32_bf16 v[160:163], v[252:255], v[100:103], v[160:163]
  v_mfma_f32_16x16x32_bf16 v[164:167], v[252:255], v[132:135], v[164:167]
  ds_read_b128 v[216:219], v190 offset:384
  ds_read_b128 v[248:251], v190 offset:2496
  ds_read_b128 v[220:223], v190 offset:448
  ds_read_b128 v[252:255], v190 offset:2560
  s_nop 7
  s_add_u32 s24, s8, 8
  s_lshl_b32 s24, s24, 10
  s_add_u32 s26, s38, s24
  s_addc_u32 s27, s39, 0
  v_pk_mul_f32 v[136:137], v[136:137], v[178:179] op_sel_hi:[1,0]
  v_pk_mul_f32 v[152:153], v[152:153], v[178:179] op_sel_hi:[1,0]
  v_pk_mul_f32 v[138:139], v[138:139], v[178:179] op_sel_hi:[1,0]
  v_pk_mul_f32 v[154:155], v[154:155], v[178:179] op_sel_hi:[1,0]
  v_cvt_pk_bf16_f32 v168, v136, v137
  v_cvt_pk_bf16_f32 v169, v138, v139
  v_cvt_pk_bf16_f32 v170, v152, v153
  v_cvt_pk_bf16_f32 v171, v154, v155
  global_store_dwordx4 v180, v[168:171], s[26:27] sc1
  s_add_u32 s26, s26, 14336
  s_addc_u32 s27, s27, 0
  v_pk_mul_f32 v[140:141], v[140:141], v[178:179] op_sel_hi:[1,0]
  v_pk_mul_f32 v[156:157], v[156:157], v[178:179] op_sel_hi:[1,0]
  v_pk_mul_f32 v[142:143], v[142:143], v[178:179] op_sel_hi:[1,0]
  v_pk_mul_f32 v[158:159], v[158:159], v[178:179] op_sel_hi:[1,0]
  v_cvt_pk_bf16_f32 v172, v140, v141
  v_cvt_pk_bf16_f32 v173, v142, v143
  v_cvt_pk_bf16_f32 v174, v156, v157
  v_cvt_pk_bf16_f32 v175, v158, v159
  global_store_dwordx4 v180, v[172:175], s[26:27] sc1
  s_add_u32 s26, s26, 14336
  s_addc_u32 s27, s27, 0
  v_pk_mul_f32 v[144:145], v[144:145], v[178:179] op_sel_hi:[1,0]
  v_pk_mul_f32 v[160:161], v[160:161], v[178:179] op_sel_hi:[1,0]
  v_pk_mul_f32 v[146:147], v[146:147], v[178:179] op_sel_hi:[1,0]
  v_pk_mul_f32 v[162:163], v[162:163], v[178:179] op_sel_hi:[1,0]
  v_cvt_pk_bf16_f32 v168, v144, v145
  v_cvt_pk_bf16_f32 v169, v146, v147
  v_cvt_pk_bf16_f32 v170, v160, v161
  v_cvt_pk_bf16_f32 v171, v162, v163
  global_store_dwordx4 v180, v[168:171], s[26:27] sc1
  s_add_u32 s26, s26, 14336
  s_addc_u32 s27, s27, 0
  v_pk_mul_f32 v[148:149], v[148:149], v[178:179] op_sel_hi:[1,0]
  v_pk_mul_f32 v[164:165], v[164:165], v[178:179] op_sel_hi:[1,0]
  v_pk_mul_f32 v[150:151], v[150:151], v[178:179] op_sel_hi:[1,0]
  v_pk_mul_f32 v[166:167], v[166:167], v[178:179] op_sel_hi:[1,0]
  v_cvt_pk_bf16_f32 v172, v148, v149
  v_cvt_pk_bf16_f32 v173, v150, v151
  v_cvt_pk_bf16_f32 v174, v164, v165
  v_cvt_pk_bf16_f32 v175, v166, v167
  global_store_dwordx4 v180, v[172:175], s[26:27] sc1
  s_waitcnt lgkmcnt(0)
  v_mfma_f32_16x16x32_bf16 v[136:139], v[192:195], v[8:11], 0
  v_mfma_f32_16x16x32_bf16 v[140:143], v[192:195], v[40:43], 0
  v_mfma_f32_16x16x32_bf16 v[144:147], v[192:195], v[72:75], 0
  v_mfma_f32_16x16x32_bf16 v[148:151], v[192:195], v[104:107], 0
  v_mfma_f32_16x16x32_bf16 v[152:155], v[224:227], v[8:11], 0
  v_mfma_f32_16x16x32_bf16 v[156:159], v[224:227], v[40:43], 0
  v_mfma_f32_16x16x32_bf16 v[160:163], v[224:227], v[72:75], 0
  v_mfma_f32_16x16x32_bf16 v[164:167], v[224:227], v[104:107], 0
  v_mfma_f32_16x16x32_bf16 v[136:139], v[196:199], v[12:15], v[136:139]
  v_mfma_f32_16x16x32_bf16 v[140:143], v[196:199], v[44:47], v[140:143]
  v_mfma_f32_16x16x32_bf16 v[144:147], v[196:199], v[76:79], v[144:147]
  v_mfma_f32_16x16x32_bf16 v[148:151], v[196:199], v[108:111], v[148:151]
  v_mfma_f32_16x16x32_bf16 v[152:155], v[228:231], v[12:15], v[152:155]
  v_mfma_f32_16x16x32_bf16 v[156:159], v[228:231], v[44:47], v[156:159]
  v_mfma_f32_16x16x32_bf16 v[160:163], v[228:231], v[76:79], v[160:163]
  v_mfma_f32_16x16x32_bf16 v[164:167], v[228:231], v[108:111], v[164:167]
  v_mfma_f32_16x16x32_bf16 v[136:139], v[200:203], v[16:19], v[136:139]
  v_mfma_f32_16x16x32_bf16 v[140:143], v[200:203], v[48:51], v[140:143]
  v_mfma_f32_16x16x32_bf16 v[144:147], v[200:203], v[80:83], v[144:147]
  v_mfma_f32_16x16x32_bf16 v[148:151], v[200:203], v[112:115], v[148:151]
  v_mfma_f32_16x16x32_bf16 v[152:155], v[232:235], v[16:19], v[152:155]
  v_mfma_f32_16x16x32_bf16 v[156:159], v[232:235], v[48:51], v[156:159]
  v_mfma_f32_16x16x32_bf16 v[160:163], v[232:235], v[80:83], v[160:163]
  v_mfma_f32_16x16x32_bf16 v[164:167], v[232:235], v[112:115], v[164:167]
  v_mfma_f32_16x16x32_bf16 v[136:139], v[204:207], v[20:23], v[136:139]
  v_mfma_f32_16x16x32_bf16 v[140:143], v[204:207], v[52:55], v[140:143]
  v_mfma_f32_16x16x32_bf16 v[144:147], v[204:207], v[84:87], v[144:147]
  v_mfma_f32_16x16x32_bf16 v[148:151], v[204:207], v[116:119], v[148:151]
  v_mfma_f32_16x16x32_bf16 v[152:155], v[236:239], v[20:23], v[152:155]
  v_mfma_f32_16x16x32_bf16 v[156:159], v[236:239], v[52:55], v[156:159]
  v_mfma_f32_16x16x32_bf16 v[160:163], v[236:239], v[84:87], v[160:163]
  v_mfma_f32_16x16x32_bf16 v[164:167], v[236:239], v[116:119], v[164:167]
  v_mfma_f32_16x16x32_bf16 v[136:139], v[208:211], v[24:27], v[136:139]
  v_mfma_f32_16x16x32_bf16 v[140:143], v[208:211], v[56:59], v[140:143]
  v_mfma_f32_16x16x32_bf16 v[144:147], v[208:211], v[88:91], v[144:147]
  v_mfma_f32_16x16x32_bf16 v[148:151], v[208:211], v[120:123], v[148:151]
  v_mfma_f32_16x16x32_bf16 v[152:155], v[240:243], v[24:27], v[152:155]
  v_mfma_f32_16x16x32_bf16 v[156:159], v[240:243], v[56:59], v[156:159]
  v_mfma_f32_16x16x32_bf16 v[160:163], v[240:243], v[88:91], v[160:163]
  v_mfma_f32_16x16x32_bf16 v[164:167], v[240:243], v[120:123], v[164:167]
  v_mfma_f32_16x16x32_bf16 v[136:139], v[212:215], v[28:31], v[136:139]
  v_mfma_f32_16x16x32_bf16 v[140:143], v[212:215], v[60:63], v[140:143]
  v_mfma_f32_16x16x32_bf16 v[144:147], v[212:215], v[92:95], v[144:147]
  v_mfma_f32_16x16x32_bf16 v[148:151], v[212:215], v[124:127], v[148:151]
  v_mfma_f32_16x16x32_bf16 v[152:155], v[244:247], v[28:31], v[152:155]
  v_mfma_f32_16x16x32_bf16 v[156:159], v[244:247], v[60:63], v[156:159]
  v_mfma_f32_16x16x32_bf16 v[160:163], v[244:247], v[92:95], v[160:163]
  v_mfma_f32_16x16x32_bf16 v[164:167], v[244:247], v[124:127], v[164:167]
  v_mfma_f32_16x16x32_bf16 v[136:139], v[216:219], v[32:35], v[136:139]
  v_mfma_f32_16x16x32_bf16 v[140:143], v[216:219], v[64:67], v[140:143]
  v_mfma_f32_16x16x32_bf16 v[144:147], v[216:219], v[96:99], v[144:147]
  v_mfma_f32_16x16x32_bf16 v[148:151], v[216:219], v[128:131], v[148:151]
  v_mfma_f32_16x16x32_bf16 v[152:155], v[248:251], v[32:35], v[152:155]
  v_mfma_f32_16x16x32_bf16 v[156:159], v[248:251], v[64:67], v[156:159]
  v_mfma_f32_16x16x32_bf16 v[160:163], v[248:251], v[96:99], v[160:163]
  v_mfma_f32_16x16x32_bf16 v[164:167], v[248:251], v[128:131], v[164:167]
  v_mfma_f32_16x16x32_bf16 v[136:139], v[220:223], v[36:39], v[136:139]
  v_mfma_f32_16x16x32_bf16 v[140:143], v[220:223], v[68:71], v[140:143]
  v_mfma_f32_16x16x32_bf16 v[144:147], v[220:223], v[100:103], v[144:147]
  v_mfma_f32_16x16x32_bf16 v[148:151], v[220:223], v[132:135], v[148:151]
  v_mfma_f32_16x16x32_bf16 v[152:155], v[252:255], v[36:39], v[152:155]
  v_mfma_f32_16x16x32_bf16 v[156:159], v[252:255], v[68:71], v[156:159]
  v_mfma_f32_16x16x32_bf16 v[160:163], v[252:255], v[100:103], v[160:163]
  v_mfma_f32_16x16x32_bf16 v[164:167], v[252:255], v[132:135], v[164:167]
  s_nop 7
  s_add_u32 s24, s8, 12
  s_lshl_b32 s24, s24, 10
  s_add_u32 s26, s38, s24
  s_addc_u32 s27, s39, 0
  v_pk_mul_f32 v[136:137], v[136:137], v[178:179] op_sel_hi:[1,0]
  v_pk_mul_f32 v[152:153], v[152:153], v[178:179] op_sel_hi:[1,0]
  v_pk_mul_f32 v[138:139], v[138:139], v[178:179] op_sel_hi:[1,0]
  v_pk_mul_f32 v[154:155], v[154:155], v[178:179] op_sel_hi:[1,0]
  v_cvt_pk_bf16_f32 v168, v136, v137
  v_cvt_pk_bf16_f32 v169, v138, v139
  v_cvt_pk_bf16_f32 v170, v152, v153
  v_cvt_pk_bf16_f32 v171, v154, v155
  global_store_dwordx4 v180, v[168:171], s[26:27] sc1
  s_add_u32 s26, s26, 14336
  s_addc_u32 s27, s27, 0
  v_pk_mul_f32 v[140:141], v[140:141], v[178:179] op_sel_hi:[1,0]
  v_pk_mul_f32 v[156:157], v[156:157], v[178:179] op_sel_hi:[1,0]
  v_pk_mul_f32 v[142:143], v[142:143], v[178:179] op_sel_hi:[1,0]
  v_pk_mul_f32 v[158:159], v[158:159], v[178:179] op_sel_hi:[1,0]
  v_cvt_pk_bf16_f32 v172, v140, v141
  v_cvt_pk_bf16_f32 v173, v142, v143
  v_cvt_pk_bf16_f32 v174, v156, v157
  v_cvt_pk_bf16_f32 v175, v158, v159
  global_store_dwordx4 v180, v[172:175], s[26:27] sc1
  s_add_u32 s26, s26, 14336
  s_addc_u32 s27, s27, 0
  v_pk_mul_f32 v[144:145], v[144:145], v[178:179] op_sel_hi:[1,0]
  v_pk_mul_f32 v[160:161], v[160:161], v[178:179] op_sel_hi:[1,0]
  v_pk_mul_f32 v[146:147], v[146:147], v[178:179] op_sel_hi:[1,0]
  v_pk_mul_f32 v[162:163], v[162:163], v[178:179] op_sel_hi:[1,0]
  v_cvt_pk_bf16_f32 v168, v144, v145
  v_cvt_pk_bf16_f32 v169, v146, v147
  v_cvt_pk_bf16_f32 v170, v160, v161
  v_cvt_pk_bf16_f32 v171, v162, v163
  global_store_dwordx4 v180, v[168:171], s[26:27] sc1
  s_add_u32 s26, s26, 14336
  s_addc_u32 s27, s27, 0
  v_pk_mul_f32 v[148:149], v[148:149], v[178:179] op_sel_hi:[1,0]
  v_pk_mul_f32 v[164:165], v[164:165], v[178:179] op_sel_hi:[1,0]
  v_pk_mul_f32 v[150:151], v[150:151], v[178:179] op_sel_hi:[1,0]
  v_pk_mul_f32 v[166:167], v[166:167], v[178:179] op_sel_hi:[1,0]
  v_cvt_pk_bf16_f32 v172, v148, v149
  v_cvt_pk_bf16_f32 v173, v150, v151
  v_cvt_pk_bf16_f32 v174, v164, v165
  v_cvt_pk_bf16_f32 v175, v166, v167
  global_store_dwordx4 v180, v[172:175], s[26:27] sc1
  s_branch L_flend_9
L_blk3_10:
  s_waitcnt vmcnt(32)
  ds_write_b128 v186, a[0:3] offset:0
  ds_write_b128 v186, a[4:7] offset:1056
  ds_write_b128 v186, a[8:11] offset:2112
  ds_write_b128 v186, a[12:15] offset:3168
  ds_write_b128 v186, a[16:19] offset:4224
  ds_write_b128 v186, a[20:23] offset:5280
  ds_write_b128 v186, a[24:27] offset:6336
  ds_write_b128 v186, a[28:31] offset:7392
  ds_write_b128 v186, a[32:35] offset:8448
  ds_write_b128 v186, a[36:39] offset:9504
  ds_write_b128 v186, a[40:43] offset:10560
  ds_write_b128 v186, a[44:47] offset:11616
  ds_write_b128 v186, a[48:51] offset:12672
  ds_write_b128 v186, a[52:55] offset:13728
  ds_write_b128 v186, a[56:59] offset:14784
  ds_write_b128 v186, a[60:63] offset:15840
  ds_read_b128 v[192:195], v187 offset:0
  ds_read_b128 v[224:227], v187 offset:2112
  ds_read_b128 v[196:199], v187 offset:64
  ds_read_b128 v[228:231], v187 offset:2176
  ds_read_b128 v[200:203], v187 offset:128
  ds_read_b128 v[232:235], v187 offset:2240
  ds_read_b128 v[204:207], v187 offset:192
  ds_read_b128 v[236:239], v187 offset:2304
  ds_read_b128 v[208:211], v187 offset:256
  ds_read_b128 v[240:243], v187 offset:2368
  ds_read_b128 v[212:215], v187 offset:320
  ds_read_b128 v[244:247], v187 offset:2432
  ds_read_b128 v[216:219], v187 offset:384
  ds_read_b128 v[248:251], v187 offset:2496
  ds_read_b128 v[220:223], v187 offset:448
  ds_read_b128 v[252:255], v187 offset:2560
  s_lshl_b32 s24, s9, 8
  v_add_u32 v2, s24, v0
  v_mov_b32 v4, -1
  v_mov_b32 v5, -1
  v_mov_b32 v6, -1
  v_mov_b32 v7, -1
  s_add_u32 s26, s4, 48241664
  s_addc_u32 s27, s5, 0
  v_lshlrev_b32 v3, 4, v2
  global_store_dwordx4 v3, v[4:7], s[26:27] sc1
  s_add_u32 s26, s26, 1048576
  s_addc_u32 s27, s27, 0
  v_lshlrev_b32 v3, 4, v2
  global_store_dwordx4 v3, v[4:7], s[26:27] sc1
  s_add_u32 s26, s26, 1048576
  s_addc_u32 s27, s27, 0
  v_lshlrev_b32 v3, 4, v2
  global_store_dwordx4 v3, v[4:7], s[26:27] sc1
  s_add_u32 s26, s26, 1048576
  s_addc_u32 s27, s27, 0
  v_lshlrev_b32 v3, 4, v2
  global_store_dwordx4 v3, v[4:7], s[26:27] sc1
  s_add_u32 s26, s26, 1048576
  s_addc_u32 s27, s27, 0
  v_lshlrev_b32 v3, 4, v2
  global_store_dwordx4 v3, v[4:7], s[26:27] sc1
  s_add_u32 s26, s26, 1048576
  s_addc_u32 s27, s27, 0
  v_lshlrev_b32 v3, 4, v2
  global_store_dwordx4 v3, v[4:7], s[26:27] sc1
  s_add_u32 s26, s26, 1048576
  s_addc_u32 s27, s27, 0
  v_lshlrev_b32 v3, 4, v2
  global_store_dwordx4 v3, v[4:7], s[26:27] sc1
  s_add_u32 s26, s26, 1048576
  s_addc_u32 s27, s27, 0
  v_lshlrev_b32 v3, 4, v2
  global_store_dwordx4 v3, v[4:7], s[26:27] sc1
  s_add_u32 s26, s26, 1048576
  s_addc_u32 s27, s27, 0
  v_lshlrev_b32 v3, 4, v2
  global_store_dwordx4 v3, v[4:7], s[26:27] sc1
  s_add_u32 s26, s26, 1048576
  s_addc_u32 s27, s27, 0
  v_cmp_gt_u32 vcc, 15936, v2
  v_lshlrev_b32 v3, 4, v2
  s_and_saveexec_b64 s[22:23], vcc
  s_cbranch_execz L_nz_12
  global_store_dwordx4 v3, v[4:7], s[26:27] sc1
L_nz_12:
  s_mov_b64 exec, s[22:23]
  s_add_u32 s26, s26, 1048576
  s_addc_u32 s27, s27, 0
  s_waitcnt lgkmcnt(0)
  v_mfma_f32_16x16x32_bf16 v[136:139], v[192:195], v[8:11], 0
  s_waitcnt vmcnt(25)
  ds_write_b128 v189, a[64:67] offset:0
  v_mfma_f32_16x16x32_bf16 v[140:143], v[192:195], v[40:43], 0
  ds_write_b128 v189, a[68:71] offset:1056
  v_mfma_f32_16x16x32_bf16 v[144:147], v[192:195], v[72:75], 0
  ds_write_b128 v189, a[72:75] offset:2112
  v_mfma_f32_16x16x32_bf16 v[148:151], v[192:195], v[104:107], 0
  ds_write_b128 v189, a[76:79] offset:3168
  v_mfma_f32_16x16x32_bf16 v[152:155], v[224:227], v[8:11], 0
  ds_write_b128 v189, a[80:83] offset:4224
  v_mfma_f32_16x16x32_bf16 v[156:159], v[224:227], v[40:43], 0
  ds_write_b128 v189, a[84:87] offset:5280
  v_mfma_f32_16x16x32_bf16 v[160:163], v[224:227], v[72:75], 0
  ds_write_b128 v189, a[88:91] offset:6336
  v_mfma_f32_16x16x32_bf16 v[164:167], v[224:227], v[104:107], 0
  ds_write_b128 v189, a[92:95] offset:7392
  v_mfma_f32_16x16x32_bf16 v[136:139], v[196:199], v[12:15], v[136:139]
  ds_write_b128 v189, a[96:99] offset:8448
  v_mfma_f32_16x16x32_bf16 v[140:143], v[196:199], v[44:47], v[140:143]
  ds_write_b128 v189, a[100:103] offset:9504
  v_mfma_f32_16x16x32_bf16 v[144:147], v[196:199], v[76:79], v[144:147]
  ds_write_b128 v189, a[104:107] offset:10560
  v_mfma_f32_16x16x32_bf16 v[148:151], v[196:199], v[108:111], v[148:151]
  ds_write_b128 v189, a[108:111] offset:11616
  v_mfma_f32_16x16x32_bf16 v[152:155], v[228:231], v[12:15], v[152:155]
  ds_write_b128 v189, a[112:115] offset:12672
  v_mfma_f32_16x16x32_bf16 v[156:159], v[228:231], v[44:47], v[156:159]
  ds_write_b128 v189, a[116:119] offset:13728
  v_mfma_f32_16x16x32_bf16 v[160:163], v[228:231], v[76:79], v[160:163]
  ds_write_b128 v189, a[120:123] offset:14784
  v_mfma_f32_16x16x32_bf16 v[164:167], v[228:231], v[108:111], v[164:167]
  ds_write_b128 v189, a[124:127] offset:15840
  v_mfma_f32_16x16x32_bf16 v[136:139], v[200:203], v[16:19], v[136:139]
  v_mfma_f32_16x16x32_bf16 v[140:143], v[200:203], v[48:51], v[140:143]
  ds_read_b128 v[192:195], v190 offset:0
  v_mfma_f32_16x16x32_bf16 v[144:147], v[200:203], v[80:83], v[144:147]
  v_mfma_f32_16x16x32_bf16 v[148:151], v[200:203], v[112:115], v[148:151]
  v_mfma_f32_16x16x32_bf16 v[152:155], v[232:235], v[16:19], v[152:155]
  v_mfma_f32_16x16x32_bf16 v[156:159], v[232:235], v[48:51], v[156:159]
  ds_read_b128 v[224:227], v190 offset:2112
  v_mfma_f32_16x16x32_bf16 v[160:163], v[232:235], v[80:83], v[160:163]
  v_mfma_f32_16x16x32_bf16 v[164:167], v[232:235], v[112:115], v[164:167]
  v_mfma_f32_16x16x32_bf16 v[136:139], v[204:207], v[20:23], v[136:139]
  v_mfma_f32_16x16x32_bf16 v[140:143], v[204:207], v[52:55], v[140:143]
  ds_read_b128 v[196:199], v190 offset:64
  v_mfma_f32_16x16x32_bf16 v[144:147], v[204:207], v[84:87], v[144:147]
  v_mfma_f32_16x16x32_bf16 v[148:151], v[204:207], v[116:119], v[148:151]
  v_mfma_f32_16x16x32_bf16 v[152:155], v[236:239], v[20:23], v[152:155]
  v_mfma_f32_16x16x32_bf16 v[156:159], v[236:239], v[52:55], v[156:159]
  ds_read_b128 v[228:231], v190 offset:2176
  v_mfma_f32_16x16x32_bf16 v[160:163], v[236:239], v[84:87], v[160:163]
  v_mfma_f32_16x16x32_bf16 v[164:167], v[236:239], v[116:119], v[164:167]
  v_mfma_f32_16x16x32_bf16 v[136:139], v[208:211], v[24:27], v[136:139]
  v_mfma_f32_16x16x32_bf16 v[140:143], v[208:211], v[56:59], v[140:143]
  ds_read_b128 v[200:203], v190 offset:128
  v_mfma_f32_16x16x32_bf16 v[144:147], v[208:211], v[88:91], v[144:147]
  v_mfma_f32_16x16x32_bf16 v[148:151], v[208:211], v[120:123], v[148:151]
  v_mfma_f32_16x16x32_bf16 v[152:155], v[240:243], v[24:27], v[152:155]
  v_mfma_f32_16x16x32_bf16 v[156:159], v[240:243], v[56:59], v[156:159]
  ds_read_b128 v[232:235], v190 offset:2240
  v_mfma_f32_16x16x32_bf16 v[160:163], v[240:243], v[88:91], v[160:163]
  v_mfma_f32_16x16x32_bf16 v[164:167], v[240:243], v[120:123], v[164:167]
  v_mfma_f32_16x16x32_bf16 v[136:139], v[212:215], v[28:31], v[136:139]
  v_mfma_f32_16x16x32_bf16 v[140:143], v[212:215], v[60:63], v[140:143]
  ds_read_b128 v[204:207], v190 offset:192
  v_mfma_f32_16x16x32_bf16 v[144:147], v[212:215], v[92:95], v[144:147]
  v_mfma_f32_16x16x32_bf16 v[148:151], v[212:215], v[124:127], v[148:151]
  v_mfma_f32_16x16x32_bf16 v[152:155], v[244:247], v[28:31], v[152:155]
  v_mfma_f32_16x16x32_bf16 v[156:159], v[244:247], v[60:63], v[156:159]
  ds_read_b128 v[236:239], v190 offset:2304
  v_mfma_f32_16x16x32_bf16 v[160:163], v[244:247], v[92:95], v[160:163]
  v_mfma_f32_16x16x32_bf16 v[164:167], v[244:247], v[124:127], v[164:167]
  v_mfma_f32_16x16x32_bf16 v[136:139], v[216:219], v[32:35], v[136:139]
  v_mfma_f32_16x16x32_bf16 v[140:143], v[216:219], v[64:67], v[140:143]
  ds_read_b128 v[208:211], v190 offset:256
  v_mfma_f32_16x16x32_bf16 v[144:147], v[216:219], v[96:99], v[144:147]
  v_mfma_f32_16x16x32_bf16 v[148:151], v[216:219], v[128:131], v[148:151]
  v_mfma_f32_16x16x32_bf16 v[152:155], v[248:251], v[32:35], v[152:155]
  v_mfma_f32_16x16x32_bf16 v[156:159], v[248:251], v[64:67], v[156:159]
  ds_read_b128 v[240:243], v190 offset:2368
  v_mfma_f32_16x16x32_bf16 v[160:163], v[248:251], v[96:99], v[160:163]
  v_mfma_f32_16x16x32_bf16 v[164:167], v[248:251], v[128:131], v[164:167]
  v_mfma_f32_16x16x32_bf16 v[136:139], v[220:223], v[36:39], v[136:139]
  v_mfma_f32_16x16x32_bf16 v[140:143], v[220:223], v[68:71], v[140:143]
  ds_read_b128 v[212:215], v190 offset:320
  v_mfma_f32_16x16x32_bf16 v[144:147], v[220:223], v[100:103], v[144:147]
  v_mfma_f32_16x16x32_bf16 v[148:151], v[220:223], v[132:135], v[148:151]
  v_mfma_f32_16x16x32_bf16 v[152:155], v[252:255], v[36:39], v[152:155]
  v_mfma_f32_16x16x32_bf16 v[156:159], v[252:255], v[68:71], v[156:159]
  ds_read_b128 v[244:247], v190 offset:2432
  v_mfma_f32_16x16x32_bf16 v[160:163], v[252:255], v[100:103], v[160:163]
  v_mfma_f32_16x16x32_bf16 v[164:167], v[252:255], v[132:135], v[164:167]
  ds_read_b128 v[216:219], v190 offset:384
  ds_read_b128 v[248:251], v190 offset:2496
  ds_read_b128 v[220:223], v190 offset:448
  ds_read_b128 v[252:255], v190 offset:2560
  s_nop 7
  s_add_u32 s24, s8, 0
  s_lshl_b32 s24, s24, 10
  s_add_u32 s26, s38, s24
  s_addc_u32 s27, s39, 0
  v_pk_mul_f32 v[136:137], v[136:137], v[178:179] op_sel_hi:[1,0]
  v_pk_mul_f32 v[152:153], v[152:153], v[178:179] op_sel_hi:[1,0]
  v_pk_mul_f32 v[138:139], v[138:139], v[178:179] op_sel_hi:[1,0]
  v_pk_mul_f32 v[154:155], v[154:155], v[178:179] op_sel_hi:[1,0]
  v_cvt_pk_bf16_f32 v168, v136, v137
  v_cvt_pk_bf16_f32 v169, v138, v139
  v_cvt_pk_bf16_f32 v170, v152, v153
  v_cvt_pk_bf16_f32 v171, v154, v155
  global_store_dwordx4 v180, v[168:171], s[26:27] sc1
  s_add_u32 s26, s26, 14336
  s_addc_u32 s27, s27, 0
  v_pk_mul_f32 v[140:141], v[140:141], v[178:179] op_sel_hi:[1,0]
  v_pk_mul_f32 v[156:157], v[156:157], v[178:179] op_sel_hi:[1,0]
  v_pk_mul_f32 v[142:143], v[142:143], v[178:179] op_sel_hi:[1,0]
  v_pk_mul_f32 v[158:159], v[158:159], v[178:179] op_sel_hi:[1,0]
  v_cvt_pk_bf16_f32 v172, v140, v141
  v_cvt_pk_bf16_f32 v173, v142, v143
  v_cvt_pk_bf16_f32 v174, v156, v157
  v_cvt_pk_bf16_f32 v175, v158, v159
  global_store_dwordx4 v180, v[172:175], s[26:27] sc1
  s_add_u32 s26, s26, 14336
  s_addc_u32 s27, s27, 0
  v_pk_mul_f32 v[144:145], v[144:145], v[178:179] op_sel_hi:[1,0]
  v_pk_mul_f32 v[160:161], v[160:161], v[178:179] op_sel_hi:[1,0]
  v_pk_mul_f32 v[146:147], v[146:147], v[178:179] op_sel_hi:[1,0]
  v_pk_mul_f32 v[162:163], v[162:163], v[178:179] op_sel_hi:[1,0]
  v_cvt_pk_bf16_f32 v168, v144, v145
  v_cvt_pk_bf16_f32 v169, v146, v147
  v_cvt_pk_bf16_f32 v170, v160, v161
  v_cvt_pk_bf16_f32 v171, v162, v163
  global_store_dwordx4 v180, v[168:171], s[26:27] sc1
  s_add_u32 s26, s26, 14336
  s_addc_u32 s27, s27, 0
  v_pk_mul_f32 v[148:149], v[148:149], v[178:179] op_sel_hi:[1,0]
  v_pk_mul_f32 v[164:165], v[164:165], v[178:179] op_sel_hi:[1,0]
  v_pk_mul_f32 v[150:151], v[150:151], v[178:179] op_sel_hi:[1,0]
  v_pk_mul_f32 v[166:167], v[166:167], v[178:179] op_sel_hi:[1,0]
  v_cvt_pk_bf16_f32 v172, v148, v149
  v_cvt_pk_bf16_f32 v173, v150, v151
  v_cvt_pk_bf16_f32 v174, v164, v165
  v_cvt_pk_bf16_f32 v175, v166, v167
  global_store_dwordx4 v180, v[172:175], s[26:27] sc1
  s_waitcnt lgkmcnt(0)
  v_mfma_f32_16x16x32_bf16 v[136:139], v[192:195], v[8:11], 0
  s_waitcnt vmcnt(13)
  ds_write_b128 v186, a[128:131] offset:0
  v_mfma_f32_16x16x32_bf16 v[140:143], v[192:195], v[40:43], 0
  ds_write_b128 v186, a[132:135] offset:1056
  v_mfma_f32_16x16x32_bf16 v[144:147], v[192:195], v[72:75], 0
  ds_write_b128 v186, a[136:139] offset:2112
  v_mfma_f32_16x16x32_bf16 v[148:151], v[192:195], v[104:107], 0
  ds_write_b128 v186, a[140:143] offset:3168
  v_mfma_f32_16x16x32_bf16 v[152:155], v[224:227], v[8:11], 0
  ds_write_b128 v186, a[144:147] offset:4224
  v_mfma_f32_16x16x32_bf16 v[156:159], v[224:227], v[40:43], 0
  ds_write_b128 v186, a[148:151] offset:5280
  v_mfma_f32_16x16x32_bf16 v[160:163], v[224:227], v[72:75], 0
  ds_write_b128 v186, a[152:155] offset:6336
  v_mfma_f32_16x16x32_bf16 v[164:167], v[224:227], v[104:107], 0
  ds_write_b128 v186, a[156:159] offset:7392
  v_mfma_f32_16x16x32_bf16 v[136:139], v[196:199], v[12:15], v[136:139]
  ds_write_b128 v186, a[160:163] offset:8448
  v_mfma_f32_16x16x32_bf16 v[140:143], v[196:199], v[44:47], v[140:143]
  ds_write_b128 v186, a[164:167] offset:9504
  v_mfma_f32_16x16x32_bf16 v[144:147], v[196:199], v[76:79], v[144:147]
  ds_write_b128 v186, a[168:171] offset:10560
  v_mfma_f32_16x16x32_bf16 v[148:151], v[196:199], v[108:111], v[148:151]
  ds_write_b128 v186, a[172:175] offset:11616
  v_mfma_f32_16x16x32_bf16 v[152:155], v[228:231], v[12:15], v[152:155]
  ds_write_b128 v186, a[176:179] offset:12672
  v_mfma_f32_16x16x32_bf16 v[156:159], v[228:231], v[44:47], v[156:159]
  ds_write_b128 v186, a[180:183] offset:13728
  v_mfma_f32_16x16x32_bf16 v[160:163], v[228:231], v[76:79], v[160:163]
  ds_write_b128 v186, a[184:187] offset:14784
  v_mfma_f32_16x16x32_bf16 v[164:167], v[228:231], v[108:111], v[164:167]
  ds_write_b128 v186, a[188:191] offset:15840
  v_mfma_f32_16x16x32_bf16 v[136:139], v[200:203], v[16:19], v[136:139]
  v_mfma_f32_16x16x32_bf16 v[140:143], v[200:203], v[48:51], v[140:143]
  ds_read_b128 v[192:195], v187 offset:0
  v_mfma_f32_16x16x32_bf16 v[144:147], v[200:203], v[80:83], v[144:147]
  v_mfma_f32_16x16x32_bf16 v[148:151], v[200:203], v[112:115], v[148:151]
  v_mfma_f32_16x16x32_bf16 v[152:155], v[232:235], v[16:19], v[152:155]
  v_mfma_f32_16x16x32_bf16 v[156:159], v[232:235], v[48:51], v[156:159]
  ds_read_b128 v[224:227], v187 offset:2112
  v_mfma_f32_16x16x32_bf16 v[160:163], v[232:235], v[80:83], v[160:163]
  v_mfma_f32_16x16x32_bf16 v[164:167], v[232:235], v[112:115], v[164:167]
  v_mfma_f32_16x16x32_bf16 v[136:139], v[204:207], v[20:23], v[136:139]
  v_mfma_f32_16x16x32_bf16 v[140:143], v[204:207], v[52:55], v[140:143]
  ds_read_b128 v[196:199], v187 offset:64
  v_mfma_f32_16x16x32_bf16 v[144:147], v[204:207], v[84:87], v[144:147]
  v_mfma_f32_16x16x32_bf16 v[148:151], v[204:207], v[116:119], v[148:151]
  v_mfma_f32_16x16x32_bf16 v[152:155], v[236:239], v[20:23], v[152:155]
  v_mfma_f32_16x16x32_bf16 v[156:159], v[236:239], v[52:55], v[156:159]
  ds_read_b128 v[228:231], v187 offset:2176
  v_mfma_f32_16x16x32_bf16 v[160:163], v[236:239], v[84:87], v[160:163]
  v_mfma_f32_16x16x32_bf16 v[164:167], v[236:239], v[116:119], v[164:167]
  v_mfma_f32_16x16x32_bf16 v[136:139], v[208:211], v[24:27], v[136:139]
  v_mfma_f32_16x16x32_bf16 v[140:143], v[208:211], v[56:59], v[140:143]
  ds_read_b128 v[200:203], v187 offset:128
  v_mfma_f32_16x16x32_bf16 v[144:147], v[208:211], v[88:91], v[144:147]
  v_mfma_f32_16x16x32_bf16 v[148:151], v[208:211], v[120:123], v[148:151]
  v_mfma_f32_16x16x32_bf16 v[152:155], v[240:243], v[24:27], v[152:155]
  v_mfma_f32_16x16x32_bf16 v[156:159], v[240:243], v[56:59], v[156:159]
  ds_read_b128 v[232:235], v187 offset:2240
  v_mfma_f32_16x16x32_bf16 v[160:163], v[240:243], v[88:91], v[160:163]
  v_mfma_f32_16x16x32_bf16 v[164:167], v[240:243], v[120:123], v[164:167]
  v_mfma_f32_16x16x32_bf16 v[136:139], v[212:215], v[28:31], v[136:139]
  v_mfma_f32_16x16x32_bf16 v[140:143], v[212:215], v[60:63], v[140:143]
  ds_read_b128 v[204:207], v187 offset:192
  v_mfma_f32_16x16x32_bf16 v[144:147], v[212:215], v[92:95], v[144:147]
  v_mfma_f32_16x16x32_bf16 v[148:151], v[212:215], v[124:127], v[148:151]
  v_mfma_f32_16x16x32_bf16 v[152:155], v[244:247], v[28:31], v[152:155]
  v_mfma_f32_16x16x32_bf16 v[156:159], v[244:247], v[60:63], v[156:159]
  ds_read_b128 v[236:239], v187 offset:2304
  v_mfma_f32_16x16x32_bf16 v[160:163], v[244:247], v[92:95], v[160:163]
  v_mfma_f32_16x16x32_bf16 v[164:167], v[244:247], v[124:127], v[164:167]
  v_mfma_f32_16x16x32_bf16 v[136:139], v[216:219], v[32:35], v[136:139]
  v_mfma_f32_16x16x32_bf16 v[140:143], v[216:219], v[64:67], v[140:143]
  ds_read_b128 v[208:211], v187 offset:256
  v_mfma_f32_16x16x32_bf16 v[144:147], v[216:219], v[96:99], v[144:147]
  v_mfma_f32_16x16x32_bf16 v[148:151], v[216:219], v[128:131], v[148:151]
  v_mfma_f32_16x16x32_bf16 v[152:155], v[248:251], v[32:35], v[152:155]
  v_mfma_f32_16x16x32_bf16 v[156:159], v[248:251], v[64:67], v[156:159]
  ds_read_b128 v[240:243], v187 offset:2368
  v_mfma_f32_16x16x32_bf16 v[160:163], v[248:251], v[96:99], v[160:163]
  v_mfma_f32_16x16x32_bf16 v[164:167], v[248:251], v[128:131], v[164:167]
  v_mfma_f32_16x16x32_bf16 v[136:139], v[220:223], v[36:39], v[136:139]
  v_mfma_f32_16x16x32_bf16 v[140:143], v[220:223], v[68:71], v[140:143]
  ds_read_b128 v[212:215], v187 offset:320
  v_mfma_f32_16x16x32_bf16 v[144:147], v[220:223], v[100:103], v[144:147]
  v_mfma_f32_16x16x32_bf16 v[148:151], v[220:223], v[132:135], v[148:151]
  v_mfma_f32_16x16x32_bf16 v[152:155], v[252:255], v[36:39], v[152:155]
  v_mfma_f32_16x16x32_bf16 v[156:159], v[252:255], v[68:71], v[156:159]
  ds_read_b128 v[244:247], v187 offset:2432
  v_mfma_f32_16x16x32_bf16 v[160:163], v[252:255], v[100:103], v[160:163]
  v_mfma_f32_16x16x32_bf16 v[164:167], v[252:255], v[132:135], v[164:167]
  ds_read_b128 v[216:219], v187 offset:384
  ds_read_b128 v[248:251], v187 offset:2496
  ds_read_b128 v[220:223], v187 offset:448
  ds_read_b128 v[252:255], v187 offset:2560
  s_nop 7
  s_add_u32 s24, s8, 4
  s_lshl_b32 s24, s24, 10
  s_add_u32 s26, s38, s24
  s_addc_u32 s27, s39, 0
  v_pk_mul_f32 v[136:137], v[136:137], v[178:179] op_sel_hi:[1,0]
  v_pk_mul_f32 v[152:153], v[152:153], v[178:179] op_sel_hi:[1,0]
  v_pk_mul_f32 v[138:139], v[138:139], v[178:179] op_sel_hi:[1,0]
  v_pk_mul_f32 v[154:155], v[154:155], v[178:179] op_sel_hi:[1,0]
  v_cvt_pk_bf16_f32 v168, v136, v137
  v_cvt_pk_bf16_f32 v169, v138, v139
  v_cvt_pk_bf16_f32 v170, v152, v153
  v_cvt_pk_bf16_f32 v171, v154, v155
  global_store_dwordx4 v180, v[168:171], s[26:27] sc1
  s_add_u32 s26, s26, 14336
  s_addc_u32 s27, s27, 0
  v_pk_mul_f32 v[140:141], v[140:141], v[178:179] op_sel_hi:[1,0]
  v_pk_mul_f32 v[156:157], v[156:157], v[178:179] op_sel_hi:[1,0]
  v_pk_mul_f32 v[142:143], v[142:143], v[178:179] op_sel_hi:[1,0]
  v_pk_mul_f32 v[158:159], v[158:159], v[178:179] op_sel_hi:[1,0]
  v_cvt_pk_bf16_f32 v172, v140, v141
  v_cvt_pk_bf16_f32 v173, v142, v143
  v_cvt_pk_bf16_f32 v174, v156, v157
  v_cvt_pk_bf16_f32 v175, v158, v159
  global_store_dwordx4 v180, v[172:175], s[26:27] sc1
  s_add_u32 s26, s26, 14336
  s_addc_u32 s27, s27, 0
  v_pk_mul_f32 v[144:145], v[144:145], v[178:179] op_sel_hi:[1,0]
  v_pk_mul_f32 v[160:161], v[160:161], v[178:179] op_sel_hi:[1,0]
  v_pk_mul_f32 v[146:147], v[146:147], v[178:179] op_sel_hi:[1,0]
  v_pk_mul_f32 v[162:163], v[162:163], v[178:179] op_sel_hi:[1,0]
  v_cvt_pk_bf16_f32 v168, v144, v145
  v_cvt_pk_bf16_f32 v169, v146, v147
  v_cvt_pk_bf16_f32 v170, v160, v161
  v_cvt_pk_bf16_f32 v171, v162, v163
  global_store_dwordx4 v180, v[168:171], s[26:27] sc1
  s_add_u32 s26, s26, 14336
  s_addc_u32 s27, s27, 0
  v_pk_mul_f32 v[148:149], v[148:149], v[178:179] op_sel_hi:[1,0]
  v_pk_mul_f32 v[164:165], v[164:165], v[178:179] op_sel_hi:[1,0]
  v_pk_mul_f32 v[150:151], v[150:151], v[178:179] op_sel_hi:[1,0]
  v_pk_mul_f32 v[166:167], v[166:167], v[178:179] op_sel_hi:[1,0]
  v_cvt_pk_bf16_f32 v172, v148, v149
  v_cvt_pk_bf16_f32 v173, v150, v151
  v_cvt_pk_bf16_f32 v174, v164, v165
  v_cvt_pk_bf16_f32 v175, v166, v167
  global_store_dwordx4 v180, v[172:175], s[26:27] sc1
  s_waitcnt lgkmcnt(0)
  v_mfma_f32_16x16x32_bf16 v[136:139], v[192:195], v[8:11], 0
  v_mfma_f32_16x16x32_bf16 v[140:143], v[192:195], v[40:43], 0
  v_mfma_f32_16x16x32_bf16 v[144:147], v[192:195], v[72:75], 0
  v_mfma_f32_16x16x32_bf16 v[148:151], v[192:195], v[104:107], 0
  v_mfma_f32_16x16x32_bf16 v[152:155], v[224:227], v[8:11], 0
  v_mfma_f32_16x16x32_bf16 v[156:159], v[224:227], v[40:43], 0
  v_mfma_f32_16x16x32_bf16 v[160:163], v[224:227], v[72:75], 0
  v_mfma_f32_16x16x32_bf16 v[164:167], v[224:227], v[104:107], 0
  v_mfma_f32_16x16x32_bf16 v[136:139], v[196:199], v[12:15], v[136:139]
  v_mfma_f32_16x16x32_bf16 v[140:143], v[196:199], v[44:47], v[140:143]
  v_mfma_f32_16x16x32_bf16 v[144:147], v[196:199], v[76:79], v[144:147]
  v_mfma_f32_16x16x32_bf16 v[148:151], v[196:199], v[108:111], v[148:151]
  v_mfma_f32_16x16x32_bf16 v[152:155], v[228:231], v[12:15], v[152:155]
  v_mfma_f32_16x16x32_bf16 v[156:159], v[228:231], v[44:47], v[156:159]
  v_mfma_f32_16x16x32_bf16 v[160:163], v[228:231], v[76:79], v[160:163]
  v_mfma_f32_16x16x32_bf16 v[164:167], v[228:231], v[108:111], v[164:167]
  v_mfma_f32_16x16x32_bf16 v[136:139], v[200:203], v[16:19], v[136:139]
  v_mfma_f32_16x16x32_bf16 v[140:143], v[200:203], v[48:51], v[140:143]
  v_mfma_f32_16x16x32_bf16 v[144:147], v[200:203], v[80:83], v[144:147]
  v_mfma_f32_16x16x32_bf16 v[148:151], v[200:203], v[112:115], v[148:151]
  v_mfma_f32_16x16x32_bf16 v[152:155], v[232:235], v[16:19], v[152:155]
  v_mfma_f32_16x16x32_bf16 v[156:159], v[232:235], v[48:51], v[156:159]
  v_mfma_f32_16x16x32_bf16 v[160:163], v[232:235], v[80:83], v[160:163]
  v_mfma_f32_16x16x32_bf16 v[164:167], v[232:235], v[112:115], v[164:167]
  v_mfma_f32_16x16x32_bf16 v[136:139], v[204:207], v[20:23], v[136:139]
  v_mfma_f32_16x16x32_bf16 v[140:143], v[204:207], v[52:55], v[140:143]
  v_mfma_f32_16x16x32_bf16 v[144:147], v[204:207], v[84:87], v[144:147]
  v_mfma_f32_16x16x32_bf16 v[148:151], v[204:207], v[116:119], v[148:151]
  v_mfma_f32_16x16x32_bf16 v[152:155], v[236:239], v[20:23], v[152:155]
  v_mfma_f32_16x16x32_bf16 v[156:159], v[236:239], v[52:55], v[156:159]
  v_mfma_f32_16x16x32_bf16 v[160:163], v[236:239], v[84:87], v[160:163]
  v_mfma_f32_16x16x32_bf16 v[164:167], v[236:239], v[116:119], v[164:167]
  v_mfma_f32_16x16x32_bf16 v[136:139], v[208:211], v[24:27], v[136:139]
  v_mfma_f32_16x16x32_bf16 v[140:143], v[208:211], v[56:59], v[140:143]
  v_mfma_f32_16x16x32_bf16 v[144:147], v[208:211], v[88:91], v[144:147]
  v_mfma_f32_16x16x32_bf16 v[148:151], v[208:211], v[120:123], v[148:151]
  v_mfma_f32_16x16x32_bf16 v[152:155], v[240:243], v[24:27], v[152:155]
  v_mfma_f32_16x16x32_bf16 v[156:159], v[240:243], v[56:59], v[156:159]
  v_mfma_f32_16x16x32_bf16 v[160:163], v[240:243], v[88:91], v[160:163]
  v_mfma_f32_16x16x32_bf16 v[164:167], v[240:243], v[120:123], v[164:167]
  v_mfma_f32_16x16x32_bf16 v[136:139], v[212:215], v[28:31], v[136:139]
  v_mfma_f32_16x16x32_bf16 v[140:143], v[212:215], v[60:63], v[140:143]
  v_mfma_f32_16x16x32_bf16 v[144:147], v[212:215], v[92:95], v[144:147]
  v_mfma_f32_16x16x32_bf16 v[148:151], v[212:215], v[124:127], v[148:151]
  v_mfma_f32_16x16x32_bf16 v[152:155], v[244:247], v[28:31], v[152:155]
  v_mfma_f32_16x16x32_bf16 v[156:159], v[244:247], v[60:63], v[156:159]
  v_mfma_f32_16x16x32_bf16 v[160:163], v[244:247], v[92:95], v[160:163]
  v_mfma_f32_16x16x32_bf16 v[164:167], v[244:247], v[124:127], v[164:167]
  v_mfma_f32_16x16x32_bf16 v[136:139], v[216:219], v[32:35], v[136:139]
  v_mfma_f32_16x16x32_bf16 v[140:143], v[216:219], v[64:67], v[140:143]
  v_mfma_f32_16x16x32_bf16 v[144:147], v[216:219], v[96:99], v[144:147]
  v_mfma_f32_16x16x32_bf16 v[148:151], v[216:219], v[128:131], v[148:151]
  v_mfma_f32_16x16x32_bf16 v[152:155], v[248:251], v[32:35], v[152:155]
  v_mfma_f32_16x16x32_bf16 v[156:159], v[248:251], v[64:67], v[156:159]
  v_mfma_f32_16x16x32_bf16 v[160:163], v[248:251], v[96:99], v[160:163]
  v_mfma_f32_16x16x32_bf16 v[164:167], v[248:251], v[128:131], v[164:167]
  v_mfma_f32_16x16x32_bf16 v[136:139], v[220:223], v[36:39], v[136:139]
  v_mfma_f32_16x16x32_bf16 v[140:143], v[220:223], v[68:71], v[140:143]
  v_mfma_f32_16x16x32_bf16 v[144:147], v[220:223], v[100:103], v[144:147]
  v_mfma_f32_16x16x32_bf16 v[148:151], v[220:223], v[132:135], v[148:151]
  v_mfma_f32_16x16x32_bf16 v[152:155], v[252:255], v[36:39], v[152:155]
  v_mfma_f32_16x16x32_bf16 v[156:159], v[252:255], v[68:71], v[156:159]
  v_mfma_f32_16x16x32_bf16 v[160:163], v[252:255], v[100:103], v[160:163]
  v_mfma_f32_16x16x32_bf16 v[164:167], v[252:255], v[132:135], v[164:167]
  s_nop 7
  s_add_u32 s24, s8, 8
  s_lshl_b32 s24, s24, 10
  s_add_u32 s26, s38, s24
  s_addc_u32 s27, s39, 0
  v_pk_mul_f32 v[136:137], v[136:137], v[178:179] op_sel_hi:[1,0]
  v_pk_mul_f32 v[152:153], v[152:153], v[178:179] op_sel_hi:[1,0]
  v_pk_mul_f32 v[138:139], v[138:139], v[178:179] op_sel_hi:[1,0]
  v_pk_mul_f32 v[154:155], v[154:155], v[178:179] op_sel_hi:[1,0]
  v_cvt_pk_bf16_f32 v168, v136, v137
  v_cvt_pk_bf16_f32 v169, v138, v139
  v_cvt_pk_bf16_f32 v170, v152, v153
  v_cvt_pk_bf16_f32 v171, v154, v155
  global_store_dwordx4 v180, v[168:171], s[26:27] sc1
  s_add_u32 s26, s26, 14336
  s_addc_u32 s27, s27, 0
  v_pk_mul_f32 v[140:141], v[140:141], v[178:179] op_sel_hi:[1,0]
  v_pk_mul_f32 v[156:157], v[156:157], v[178:179] op_sel_hi:[1,0]
  v_pk_mul_f32 v[142:143], v[142:143], v[178:179] op_sel_hi:[1,0]
  v_pk_mul_f32 v[158:159], v[158:159], v[178:179] op_sel_hi:[1,0]
  v_cvt_pk_bf16_f32 v172, v140, v141
  v_cvt_pk_bf16_f32 v173, v142, v143
  v_cvt_pk_bf16_f32 v174, v156, v157
  v_cvt_pk_bf16_f32 v175, v158, v159
  global_store_dwordx4 v180, v[172:175], s[26:27] sc1
  s_add_u32 s26, s26, 14336
  s_addc_u32 s27, s27, 0
  v_pk_mul_f32 v[144:145], v[144:145], v[178:179] op_sel_hi:[1,0]
  v_pk_mul_f32 v[160:161], v[160:161], v[178:179] op_sel_hi:[1,0]
  v_pk_mul_f32 v[146:147], v[146:147], v[178:179] op_sel_hi:[1,0]
  v_pk_mul_f32 v[162:163], v[162:163], v[178:179] op_sel_hi:[1,0]
  v_cvt_pk_bf16_f32 v168, v144, v145
  v_cvt_pk_bf16_f32 v169, v146, v147
  v_cvt_pk_bf16_f32 v170, v160, v161
  v_cvt_pk_bf16_f32 v171, v162, v163
  global_store_dwordx4 v180, v[168:171], s[26:27] sc1
  s_add_u32 s26, s26, 14336
  s_addc_u32 s27, s27, 0
  v_pk_mul_f32 v[148:149], v[148:149], v[178:179] op_sel_hi:[1,0]
  v_pk_mul_f32 v[164:165], v[164:165], v[178:179] op_sel_hi:[1,0]
  v_pk_mul_f32 v[150:151], v[150:151], v[178:179] op_sel_hi:[1,0]
  v_pk_mul_f32 v[166:167], v[166:167], v[178:179] op_sel_hi:[1,0]
  v_cvt_pk_bf16_f32 v172, v148, v149
  v_cvt_pk_bf16_f32 v173, v150, v151
  v_cvt_pk_bf16_f32 v174, v164, v165
  v_cvt_pk_bf16_f32 v175, v166, v167
  global_store_dwordx4 v180, v[172:175], s[26:27] sc1
L_flend_9:
  s_branch L_sequential_preLN__memory_aug_recurrent_mem_tr__mixer_token_mlp__prompt_kernel_p1fin
L_sequential_preLN__memory_aug_recurrent_mem_tr__mixer_token_mlp__prompt_kernel_p1ln:
  s_sub_u32 s32, s9, 224
  s_lshl_b32 s32, s32, 1
  v_and_b32 v1, 15, v0
  v_bfe_u32 v2, v0, 4, 2
  s_lshl_b32 s24, s8, 4
  v_add_u32 v3, s24, v2
  v_mul_u32_u24 v4, 896, v3
  v_lshl_add_u32 v4, v1, 4, v4
  v_mul_u32_u24 v5, 912, v3
  v_lshl_add_u32 v5, v1, 4, v5
  s_mul_i32 s24, s32, 28672
  s_add_u32 s34, s10, s24
  s_addc_u32 s35, s11, 0
  v_cmp_gt_u32 s[36:37], 8, v1
  global_load_dwordx4 v[72:75], v4, s[34:35] offset:0
  global_load_dwordx4 v[76:79], v4, s[34:35] offset:256
  global_load_dwordx4 v[80:83], v4, s[34:35] offset:512
  v_mov_b32 v84, 0
  v_mov_b32 v85, 0
  v_mov_b32 v86, 0
  v_mov_b32 v87, 0
  s_mov_b64 exec, s[36:37]
  global_load_dwordx4 v[84:87], v4, s[34:35] offset:768
  s_mov_b64 exec, -1
  v_add_u32 v4, 3584, v4
  global_load_dwordx4 v[88:91], v4, s[34:35] offset:0
  global_load_dwordx4 v[92:95], v4, s[34:35] offset:256
  global_load_dwordx4 v[96:99], v4, s[34:35] offset:512
  v_mov_b32 v100, 0
  v_mov_b32 v101, 0
  v_mov_b32 v102, 0
  v_mov_b32 v103, 0
  s_mov_b64 exec, s[36:37]
  global_load_dwordx4 v[100:103], v4, s[34:35] offset:768
  s_mov_b64 exec, -1
  v_add_u32 v4, 3584, v4
  global_load_dwordx4 v[104:107], v4, s[34:35] offset:0
  global_load_dwordx4 v[108:111], v4, s[34:35] offset:256
  global_load_dwordx4 v[112:115], v4, s[34:35] offset:512
  v_mov_b32 v116, 0
  v_mov_b32 v117, 0
  v_mov_b32 v118, 0
  v_mov_b32 v119, 0
  s_mov_b64 exec, s[36:37]
  global_load_dwordx4 v[116:119], v4, s[34:35] offset:768
  s_mov_b64 exec, -1
  v_add_u32 v4, 3584, v4
  global_load_dwordx4 v[120:123], v4, s[34:35] offset:0
  global_load_dwordx4 v[124:127], v4, s[34:35] offset:256
  global_load_dwordx4 v[128:131], v4, s[34:35] offset:512
  v_mov_b32 v132, 0
  v_mov_b32 v133, 0
  v_mov_b32 v134, 0
  v_mov_b32 v135, 0
  s_mov_b64 exec, s[36:37]
  global_load_dwordx4 v[132:135], v4, s[34:35] offset:768
  s_mov_b64 exec, -1
  s_waitcnt vmcnt(12)
  v_lshlrev_b32 v32, 16, v72
  v_and_b32 v33, 0xffff0000, v72
  v_lshlrev_b32 v34, 16, v73
  v_and_b32 v35, 0xffff0000, v73
  v_lshlrev_b32 v36, 16, v74
  v_and_b32 v37, 0xffff0000, v74
  v_lshlrev_b32 v38, 16, v75
  v_and_b32 v39, 0xffff0000, v75
  v_lshlrev_b32 v40, 16, v76
  v_and_b32 v41, 0xffff0000, v76
  v_lshlrev_b32 v42, 16, v77
  v_and_b32 v43, 0xffff0000, v77
  v_lshlrev_b32 v44, 16, v78
  v_and_b32 v45, 0xffff0000, v78
  v_lshlrev_b32 v46, 16, v79
  v_and_b32 v47, 0xffff0000, v79
  v_lshlrev_b32 v48, 16, v80
  v_and_b32 v49, 0xffff0000, v80
  v_lshlrev_b32 v50, 16, v81
  v_and_b32 v51, 0xffff0000, v81
  v_lshlrev_b32 v52, 16, v82
  v_and_b32 v53, 0xffff0000, v82
  v_lshlrev_b32 v54, 16, v83
  v_and_b32 v55, 0xffff0000, v83
  v_lshlrev_b32 v56, 16, v84
  v_and_b32 v57, 0xffff0000, v84
  v_lshlrev_b32 v58, 16, v85
  v_and_b32 v59, 0xffff0000, v85
  v_lshlrev_b32 v60, 16, v86
  v_and_b32 v61, 0xffff0000, v86
  v_lshlrev_b32 v62, 16, v87
  v_and_b32 v63, 0xffff0000, v87
  v_pk_add_f32 v[8:9], v[32:33], v[34:35]
  v_pk_add_f32 v[8:9], v[8:9], v[36:37]
  v_pk_add_f32 v[8:9], v[8:9], v[38:39]
  v_pk_add_f32 v[8:9], v[8:9], v[40:41]
  v_pk_add_f32 v[8:9], v[8:9], v[42:43]
  v_pk_add_f32 v[8:9], v[8:9], v[44:45]
  v_pk_add_f32 v[8:9], v[8:9], v[46:47]
  v_pk_add_f32 v[8:9], v[8:9], v[48:49]
  v_pk_add_f32 v[8:9], v[8:9], v[50:51]
  v_pk_add_f32 v[8:9], v[8:9], v[52:53]
  v_pk_add_f32 v[8:9], v[8:9], v[54:55]
  v_pk_add_f32 v[8:9], v[8:9], v[56:57]
  v_pk_add_f32 v[8:9], v[8:9], v[58:59]
  v_pk_add_f32 v[8:9], v[8:9], v[60:61]
  v_pk_add_f32 v[8:9], v[8:9], v[62:63]
  v_add_f32 v6, v8, v9
  s_nop 1
  v_add_f32_dpp v6, v6, v6 row_ror:8 row_mask:0xf bank_mask:0xf
  s_nop 1
  v_add_f32_dpp v6, v6, v6 row_ror:4 row_mask:0xf bank_mask:0xf
  s_nop 1
  v_add_f32_dpp v6, v6, v6 row_ror:2 row_mask:0xf bank_mask:0xf
  s_nop 1
  v_add_f32_dpp v6, v6, v6 row_ror:1 row_mask:0xf bank_mask:0xf
  v_mul_f32 v6, 0x3b124925, v6
  v_pk_add_f32 v[32:33], v[32:33], v[6:7] op_sel_hi:[1,0] neg_lo:[0,1] neg_hi:[0,1]
  v_pk_add_f32 v[34:35], v[34:35], v[6:7] op_sel_hi:[1,0] neg_lo:[0,1] neg_hi:[0,1]
  v_pk_add_f32 v[36:37], v[36:37], v[6:7] op_sel_hi:[1,0] neg_lo:[0,1] neg_hi:[0,1]
  v_pk_add_f32 v[38:39], v[38:39], v[6:7] op_sel_hi:[1,0] neg_lo:[0,1] neg_hi:[0,1]
  v_pk_add_f32 v[40:41], v[40:41], v[6:7] op_sel_hi:[1,0] neg_lo:[0,1] neg_hi:[0,1]
  v_pk_add_f32 v[42:43], v[42:43], v[6:7] op_sel_hi:[1,0] neg_lo:[0,1] neg_hi:[0,1]
  v_pk_add_f32 v[44:45], v[44:45], v[6:7] op_sel_hi:[1,0] neg_lo:[0,1] neg_hi:[0,1]
  v_pk_add_f32 v[46:47], v[46:47], v[6:7] op_sel_hi:[1,0] neg_lo:[0,1] neg_hi:[0,1]
  v_pk_add_f32 v[48:49], v[48:49], v[6:7] op_sel_hi:[1,0] neg_lo:[0,1] neg_hi:[0,1]
  v_pk_add_f32 v[50:51], v[50:51], v[6:7] op_sel_hi:[1,0] neg_lo:[0,1] neg_hi:[0,1]
  v_pk_add_f32 v[52:53], v[52:53], v[6:7] op_sel_hi:[1,0] neg_lo:[0,1] neg_hi:[0,1]
  v_pk_add_f32 v[54:55], v[54:55], v[6:7] op_sel_hi:[1,0] neg_lo:[0,1] neg_hi:[0,1]
  v_pk_add_f32 v[56:57], v[56:57], v[6:7] op_sel_hi:[1,0] neg_lo:[0,1] neg_hi:[0,1]
  v_pk_add_f32 v[58:59], v[58:59], v[6:7] op_sel_hi:[1,0] neg_lo:[0,1] neg_hi:[0,1]
  v_pk_add_f32 v[60:61], v[60:61], v[6:7] op_sel_hi:[1,0] neg_lo:[0,1] neg_hi:[0,1]
  v_pk_add_f32 v[62:63], v[62:63], v[6:7] op_sel_hi:[1,0] neg_lo:[0,1] neg_hi:[0,1]
  s_mov_b64 exec, s[36:37]
  s_not_b64 exec, exec
  v_mov_b32 v56, 0
  v_mov_b32 v57, 0
  v_mov_b32 v58, 0
  v_mov_b32 v59, 0
  v_mov_b32 v60, 0
  v_mov_b32 v61, 0
  v_mov_b32 v62, 0
  v_mov_b32 v63, 0
  s_mov_b64 exec, -1
  v_pk_mul_f32 v[8:9], v[32:33], v[32:33]
  v_pk_fma_f32 v[8:9], v[34:35], v[34:35], v[8:9]
  v_pk_fma_f32 v[8:9], v[36:37], v[36:37], v[8:9]
  v_pk_fma_f32 v[8:9], v[38:39], v[38:39], v[8:9]
  v_pk_fma_f32 v[8:9], v[40:41], v[40:41], v[8:9]
  v_pk_fma_f32 v[8:9], v[42:43], v[42:43], v[8:9]
  v_pk_fma_f32 v[8:9], v[44:45], v[44:45], v[8:9]
  v_pk_fma_f32 v[8:9], v[46:47], v[46:47], v[8:9]
  v_pk_fma_f32 v[8:9], v[48:49], v[48:49], v[8:9]
  v_pk_fma_f32 v[8:9], v[50:51], v[50:51], v[8:9]
  v_pk_fma_f32 v[8:9], v[52:53], v[52:53], v[8:9]
  v_pk_fma_f32 v[8:9], v[54:55], v[54:55], v[8:9]
  v_pk_fma_f32 v[8:9], v[56:57], v[56:57], v[8:9]
  v_pk_fma_f32 v[8:9], v[58:59], v[58:59], v[8:9]
  v_pk_fma_f32 v[8:9], v[60:61], v[60:61], v[8:9]
  v_pk_fma_f32 v[8:9], v[62:63], v[62:63], v[8:9]
  v_add_f32 v10, v8, v9
  s_nop 1
  v_add_f32_dpp v10, v10, v10 row_ror:8 row_mask:0xf bank_mask:0xf
  s_nop 1
  v_add_f32_dpp v10, v10, v10 row_ror:4 row_mask:0xf bank_mask:0xf
  s_nop 1
  v_add_f32_dpp v10, v10, v10 row_ror:2 row_mask:0xf bank_mask:0xf
  s_nop 1
  v_add_f32_dpp v10, v10, v10 row_ror:1 row_mask:0xf bank_mask:0xf
  v_mov_b32 v6, 0x3727c5ac
  v_fmac_f32 v6, 0x3b124925, v10
  v_rsq_f32 v6, v6
  s_nop 0
  v_pk_mul_f32 v[32:33], v[32:33], v[6:7] op_sel_hi:[1,0]
  v_pk_mul_f32 v[34:35], v[34:35], v[6:7] op_sel_hi:[1,0]
  v_pk_mul_f32 v[36:37], v[36:37], v[6:7] op_sel_hi:[1,0]
  v_pk_mul_f32 v[38:39], v[38:39], v[6:7] op_sel_hi:[1,0]
  v_pk_mul_f32 v[40:41], v[40:41], v[6:7] op_sel_hi:[1,0]
  v_pk_mul_f32 v[42:43], v[42:43], v[6:7] op_sel_hi:[1,0]
  v_pk_mul_f32 v[44:45], v[44:45], v[6:7] op_sel_hi:[1,0]
  v_pk_mul_f32 v[46:47], v[46:47], v[6:7] op_sel_hi:[1,0]
  v_pk_mul_f32 v[48:49], v[48:49], v[6:7] op_sel_hi:[1,0]
  v_pk_mul_f32 v[50:51], v[50:51], v[6:7] op_sel_hi:[1,0]
  v_pk_mul_f32 v[52:53], v[52:53], v[6:7] op_sel_hi:[1,0]
  v_pk_mul_f32 v[54:55], v[54:55], v[6:7] op_sel_hi:[1,0]
  v_pk_mul_f32 v[56:57], v[56:57], v[6:7] op_sel_hi:[1,0]
  v_pk_mul_f32 v[58:59], v[58:59], v[6:7] op_sel_hi:[1,0]
  v_pk_mul_f32 v[60:61], v[60:61], v[6:7] op_sel_hi:[1,0]
  v_pk_mul_f32 v[62:63], v[62:63], v[6:7] op_sel_hi:[1,0]
  v_cvt_pk_bf16_f32 v72, v32, v33
  v_cvt_pk_bf16_f32 v73, v34, v35
  v_cvt_pk_bf16_f32 v74, v36, v37
  v_cvt_pk_bf16_f32 v75, v38, v39
  v_cvt_pk_bf16_f32 v76, v40, v41
  v_cvt_pk_bf16_f32 v77, v42, v43
  v_cvt_pk_bf16_f32 v78, v44, v45
  v_cvt_pk_bf16_f32 v79, v46, v47
  v_cvt_pk_bf16_f32 v80, v48, v49
  v_cvt_pk_bf16_f32 v81, v50, v51
  v_cvt_pk_bf16_f32 v82, v52, v53
  v_cvt_pk_bf16_f32 v83, v54, v55
  v_cvt_pk_bf16_f32 v84, v56, v57
  v_cvt_pk_bf16_f32 v85, v58, v59
  v_cvt_pk_bf16_f32 v86, v60, v61
  v_cvt_pk_bf16_f32 v87, v62, v63
  ds_write_b128 v5, v[72:75] offset:0
  ds_write_b128 v5, v[76:79] offset:256
  ds_write_b128 v5, v[80:83] offset:512
  s_mov_b64 exec, s[36:37]
  ds_write_b128 v5, v[84:87] offset:768
  s_mov_b64 exec, -1
  s_waitcnt vmcnt(8)
  v_lshlrev_b32 v32, 16, v88
  v_and_b32 v33, 0xffff0000, v88
  v_lshlrev_b32 v34, 16, v89
  v_and_b32 v35, 0xffff0000, v89
  v_lshlrev_b32 v36, 16, v90
  v_and_b32 v37, 0xffff0000, v90
  v_lshlrev_b32 v38, 16, v91
  v_and_b32 v39, 0xffff0000, v91
  v_lshlrev_b32 v40, 16, v92
  v_and_b32 v41, 0xffff0000, v92
  v_lshlrev_b32 v42, 16, v93
  v_and_b32 v43, 0xffff0000, v93
  v_lshlrev_b32 v44, 16, v94
  v_and_b32 v45, 0xffff0000, v94
  v_lshlrev_b32 v46, 16, v95
  v_and_b32 v47, 0xffff0000, v95
  v_lshlrev_b32 v48, 16, v96
  v_and_b32 v49, 0xffff0000, v96
  v_lshlrev_b32 v50, 16, v97
  v_and_b32 v51, 0xffff0000, v97
  v_lshlrev_b32 v52, 16, v98
  v_and_b32 v53, 0xffff0000, v98
  v_lshlrev_b32 v54, 16, v99
  v_and_b32 v55, 0xffff0000, v99
  v_lshlrev_b32 v56, 16, v100
  v_and_b32 v57, 0xffff0000, v100
  v_lshlrev_b32 v58, 16, v101
  v_and_b32 v59, 0xffff0000, v101
  v_lshlrev_b32 v60, 16, v102
  v_and_b32 v61, 0xffff0000, v102
  v_lshlrev_b32 v62, 16, v103
  v_and_b32 v63, 0xffff0000, v103
  v_pk_add_f32 v[8:9], v[32:33], v[34:35]
  v_pk_add_f32 v[8:9], v[8:9], v[36:37]
  v_pk_add_f32 v[8:9], v[8:9], v[38:39]
  v_pk_add_f32 v[8:9], v[8:9], v[40:41]
  v_pk_add_f32 v[8:9], v[8:9], v[42:43]
  v_pk_add_f32 v[8:9], v[8:9], v[44:45]
  v_pk_add_f32 v[8:9], v[8:9], v[46:47]
  v_pk_add_f32 v[8:9], v[8:9], v[48:49]
  v_pk_add_f32 v[8:9], v[8:9], v[50:51]
  v_pk_add_f32 v[8:9], v[8:9], v[52:53]
  v_pk_add_f32 v[8:9], v[8:9], v[54:55]
  v_pk_add_f32 v[8:9], v[8:9], v[56:57]
  v_pk_add_f32 v[8:9], v[8:9], v[58:59]
  v_pk_add_f32 v[8:9], v[8:9], v[60:61]
  v_pk_add_f32 v[8:9], v[8:9], v[62:63]
  v_add_f32 v6, v8, v9
  s_nop 1
  v_add_f32_dpp v6, v6, v6 row_ror:8 row_mask:0xf bank_mask:0xf
  s_nop 1
  v_add_f32_dpp v6, v6, v6 row_ror:4 row_mask:0xf bank_mask:0xf
  s_nop 1
  v_add_f32_dpp v6, v6, v6 row_ror:2 row_mask:0xf bank_mask:0xf
  s_nop 1
  v_add_f32_dpp v6, v6, v6 row_ror:1 row_mask:0xf bank_mask:0xf
  v_mul_f32 v6, 0x3b124925, v6
  v_pk_add_f32 v[32:33], v[32:33], v[6:7] op_sel_hi:[1,0] neg_lo:[0,1] neg_hi:[0,1]
  v_pk_add_f32 v[34:35], v[34:35], v[6:7] op_sel_hi:[1,0] neg_lo:[0,1] neg_hi:[0,1]
  v_pk_add_f32 v[36:37], v[36:37], v[6:7] op_sel_hi:[1,0] neg_lo:[0,1] neg_hi:[0,1]
  v_pk_add_f32 v[38:39], v[38:39], v[6:7] op_sel_hi:[1,0] neg_lo:[0,1] neg_hi:[0,1]
  v_pk_add_f32 v[40:41], v[40:41], v[6:7] op_sel_hi:[1,0] neg_lo:[0,1] neg_hi:[0,1]
  v_pk_add_f32 v[42:43], v[42:43], v[6:7] op_sel_hi:[1,0] neg_lo:[0,1] neg_hi:[0,1]
  v_pk_add_f32 v[44:45], v[44:45], v[6:7] op_sel_hi:[1,0] neg_lo:[0,1] neg_hi:[0,1]
  v_pk_add_f32 v[46:47], v[46:47], v[6:7] op_sel_hi:[1,0] neg_lo:[0,1] neg_hi:[0,1]
  v_pk_add_f32 v[48:49], v[48:49], v[6:7] op_sel_hi:[1,0] neg_lo:[0,1] neg_hi:[0,1]
  v_pk_add_f32 v[50:51], v[50:51], v[6:7] op_sel_hi:[1,0] neg_lo:[0,1] neg_hi:[0,1]
  v_pk_add_f32 v[52:53], v[52:53], v[6:7] op_sel_hi:[1,0] neg_lo:[0,1] neg_hi:[0,1]
  v_pk_add_f32 v[54:55], v[54:55], v[6:7] op_sel_hi:[1,0] neg_lo:[0,1] neg_hi:[0,1]
  v_pk_add_f32 v[56:57], v[56:57], v[6:7] op_sel_hi:[1,0] neg_lo:[0,1] neg_hi:[0,1]
  v_pk_add_f32 v[58:59], v[58:59], v[6:7] op_sel_hi:[1,0] neg_lo:[0,1] neg_hi:[0,1]
  v_pk_add_f32 v[60:61], v[60:61], v[6:7] op_sel_hi:[1,0] neg_lo:[0,1] neg_hi:[0,1]
  v_pk_add_f32 v[62:63], v[62:63], v[6:7] op_sel_hi:[1,0] neg_lo:[0,1] neg_hi:[0,1]
  s_mov_b64 exec, s[36:37]
  s_not_b64 exec, exec
  v_mov_b32 v56, 0
  v_mov_b32 v57, 0
  v_mov_b32 v58, 0
  v_mov_b32 v59, 0
  v_mov_b32 v60, 0
  v_mov_b32 v61, 0
  v_mov_b32 v62, 0
  v_mov_b32 v63, 0
  s_mov_b64 exec, -1
  v_pk_mul_f32 v[8:9], v[32:33], v[32:33]
  v_pk_fma_f32 v[8:9], v[34:35], v[34:35], v[8:9]
  v_pk_fma_f32 v[8:9], v[36:37], v[36:37], v[8:9]
  v_pk_fma_f32 v[8:9], v[38:39], v[38:39], v[8:9]
  v_pk_fma_f32 v[8:9], v[40:41], v[40:41], v[8:9]
  v_pk_fma_f32 v[8:9], v[42:43], v[42:43], v[8:9]
  v_pk_fma_f32 v[8:9], v[44:45], v[44:45], v[8:9]
  v_pk_fma_f32 v[8:9], v[46:47], v[46:47], v[8:9]
  v_pk_fma_f32 v[8:9], v[48:49], v[48:49], v[8:9]
  v_pk_fma_f32 v[8:9], v[50:51], v[50:51], v[8:9]
  v_pk_fma_f32 v[8:9], v[52:53], v[52:53], v[8:9]
  v_pk_fma_f32 v[8:9], v[54:55], v[54:55], v[8:9]
  v_pk_fma_f32 v[8:9], v[56:57], v[56:57], v[8:9]
  v_pk_fma_f32 v[8:9], v[58:59], v[58:59], v[8:9]
  v_pk_fma_f32 v[8:9], v[60:61], v[60:61], v[8:9]
  v_pk_fma_f32 v[8:9], v[62:63], v[62:63], v[8:9]
  v_add_f32 v10, v8, v9
  s_nop 1
  v_add_f32_dpp v10, v10, v10 row_ror:8 row_mask:0xf bank_mask:0xf
  s_nop 1
  v_add_f32_dpp v10, v10, v10 row_ror:4 row_mask:0xf bank_mask:0xf
  s_nop 1
  v_add_f32_dpp v10, v10, v10 row_ror:2 row_mask:0xf bank_mask:0xf
  s_nop 1
  v_add_f32_dpp v10, v10, v10 row_ror:1 row_mask:0xf bank_mask:0xf
  v_mov_b32 v6, 0x3727c5ac
  v_fmac_f32 v6, 0x3b124925, v10
  v_rsq_f32 v6, v6
  s_nop 0
  v_pk_mul_f32 v[32:33], v[32:33], v[6:7] op_sel_hi:[1,0]
  v_pk_mul_f32 v[34:35], v[34:35], v[6:7] op_sel_hi:[1,0]
  v_pk_mul_f32 v[36:37], v[36:37], v[6:7] op_sel_hi:[1,0]
  v_pk_mul_f32 v[38:39], v[38:39], v[6:7] op_sel_hi:[1,0]
  v_pk_mul_f32 v[40:41], v[40:41], v[6:7] op_sel_hi:[1,0]
  v_pk_mul_f32 v[42:43], v[42:43], v[6:7] op_sel_hi:[1,0]
  v_pk_mul_f32 v[44:45], v[44:45], v[6:7] op_sel_hi:[1,0]
  v_pk_mul_f32 v[46:47], v[46:47], v[6:7] op_sel_hi:[1,0]
  v_pk_mul_f32 v[48:49], v[48:49], v[6:7] op_sel_hi:[1,0]
  v_pk_mul_f32 v[50:51], v[50:51], v[6:7] op_sel_hi:[1,0]
  v_pk_mul_f32 v[52:53], v[52:53], v[6:7] op_sel_hi:[1,0]
  v_pk_mul_f32 v[54:55], v[54:55], v[6:7] op_sel_hi:[1,0]
  v_pk_mul_f32 v[56:57], v[56:57], v[6:7] op_sel_hi:[1,0]
  v_pk_mul_f32 v[58:59], v[58:59], v[6:7] op_sel_hi:[1,0]
  v_pk_mul_f32 v[60:61], v[60:61], v[6:7] op_sel_hi:[1,0]
  v_pk_mul_f32 v[62:63], v[62:63], v[6:7] op_sel_hi:[1,0]
  v_cvt_pk_bf16_f32 v88, v32, v33
  v_cvt_pk_bf16_f32 v89, v34, v35
  v_cvt_pk_bf16_f32 v90, v36, v37
  v_cvt_pk_bf16_f32 v91, v38, v39
  v_cvt_pk_bf16_f32 v92, v40, v41
  v_cvt_pk_bf16_f32 v93, v42, v43
  v_cvt_pk_bf16_f32 v94, v44, v45
  v_cvt_pk_bf16_f32 v95, v46, v47
  v_cvt_pk_bf16_f32 v96, v48, v49
  v_cvt_pk_bf16_f32 v97, v50, v51
  v_cvt_pk_bf16_f32 v98, v52, v53
  v_cvt_pk_bf16_f32 v99, v54, v55
  v_cvt_pk_bf16_f32 v100, v56, v57
  v_cvt_pk_bf16_f32 v101, v58, v59
  v_cvt_pk_bf16_f32 v102, v60, v61
  v_cvt_pk_bf16_f32 v103, v62, v63
  ds_write_b128 v5, v[88:91] offset:3648
  ds_write_b128 v5, v[92:95] offset:3904
  ds_write_b128 v5, v[96:99] offset:4160
  s_mov_b64 exec, s[36:37]
  ds_write_b128 v5, v[100:103] offset:4416
  s_mov_b64 exec, -1
  s_waitcnt vmcnt(4)
  v_lshlrev_b32 v32, 16, v104
  v_and_b32 v33, 0xffff0000, v104
  v_lshlrev_b32 v34, 16, v105
  v_and_b32 v35, 0xffff0000, v105
  v_lshlrev_b32 v36, 16, v106
  v_and_b32 v37, 0xffff0000, v106
  v_lshlrev_b32 v38, 16, v107
  v_and_b32 v39, 0xffff0000, v107
  v_lshlrev_b32 v40, 16, v108
  v_and_b32 v41, 0xffff0000, v108
  v_lshlrev_b32 v42, 16, v109
  v_and_b32 v43, 0xffff0000, v109
  v_lshlrev_b32 v44, 16, v110
  v_and_b32 v45, 0xffff0000, v110
  v_lshlrev_b32 v46, 16, v111
  v_and_b32 v47, 0xffff0000, v111
  v_lshlrev_b32 v48, 16, v112
  v_and_b32 v49, 0xffff0000, v112
  v_lshlrev_b32 v50, 16, v113
  v_and_b32 v51, 0xffff0000, v113
  v_lshlrev_b32 v52, 16, v114
  v_and_b32 v53, 0xffff0000, v114
  v_lshlrev_b32 v54, 16, v115
  v_and_b32 v55, 0xffff0000, v115
  v_lshlrev_b32 v56, 16, v116
  v_and_b32 v57, 0xffff0000, v116
  v_lshlrev_b32 v58, 16, v117
  v_and_b32 v59, 0xffff0000, v117
  v_lshlrev_b32 v60, 16, v118
  v_and_b32 v61, 0xffff0000, v118
  v_lshlrev_b32 v62, 16, v119
  v_and_b32 v63, 0xffff0000, v119
  v_pk_add_f32 v[8:9], v[32:33], v[34:35]
  v_pk_add_f32 v[8:9], v[8:9], v[36:37]
  v_pk_add_f32 v[8:9], v[8:9], v[38:39]
  v_pk_add_f32 v[8:9], v[8:9], v[40:41]
  v_pk_add_f32 v[8:9], v[8:9], v[42:43]
  v_pk_add_f32 v[8:9], v[8:9], v[44:45]
  v_pk_add_f32 v[8:9], v[8:9], v[46:47]
  v_pk_add_f32 v[8:9], v[8:9], v[48:49]
  v_pk_add_f32 v[8:9], v[8:9], v[50:51]
  v_pk_add_f32 v[8:9], v[8:9], v[52:53]
  v_pk_add_f32 v[8:9], v[8:9], v[54:55]
  v_pk_add_f32 v[8:9], v[8:9], v[56:57]
  v_pk_add_f32 v[8:9], v[8:9], v[58:59]
  v_pk_add_f32 v[8:9], v[8:9], v[60:61]
  v_pk_add_f32 v[8:9], v[8:9], v[62:63]
  v_add_f32 v6, v8, v9
  s_nop 1
  v_add_f32_dpp v6, v6, v6 row_ror:8 row_mask:0xf bank_mask:0xf
  s_nop 1
  v_add_f32_dpp v6, v6, v6 row_ror:4 row_mask:0xf bank_mask:0xf
  s_nop 1
  v_add_f32_dpp v6, v6, v6 row_ror:2 row_mask:0xf bank_mask:0xf
  s_nop 1
  v_add_f32_dpp v6, v6, v6 row_ror:1 row_mask:0xf bank_mask:0xf
  v_mul_f32 v6, 0x3b124925, v6
  v_pk_add_f32 v[32:33], v[32:33], v[6:7] op_sel_hi:[1,0] neg_lo:[0,1] neg_hi:[0,1]
  v_pk_add_f32 v[34:35], v[34:35], v[6:7] op_sel_hi:[1,0] neg_lo:[0,1] neg_hi:[0,1]
  v_pk_add_f32 v[36:37], v[36:37], v[6:7] op_sel_hi:[1,0] neg_lo:[0,1] neg_hi:[0,1]
  v_pk_add_f32 v[38:39], v[38:39], v[6:7] op_sel_hi:[1,0] neg_lo:[0,1] neg_hi:[0,1]
  v_pk_add_f32 v[40:41], v[40:41], v[6:7] op_sel_hi:[1,0] neg_lo:[0,1] neg_hi:[0,1]
  v_pk_add_f32 v[42:43], v[42:43], v[6:7] op_sel_hi:[1,0] neg_lo:[0,1] neg_hi:[0,1]
  v_pk_add_f32 v[44:45], v[44:45], v[6:7] op_sel_hi:[1,0] neg_lo:[0,1] neg_hi:[0,1]
  v_pk_add_f32 v[46:47], v[46:47], v[6:7] op_sel_hi:[1,0] neg_lo:[0,1] neg_hi:[0,1]
  v_pk_add_f32 v[48:49], v[48:49], v[6:7] op_sel_hi:[1,0] neg_lo:[0,1] neg_hi:[0,1]
  v_pk_add_f32 v[50:51], v[50:51], v[6:7] op_sel_hi:[1,0] neg_lo:[0,1] neg_hi:[0,1]
  v_pk_add_f32 v[52:53], v[52:53], v[6:7] op_sel_hi:[1,0] neg_lo:[0,1] neg_hi:[0,1]
  v_pk_add_f32 v[54:55], v[54:55], v[6:7] op_sel_hi:[1,0] neg_lo:[0,1] neg_hi:[0,1]
  v_pk_add_f32 v[56:57], v[56:57], v[6:7] op_sel_hi:[1,0] neg_lo:[0,1] neg_hi:[0,1]
  v_pk_add_f32 v[58:59], v[58:59], v[6:7] op_sel_hi:[1,0] neg_lo:[0,1] neg_hi:[0,1]
  v_pk_add_f32 v[60:61], v[60:61], v[6:7] op_sel_hi:[1,0] neg_lo:[0,1] neg_hi:[0,1]
  v_pk_add_f32 v[62:63], v[62:63], v[6:7] op_sel_hi:[1,0] neg_lo:[0,1] neg_hi:[0,1]
  s_mov_b64 exec, s[36:37]
  s_not_b64 exec, exec
  v_mov_b32 v56, 0
  v_mov_b32 v57, 0
  v_mov_b32 v58, 0
  v_mov_b32 v59, 0
  v_mov_b32 v60, 0
  v_mov_b32 v61, 0
  v_mov_b32 v62, 0
  v_mov_b32 v63, 0
  s_mov_b64 exec, -1
  v_pk_mul_f32 v[8:9], v[32:33], v[32:33]
  v_pk_fma_f32 v[8:9], v[34:35], v[34:35], v[8:9]
  v_pk_fma_f32 v[8:9], v[36:37], v[36:37], v[8:9]
  v_pk_fma_f32 v[8:9], v[38:39], v[38:39], v[8:9]
  v_pk_fma_f32 v[8:9], v[40:41], v[40:41], v[8:9]
  v_pk_fma_f32 v[8:9], v[42:43], v[42:43], v[8:9]
  v_pk_fma_f32 v[8:9], v[44:45], v[44:45], v[8:9]
  v_pk_fma_f32 v[8:9], v[46:47], v[46:47], v[8:9]
  v_pk_fma_f32 v[8:9], v[48:49], v[48:49], v[8:9]
  v_pk_fma_f32 v[8:9], v[50:51], v[50:51], v[8:9]
  v_pk_fma_f32 v[8:9], v[52:53], v[52:53], v[8:9]
  v_pk_fma_f32 v[8:9], v[54:55], v[54:55], v[8:9]
  v_pk_fma_f32 v[8:9], v[56:57], v[56:57], v[8:9]
  v_pk_fma_f32 v[8:9], v[58:59], v[58:59], v[8:9]
  v_pk_fma_f32 v[8:9], v[60:61], v[60:61], v[8:9]
  v_pk_fma_f32 v[8:9], v[62:63], v[62:63], v[8:9]
  v_add_f32 v10, v8, v9
  s_nop 1
  v_add_f32_dpp v10, v10, v10 row_ror:8 row_mask:0xf bank_mask:0xf
  s_nop 1
  v_add_f32_dpp v10, v10, v10 row_ror:4 row_mask:0xf bank_mask:0xf
  s_nop 1
  v_add_f32_dpp v10, v10, v10 row_ror:2 row_mask:0xf bank_mask:0xf
  s_nop 1
  v_add_f32_dpp v10, v10, v10 row_ror:1 row_mask:0xf bank_mask:0xf
  v_mov_b32 v6, 0x3727c5ac
  v_fmac_f32 v6, 0x3b124925, v10
  v_rsq_f32 v6, v6
  s_nop 0
  v_pk_mul_f32 v[32:33], v[32:33], v[6:7] op_sel_hi:[1,0]
  v_pk_mul_f32 v[34:35], v[34:35], v[6:7] op_sel_hi:[1,0]
  v_pk_mul_f32 v[36:37], v[36:37], v[6:7] op_sel_hi:[1,0]
  v_pk_mul_f32 v[38:39], v[38:39], v[6:7] op_sel_hi:[1,0]
  v_pk_mul_f32 v[40:41], v[40:41], v[6:7] op_sel_hi:[1,0]
  v_pk_mul_f32 v[42:43], v[42:43], v[6:7] op_sel_hi:[1,0]
  v_pk_mul_f32 v[44:45], v[44:45], v[6:7] op_sel_hi:[1,0]
  v_pk_mul_f32 v[46:47], v[46:47], v[6:7] op_sel_hi:[1,0]
  v_pk_mul_f32 v[48:49], v[48:49], v[6:7] op_sel_hi:[1,0]
  v_pk_mul_f32 v[50:51], v[50:51], v[6:7] op_sel_hi:[1,0]
  v_pk_mul_f32 v[52:53], v[52:53], v[6:7] op_sel_hi:[1,0]
  v_pk_mul_f32 v[54:55], v[54:55], v[6:7] op_sel_hi:[1,0]
  v_pk_mul_f32 v[56:57], v[56:57], v[6:7] op_sel_hi:[1,0]
  v_pk_mul_f32 v[58:59], v[58:59], v[6:7] op_sel_hi:[1,0]
  v_pk_mul_f32 v[60:61], v[60:61], v[6:7] op_sel_hi:[1,0]
  v_pk_mul_f32 v[62:63], v[62:63], v[6:7] op_sel_hi:[1,0]
  v_cvt_pk_bf16_f32 v104, v32, v33
  v_cvt_pk_bf16_f32 v105, v34, v35
  v_cvt_pk_bf16_f32 v106, v36, v37
  v_cvt_pk_bf16_f32 v107, v38, v39
  v_cvt_pk_bf16_f32 v108, v40, v41
  v_cvt_pk_bf16_f32 v109, v42, v43
  v_cvt_pk_bf16_f32 v110, v44, v45
  v_cvt_pk_bf16_f32 v111, v46, v47
  v_cvt_pk_bf16_f32 v112, v48, v49
  v_cvt_pk_bf16_f32 v113, v50, v51
  v_cvt_pk_bf16_f32 v114, v52, v53
  v_cvt_pk_bf16_f32 v115, v54, v55
  v_cvt_pk_bf16_f32 v116, v56, v57
  v_cvt_pk_bf16_f32 v117, v58, v59
  v_cvt_pk_bf16_f32 v118, v60, v61
  v_cvt_pk_bf16_f32 v119, v62, v63
  ds_write_b128 v5, v[104:107] offset:7296
  ds_write_b128 v5, v[108:111] offset:7552
  ds_write_b128 v5, v[112:115] offset:7808
  s_mov_b64 exec, s[36:37]
  ds_write_b128 v5, v[116:119] offset:8064
  s_mov_b64 exec, -1
  s_waitcnt vmcnt(0)
  v_lshlrev_b32 v32, 16, v120
  v_and_b32 v33, 0xffff0000, v120
  v_lshlrev_b32 v34, 16, v121
  v_and_b32 v35, 0xffff0000, v121
  v_lshlrev_b32 v36, 16, v122
  v_and_b32 v37, 0xffff0000, v122
  v_lshlrev_b32 v38, 16, v123
  v_and_b32 v39, 0xffff0000, v123
  v_lshlrev_b32 v40, 16, v124
  v_and_b32 v41, 0xffff0000, v124
  v_lshlrev_b32 v42, 16, v125
  v_and_b32 v43, 0xffff0000, v125
  v_lshlrev_b32 v44, 16, v126
  v_and_b32 v45, 0xffff0000, v126
  v_lshlrev_b32 v46, 16, v127
  v_and_b32 v47, 0xffff0000, v127
  v_lshlrev_b32 v48, 16, v128
  v_and_b32 v49, 0xffff0000, v128
  v_lshlrev_b32 v50, 16, v129
  v_and_b32 v51, 0xffff0000, v129
  v_lshlrev_b32 v52, 16, v130
  v_and_b32 v53, 0xffff0000, v130
  v_lshlrev_b32 v54, 16, v131
  v_and_b32 v55, 0xffff0000, v131
  v_lshlrev_b32 v56, 16, v132
  v_and_b32 v57, 0xffff0000, v132
  v_lshlrev_b32 v58, 16, v133
  v_and_b32 v59, 0xffff0000, v133
  v_lshlrev_b32 v60, 16, v134
  v_and_b32 v61, 0xffff0000, v134
  v_lshlrev_b32 v62, 16, v135
  v_and_b32 v63, 0xffff0000, v135
  v_pk_add_f32 v[8:9], v[32:33], v[34:35]
  v_pk_add_f32 v[8:9], v[8:9], v[36:37]
  v_pk_add_f32 v[8:9], v[8:9], v[38:39]
  v_pk_add_f32 v[8:9], v[8:9], v[40:41]
  v_pk_add_f32 v[8:9], v[8:9], v[42:43]
  v_pk_add_f32 v[8:9], v[8:9], v[44:45]
  v_pk_add_f32 v[8:9], v[8:9], v[46:47]
  v_pk_add_f32 v[8:9], v[8:9], v[48:49]
  v_pk_add_f32 v[8:9], v[8:9], v[50:51]
  v_pk_add_f32 v[8:9], v[8:9], v[52:53]
  v_pk_add_f32 v[8:9], v[8:9], v[54:55]
  v_pk_add_f32 v[8:9], v[8:9], v[56:57]
  v_pk_add_f32 v[8:9], v[8:9], v[58:59]
  v_pk_add_f32 v[8:9], v[8:9], v[60:61]
  v_pk_add_f32 v[8:9], v[8:9], v[62:63]
  v_add_f32 v6, v8, v9
  s_nop 1
  v_add_f32_dpp v6, v6, v6 row_ror:8 row_mask:0xf bank_mask:0xf
  s_nop 1
  v_add_f32_dpp v6, v6, v6 row_ror:4 row_mask:0xf bank_mask:0xf
  s_nop 1
  v_add_f32_dpp v6, v6, v6 row_ror:2 row_mask:0xf bank_mask:0xf
  s_nop 1
  v_add_f32_dpp v6, v6, v6 row_ror:1 row_mask:0xf bank_mask:0xf
  v_mul_f32 v6, 0x3b124925, v6
  v_pk_add_f32 v[32:33], v[32:33], v[6:7] op_sel_hi:[1,0] neg_lo:[0,1] neg_hi:[0,1]
  v_pk_add_f32 v[34:35], v[34:35], v[6:7] op_sel_hi:[1,0] neg_lo:[0,1] neg_hi:[0,1]
  v_pk_add_f32 v[36:37], v[36:37], v[6:7] op_sel_hi:[1,0] neg_lo:[0,1] neg_hi:[0,1]
  v_pk_add_f32 v[38:39], v[38:39], v[6:7] op_sel_hi:[1,0] neg_lo:[0,1] neg_hi:[0,1]
  v_pk_add_f32 v[40:41], v[40:41], v[6:7] op_sel_hi:[1,0] neg_lo:[0,1] neg_hi:[0,1]
  v_pk_add_f32 v[42:43], v[42:43], v[6:7] op_sel_hi:[1,0] neg_lo:[0,1] neg_hi:[0,1]
  v_pk_add_f32 v[44:45], v[44:45], v[6:7] op_sel_hi:[1,0] neg_lo:[0,1] neg_hi:[0,1]
  v_pk_add_f32 v[46:47], v[46:47], v[6:7] op_sel_hi:[1,0] neg_lo:[0,1] neg_hi:[0,1]
  v_pk_add_f32 v[48:49], v[48:49], v[6:7] op_sel_hi:[1,0] neg_lo:[0,1] neg_hi:[0,1]
  v_pk_add_f32 v[50:51], v[50:51], v[6:7] op_sel_hi:[1,0] neg_lo:[0,1] neg_hi:[0,1]
  v_pk_add_f32 v[52:53], v[52:53], v[6:7] op_sel_hi:[1,0] neg_lo:[0,1] neg_hi:[0,1]
  v_pk_add_f32 v[54:55], v[54:55], v[6:7] op_sel_hi:[1,0] neg_lo:[0,1] neg_hi:[0,1]
  v_pk_add_f32 v[56:57], v[56:57], v[6:7] op_sel_hi:[1,0] neg_lo:[0,1] neg_hi:[0,1]
  v_pk_add_f32 v[58:59], v[58:59], v[6:7] op_sel_hi:[1,0] neg_lo:[0,1] neg_hi:[0,1]
  v_pk_add_f32 v[60:61], v[60:61], v[6:7] op_sel_hi:[1,0] neg_lo:[0,1] neg_hi:[0,1]
  v_pk_add_f32 v[62:63], v[62:63], v[6:7] op_sel_hi:[1,0] neg_lo:[0,1] neg_hi:[0,1]
  s_mov_b64 exec, s[36:37]
  s_not_b64 exec, exec
  v_mov_b32 v56, 0
  v_mov_b32 v57, 0
  v_mov_b32 v58, 0
  v_mov_b32 v59, 0
  v_mov_b32 v60, 0
  v_mov_b32 v61, 0
  v_mov_b32 v62, 0
  v_mov_b32 v63, 0
  s_mov_b64 exec, -1
  v_pk_mul_f32 v[8:9], v[32:33], v[32:33]
  v_pk_fma_f32 v[8:9], v[34:35], v[34:35], v[8:9]
  v_pk_fma_f32 v[8:9], v[36:37], v[36:37], v[8:9]
  v_pk_fma_f32 v[8:9], v[38:39], v[38:39], v[8:9]
  v_pk_fma_f32 v[8:9], v[40:41], v[40:41], v[8:9]
  v_pk_fma_f32 v[8:9], v[42:43], v[42:43], v[8:9]
  v_pk_fma_f32 v[8:9], v[44:45], v[44:45], v[8:9]
  v_pk_fma_f32 v[8:9], v[46:47], v[46:47], v[8:9]
  v_pk_fma_f32 v[8:9], v[48:49], v[48:49], v[8:9]
  v_pk_fma_f32 v[8:9], v[50:51], v[50:51], v[8:9]
  v_pk_fma_f32 v[8:9], v[52:53], v[52:53], v[8:9]
  v_pk_fma_f32 v[8:9], v[54:55], v[54:55], v[8:9]
  v_pk_fma_f32 v[8:9], v[56:57], v[56:57], v[8:9]
  v_pk_fma_f32 v[8:9], v[58:59], v[58:59], v[8:9]
  v_pk_fma_f32 v[8:9], v[60:61], v[60:61], v[8:9]
  v_pk_fma_f32 v[8:9], v[62:63], v[62:63], v[8:9]
  v_add_f32 v10, v8, v9
  s_nop 1
  v_add_f32_dpp v10, v10, v10 row_ror:8 row_mask:0xf bank_mask:0xf
  s_nop 1
  v_add_f32_dpp v10, v10, v10 row_ror:4 row_mask:0xf bank_mask:0xf
  s_nop 1
  v_add_f32_dpp v10, v10, v10 row_ror:2 row_mask:0xf bank_mask:0xf
  s_nop 1
  v_add_f32_dpp v10, v10, v10 row_ror:1 row_mask:0xf bank_mask:0xf
  v_mov_b32 v6, 0x3727c5ac
  v_fmac_f32 v6, 0x3b124925, v10
  v_rsq_f32 v6, v6
  s_nop 0
  v_pk_mul_f32 v[32:33], v[32:33], v[6:7] op_sel_hi:[1,0]
  v_pk_mul_f32 v[34:35], v[34:35], v[6:7] op_sel_hi:[1,0]
  v_pk_mul_f32 v[36:37], v[36:37], v[6:7] op_sel_hi:[1,0]
  v_pk_mul_f32 v[38:39], v[38:39], v[6:7] op_sel_hi:[1,0]
  v_pk_mul_f32 v[40:41], v[40:41], v[6:7] op_sel_hi:[1,0]
  v_pk_mul_f32 v[42:43], v[42:43], v[6:7] op_sel_hi:[1,0]
  v_pk_mul_f32 v[44:45], v[44:45], v[6:7] op_sel_hi:[1,0]
  v_pk_mul_f32 v[46:47], v[46:47], v[6:7] op_sel_hi:[1,0]
  v_pk_mul_f32 v[48:49], v[48:49], v[6:7] op_sel_hi:[1,0]
  v_pk_mul_f32 v[50:51], v[50:51], v[6:7] op_sel_hi:[1,0]
  v_pk_mul_f32 v[52:53], v[52:53], v[6:7] op_sel_hi:[1,0]
  v_pk_mul_f32 v[54:55], v[54:55], v[6:7] op_sel_hi:[1,0]
  v_pk_mul_f32 v[56:57], v[56:57], v[6:7] op_sel_hi:[1,0]
  v_pk_mul_f32 v[58:59], v[58:59], v[6:7] op_sel_hi:[1,0]
  v_pk_mul_f32 v[60:61], v[60:61], v[6:7] op_sel_hi:[1,0]
  v_pk_mul_f32 v[62:63], v[62:63], v[6:7] op_sel_hi:[1,0]
  v_cvt_pk_bf16_f32 v120, v32, v33
  v_cvt_pk_bf16_f32 v121, v34, v35
  v_cvt_pk_bf16_f32 v122, v36, v37
  v_cvt_pk_bf16_f32 v123, v38, v39
  v_cvt_pk_bf16_f32 v124, v40, v41
  v_cvt_pk_bf16_f32 v125, v42, v43
  v_cvt_pk_bf16_f32 v126, v44, v45
  v_cvt_pk_bf16_f32 v127, v46, v47
  v_cvt_pk_bf16_f32 v128, v48, v49
  v_cvt_pk_bf16_f32 v129, v50, v51
  v_cvt_pk_bf16_f32 v130, v52, v53
  v_cvt_pk_bf16_f32 v131, v54, v55
  v_cvt_pk_bf16_f32 v132, v56, v57
  v_cvt_pk_bf16_f32 v133, v58, v59
  v_cvt_pk_bf16_f32 v134, v60, v61
  v_cvt_pk_bf16_f32 v135, v62, v63
  ds_write_b128 v5, v[120:123] offset:10944
  ds_write_b128 v5, v[124:127] offset:11200
  ds_write_b128 v5, v[128:131] offset:11456
  s_mov_b64 exec, s[36:37]
  ds_write_b128 v5, v[132:135] offset:11712
  s_mov_b64 exec, -1
  s_waitcnt lgkmcnt(0)
  s_barrier
  v_and_b32 v1, 63, v0
  v_lshlrev_b32 v64, 4, v1
  v_and_b32 v65, 15, v0
  v_bfe_u32 v66, v0, 4, 2
  v_cmp_gt_u32 s[38:39], 2, v66
  v_mul_u32_u24 v67, 912, v65
  v_lshl_add_u32 v67, v66, 4, v67
  s_add_u32 s24, s8, 0
  s_cmp_ge_u32 s24, 14
  s_cselect_b32 s28, 13696, 0
  s_lshl_b32 s29, s24, 6
  s_add_u32 s28, s28, s29
  s_add_u32 s28, s28, 0
  v_add_u32 v1, s28, v67
  ds_read_b128 v[72:75], v1
  s_add_u32 s24, s8, 4
  s_cmp_ge_u32 s24, 14
  s_cselect_b32 s28, 13696, 0
  s_lshl_b32 s29, s24, 6
  s_add_u32 s28, s28, s29
  s_add_u32 s28, s28, 0
  v_add_u32 v1, s28, v67
  ds_read_b128 v[76:79], v1
  s_add_u32 s24, s8, 8
  s_cmp_ge_u32 s24, 14
  s_cselect_b32 s28, 13696, 0
  s_lshl_b32 s29, s24, 6
  s_add_u32 s28, s28, s29
  s_add_u32 s28, s28, 0
  v_add_u32 v1, s28, v67
  ds_read_b128 v[80:83], v1
  s_add_u32 s24, s8, 12
  s_cmp_ge_u32 s24, 14
  s_cselect_b32 s28, 13696, 0
  s_lshl_b32 s29, s24, 6
  s_add_u32 s28, s28, s29
  s_add_u32 s28, s28, 0
  v_add_u32 v1, s28, v67
  ds_read_b128 v[84:87], v1
  s_add_u32 s24, s8, 16
  s_cmp_ge_u32 s24, 14
  s_cselect_b32 s28, 13696, 0
  s_lshl_b32 s29, s24, 6
  s_add_u32 s28, s28, s29
  s_add_u32 s28, s28, 0
  v_add_u32 v1, s28, v67
  ds_read_b128 v[88:91], v1
  s_add_u32 s24, s8, 20
  s_cmp_ge_u32 s24, 14
  s_cselect_b32 s28, 13696, 0
  s_lshl_b32 s29, s24, 6
  s_add_u32 s28, s28, s29
  s_add_u32 s28, s28, 0
  v_add_u32 v1, s28, v67
  ds_read_b128 v[92:95], v1
  s_add_u32 s24, s8, 24
  s_cmp_ge_u32 s24, 14
  s_cselect_b32 s28, 13696, 0
  s_lshl_b32 s29, s24, 6
  s_add_u32 s28, s28, s29
  s_add_u32 s28, s28, 0
  v_add_u32 v1, s28, v67
  ds_read_b128 v[96:99], v1
  s_mul_i32 s24, s8, 224
  s_add_u32 s24, s24, 0
  v_add_u32 v67, s24, v67
  ds_read_b128 v[100:103], v67 offset:0
  ds_read_b128 v[104:107], v67 offset:14592
  ds_read_b128 v[108:111], v67 offset:64
  ds_read_b128 v[112:115], v67 offset:14656
  ds_read_b128 v[116:119], v67 offset:128
  ds_read_b128 v[120:123], v67 offset:14720
  ds_read_b128 v[124:127], v67 offset:192
  ds_read_b128 v[128:131], v67 offset:14784
  s_add_u32 s24, s32, 0
  s_mul_i32 s24, s24, 28672
  s_lshl_b32 s25, s8, 10
  s_add_u32 s24, s24, s25
  s_add_u32 s26, s4, 44564480
  s_addc_u32 s27, s5, 0
  s_add_u32 s26, s26, s24
  s_addc_u32 s27, s27, 0
  s_waitcnt lgkmcnt(8)
  global_store_dwordx4 v64, v[72:75], s[26:27] sc1
  s_add_u32 s26, s26, 4096
  s_addc_u32 s27, s27, 0
  global_store_dwordx4 v64, v[76:79], s[26:27] sc1
  s_add_u32 s26, s26, 4096
  s_addc_u32 s27, s27, 0
  global_store_dwordx4 v64, v[80:83], s[26:27] sc1
  s_add_u32 s26, s26, 4096
  s_addc_u32 s27, s27, 0
  global_store_dwordx4 v64, v[84:87], s[26:27] sc1
  s_add_u32 s26, s26, 4096
  s_addc_u32 s27, s27, 0
  global_store_dwordx4 v64, v[88:91], s[26:27] sc1
  s_add_u32 s26, s26, 4096
  s_addc_u32 s27, s27, 0
  global_store_dwordx4 v64, v[92:95], s[26:27] sc1
  s_add_u32 s26, s26, 4096
  s_addc_u32 s27, s27, 0
  global_store_dwordx4 v64, v[96:99], s[26:27] sc1
  v_mul_u32_u24 v1, 912, v65
  v_lshl_add_u32 v1, v66, 3, v1
  s_mul_i32 s24, s8, 224
  s_add_u32 s24, s24, 192
  v_add_u32 v1, s24, v1
  ds_read_b64 v[160:161], v1 offset:0
  ds_read_b64 v[162:163], v1 offset:14592
  s_add_u32 s24, s32, 0
  s_lshl_b32 s24, s24, 12
  s_lshl_b32 s25, s8, 10
  s_add_u32 s24, s24, s25
  s_add_u32 s28, s4, 44302336
  s_addc_u32 s29, s5, 0
  s_add_u32 s28, s28, s24
  s_addc_u32 s29, s29, 0
  v_lshrrev_b32 v1, 1, v64
  s_waitcnt lgkmcnt(0)
  global_store_dwordx2 v1, v[160:161], s[28:29] offset:0 sc1
  global_store_dwordx2 v1, v[162:163], s[28:29] offset:512 sc1
  v_and_b32 v1, 7, v0
  s_lshl_b32 s24, s8, 3
  v_add_u32 v1, s24, v1
  v_mul_u32_u24 v2, 912, v1
  v_lshl_add_u32 v2, v66, 5, v2
  v_bfe_u32 v1, v0, 3, 1
  v_lshl_add_u32 v2, v1, 2, v2
  v_add_u32 v2, 0, v2
  s_waitcnt lgkmcnt(0)
  v_add_u32 v1, 0, v2
  ds_read2_b32 v[132:133], v1 offset0:0 offset1:2
  ds_read2_b32 v[134:135], v1 offset0:4 offset1:6
  v_add_u32 v1, 128, v2
  ds_read2_b32 v[136:137], v1 offset0:0 offset1:2
  ds_read2_b32 v[138:139], v1 offset0:4 offset1:6
  v_add_u32 v1, 256, v2
  ds_read2_b32 v[140:141], v1 offset0:0 offset1:2
  ds_read2_b32 v[142:143], v1 offset0:4 offset1:6
  v_add_u32 v1, 384, v2
  ds_read2_b32 v[144:145], v1 offset0:0 offset1:2
  ds_read2_b32 v[146:147], v1 offset0:4 offset1:6
  v_add_u32 v1, 512, v2
  ds_read2_b32 v[148:149], v1 offset0:0 offset1:2
  ds_read2_b32 v[150:151], v1 offset0:4 offset1:6
  v_add_u32 v1, 640, v2
  ds_read2_b32 v[152:153], v1 offset0:0 offset1:2
  ds_read2_b32 v[154:155], v1 offset0:4 offset1:6
  v_add_u32 v1, 768, v2
  ds_read2_b32 v[156:157], v1 offset0:0 offset1:2
  ds_read2_b32 v[158:159], v1 offset0:4 offset1:6
  s_add_u32 s24, s32, 0
  s_lshl_b32 s24, s24, 15
  s_lshl_b32 s25, s8, 13
  s_add_u32 s24, s24, s25
  s_add_u32 s26, s4, 42205184
  s_addc_u32 s27, s5, 0
  s_add_u32 s26, s26, s24
  s_addc_u32 s27, s27, 0
  v_swap_b32 v101, v102
  global_store_dwordx4 v64, v[100:103], s[26:27] offset:0 sc1
  v_swap_b32 v105, v106
  global_store_dwordx4 v64, v[104:107], s[26:27] offset:1024 sc1
  v_swap_b32 v109, v110
  global_store_dwordx4 v64, v[108:111], s[26:27] offset:2048 sc1
  v_swap_b32 v113, v114
  global_store_dwordx4 v64, v[112:115], s[26:27] offset:3072 sc1
  v_swap_b32 v117, v118
  s_add_u32 s26, s26, 4096
  s_addc_u32 s27, s27, 0
  global_store_dwordx4 v64, v[116:119], s[26:27] offset:0 sc1
  v_swap_b32 v121, v122
  global_store_dwordx4 v64, v[120:123], s[26:27] offset:1024 sc1
  v_swap_b32 v125, v126
  v_cndmask_b32 v124, 0, v124, s[38:39]
  v_cndmask_b32 v125, 0, v125, s[38:39]
  v_cndmask_b32 v126, 0, v126, s[38:39]
  v_cndmask_b32 v127, 0, v127, s[38:39]
  global_store_dwordx4 v64, v[124:127], s[26:27] offset:2048 sc1
  v_swap_b32 v129, v130
  v_cndmask_b32 v128, 0, v128, s[38:39]
  v_cndmask_b32 v129, 0, v129, s[38:39]
  v_cndmask_b32 v130, 0, v130, s[38:39]
  v_cndmask_b32 v131, 0, v131, s[38:39]
  global_store_dwordx4 v64, v[128:131], s[26:27] offset:3072 sc1
  s_add_u32 s24, s32, 0
  s_lshl_b32 s24, s24, 2
  s_add_u32 s24, s24, s8
  s_mul_i32 s24, s24, 7168
  s_add_u32 s26, s4, 46399488
  s_addc_u32 s27, s5, 0
  s_add_u32 s26, s26, s24
  s_addc_u32 s27, s27, 0
  s_waitcnt lgkmcnt(0)
  global_store_dwordx4 v64, v[132:135], s[26:27] offset:0 sc1
  global_store_dwordx4 v64, v[136:139], s[26:27] offset:1024 sc1
  global_store_dwordx4 v64, v[140:143], s[26:27] offset:2048 sc1
  global_store_dwordx4 v64, v[144:147], s[26:27] offset:3072 sc1
  s_add_u32 s26, s26, 4096
  s_addc_u32 s27, s27, 0
  global_store_dwordx4 v64, v[148:151], s[26:27] offset:0 sc1
  global_store_dwordx4 v64, v[152:155], s[26:27] offset:1024 sc1
  global_store_dwordx4 v64, v[156:159], s[26:27] offset:2048 sc1
  s_nop 1
  v_mul_u32_u24 v67, 912, v65
  v_lshl_add_u32 v67, v66, 4, v67
  s_add_u32 s24, s8, 0
  s_cmp_ge_u32 s24, 14
  s_cselect_b32 s28, 13696, 0
  s_lshl_b32 s29, s24, 6
  s_add_u32 s28, s28, s29
  s_add_u32 s28, s28, 29184
  v_add_u32 v1, s28, v67
  ds_read_b128 v[72:75], v1
  s_add_u32 s24, s8, 4
  s_cmp_ge_u32 s24, 14
  s_cselect_b32 s28, 13696, 0
  s_lshl_b32 s29, s24, 6
  s_add_u32 s28, s28, s29
  s_add_u32 s28, s28, 29184
  v_add_u32 v1, s28, v67
  ds_read_b128 v[76:79], v1
  s_add_u32 s24, s8, 8
  s_cmp_ge_u32 s24, 14
  s_cselect_b32 s28, 13696, 0
  s_lshl_b32 s29, s24, 6
  s_add_u32 s28, s28, s29
  s_add_u32 s28, s28, 29184
  v_add_u32 v1, s28, v67
  ds_read_b128 v[80:83], v1
  s_add_u32 s24, s8, 12
  s_cmp_ge_u32 s24, 14
  s_cselect_b32 s28, 13696, 0
  s_lshl_b32 s29, s24, 6
  s_add_u32 s28, s28, s29
  s_add_u32 s28, s28, 29184
  v_add_u32 v1, s28, v67
  ds_read_b128 v[84:87], v1
  s_add_u32 s24, s8, 16
  s_cmp_ge_u32 s24, 14
  s_cselect_b32 s28, 13696, 0
  s_lshl_b32 s29, s24, 6
  s_add_u32 s28, s28, s29
  s_add_u32 s28, s28, 29184
  v_add_u32 v1, s28, v67
  ds_read_b128 v[88:91], v1
  s_add_u32 s24, s8, 20
  s_cmp_ge_u32 s24, 14
  s_cselect_b32 s28, 13696, 0
  s_lshl_b32 s29, s24, 6
  s_add_u32 s28, s28, s29
  s_add_u32 s28, s28, 29184
  v_add_u32 v1, s28, v67
  ds_read_b128 v[92:95], v1
  s_add_u32 s24, s8, 24
  s_cmp_ge_u32 s24, 14
  s_cselect_b32 s28, 13696, 0
  s_lshl_b32 s29, s24, 6
  s_add_u32 s28, s28, s29
  s_add_u32 s28, s28, 29184
  v_add_u32 v1, s28, v67
  ds_read_b128 v[96:99], v1
  s_mul_i32 s24, s8, 224
  s_add_u32 s24, s24, 29184
  v_add_u32 v67, s24, v67
  ds_read_b128 v[100:103], v67 offset:0
  ds_read_b128 v[104:107], v67 offset:14592
  ds_read_b128 v[108:111], v67 offset:64
  ds_read_b128 v[112:115], v67 offset:14656
  ds_read_b128 v[116:119], v67 offset:128
  ds_read_b128 v[120:123], v67 offset:14720
  ds_read_b128 v[124:127], v67 offset:192
  ds_read_b128 v[128:131], v67 offset:14784
  s_add_u32 s24, s32, 1
  s_mul_i32 s24, s24, 28672
  s_lshl_b32 s25, s8, 10
  s_add_u32 s24, s24, s25
  s_add_u32 s26, s4, 44564480
  s_addc_u32 s27, s5, 0
  s_add_u32 s26, s26, s24
  s_addc_u32 s27, s27, 0
  s_waitcnt lgkmcnt(8)
  global_store_dwordx4 v64, v[72:75], s[26:27] sc1
  s_add_u32 s26, s26, 4096
  s_addc_u32 s27, s27, 0
  global_store_dwordx4 v64, v[76:79], s[26:27] sc1
  s_add_u32 s26, s26, 4096
  s_addc_u32 s27, s27, 0
  global_store_dwordx4 v64, v[80:83], s[26:27] sc1
  s_add_u32 s26, s26, 4096
  s_addc_u32 s27, s27, 0
  global_store_dwordx4 v64, v[84:87], s[26:27] sc1
  s_add_u32 s26, s26, 4096
  s_addc_u32 s27, s27, 0
  global_store_dwordx4 v64, v[88:91], s[26:27] sc1
  s_add_u32 s26, s26, 4096
  s_addc_u32 s27, s27, 0
  global_store_dwordx4 v64, v[92:95], s[26:27] sc1
  s_add_u32 s26, s26, 4096
  s_addc_u32 s27, s27, 0
  global_store_dwordx4 v64, v[96:99], s[26:27] sc1
  v_mul_u32_u24 v1, 912, v65
  v_lshl_add_u32 v1, v66, 3, v1
  s_mul_i32 s24, s8, 224
  s_add_u32 s24, s24, 29376
  v_add_u32 v1, s24, v1
  ds_read_b64 v[160:161], v1 offset:0
  ds_read_b64 v[162:163], v1 offset:14592
  s_add_u32 s24, s32, 1
  s_lshl_b32 s24, s24, 12
  s_lshl_b32 s25, s8, 10
  s_add_u32 s24, s24, s25
  s_add_u32 s28, s4, 44302336
  s_addc_u32 s29, s5, 0
  s_add_u32 s28, s28, s24
  s_addc_u32 s29, s29, 0
  v_lshrrev_b32 v1, 1, v64
  s_waitcnt lgkmcnt(0)
  global_store_dwordx2 v1, v[160:161], s[28:29] offset:0 sc1
  global_store_dwordx2 v1, v[162:163], s[28:29] offset:512 sc1
  v_and_b32 v1, 7, v0
  s_lshl_b32 s24, s8, 3
  v_add_u32 v1, s24, v1
  v_mul_u32_u24 v2, 912, v1
  v_lshl_add_u32 v2, v66, 5, v2
  v_bfe_u32 v1, v0, 3, 1
  v_lshl_add_u32 v2, v1, 2, v2
  v_add_u32 v2, 29184, v2
  s_waitcnt lgkmcnt(0)
  v_add_u32 v1, 0, v2
  ds_read2_b32 v[132:133], v1 offset0:0 offset1:2
  ds_read2_b32 v[134:135], v1 offset0:4 offset1:6
  v_add_u32 v1, 128, v2
  ds_read2_b32 v[136:137], v1 offset0:0 offset1:2
  ds_read2_b32 v[138:139], v1 offset0:4 offset1:6
  v_add_u32 v1, 256, v2
  ds_read2_b32 v[140:141], v1 offset0:0 offset1:2
  ds_read2_b32 v[142:143], v1 offset0:4 offset1:6
  v_add_u32 v1, 384, v2
  ds_read2_b32 v[144:145], v1 offset0:0 offset1:2
  ds_read2_b32 v[146:147], v1 offset0:4 offset1:6
  v_add_u32 v1, 512, v2
  ds_read2_b32 v[148:149], v1 offset0:0 offset1:2
  ds_read2_b32 v[150:151], v1 offset0:4 offset1:6
  v_add_u32 v1, 640, v2
  ds_read2_b32 v[152:153], v1 offset0:0 offset1:2
  ds_read2_b32 v[154:155], v1 offset0:4 offset1:6
  v_add_u32 v1, 768, v2
  ds_read2_b32 v[156:157], v1 offset0:0 offset1:2
  ds_read2_b32 v[158:159], v1 offset0:4 offset1:6
  s_add_u32 s24, s32, 1
  s_lshl_b32 s24, s24, 15
  s_lshl_b32 s25, s8, 13
  s_add_u32 s24, s24, s25
  s_add_u32 s26, s4, 42205184
  s_addc_u32 s27, s5, 0
  s_add_u32 s26, s26, s24
  s_addc_u32 s27, s27, 0
  v_swap_b32 v101, v102
  global_store_dwordx4 v64, v[100:103], s[26:27] offset:0 sc1
  v_swap_b32 v105, v106
  global_store_dwordx4 v64, v[104:107], s[26:27] offset:1024 sc1
  v_swap_b32 v109, v110
  global_store_dwordx4 v64, v[108:111], s[26:27] offset:2048 sc1
  v_swap_b32 v113, v114
  global_store_dwordx4 v64, v[112:115], s[26:27] offset:3072 sc1
  v_swap_b32 v117, v118
  s_add_u32 s26, s26, 4096
  s_addc_u32 s27, s27, 0
  global_store_dwordx4 v64, v[116:119], s[26:27] offset:0 sc1
  v_swap_b32 v121, v122
  global_store_dwordx4 v64, v[120:123], s[26:27] offset:1024 sc1
  v_swap_b32 v125, v126
  v_cndmask_b32 v124, 0, v124, s[38:39]
  v_cndmask_b32 v125, 0, v125, s[38:39]
  v_cndmask_b32 v126, 0, v126, s[38:39]
  v_cndmask_b32 v127, 0, v127, s[38:39]
  global_store_dwordx4 v64, v[124:127], s[26:27] offset:2048 sc1
  v_swap_b32 v129, v130
  v_cndmask_b32 v128, 0, v128, s[38:39]
  v_cndmask_b32 v129, 0, v129, s[38:39]
  v_cndmask_b32 v130, 0, v130, s[38:39]
  v_cndmask_b32 v131, 0, v131, s[38:39]
  global_store_dwordx4 v64, v[128:131], s[26:27] offset:3072 sc1
  s_add_u32 s24, s32, 1
  s_lshl_b32 s24, s24, 2
  s_add_u32 s24, s24, s8
  s_mul_i32 s24, s24, 7168
  s_add_u32 s26, s4, 46399488
  s_addc_u32 s27, s5, 0
  s_add_u32 s26, s26, s24
  s_addc_u32 s27, s27, 0
  s_waitcnt lgkmcnt(0)
  global_store_dwordx4 v64, v[132:135], s[26:27] offset:0 sc1
  global_store_dwordx4 v64, v[136:139], s[26:27] offset:1024 sc1
  global_store_dwordx4 v64, v[140:143], s[26:27] offset:2048 sc1
  global_store_dwordx4 v64, v[144:147], s[26:27] offset:3072 sc1
  s_add_u32 s26, s26, 4096
  s_addc_u32 s27, s27, 0
  global_store_dwordx4 v64, v[148:151], s[26:27] offset:0 sc1
  global_store_dwordx4 v64, v[152:155], s[26:27] offset:1024 sc1
  global_store_dwordx4 v64, v[156:159], s[26:27] offset:2048 sc1
  s_nop 1
  s_cmp_lg_u32 s9, 255
  s_cbranch_scc1 L_nomem0_13
  s_cmp_lg_u32 s8, 0
  s_cbranch_scc1 L_nomem0_13
  v_and_b32 v1, 7, v0
  v_mul_u32_u24 v67, 896, v1
  v_lshl_add_u32 v67, v66, 5, v67
  v_bfe_u32 v1, v0, 3, 1
  v_lshl_add_u32 v67, v1, 2, v67
  s_add_u32 s26, s4, 48234496
  s_addc_u32 s27, s5, 0
  global_load_dword v72, v67, s[12:13] offset:0
  global_load_dword v73, v67, s[12:13] offset:8
  global_load_dword v74, v67, s[12:13] offset:16
  global_load_dword v75, v67, s[12:13] offset:24
  global_load_dword v76, v67, s[12:13] offset:128
  global_load_dword v77, v67, s[12:13] offset:136
  global_load_dword v78, v67, s[12:13] offset:144
  global_load_dword v79, v67, s[12:13] offset:152
  global_load_dword v80, v67, s[12:13] offset:256
  global_load_dword v81, v67, s[12:13] offset:264
  global_load_dword v82, v67, s[12:13] offset:272
  global_load_dword v83, v67, s[12:13] offset:280
  global_load_dword v84, v67, s[12:13] offset:384
  global_load_dword v85, v67, s[12:13] offset:392
  global_load_dword v86, v67, s[12:13] offset:400
  global_load_dword v87, v67, s[12:13] offset:408
  global_load_dword v88, v67, s[12:13] offset:512
  global_load_dword v89, v67, s[12:13] offset:520
  global_load_dword v90, v67, s[12:13] offset:528
  global_load_dword v91, v67, s[12:13] offset:536
  global_load_dword v92, v67, s[12:13] offset:640
  global_load_dword v93, v67, s[12:13] offset:648
  global_load_dword v94, v67, s[12:13] offset:656
  global_load_dword v95, v67, s[12:13] offset:664
  global_load_dword v96, v67, s[12:13] offset:768
  global_load_dword v97, v67, s[12:13] offset:776
  global_load_dword v98, v67, s[12:13] offset:784
  global_load_dword v99, v67, s[12:13] offset:792
  s_waitcnt vmcnt(0)
  v_min_u32 v72, -2, v72
  v_min_u32 v73, -2, v73
  v_min_u32 v74, -2, v74
  v_min_u32 v75, -2, v75
  global_store_dwordx4 v64, v[72:75], s[26:27] offset:0 sc1
  v_min_u32 v76, -2, v76
  v_min_u32 v77, -2, v77
  v_min_u32 v78, -2, v78
  v_min_u32 v79, -2, v79
  global_store_dwordx4 v64, v[76:79], s[26:27] offset:1024 sc1
  v_min_u32 v80, -2, v80
  v_min_u32 v81, -2, v81
  v_min_u32 v82, -2, v82
  v_min_u32 v83, -2, v83
  global_store_dwordx4 v64, v[80:83], s[26:27] offset:2048 sc1
  v_min_u32 v84, -2, v84
  v_min_u32 v85, -2, v85
  v_min_u32 v86, -2, v86
  v_min_u32 v87, -2, v87
  global_store_dwordx4 v64, v[84:87], s[26:27] offset:3072 sc1
  v_min_u32 v88, -2, v88
  v_min_u32 v89, -2, v89
  v_min_u32 v90, -2, v90
  v_min_u32 v91, -2, v91
  s_add_u32 s26, s26, 4096
  s_addc_u32 s27, s27, 0
  global_store_dwordx4 v64, v[88:91], s[26:27] offset:0 sc1
  v_min_u32 v92, -2, v92
  v_min_u32 v93, -2, v93
  v_min_u32 v94, -2, v94
  v_min_u32 v95, -2, v95
  global_store_dwordx4 v64, v[92:95], s[26:27] offset:1024 sc1
  v_min_u32 v96, -2, v96
  v_min_u32 v97, -2, v97
  v_min_u32 v98, -2, v98
  v_min_u32 v99, -2, v99
  global_store_dwordx4 v64, v[96:99], s[26:27] offset:2048 sc1
L_nomem0_13:
  s_lshl_b32 s24, s9, 8
  v_add_u32 v2, s24, v0
  v_mov_b32 v4, -1
  v_mov_b32 v5, -1
  v_mov_b32 v6, -1
  v_mov_b32 v7, -1
  s_add_u32 s26, s4, 48241664
  s_addc_u32 s27, s5, 0
  v_lshlrev_b32 v3, 4, v2
  global_store_dwordx4 v3, v[4:7], s[26:27] sc1
  s_add_u32 s26, s26, 1048576
  s_addc_u32 s27, s27, 0
  v_lshlrev_b32 v3, 4, v2
  global_store_dwordx4 v3, v[4:7], s[26:27] sc1
  s_add_u32 s26, s26, 1048576
  s_addc_u32 s27, s27, 0
  v_lshlrev_b32 v3, 4, v2
  global_store_dwordx4 v3, v[4:7], s[26:27] sc1
  s_add_u32 s26, s26, 1048576
  s_addc_u32 s27, s27, 0
  v_lshlrev_b32 v3, 4, v2
  global_store_dwordx4 v3, v[4:7], s[26:27] sc1
  s_add_u32 s26, s26, 1048576
  s_addc_u32 s27, s27, 0
  v_lshlrev_b32 v3, 4, v2
  global_store_dwordx4 v3, v[4:7], s[26:27] sc1
  s_add_u32 s26, s26, 1048576
  s_addc_u32 s27, s27, 0
  v_lshlrev_b32 v3, 4, v2
  global_store_dwordx4 v3, v[4:7], s[26:27] sc1
  s_add_u32 s26, s26, 1048576
  s_addc_u32 s27, s27, 0
  v_lshlrev_b32 v3, 4, v2
  global_store_dwordx4 v3, v[4:7], s[26:27] sc1
  s_add_u32 s26, s26, 1048576
  s_addc_u32 s27, s27, 0
  v_lshlrev_b32 v3, 4, v2
  global_store_dwordx4 v3, v[4:7], s[26:27] sc1
  s_add_u32 s26, s26, 1048576
  s_addc_u32 s27, s27, 0
  v_lshlrev_b32 v3, 4, v2
  global_store_dwordx4 v3, v[4:7], s[26:27] sc1
  s_add_u32 s26, s26, 1048576
  s_addc_u32 s27, s27, 0
  v_cmp_gt_u32 vcc, 15936, v2
  v_lshlrev_b32 v3, 4, v2
  s_and_saveexec_b64 s[22:23], vcc
  s_cbranch_execz L_nz_14
  global_store_dwordx4 v3, v[4:7], s[26:27] sc1
L_nz_14:
  s_mov_b64 exec, s[22:23]
  s_add_u32 s26, s26, 1048576
  s_addc_u32 s27, s27, 0
L_sequential_preLN__memory_aug_recurrent_mem_tr__mixer_token_mlp__prompt_kernel_p1fin:
  s_mov_b64 exec, -1
  s_cmp_lg_u32 s9, 0
  s_cbranch_scc1 L_nc_15
  v_lshlrev_b32 v3, 4, v0
  v_mov_b32 v4, 0
  v_mov_b32 v5, 0
  v_mov_b32 v6, 0
  v_mov_b32 v7, 0
  s_add_u32 s26, s4, 61517824
  s_addc_u32 s27, s5, 0
  global_store_dwordx4 v3, v[4:7], s[26:27] sc1
  s_add_u32 s26, s26, 4096
  s_addc_u32 s27, s27, 0
  global_store_dwordx4 v3, v[4:7], s[26:27] sc1
  s_add_u32 s26, s26, 4096
  s_addc_u32 s27, s27, 0
  global_store_dwordx4 v3, v[4:7], s[26:27] sc1
  s_add_u32 s26, s26, 4096
  s_addc_u32 s27, s27, 0
  global_store_dwordx4 v3, v[4:7], s[26:27] sc1
  s_add_u32 s26, s26, 4096
  s_addc_u32 s27, s27, 0
L_nc_15:
  s_mov_b64 exec, -1
  s_waitcnt vmcnt(0) lgkmcnt(0)
  s_barrier
  s_cmp_lg_u32 s8, 0
  s_cbranch_scc1 L_rkw_16
  s_mov_b32 s11, 0
  v_mov_b32 v1, 8
  v_mov_b32 v2, v179
  v_cmp_eq_u32 vcc, 0, v2
  s_cbranch_vccz L_ng_18
L_np_17:
  global_load_dword v2, v1, s[6:7] sc1
  s_waitcnt vmcnt(0)
  v_cmp_eq_u32 vcc, 0, v2
  s_cbranch_vccz L_ng_18
  s_add_u32 s11, s11, 1
  s_cmp_gt_u32 s11, 262144
  s_cbranch_scc1 L_abort
  s_sleep 1
  s_branch L_np_17
L_ng_18:
  v_cmp_eq_u32 vcc, 0, v0
  s_and_saveexec_b64 s[20:21], vcc
  s_and_b32 s24, s2, 31
  s_lshl_b32 s24, s24, 7
  s_lshr_b32 s25, s2, 5
  s_lshl_b32 s25, s25, 2
  s_add_u32 s24, s24, s25
  s_add_u32 s24, s24, 61513728
  v_mov_b32 v1, s24
  global_store_dword v1, v2, s[4:5] sc1
  v_mov_b32 v1, 135176
  ds_write_b32 v1, v2
  v_mov_b32 v1, 135172
  ds_write_b32 v1, v191
  v_mov_b32 v2, 135168
  v_mov_b32 v1, 0
  ds_write_b32 v2, v1
  s_waitcnt lgkmcnt(0)
  s_mov_b64 exec, s[20:21]
L_rkw_16:
  s_barrier
  v_mov_b32 v1, 135172
  ds_read_b32 v3, v1
  v_mov_b32 v1, 135176
  ds_read_b32 v4, v1
  s_waitcnt lgkmcnt(0)
  s_nop 0
  v_readfirstlane_b32 s64, v3
  v_readfirstlane_b32 s88, v4
  s_nop 3
  s_barrier
L_fast_entry:
  s_mov_b32 s9, s64
  s_mov_b32 s38, 0
  s_cmp_ge_u32 s9, 32
  s_cbranch_scc1 L_recheck
  s_cmp_eq_u32 s68, 0
  s_cbranch_scc1 L_chain
  s_cmp_ge_u32 s68, 5
  s_cbranch_scc1 L_free
  s_sub_u32 s65, s68, 1
  s_cmp_eq_u32 s9, 31
  s_cbranch_scc1 L_qF
  s_cmp_eq_u32 s9, 30
  s_cbranch_scc1 L_qL
  s_cmp_ge_u32 s9, 16
  s_cbranch_scc1 L_qB
  v_and_b32 v5, 31, v0
  v_lshlrev_b32 v5, 7, v5
  v_lshrrev_b32 v6, 5, v0
  v_lshl_add_u32 v6, v6, 2, v5
  v_add_u32 v6, 61513728, v6
  s_mov_b32 s11, 0
L_wa_19:
  global_load_dword v7, v6, s[4:5] sc1
  s_waitcnt vmcnt(0)
  v_cmp_ne_u32 vcc, s88, v7
  s_cbranch_vccz L_wag_20
  s_add_u32 s11, s11, 1
  s_cmp_gt_u32 s11, 262144
  s_cbranch_scc1 L_abort
  s_branch L_wa_19
L_wag_20:
  v_and_b32 v6, 31, v0
  v_lshlrev_b32 v6, 7, v6
  v_lshrrev_b32 v7, 5, v0
  v_lshl_add_u32 v7, v7, 2, v6
  v_add_u32 v7, 61513728, v7
  global_load_dword v7, v7, s[4:5] sc1
  v_and_b32 v4, 7, v0
  v_lshlrev_b32 v4, 5, v4
  global_load_dword v4, v4, s[6:7] sc1
  s_waitcnt vmcnt(0)
  v_cmp_ne_u32 vcc, 32, v4
  s_cbranch_vccnz L_cfbad_22
  v_cmp_ne_u32 vcc, s88, v7
  s_cbranch_vccnz L_cfbad_22
  s_branch L_cfok_21
L_cfbad_22:
  v_mov_b32 v4, 135168
  ds_write_b32 v4, v4
L_cfok_21:
  s_waitcnt lgkmcnt(0)
  s_barrier
  v_mov_b32 v4, 135168
  ds_read_b32 v4, v4
  s_waitcnt lgkmcnt(0)
  s_nop 0
  v_readfirstlane_b32 s14, v4
  s_nop 3
  s_cmp_lg_u32 s14, 0
  s_cbranch_scc1 L_recheck
  s_mov_b32 s11, 0
  v_mov_b32 v1, 1024
L_vxw_23:
  global_load_dword v2, v1, s[86:87] sc1
  s_waitcnt vmcnt(0)
  v_cmp_gt_u32 vcc, 84, v2
  s_cbranch_vccz L_vxg_24
  s_add_u32 s11, s11, 1
  s_cmp_gt_u32 s11, 262144
  s_cbranch_scc1 L_abort
  s_sleep 8
  s_branch L_vxw_23
L_vxg_24:
  s_cmp_lt_u32 s65, 2
  s_cbranch_scc1 L_stg_25
  s_add_u32 s16, s4, 48721920
  s_addc_u32 s17, s5, 0
  s_mov_b32 s11, 0
  v_mov_b32 v1, 0
L_stgp_26:
  global_load_dword v2, v1, s[16:17] sc1
  s_waitcnt vmcnt(0)
  v_cmp_eq_u32 vcc, -1, v2
  s_cbranch_vccz L_stg_25
  s_add_u32 s11, s11, 1
  s_cmp_gt_u32 s11, 262144
  s_cbranch_scc1 L_abort
  s_sleep 8
  s_branch L_stgp_26
L_stg_25:
  v_and_b32 v78, 63, v0
  v_lshlrev_b32 v113, 4, v78
  s_lshl_b32 s14, s8, 10
  v_add_u32 v114, s14, v113
  s_add_u32 s14, s8, 4
  s_min_u32 s14, s14, 6
  s_lshl_b32 s14, s14, 10
  v_add_u32 v115, s14, v113
  v_and_b32 v78, 8, v0
  v_cmp_eq_u32 vcc, 0, v78
  v_mov_b32 v112, 0xeeeeeeee
  v_mov_b32 v78, 0x44444444
  s_nop 1
  v_cndmask_b32 v112, v112, v78, vcc
  s_and_b32 s14, s8, 1
  s_mul_i32 s14, s14, 3072
  v_add_u32 v114, s14, v113
  s_mul_i32 s14, s9, 401408
  s_mul_i32 s15, s8, 100352
  s_add_u32 s14, s14, s15
  s_add_u32 s16, s4, 0
  s_addc_u32 s17, s5, 0
  s_add_u32 s16, s16, s14
  s_addc_u32 s17, s17, 0
  global_load_dwordx4 a[0:3], v113, s[16:17] offset:0
  global_load_dwordx4 a[4:7], v113, s[16:17] offset:1024
  global_load_dwordx4 a[8:11], v113, s[16:17] offset:2048
  global_load_dwordx4 a[12:15], v113, s[16:17] offset:3072
  s_add_u32 s16, s16, 4096
  s_addc_u32 s17, s17, 0
  global_load_dwordx4 a[16:19], v113, s[16:17] offset:0
  global_load_dwordx4 a[20:23], v113, s[16:17] offset:1024
  global_load_dwordx4 a[24:27], v113, s[16:17] offset:2048
  global_load_dwordx4 a[28:31], v113, s[16:17] offset:3072
  s_add_u32 s16, s16, 4096
  s_addc_u32 s17, s17, 0
  global_load_dwordx4 a[32:35], v113, s[16:17] offset:0
  global_load_dwordx4 a[36:39], v113, s[16:17] offset:1024
  global_load_dwordx4 a[40:43], v113, s[16:17] offset:2048
  global_load_dwordx4 a[44:47], v113, s[16:17] offset:3072
  s_add_u32 s16, s16, 4096
  s_addc_u32 s17, s17, 0
  global_load_dwordx4 a[48:51], v113, s[16:17] offset:0
  global_load_dwordx4 a[52:55], v113, s[16:17] offset:1024
  global_load_dwordx4 a[56:59], v113, s[16:17] offset:2048
  global_load_dwordx4 a[60:63], v113, s[16:17] offset:3072
  s_add_u32 s16, s16, 4096
  s_addc_u32 s17, s17, 0
  global_load_dwordx4 a[64:67], v113, s[16:17] offset:0
  global_load_dwordx4 a[68:71], v113, s[16:17] offset:1024
  global_load_dwordx4 a[72:75], v113, s[16:17] offset:2048
  global_load_dwordx4 a[76:79], v113, s[16:17] offset:3072
  s_add_u32 s16, s16, 4096
  s_addc_u32 s17, s17, 0
  global_load_dwordx4 a[80:83], v113, s[16:17] offset:0
  global_load_dwordx4 a[84:87], v113, s[16:17] offset:1024
  global_load_dwordx4 a[88:91], v113, s[16:17] offset:2048
  global_load_dwordx4 a[92:95], v113, s[16:17] offset:3072
  s_add_u32 s16, s16, 4096
  s_addc_u32 s17, s17, 0
  global_load_dwordx4 a[96:99], v113, s[16:17] offset:0
  global_load_dwordx4 a[100:103], v113, s[16:17] offset:1024
  global_load_dwordx4 a[104:107], v113, s[16:17] offset:2048
  global_load_dwordx4 a[108:111], v113, s[16:17] offset:3072
  s_add_u32 s16, s16, 4096
  s_addc_u32 s17, s17, 0
  global_load_dwordx4 a[112:115], v113, s[16:17] offset:0
  global_load_dwordx4 a[116:119], v113, s[16:17] offset:1024
  global_load_dwordx4 a[120:123], v113, s[16:17] offset:2048
  global_load_dwordx4 a[124:127], v113, s[16:17] offset:3072
  s_add_u32 s16, s16, 4096
  s_addc_u32 s17, s17, 0
  global_load_dwordx4 a[128:131], v113, s[16:17] offset:0
  global_load_dwordx4 a[132:135], v113, s[16:17] offset:1024
  global_load_dwordx4 a[136:139], v113, s[16:17] offset:2048
  global_load_dwordx4 a[140:143], v113, s[16:17] offset:3072
  s_add_u32 s16, s16, 4096
  s_addc_u32 s17, s17, 0
  global_load_dwordx4 a[144:147], v113, s[16:17] offset:0
  global_load_dwordx4 a[148:151], v113, s[16:17] offset:1024
  global_load_dwordx4 a[152:155], v113, s[16:17] offset:2048
  global_load_dwordx4 a[156:159], v113, s[16:17] offset:3072
  s_add_u32 s16, s16, 4096
  s_addc_u32 s17, s17, 0
  global_load_dwordx4 a[160:163], v113, s[16:17] offset:0
  global_load_dwordx4 a[164:167], v113, s[16:17] offset:1024
  global_load_dwordx4 a[168:171], v113, s[16:17] offset:2048
  global_load_dwordx4 a[172:175], v113, s[16:17] offset:3072
  s_add_u32 s16, s16, 4096
  s_addc_u32 s17, s17, 0
  global_load_dwordx4 a[176:179], v113, s[16:17] offset:0
  global_load_dwordx4 a[180:183], v113, s[16:17] offset:1024
  global_load_dwordx4 a[184:187], v113, s[16:17] offset:2048
  global_load_dwordx4 a[188:191], v113, s[16:17] offset:3072
  s_add_u32 s16, s16, 4096
  s_addc_u32 s17, s17, 0
  global_load_dwordx4 a[192:195], v113, s[16:17] offset:0
  global_load_dwordx4 a[196:199], v113, s[16:17] offset:1024
  global_load_dwordx4 a[200:203], v113, s[16:17] offset:2048
  global_load_dwordx4 a[204:207], v113, s[16:17] offset:3072
  s_add_u32 s16, s16, 4096
  s_addc_u32 s17, s17, 0
  global_load_dwordx4 a[208:211], v113, s[16:17] offset:0
  global_load_dwordx4 a[212:215], v113, s[16:17] offset:1024
  global_load_dwordx4 a[216:219], v113, s[16:17] offset:2048
  global_load_dwordx4 a[220:223], v113, s[16:17] offset:3072
  s_add_u32 s16, s16, 4096
  s_addc_u32 s17, s17, 0
  global_load_dwordx4 a[224:227], v113, s[16:17] offset:0
  global_load_dwordx4 a[228:231], v113, s[16:17] offset:1024
  global_load_dwordx4 a[232:235], v113, s[16:17] offset:2048
  global_load_dwordx4 a[236:239], v113, s[16:17] offset:3072
  s_add_u32 s16, s16, 4096
  s_addc_u32 s17, s17, 0
  global_load_dwordx4 a[240:243], v113, s[16:17] offset:0
  global_load_dwordx4 a[244:247], v113, s[16:17] offset:1024
  global_load_dwordx4 a[248:251], v113, s[16:17] offset:2048
  global_load_dwordx4 a[252:255], v113, s[16:17] offset:3072
  s_add_u32 s16, s16, 4096
  s_addc_u32 s17, s17, 0
  global_load_dwordx4 v[120:123], v113, s[16:17] offset:0
  global_load_dwordx4 v[124:127], v113, s[16:17] offset:1024
  global_load_dwordx4 v[128:131], v113, s[16:17] offset:2048
  global_load_dwordx4 v[132:135], v113, s[16:17] offset:3072
  s_add_u32 s16, s16, 4096
  s_addc_u32 s17, s17, 0
  global_load_dwordx4 v[136:139], v113, s[16:17] offset:0
  global_load_dwordx4 v[140:143], v113, s[16:17] offset:1024
  global_load_dwordx4 v[144:147], v113, s[16:17] offset:2048
  global_load_dwordx4 v[148:151], v113, s[16:17] offset:3072
  s_add_u32 s16, s16, 4096
  s_addc_u32 s17, s17, 0
  global_load_dwordx4 v[152:155], v113, s[16:17] offset:0
  global_load_dwordx4 v[156:159], v113, s[16:17] offset:1024
  global_load_dwordx4 v[160:163], v113, s[16:17] offset:2048
  global_load_dwordx4 v[164:167], v113, s[16:17] offset:3072
  s_add_u32 s16, s16, 4096
  s_addc_u32 s17, s17, 0
  global_load_dwordx4 v[168:171], v113, s[16:17] offset:0
  global_load_dwordx4 v[172:175], v113, s[16:17] offset:1024
  global_load_dwordx4 v[176:179], v113, s[16:17] offset:2048
  global_load_dwordx4 v[180:183], v113, s[16:17] offset:3072
  s_add_u32 s16, s16, 4096
  s_addc_u32 s17, s17, 0
  global_load_dwordx4 v[184:187], v113, s[16:17] offset:0
  global_load_dwordx4 v[188:191], v113, s[16:17] offset:1024
  global_load_dwordx4 v[192:195], v113, s[16:17] offset:2048
  global_load_dwordx4 v[196:199], v113, s[16:17] offset:3072
  s_add_u32 s16, s16, 4096
  s_addc_u32 s17, s17, 0
  global_load_dwordx4 v[200:203], v113, s[16:17] offset:0
  global_load_dwordx4 v[204:207], v113, s[16:17] offset:1024
  global_load_dwordx4 v[208:211], v113, s[16:17] offset:2048
  global_load_dwordx4 v[212:215], v113, s[16:17] offset:3072
  s_add_u32 s16, s16, 4096
  s_addc_u32 s17, s17, 0
  global_load_dwordx4 v[216:219], v113, s[16:17] offset:0
  global_load_dwordx4 v[220:223], v113, s[16:17] offset:1024
  global_load_dwordx4 v[224:227], v113, s[16:17] offset:2048
  global_load_dwordx4 v[228:231], v113, s[16:17] offset:3072
  s_add_u32 s16, s16, 4096
  s_addc_u32 s17, s17, 0
  global_load_dwordx4 v[232:235], v113, s[16:17] offset:0
  global_load_dwordx4 v[236:239], v113, s[16:17] offset:1024
  global_load_dwordx4 v[240:243], v113, s[16:17] offset:2048
  global_load_dwordx4 v[244:247], v113, s[16:17] offset:3072
  s_add_u32 s16, s16, 4096
  s_addc_u32 s17, s17, 0
  global_load_dwordx4 v[248:251], v113, s[16:17] offset:0
  global_load_dwordx4 v[252:255], v113, s[16:17] offset:1024
  v_and_b32 v78, 15, v0
  v_bfe_u32 v79, v0, 4, 2
  s_mul_i32 s14, s8, 5120
  s_add_u32 s14, s14, 8192
  v_mul_u32_u24 v116, 40, v78
  v_lshl_add_u32 v116, v79, 3, v116
  v_add_u32 v116, s14, v116
  v_bfe_u32 v88, v0, 2, 1
  v_bfe_u32 v117, v0, 3, 1
  v_lshl_add_u32 v88, v117, 2, v88
  v_lshl_add_u32 v88, v79, 3, v88
  v_mul_u32_u24 v88, 40, v88
  v_and_b32 v117, 3, v0
  v_lshl_add_u32 v117, v117, 3, v88
  v_add_u32 v117, s14, v117
  s_mul_i32 s14, s8, 112
  v_lshl_add_u32 v88, v79, 3, s14
  v_lshrrev_b32 v118, 6, v88
  v_lshlrev_b32 v118, 10, v118
  v_bfe_u32 v119, v88, 4, 2
  v_lshl_add_u32 v118, v119, 8, v118
  v_bfe_u32 v119, v88, 3, 1
  v_lshl_add_u32 v118, v119, 3, v118
  v_and_b32 v119, 7, v0
  v_lshl_add_u32 v118, v119, 4, v118
  s_mul_i32 s14, s8, 1664
  s_add_u32 s14, s14, 28672
  v_mul_u32_u24 v119, 288, v79
  v_lshl_add_u32 v119, v78, 4, v119
  v_add_u32 v119, s14, v119
  v_lshlrev_b32 v1, 7, v79
  v_lshl_add_u32 v1, v78, 3, v1
  v_add_u32 v1, s14, v1
  v_add_u32 v1, 1152, v1
  s_and_b32 s14, s8, 1
  s_lshl_b32 s14, s14, 2
  v_add_u32 v78, s14, v79
  v_and_b32 v79, 15, v0
  v_lshrrev_b32 v88, 2, v79
  v_mul_u32_u24 v2, 288, v88
  v_lshlrev_b32 v90, 2, v88
  v_bfe_u32 v91, v79, 1, 1
  v_lshl_add_u32 v90, v91, 4, v90
  v_and_b32 v91, 1, v79
  v_lshl_add_u32 v90, v91, 1, v90
  s_lshl_b32 s14, s65, 3
  v_add_u32 v88, s14, v78
  v_add_u32 v91, 1, v90
  v_cmp_gt_u32 vcc, v90, v88
  v_mov_b32 v90, 0
  v_mov_b32 v89, 0xf149f2ca
  s_nop 0
  v_cndmask_b32 v90, v90, v89, vcc
  v_cmp_gt_u32 vcc, v91, v88
  v_mov_b32 v91, 0
  s_nop 1
  v_cndmask_b32 v91, v91, v89, vcc
  v_lshl_add_u32 v2, v78, 4, v2
  v_and_b32 v88, 1, v79
  v_lshl_add_u32 v2, v88, 7, v2
  v_bfe_u32 v88, v79, 1, 1
  v_lshl_add_u32 v2, v88, 3, v2
  v_add_u32 v2, 28672, v2
  v_lshrrev_b32 v88, 1, v79
  v_lshlrev_b32 v3, 7, v88
  v_lshl_add_u32 v3, v78, 3, v3
  v_and_b32 v88, 1, v79
  v_lshl_add_u32 v3, v88, 6, v3
  v_add_u32 v3, 29824, v3
  v_mov_b32 v88, 36864
  v_cmp_gt_u32 vcc, 4, v79
  s_nop 1
  v_cndmask_b32 v3, v88, v3, vcc
  v_lshrrev_b32 v88, 3, v79
  v_lshlrev_b32 v77, 8, v88
  v_and_b32 v88, 1, v79
  v_lshl_add_u32 v77, v88, 7, v77
  v_lshl_add_u32 v77, v78, 4, v77
  v_bfe_u32 v88, v79, 1, 2
  v_lshl_add_u32 v77, v88, 2, v77
  v_lshlrev_b32 v76, 2, v79
  v_lshl_add_u32 v76, v78, 4, v76
  v_cmp_gt_u32 s[62:63], 4, v79
  v_lshlrev_b32 v78, 4, v0
  v_add_u32 v78, 7168, v78
  v_mov_b32 v80, 0
  v_mov_b32 v81, 0
  v_mov_b32 v82, 0
  v_mov_b32 v83, 0
  ds_write_b128 v78, v[80:83] offset:0
  ds_write_b128 v78, v[80:83] offset:4096
  ds_write_b128 v78, v[80:83] offset:8192
  ds_write_b128 v78, v[80:83] offset:12288
  ds_write_b128 v78, v[80:83] offset:16384
  ds_write_b128 v78, v[80:83] offset:20480
  v_mov_b32 v84, 0xf149f2ca
  v_mov_b32 v85, v84
  v_mov_b32 v78, 36864
  ds_write_b64 v78, v[84:85] offset:0
  ds_write_b64 v78, v[84:85] offset:1664
  ds_write_b64 v78, v[84:85] offset:3328
  ds_write_b64 v78, v[84:85] offset:4992
  v_mov_b32 v78, v90
  v_mov_b32 v79, v91
  s_mov_b32 s10, 0
  s_add_u32 s12, s4, 49807360
  s_addc_u32 s13, s5, 0
  s_mul_i32 s14, s65, 458752
  s_add_u32 s12, s12, s14
  s_addc_u32 s13, s13, 0
  s_mul_i32 s14, s65, 7168
  s_add_u32 s66, s4, 46403584
  s_addc_u32 s67, s5, 0
  s_add_u32 s66, s66, s14
  s_addc_u32 s67, s67, 0
  s_lshl_b32 s14, s8, 13
  s_add_u32 s14, s14, 4096
  s_add_u32 s26, s4, 42205184
  s_addc_u32 s27, s5, 0
  s_add_u32 s26, s26, s14
  s_addc_u32 s27, s27, 0
  s_lshr_b32 s14, s9, 1
  s_lshl_b32 s14, s14, 10
  s_and_b32 s15, s9, 1
  s_lshl_b32 s15, s15, 9
  s_add_u32 s14, s14, s15
  s_add_u32 s22, s4, 51642368
  s_addc_u32 s23, s5, 0
  s_add_u32 s22, s22, s14
  s_addc_u32 s23, s23, 0
  s_lshl_b32 s14, s9, 7
  s_add_u32 s24, s4, 53739520
  s_addc_u32 s25, s5, 0
  s_add_u32 s24, s24, s14
  s_addc_u32 s25, s25, 0
  s_lshl_b32 s14, s65, 19
  s_add_u32 s22, s22, s14
  s_addc_u32 s23, s23, 0
  s_lshl_b32 s14, s65, 17
  s_add_u32 s24, s24, s14
  s_addc_u32 s25, s25, 0
  global_load_dwordx4 v[4:7], v113, s[66:67] offset:-4096
  global_load_dwordx4 v[8:11], v113, s[66:67] offset:-3072
  global_load_dwordx4 v[12:15], v113, s[66:67] offset:-2048
  global_load_dwordx4 v[16:19], v113, s[66:67] offset:-1024
  global_load_dwordx4 v[20:23], v113, s[66:67] offset:0
  global_load_dwordx4 v[24:27], v113, s[66:67] offset:1024
  global_load_dwordx4 v[28:31], v113, s[66:67] offset:2048
  s_add_u32 s66, s66, 28672
  s_addc_u32 s67, s67, 0
  v_mov_b32 v80, 0
  v_mov_b32 v81, 0
  v_mov_b32 v82, 0
  v_mov_b32 v83, 0
  s_waitcnt vmcnt(0) lgkmcnt(0)
  s_barrier
L_A_loop_27:
  s_cmp_lt_u32 s8, 2
  s_cbranch_scc1 L_A_b1_28
  s_mov_b32 s11, 0
L_A_poll_29:
  global_load_dwordx4 v[84:87], v114, s[12:13] offset:0 sc1
  global_load_dwordx4 v[88:91], v114, s[12:13] offset:1024 sc1
  global_load_dwordx4 v[92:95], v114, s[12:13] offset:2048 sc1
  global_load_dwordx4 v[96:99], v114, s[12:13] offset:3072 sc1
  s_waitcnt vmcnt(0)
  v_max3_u32 v100, v84, v85, v86
  v_max3_u32 v100, v100, v87, v88
  v_max3_u32 v100, v100, v89, v90
  v_max3_u32 v100, v100, v91, v92
  v_max3_u32 v100, v100, v93, v94
  v_max3_u32 v100, v100, v95, v96
  v_max3_u32 v100, v100, v97, v98
  v_max_u32 v100, v100, v99
  v_cmp_eq_u32 vcc, -1, v100
  s_cbranch_vccz L_A_got_30
  s_add_u32 s11, s11, 1
  s_cmp_gt_u32 s11, 262144
  s_cbranch_scc1 L_abort
  s_branch L_A_poll_29
L_A_got_30:
  ds_write_b128 v114, v[84:87] offset:0
  ds_write_b128 v114, v[88:91] offset:1024
  ds_write_b128 v114, v[92:95] offset:2048
  ds_write_b128 v114, v[96:99] offset:3072
L_A_b1_28:
  s_waitcnt vmcnt(0) lgkmcnt(0)
  s_barrier
  v_smfmac_f32_16x16x64_bf16 v[80:83], v[4:7], a[0:7], v112
  v_smfmac_f32_16x16x64_bf16 v[80:83], v[8:11], a[8:15], v112
  v_smfmac_f32_16x16x64_bf16 v[80:83], v[12:15], a[16:23], v112
  s_waitcnt vmcnt(0)
  global_load_dwordx4 v[32:35], v113, s[26:27] offset:-4096
  v_smfmac_f32_16x16x64_bf16 v[80:83], v[16:19], a[24:31], v112
  v_smfmac_f32_16x16x64_bf16 v[80:83], v[20:23], a[32:39], v112
  v_mov_b64 v[84:85], 0
  v_smfmac_f32_16x16x64_bf16 v[80:83], v[24:27], a[40:47], v112
  v_mov_b64 v[86:87], 0
  v_smfmac_f32_16x16x64_bf16 v[80:83], v[28:31], a[48:55], v112
  global_load_dwordx4 v[36:39], v113, s[26:27] offset:-3072
  v_smfmac_f32_16x16x64_bf16 v[84:87], v[4:7], a[56:63], v112
  v_smfmac_f32_16x16x64_bf16 v[84:87], v[8:11], a[64:71], v112
  v_cvt_pk_bf16_f32 v72, v80, v81
  v_smfmac_f32_16x16x64_bf16 v[84:87], v[12:15], a[72:79], v112
  v_cvt_pk_bf16_f32 v73, v82, v83
  v_smfmac_f32_16x16x64_bf16 v[84:87], v[16:19], a[80:87], v112
  ds_write_b64 v116, v[72:73] offset:0
  global_load_dwordx4 v[40:43], v113, s[26:27] offset:-2048
  v_smfmac_f32_16x16x64_bf16 v[84:87], v[20:23], a[88:95], v112
  v_mov_b64 v[88:89], 0
  v_smfmac_f32_16x16x64_bf16 v[84:87], v[24:27], a[96:103], v112
  v_mov_b64 v[90:91], 0
  v_smfmac_f32_16x16x64_bf16 v[84:87], v[28:31], a[104:111], v112
  v_smfmac_f32_16x16x64_bf16 v[88:91], v[4:7], a[112:119], v112
  global_load_dwordx4 v[44:47], v113, s[26:27] offset:-1024
  v_smfmac_f32_16x16x64_bf16 v[88:91], v[8:11], a[120:127], v112
  v_cvt_pk_bf16_f32 v74, v84, v85
  v_smfmac_f32_16x16x64_bf16 v[88:91], v[12:15], a[128:135], v112
  v_cvt_pk_bf16_f32 v75, v86, v87
  v_smfmac_f32_16x16x64_bf16 v[88:91], v[16:19], a[136:143], v112
  ds_write_b64 v116, v[74:75] offset:640
  v_smfmac_f32_16x16x64_bf16 v[88:91], v[20:23], a[144:151], v112
  v_mov_b64 v[80:81], 0
  global_load_dwordx4 v[48:51], v113, s[26:27] offset:0
  v_smfmac_f32_16x16x64_bf16 v[88:91], v[24:27], a[152:159], v112
  v_mov_b64 v[82:83], 0
  ds_read_b64_tr_b16 v[92:93], v117 offset:0
  ds_read_b64_tr_b16 v[94:95], v117 offset:80
  v_smfmac_f32_16x16x64_bf16 v[88:91], v[28:31], a[160:167], v112
  ds_read_b64 v[64:65], v118 offset:0
  ds_read_b64 v[66:67], v118 offset:128
  v_smfmac_f32_16x16x64_bf16 v[80:83], v[4:7], a[168:175], v112
  v_smfmac_f32_16x16x64_bf16 v[80:83], v[8:11], a[176:183], v112
  v_cvt_pk_bf16_f32 v72, v88, v89
  global_load_dwordx4 v[52:55], v113, s[26:27] offset:1024
  v_smfmac_f32_16x16x64_bf16 v[80:83], v[12:15], a[184:191], v112
  v_cvt_pk_bf16_f32 v73, v90, v91
  v_smfmac_f32_16x16x64_bf16 v[80:83], v[16:19], a[192:199], v112
  ds_write_b64 v116, v[72:73] offset:1280
  v_smfmac_f32_16x16x64_bf16 v[80:83], v[20:23], a[200:207], v112
  v_mov_b64 v[84:85], 0
  v_smfmac_f32_16x16x64_bf16 v[80:83], v[24:27], a[208:215], v112
  v_mov_b64 v[86:87], 0
  global_load_dwordx4 v[56:59], v113, s[26:27] offset:2048
  v_smfmac_f32_16x16x64_bf16 v[80:83], v[28:31], a[216:223], v112
  s_waitcnt lgkmcnt(1)
  v_mfma_f32_16x16x32_bf16 v[100:103], v[64:67], v[92:95], 0
  v_smfmac_f32_16x16x64_bf16 v[84:87], v[4:7], a[224:231], v112
  s_waitcnt vmcnt(5)
  v_mfma_f32_16x16x32_bf16 v[104:107], v[32:35], v[92:95], 0
  v_smfmac_f32_16x16x64_bf16 v[84:87], v[8:11], a[232:239], v112
  v_cvt_pk_bf16_f32 v74, v80, v81
  v_mfma_f32_16x16x32_bf16 v[108:111], v[36:39], v[92:95], 0
  v_smfmac_f32_16x16x64_bf16 v[84:87], v[12:15], a[240:247], v112
  v_cvt_pk_bf16_f32 v75, v82, v83
  global_load_dwordx4 v[60:63], v113, s[26:27] offset:3072
  v_smfmac_f32_16x16x64_bf16 v[84:87], v[16:19], a[248:255], v112
  ds_write_b64 v116, v[74:75] offset:1920
  v_smfmac_f32_16x16x64_bf16 v[84:87], v[20:23], v[120:127], v112
  v_mov_b64 v[88:89], 0
  v_smfmac_f32_16x16x64_bf16 v[84:87], v[24:27], v[128:135], v112
  v_mov_b64 v[90:91], 0
  ds_read_b64_tr_b16 v[96:97], v117 offset:1280
  ds_read_b64_tr_b16 v[98:99], v117 offset:1360
  v_smfmac_f32_16x16x64_bf16 v[84:87], v[28:31], v[136:143], v112
  ds_read_b64 v[68:69], v118 offset:512
  ds_read_b64 v[70:71], v118 offset:640
  v_smfmac_f32_16x16x64_bf16 v[88:91], v[4:7], v[144:151], v112
  v_smfmac_f32_16x16x64_bf16 v[88:91], v[8:11], v[152:159], v112
  v_cvt_pk_bf16_f32 v72, v84, v85
  v_smfmac_f32_16x16x64_bf16 v[88:91], v[12:15], v[160:167], v112
  v_cvt_pk_bf16_f32 v73, v86, v87
  v_smfmac_f32_16x16x64_bf16 v[88:91], v[16:19], v[168:175], v112
  ds_write_b64 v116, v[72:73] offset:2560
  v_smfmac_f32_16x16x64_bf16 v[88:91], v[20:23], v[176:183], v112
  v_mov_b64 v[80:81], 0
  v_smfmac_f32_16x16x64_bf16 v[88:91], v[24:27], v[184:191], v112
  v_mov_b64 v[82:83], 0
  ds_read_b64 v[64:65], v118 offset:1024
  ds_read_b64 v[66:67], v118 offset:1152
  v_smfmac_f32_16x16x64_bf16 v[88:91], v[28:31], v[192:199], v112
  s_waitcnt lgkmcnt(3)
  v_mfma_f32_16x16x32_bf16 v[100:103], v[68:71], v[96:99], v[100:103]
  v_smfmac_f32_16x16x64_bf16 v[80:83], v[4:7], v[200:207], v112
  s_waitcnt vmcnt(4)
  v_mfma_f32_16x16x32_bf16 v[104:107], v[40:43], v[96:99], v[104:107]
  v_smfmac_f32_16x16x64_bf16 v[80:83], v[8:11], v[208:215], v112
  v_cvt_pk_bf16_f32 v74, v88, v89
  v_mfma_f32_16x16x32_bf16 v[108:111], v[44:47], v[96:99], v[108:111]
  v_smfmac_f32_16x16x64_bf16 v[80:83], v[12:15], v[216:223], v112
  v_cvt_pk_bf16_f32 v75, v90, v91
  v_smfmac_f32_16x16x64_bf16 v[80:83], v[16:19], v[224:231], v112
  ds_write_b64 v116, v[74:75] offset:3200
  v_smfmac_f32_16x16x64_bf16 v[80:83], v[20:23], v[232:239], v112
  ds_read_b64_tr_b16 v[92:93], v117 offset:2560
  ds_read_b64_tr_b16 v[94:95], v117 offset:2640
  v_smfmac_f32_16x16x64_bf16 v[80:83], v[24:27], v[240:247], v112
  ds_read_b64 v[68:69], v118 offset:1536
  ds_read_b64 v[70:71], v118 offset:1664
  v_smfmac_f32_16x16x64_bf16 v[80:83], v[28:31], v[248:255], v112
  global_load_dwordx4 v[4:7], v113, s[66:67] offset:-4096
  global_load_dwordx4 v[8:11], v113, s[66:67] offset:-3072
  global_load_dwordx4 v[12:15], v113, s[66:67] offset:-2048
  global_load_dwordx4 v[16:19], v113, s[66:67] offset:-1024
  global_load_dwordx4 v[20:23], v113, s[66:67] offset:0
  global_load_dwordx4 v[24:27], v113, s[66:67] offset:1024
  global_load_dwordx4 v[28:31], v113, s[66:67] offset:2048
  s_add_u32 s66, s66, 28672
  s_addc_u32 s67, s67, 0
  s_waitcnt lgkmcnt(2)
  v_mfma_f32_16x16x32_bf16 v[100:103], v[64:67], v[92:95], v[100:103]
  s_waitcnt vmcnt(9)
  v_mfma_f32_16x16x32_bf16 v[104:107], v[48:51], v[92:95], v[104:107]
  v_cvt_pk_bf16_f32 v72, v80, v81
  v_cvt_pk_bf16_f32 v73, v82, v83
  ds_write_b64 v116, v[72:73] offset:3840
  ds_read_b64_tr_b16 v[96:97], v117 offset:3840
  ds_read_b64_tr_b16 v[98:99], v117 offset:3920
  v_mfma_f32_16x16x32_bf16 v[108:111], v[52:55], v[92:95], v[108:111]
  s_waitcnt lgkmcnt(0)
  v_mfma_f32_16x16x32_bf16 v[100:103], v[68:71], v[96:99], v[100:103]
  s_waitcnt vmcnt(7)
  v_mfma_f32_16x16x32_bf16 v[104:107], v[56:59], v[96:99], v[104:107]
  v_mfma_f32_16x16x32_bf16 v[108:111], v[60:63], v[96:99], v[108:111]
  s_nop 3
  v_add_f32_dpp v88, v100, v100 row_ror:8 row_mask:0xf bank_mask:0x3
  v_add_f32_dpp v88, v102, v102 row_ror:8 row_mask:0xf bank_mask:0xc
  v_add_f32_dpp v89, v101, v101 row_ror:8 row_mask:0xf bank_mask:0x3
  v_add_f32_dpp v89, v103, v103 row_ror:8 row_mask:0xf bank_mask:0xc
  ds_write_b64 v1, v[88:89]
  v_add_f32_dpp v84, v104, v104 row_ror:8 row_mask:0xf bank_mask:0x3
  v_add_f32_dpp v84, v106, v106 row_ror:8 row_mask:0xf bank_mask:0xc
  v_add_f32_dpp v85, v105, v105 row_ror:8 row_mask:0xf bank_mask:0x3
  v_add_f32_dpp v85, v107, v107 row_ror:8 row_mask:0xf bank_mask:0xc
  v_add_f32_dpp v86, v108, v108 row_ror:8 row_mask:0xf bank_mask:0x3
  v_add_f32_dpp v86, v110, v110 row_ror:8 row_mask:0xf bank_mask:0xc
  v_add_f32_dpp v87, v109, v109 row_ror:8 row_mask:0xf bank_mask:0x3
  v_add_f32_dpp v87, v111, v111 row_ror:8 row_mask:0xf bank_mask:0xc
  ds_write_b128 v119, v[84:87]
  v_mov_b32 v80, 0
  v_mov_b32 v81, 0
  v_mov_b32 v82, 0
  v_mov_b32 v83, 0
  s_waitcnt lgkmcnt(0)
  s_barrier
  s_add_u32 s26, s26, 32768
  s_addc_u32 s27, s27, 0
  s_cmp_ge_u32 s8, 2
  s_cbranch_scc1 L_A_nosm_31
  ds_read_b64 v[84:85], v2 offset:0
  ds_read_b64 v[86:87], v3 offset:0
  ds_read_b64 v[88:89], v2 offset:1664
  ds_read_b64 v[90:91], v3 offset:1664
  ds_read_b64 v[92:93], v2 offset:3328
  ds_read_b64 v[94:95], v3 offset:3328
  ds_read_b64 v[96:97], v2 offset:4992
  ds_read_b64 v[98:99], v3 offset:4992
  s_waitcnt lgkmcnt(4)
  v_pk_add_f32 v[84:85], v[84:85], v[88:89]
  v_pk_add_f32 v[86:87], v[86:87], v[90:91]
  s_waitcnt lgkmcnt(0)
  v_pk_add_f32 v[92:93], v[92:93], v[96:97]
  v_pk_add_f32 v[94:95], v[94:95], v[98:99]
  v_pk_add_f32 v[84:85], v[84:85], v[92:93]
  v_pk_add_f32 v[86:87], v[86:87], v[94:95]
  v_pk_add_f32 v[84:85], v[84:85], v[78:79]
  v_max3_f32 v88, v84, v85, v86
  v_max_f32 v88, v88, v87
  s_nop 1
  v_max_f32_dpp v88, v88, v88 row_ror:8 row_mask:0xf bank_mask:0xf
  s_nop 1
  v_max_f32_dpp v88, v88, v88 row_ror:4 row_mask:0xf bank_mask:0xf
  s_nop 1
  v_max_f32_dpp v88, v88, v88 row_ror:2 row_mask:0xf bank_mask:0xf
  s_nop 1
  v_max_f32_dpp v88, v88, v88 row_ror:1 row_mask:0xf bank_mask:0xf
  v_pk_add_f32 v[84:85], v[84:85], v[88:89] op_sel_hi:[1,0] neg_lo:[0,1] neg_hi:[0,1]
  v_pk_add_f32 v[86:87], v[86:87], v[88:89] op_sel_hi:[1,0] neg_lo:[0,1] neg_hi:[0,1]
  v_exp_f32 v84, v84
  v_exp_f32 v85, v85
  v_exp_f32 v86, v86
  v_exp_f32 v87, v87
  s_nop 0
  v_pk_add_f32 v[90:91], v[84:85], v[86:87]
  v_add_f32 v90, v90, v91
  s_nop 1
  v_add_f32_dpp v90, v90, v90 row_ror:8 row_mask:0xf bank_mask:0xf
  s_nop 1
  v_add_f32_dpp v90, v90, v90 row_ror:4 row_mask:0xf bank_mask:0xf
  s_nop 1
  v_add_f32_dpp v90, v90, v90 row_ror:2 row_mask:0xf bank_mask:0xf
  s_nop 1
  v_add_f32_dpp v90, v90, v90 row_ror:1 row_mask:0xf bank_mask:0xf
  v_rcp_f32 v90, v90
  s_nop 0
  v_pk_mul_f32 v[84:85], v[84:85], v[90:91] op_sel_hi:[1,0]
  v_pk_mul_f32 v[86:87], v[86:87], v[90:91] op_sel_hi:[1,0]
  v_cvt_pk_bf16_f32 v84, v84, v85
  v_cvt_pk_bf16_f32 v86, v86, v87
  global_store_dword v77, v84, s[22:23]
  s_mov_b64 exec, s[62:63]
  global_store_dword v76, v86, s[24:25]
  s_mov_b64 exec, -1
L_A_nosm_31:
  s_add_u32 s12, s12, 7168
  s_addc_u32 s13, s13, 0
  s_add_u32 s22, s22, 8192
  s_addc_u32 s23, s23, 0
  s_add_u32 s24, s24, 2048
  s_addc_u32 s25, s25, 0
  s_add_u32 s10, s10, 1
  s_cmp_lt_u32 s10, 64
  s_cbranch_scc1 L_A_loop_27
  s_branch L_pdone
L_qB:
  v_and_b32 v5, 31, v0
  v_lshlrev_b32 v5, 7, v5
  v_lshrrev_b32 v6, 5, v0
  v_lshl_add_u32 v6, v6, 2, v5
  v_add_u32 v6, 61513728, v6
  s_mov_b32 s11, 0
L_wa_32:
  global_load_dword v7, v6, s[4:5] sc1
  s_waitcnt vmcnt(0)
  v_cmp_ne_u32 vcc, s88, v7
  s_cbranch_vccz L_wag_33
  s_add_u32 s11, s11, 1
  s_cmp_gt_u32 s11, 262144
  s_cbranch_scc1 L_abort
  s_branch L_wa_32
L_wag_33:
  v_and_b32 v6, 31, v0
  v_lshlrev_b32 v6, 7, v6
  v_lshrrev_b32 v7, 5, v0
  v_lshl_add_u32 v7, v7, 2, v6
  v_add_u32 v7, 61513728, v7
  global_load_dword v7, v7, s[4:5] sc1
  v_and_b32 v4, 7, v0
  v_lshlrev_b32 v4, 5, v4
  global_load_dword v4, v4, s[6:7] sc1
  s_waitcnt vmcnt(0)
  v_cmp_ne_u32 vcc, 32, v4
  s_cbranch_vccnz L_cfbad_35
  v_cmp_ne_u32 vcc, s88, v7
  s_cbranch_vccnz L_cfbad_35
  s_branch L_cfok_34
L_cfbad_35:
  v_mov_b32 v4, 135168
  ds_write_b32 v4, v4
L_cfok_34:
  s_waitcnt lgkmcnt(0)
  s_barrier
  v_mov_b32 v4, 135168
  ds_read_b32 v4, v4
  s_waitcnt lgkmcnt(0)
  s_nop 0
  v_readfirstlane_b32 s14, v4
  s_nop 3
  s_cmp_lg_u32 s14, 0
  s_cbranch_scc1 L_recheck
  s_mov_b32 s11, 0
  v_mov_b32 v1, 1024
L_vxw_36:
  global_load_dword v2, v1, s[86:87] sc1
  s_waitcnt vmcnt(0)
  v_cmp_gt_u32 vcc, 84, v2
  s_cbranch_vccz L_vxg_37
  s_add_u32 s11, s11, 1
  s_cmp_gt_u32 s11, 262144
  s_cbranch_scc1 L_abort
  s_sleep 8
  s_branch L_vxw_36
L_vxg_37:
  s_cmp_lt_u32 s65, 2
  s_cbranch_scc1 L_stg_38
  s_add_u32 s16, s4, 48721920
  s_addc_u32 s17, s5, 0
  s_mov_b32 s11, 0
  v_mov_b32 v1, 0
L_stgp_39:
  global_load_dword v2, v1, s[16:17] sc1
  s_waitcnt vmcnt(0)
  v_cmp_eq_u32 vcc, -1, v2
  s_cbranch_vccz L_stg_38
  s_add_u32 s11, s11, 1
  s_cmp_gt_u32 s11, 262144
  s_cbranch_scc1 L_abort
  s_sleep 8
  s_branch L_stgp_39
L_stg_38:
  s_sub_u32 s43, s9, 16
  v_and_b32 v140, 63, v0
  v_lshlrev_b32 v133, 4, v140
  s_lshl_b32 s14, s8, 10
  v_add_u32 v134, s14, v133
  s_add_u32 s14, s8, 4
  s_min_u32 s14, s14, 6
  s_lshl_b32 s14, s14, 10
  v_add_u32 v135, s14, v133
  v_and_b32 v140, 8, v0
  v_cmp_eq_u32 vcc, 0, v140
  v_mov_b32 v132, 0xeeeeeeee
  v_mov_b32 v140, 0x44444444
  s_nop 1
  v_cndmask_b32 v132, v132, v140, vcc
  s_mul_i32 s14, s8, 1605632
  s_mul_i32 s15, s43, 28672
  s_add_u32 s14, s14, s15
  s_add_u32 s18, s4, 6422528
  s_addc_u32 s19, s5, 0
  s_add_u32 s18, s18, s14
  s_addc_u32 s19, s19, 0
  s_add_u32 s16, s18, 1204224
  s_addc_u32 s17, s19, 0
  s_mul_i32 s14, s8, 28672
  s_add_u32 s14, s14, 16384
  v_add_u32 v143, s14, v133
  s_add_u32 s15, s14, 0
  s_mov_b32 m0, s15
  s_nop 0
  global_load_lds_dwordx4 v133, s[16:17] offset:0
  global_load_lds_dwordx4 v133, s[16:17] offset:1024
  global_load_lds_dwordx4 v133, s[16:17] offset:2048
  global_load_lds_dwordx4 v133, s[16:17] offset:3072
  s_add_u32 s16, s16, 4096
  s_addc_u32 s17, s17, 0
  s_add_u32 s15, s14, 4096
  s_mov_b32 m0, s15
  s_nop 0
  global_load_lds_dwordx4 v133, s[16:17] offset:0
  global_load_lds_dwordx4 v133, s[16:17] offset:1024
  global_load_lds_dwordx4 v133, s[16:17] offset:2048
  global_load_lds_dwordx4 v133, s[16:17] offset:3072
  s_add_u32 s16, s16, 4096
  s_addc_u32 s17, s17, 0
  s_add_u32 s15, s14, 8192
  s_mov_b32 m0, s15
  s_nop 0
  global_load_lds_dwordx4 v133, s[16:17] offset:0
  global_load_lds_dwordx4 v133, s[16:17] offset:1024
  global_load_lds_dwordx4 v133, s[16:17] offset:2048
  global_load_lds_dwordx4 v133, s[16:17] offset:3072
  s_add_u32 s16, s16, 4096
  s_addc_u32 s17, s17, 0
  s_add_u32 s15, s14, 12288
  s_mov_b32 m0, s15
  s_nop 0
  global_load_lds_dwordx4 v133, s[16:17] offset:0
  global_load_lds_dwordx4 v133, s[16:17] offset:1024
  global_load_lds_dwordx4 v133, s[16:17] offset:2048
  global_load_lds_dwordx4 v133, s[16:17] offset:3072
  s_add_u32 s16, s16, 4096
  s_addc_u32 s17, s17, 0
  s_add_u32 s15, s14, 16384
  s_mov_b32 m0, s15
  s_nop 0
  global_load_lds_dwordx4 v133, s[16:17] offset:0
  global_load_lds_dwordx4 v133, s[16:17] offset:1024
  global_load_lds_dwordx4 v133, s[16:17] offset:2048
  global_load_lds_dwordx4 v133, s[16:17] offset:3072
  s_add_u32 s16, s16, 4096
  s_addc_u32 s17, s17, 0
  s_add_u32 s15, s14, 20480
  s_mov_b32 m0, s15
  s_nop 0
  global_load_lds_dwordx4 v133, s[16:17] offset:0
  global_load_lds_dwordx4 v133, s[16:17] offset:1024
  global_load_lds_dwordx4 v133, s[16:17] offset:2048
  global_load_lds_dwordx4 v133, s[16:17] offset:3072
  s_add_u32 s16, s16, 4096
  s_addc_u32 s17, s17, 0
  s_add_u32 s15, s14, 24576
  s_mov_b32 m0, s15
  s_nop 0
  global_load_lds_dwordx4 v133, s[16:17] offset:0
  global_load_lds_dwordx4 v133, s[16:17] offset:1024
  global_load_lds_dwordx4 v133, s[16:17] offset:2048
  global_load_lds_dwordx4 v133, s[16:17] offset:3072
  s_add_u32 s16, s16, 4096
  s_addc_u32 s17, s17, 0
  s_add_u32 s16, s18, 0
  s_addc_u32 s17, s19, 0
  global_load_dwordx4 a[0:3], v133, s[16:17] offset:0
  global_load_dwordx4 a[4:7], v133, s[16:17] offset:1024
  global_load_dwordx4 a[8:11], v133, s[16:17] offset:2048
  global_load_dwordx4 a[12:15], v133, s[16:17] offset:3072
  s_add_u32 s16, s16, 4096
  s_addc_u32 s17, s17, 0
  global_load_dwordx4 a[16:19], v133, s[16:17] offset:0
  global_load_dwordx4 a[20:23], v133, s[16:17] offset:1024
  global_load_dwordx4 a[24:27], v133, s[16:17] offset:2048
  global_load_dwordx4 a[28:31], v133, s[16:17] offset:3072
  s_add_u32 s16, s16, 4096
  s_addc_u32 s17, s17, 0
  global_load_dwordx4 a[32:35], v133, s[16:17] offset:0
  global_load_dwordx4 a[36:39], v133, s[16:17] offset:1024
  global_load_dwordx4 a[40:43], v133, s[16:17] offset:2048
  global_load_dwordx4 a[44:47], v133, s[16:17] offset:3072
  s_add_u32 s16, s16, 4096
  s_addc_u32 s17, s17, 0
  global_load_dwordx4 a[48:51], v133, s[16:17] offset:0
  global_load_dwordx4 a[52:55], v133, s[16:17] offset:1024
  global_load_dwordx4 a[56:59], v133, s[16:17] offset:2048
  global_load_dwordx4 a[60:63], v133, s[16:17] offset:3072
  s_add_u32 s16, s16, 4096
  s_addc_u32 s17, s17, 0
  global_load_dwordx4 a[64:67], v133, s[16:17] offset:0
  global_load_dwordx4 a[68:71], v133, s[16:17] offset:1024
  global_load_dwordx4 a[72:75], v133, s[16:17] offset:2048
  global_load_dwordx4 a[76:79], v133, s[16:17] offset:3072
  s_add_u32 s16, s16, 4096
  s_addc_u32 s17, s17, 0
  global_load_dwordx4 a[80:83], v133, s[16:17] offset:0
  global_load_dwordx4 a[84:87], v133, s[16:17] offset:1024
  global_load_dwordx4 a[88:91], v133, s[16:17] offset:2048
  global_load_dwordx4 a[92:95], v133, s[16:17] offset:3072
  s_add_u32 s16, s16, 4096
  s_addc_u32 s17, s17, 0
  global_load_dwordx4 a[96:99], v133, s[16:17] offset:0
  global_load_dwordx4 a[100:103], v133, s[16:17] offset:1024
  global_load_dwordx4 a[104:107], v133, s[16:17] offset:2048
  global_load_dwordx4 a[108:111], v133, s[16:17] offset:3072
  s_add_u32 s16, s16, 4096
  s_addc_u32 s17, s17, 0
  s_add_u32 s16, s18, 401408
  s_addc_u32 s17, s19, 0
  global_load_dwordx4 a[112:115], v133, s[16:17] offset:0
  global_load_dwordx4 a[116:119], v133, s[16:17] offset:1024
  global_load_dwordx4 a[120:123], v133, s[16:17] offset:2048
  global_load_dwordx4 a[124:127], v133, s[16:17] offset:3072
  s_add_u32 s16, s16, 4096
  s_addc_u32 s17, s17, 0
  global_load_dwordx4 a[128:131], v133, s[16:17] offset:0
  global_load_dwordx4 a[132:135], v133, s[16:17] offset:1024
  global_load_dwordx4 a[136:139], v133, s[16:17] offset:2048
  global_load_dwordx4 a[140:143], v133, s[16:17] offset:3072
  s_add_u32 s16, s16, 4096
  s_addc_u32 s17, s17, 0
  global_load_dwordx4 a[144:147], v133, s[16:17] offset:0
  global_load_dwordx4 a[148:151], v133, s[16:17] offset:1024
  global_load_dwordx4 a[152:155], v133, s[16:17] offset:2048
  global_load_dwordx4 a[156:159], v133, s[16:17] offset:3072
  s_add_u32 s16, s16, 4096
  s_addc_u32 s17, s17, 0
  global_load_dwordx4 a[160:163], v133, s[16:17] offset:0
  global_load_dwordx4 a[164:167], v133, s[16:17] offset:1024
  global_load_dwordx4 a[168:171], v133, s[16:17] offset:2048
  global_load_dwordx4 a[172:175], v133, s[16:17] offset:3072
  s_add_u32 s16, s16, 4096
  s_addc_u32 s17, s17, 0
  global_load_dwordx4 a[176:179], v133, s[16:17] offset:0
  global_load_dwordx4 a[180:183], v133, s[16:17] offset:1024
  global_load_dwordx4 a[184:187], v133, s[16:17] offset:2048
  global_load_dwordx4 a[188:191], v133, s[16:17] offset:3072
  s_add_u32 s16, s16, 4096
  s_addc_u32 s17, s17, 0
  global_load_dwordx4 a[192:195], v133, s[16:17] offset:0
  global_load_dwordx4 a[196:199], v133, s[16:17] offset:1024
  global_load_dwordx4 a[200:203], v133, s[16:17] offset:2048
  global_load_dwordx4 a[204:207], v133, s[16:17] offset:3072
  s_add_u32 s16, s16, 4096
  s_addc_u32 s17, s17, 0
  global_load_dwordx4 a[208:211], v133, s[16:17] offset:0
  global_load_dwordx4 a[212:215], v133, s[16:17] offset:1024
  global_load_dwordx4 a[216:219], v133, s[16:17] offset:2048
  global_load_dwordx4 a[220:223], v133, s[16:17] offset:3072
  s_add_u32 s16, s16, 4096
  s_addc_u32 s17, s17, 0
  s_add_u32 s16, s18, 802816
  s_addc_u32 s17, s19, 0
  global_load_dwordx4 a[224:227], v133, s[16:17] offset:0
  global_load_dwordx4 a[228:231], v133, s[16:17] offset:1024
  global_load_dwordx4 a[232:235], v133, s[16:17] offset:2048
  global_load_dwordx4 a[236:239], v133, s[16:17] offset:3072
  s_add_u32 s16, s16, 4096
  s_addc_u32 s17, s17, 0
  global_load_dwordx4 a[240:243], v133, s[16:17] offset:0
  global_load_dwordx4 a[244:247], v133, s[16:17] offset:1024
  global_load_dwordx4 a[248:251], v133, s[16:17] offset:2048
  global_load_dwordx4 a[252:255], v133, s[16:17] offset:3072
  s_add_u32 s16, s16, 4096
  s_addc_u32 s17, s17, 0
  global_load_dwordx4 v[176:179], v133, s[16:17] offset:0
  global_load_dwordx4 v[180:183], v133, s[16:17] offset:1024
  global_load_dwordx4 v[184:187], v133, s[16:17] offset:2048
  global_load_dwordx4 v[188:191], v133, s[16:17] offset:3072
  s_add_u32 s16, s16, 4096
  s_addc_u32 s17, s17, 0
  global_load_dwordx4 v[192:195], v133, s[16:17] offset:0
  global_load_dwordx4 v[196:199], v133, s[16:17] offset:1024
  global_load_dwordx4 v[200:203], v133, s[16:17] offset:2048
  global_load_dwordx4 v[204:207], v133, s[16:17] offset:3072
  s_add_u32 s16, s16, 4096
  s_addc_u32 s17, s17, 0
  global_load_dwordx4 v[208:211], v133, s[16:17] offset:0
  global_load_dwordx4 v[212:215], v133, s[16:17] offset:1024
  global_load_dwordx4 v[216:219], v133, s[16:17] offset:2048
  global_load_dwordx4 v[220:223], v133, s[16:17] offset:3072
  s_add_u32 s16, s16, 4096
  s_addc_u32 s17, s17, 0
  global_load_dwordx4 v[224:227], v133, s[16:17] offset:0
  global_load_dwordx4 v[228:231], v133, s[16:17] offset:1024
  global_load_dwordx4 v[232:235], v133, s[16:17] offset:2048
  global_load_dwordx4 v[236:239], v133, s[16:17] offset:3072
  s_add_u32 s16, s16, 4096
  s_addc_u32 s17, s17, 0
  global_load_dwordx4 v[240:243], v133, s[16:17] offset:0
  global_load_dwordx4 v[244:247], v133, s[16:17] offset:1024
  global_load_dwordx4 v[248:251], v133, s[16:17] offset:2048
  global_load_dwordx4 v[252:255], v133, s[16:17] offset:3072
  s_add_u32 s16, s16, 4096
  s_addc_u32 s17, s17, 0
  v_and_b32 v140, 15, v0
  v_bfe_u32 v141, v0, 4, 2
  v_bfe_u32 v142, v0, 5, 1
  v_lshlrev_b32 v136, 8, v142
  v_bfe_u32 v142, v0, 3, 1
  v_lshl_add_u32 v136, v142, 7, v136
  v_and_b32 v142, 7, v0
  v_lshl_add_u32 v136, v142, 4, v136
  s_lshl_b32 s14, s8, 9
  v_add_u32 v136, s14, v136
  v_and_b32 v142, 1, v141
  v_mul_u32_u24 v137, 576, v142
  v_lshrrev_b32 v142, 1, v141
  v_mul_u32_u24 v142, 144, v142
  v_add_u32 v137, v137, v142
  s_mul_i32 s14, s8, 1152
  v_add_u32 v137, s14, v137
  v_bfe_u32 v142, v0, 1, 1
  v_lshl_add_u32 v137, v142, 5, v137
  v_bfe_u32 v142, v0, 3, 1
  v_lshl_add_u32 v137, v142, 4, v137
  v_bfe_u32 v142, v0, 2, 1
  v_lshl_add_u32 v137, v142, 3, v137
  v_and_b32 v142, 1, v0
  v_lshl_add_u32 v137, v142, 2, v137
  v_add_u32 v137, 8192, v137
  v_and_b32 v140, 31, v0
  s_lshl_b32 s14, s8, 5
  v_add_u32 v140, s14, v140
  v_bfe_u32 v142, v140, 2, 3
  v_mul_u32_u24 v139, 896, v142
  v_bfe_u32 v142, v140, 6, 1
  v_lshl_add_u32 v139, v142, 5, v139
  v_and_b32 v142, 3, v140
  v_lshl_add_u32 v139, v142, 3, v139
  v_bfe_u32 v142, v140, 5, 1
  v_lshl_add_u32 v139, v142, 2, v139
  v_bfe_u32 v142, v140, 2, 3
  v_mul_u32_u24 v138, 144, v142
  v_bfe_u32 v142, v140, 5, 2
  v_lshl_add_u32 v138, v142, 5, v138
  v_and_b32 v142, 3, v140
  v_lshl_add_u32 v138, v142, 3, v138
  v_add_u32 v138, 8192, v138
  s_mov_b32 s10, 0
  s_add_u32 s12, s4, 49807360
  s_addc_u32 s13, s5, 0
  s_mul_i32 s14, s65, 458752
  s_add_u32 s12, s12, s14
  s_addc_u32 s13, s13, 0
  s_lshr_b32 s14, s43, 1
  s_lshl_b32 s14, s14, 10
  s_and_b32 s15, s43, 1
  s_lshl_b32 s15, s15, 9
  s_add_u32 s14, s14, s15
  s_lshl_b32 s14, s43, 6
  s_mul_i32 s15, s65, 458752
  s_add_u32 s14, s14, s15
  s_add_u32 s28, s4, 54263808
  s_addc_u32 s29, s5, 0
  s_add_u32 s28, s28, s14
  s_addc_u32 s29, s29, 0
  s_lshl_b32 s14, s8, 11
  s_add_u32 s22, s4, 51642368
  s_addc_u32 s23, s5, 0
  s_add_u32 s22, s22, s14
  s_addc_u32 s23, s23, 0
  s_add_u32 s24, s4, 53739520
  s_addc_u32 s25, s5, 0
  s_lshl_b32 s14, s65, 19
  s_add_u32 s22, s22, s14
  s_addc_u32 s23, s23, 0
  s_lshl_b32 s14, s65, 17
  s_add_u32 s24, s24, s14
  s_addc_u32 s25, s25, 0
  s_mul_i32 s14, s8, 114688
  s_lshl_b32 s15, s43, 11
  s_add_u32 s14, s14, s15
  s_add_u32 s30, s4, 12845056
  s_addc_u32 s31, s5, 0
  s_add_u32 s30, s30, s14
  s_addc_u32 s31, s31, 0
  s_add_u32 s32, s30, 28672
  s_addc_u32 s33, s31, 0
  s_add_u32 s34, s30, 57344
  s_addc_u32 s35, s31, 0
  s_add_u32 s36, s30, 86016
  s_addc_u32 s37, s31, 0
  s_waitcnt vmcnt(0) lgkmcnt(0)
  s_mov_b32 s11, 0
  v_mov_b32 v1, 1024
L_vxw_40:
  global_load_dword v2, v1, s[86:87] sc1
  s_waitcnt vmcnt(0)
  v_cmp_gt_u32 vcc, 84, v2
  s_cbranch_vccz L_vxg_41
  s_add_u32 s11, s11, 1
  s_cmp_gt_u32 s11, 262144
  s_cbranch_scc1 L_abort
  s_sleep 8
  s_branch L_vxw_40
L_vxg_41:
  s_cmp_lt_u32 s65, 2
  s_cbranch_scc1 L_stg_42
  s_add_u32 s16, s4, 48721920
  s_addc_u32 s17, s5, 0
  s_mov_b32 s11, 0
  v_mov_b32 v1, 0
L_stgp_43:
  global_load_dword v2, v1, s[16:17] sc1
  s_waitcnt vmcnt(0)
  v_cmp_eq_u32 vcc, -1, v2
  s_cbranch_vccz L_stg_42
  s_add_u32 s11, s11, 1
  s_cmp_gt_u32 s11, 262144
  s_cbranch_scc1 L_abort
  s_sleep 8
  s_branch L_stgp_43
L_stg_42:
  s_barrier
  global_load_dwordx4 v[144:147], v134, s[12:13] sc1
  global_load_dwordx4 v[148:151], v135, s[12:13] sc1
  s_waitcnt vmcnt(0)
L_B_loop_44:
  v_max3_u32 v44, v144, v145, v146
  v_max3_u32 v44, v44, v147, v148
  v_max3_u32 v44, v44, v149, v150
  v_max_u32 v44, v44, v151
  v_cmp_eq_u32 vcc, -1, v44
  s_cbranch_vccnz L_B_reg_45
  ds_write_b128 v134, v[144:147]
  ds_write_b128 v135, v[148:151]
  s_waitcnt lgkmcnt(0)
  s_barrier
  s_branch L_B_st_46
L_B_reg_45:
  s_mov_b32 s11, 0
L_B_pa_47:
  global_load_dwordx4 v[36:39], v134, s[12:13] sc1
  global_load_dwordx4 v[40:43], v135, s[12:13] sc1
  s_waitcnt vmcnt(0)
  v_max3_u32 v44, v36, v37, v38
  v_max3_u32 v44, v44, v39, v40
  v_max3_u32 v44, v44, v41, v42
  v_max_u32 v44, v44, v43
  v_cmp_eq_u32 vcc, -1, v44
  s_cbranch_vccz L_B_ga_48
  s_add_u32 s11, s11, 1
  s_cmp_gt_u32 s11, 262144
  s_cbranch_scc1 L_abort
  s_branch L_B_pa_47
L_B_ga_48:
  ds_write_b128 v134, v[36:39]
  ds_write_b128 v135, v[40:43]
  s_waitcnt lgkmcnt(0)
  s_barrier
L_B_st_46:
  ds_read_b128 v[4:7], v133 offset:0
  ds_read_b128 v[8:11], v133 offset:1024
  ds_read_b128 v[12:15], v133 offset:2048
  ds_read_b128 v[16:19], v133 offset:3072
  ds_read_b128 v[20:23], v133 offset:4096
  ds_read_b128 v[24:27], v133 offset:5120
  ds_read_b128 v[28:31], v133 offset:6144
  s_waitcnt vmcnt(0)
  s_cmp_lg_u32 s10, 3
  s_cbranch_scc1 L_n8_51
  v_cmp_gt_u32 vcc, 84, v164
  s_cbranch_vccz L_n8_51
  s_mov_b32 s11, 0
  v_mov_b32 v1, 1152
L_vxw_52:
  global_load_dword v2, v1, s[86:87] sc1
  s_waitcnt vmcnt(0)
  v_cmp_gt_u32 vcc, 84, v2
  s_cbranch_vccz L_vxg_53
  s_add_u32 s11, s11, 1
  s_cmp_gt_u32 s11, 262144
  s_cbranch_scc1 L_abort
  s_sleep 8
  s_branch L_vxw_52
L_vxg_53:
L_n8_51:
  s_cmp_lg_u32 s10, 15
  s_cbranch_scc1 L_n8_54
  v_cmp_gt_u32 vcc, 84, v164
  s_cbranch_vccz L_n8_54
  s_mov_b32 s11, 0
  v_mov_b32 v1, 1280
L_vxw_55:
  global_load_dword v2, v1, s[86:87] sc1
  s_waitcnt vmcnt(0)
  v_cmp_gt_u32 vcc, 84, v2
  s_cbranch_vccz L_vxg_56
  s_add_u32 s11, s11, 1
  s_cmp_gt_u32 s11, 262144
  s_cbranch_scc1 L_abort
  s_sleep 8
  s_branch L_vxw_55
L_vxg_56:
L_n8_54:
  s_cmp_lg_u32 s10, 2
  s_cbranch_scc1 L_n9_57
  v_mov_b32 v164, 1152
  global_load_dword v164, v164, s[86:87] sc1
L_n9_57:
  s_cmp_lg_u32 s10, 14
  s_cbranch_scc1 L_n9_58
  v_mov_b32 v164, 1280
  global_load_dword v164, v164, s[86:87] sc1
L_n9_58:
  v_mov_b64 v[32:33], 0
  v_mov_b64 v[34:35], 0
  v_mov_b64 v[156:157], 0
  v_mov_b64 v[158:159], 0
  v_mov_b64 v[160:161], 0
  v_mov_b64 v[162:163], 0
  ds_read_b128 v[116:119], v143 offset:0
  ds_read_b128 v[120:123], v143 offset:1024
  ds_read_b128 v[124:127], v143 offset:2048
  ds_read_b128 v[128:131], v143 offset:3072
  s_waitcnt lgkmcnt(10)
  v_smfmac_f32_16x16x64_bf16 v[32:35], v[4:7], a[0:7], v132
  s_waitcnt lgkmcnt(9)
  v_smfmac_f32_16x16x64_bf16 v[32:35], v[8:11], a[8:15], v132
  global_load_dwordx4 v[64:67], v133, s[30:31] offset:0
  s_waitcnt lgkmcnt(8)
  v_smfmac_f32_16x16x64_bf16 v[32:35], v[12:15], a[16:23], v132
  s_waitcnt lgkmcnt(2)
  v_smfmac_f32_16x16x64_bf16 v[156:159], v[4:7], v[116:123], v132
  ds_read_b128 v[116:119], v143 offset:4096
  ds_read_b128 v[120:123], v143 offset:5120
  v_mov_b64 v[36:37], 0
  v_smfmac_f32_16x16x64_bf16 v[32:35], v[16:19], a[24:31], v132
  v_mov_b64 v[38:39], 0
  v_smfmac_f32_16x16x64_bf16 v[32:35], v[20:23], a[32:39], v132
  global_load_dwordx4 v[68:71], v133, s[32:33] offset:0
  v_smfmac_f32_16x16x64_bf16 v[32:35], v[24:27], a[40:47], v132
  s_waitcnt lgkmcnt(2)
  v_smfmac_f32_16x16x64_bf16 v[156:159], v[8:11], v[124:131], v132
  ds_read_b128 v[124:127], v143 offset:6144
  ds_read_b128 v[128:131], v143 offset:7168
  v_smfmac_f32_16x16x64_bf16 v[32:35], v[28:31], a[48:55], v132
  v_smfmac_f32_16x16x64_bf16 v[36:39], v[4:7], a[56:63], v132
  global_load_dwordx4 v[72:75], v133, s[34:35] offset:0
  v_smfmac_f32_16x16x64_bf16 v[36:39], v[8:11], a[64:71], v132
  s_waitcnt lgkmcnt(2)
  v_smfmac_f32_16x16x64_bf16 v[156:159], v[12:15], v[116:123], v132
  ds_read_b128 v[116:119], v143 offset:8192
  ds_read_b128 v[120:123], v143 offset:9216
  v_cvt_pk_bf16_f32 v48, v32, v33
  v_smfmac_f32_16x16x64_bf16 v[36:39], v[12:15], a[72:79], v132
  v_cvt_pk_bf16_f32 v50, v34, v35
  v_smfmac_f32_16x16x64_bf16 v[36:39], v[16:19], a[80:87], v132
  global_load_dwordx4 v[76:79], v133, s[36:37] offset:0
  v_mov_b64 v[40:41], 0
  v_smfmac_f32_16x16x64_bf16 v[36:39], v[20:23], a[88:95], v132
  v_mov_b64 v[42:43], 0
  s_waitcnt lgkmcnt(2)
  v_smfmac_f32_16x16x64_bf16 v[156:159], v[16:19], v[124:131], v132
  ds_read_b128 v[124:127], v143 offset:10240
  ds_read_b128 v[128:131], v143 offset:11264
  v_smfmac_f32_16x16x64_bf16 v[36:39], v[24:27], a[96:103], v132
  v_smfmac_f32_16x16x64_bf16 v[36:39], v[28:31], a[104:111], v132
  global_load_dwordx4 v[80:83], v133, s[30:31] offset:1024
  v_smfmac_f32_16x16x64_bf16 v[40:43], v[4:7], a[112:119], v132
  s_waitcnt lgkmcnt(2)
  v_smfmac_f32_16x16x64_bf16 v[156:159], v[20:23], v[116:123], v132
  ds_read_b128 v[116:119], v143 offset:12288
  ds_read_b128 v[120:123], v143 offset:13312
  v_smfmac_f32_16x16x64_bf16 v[40:43], v[8:11], a[120:127], v132
  v_cvt_pk_bf16_f32 v56, v36, v37
  v_smfmac_f32_16x16x64_bf16 v[40:43], v[12:15], a[128:135], v132
  global_load_dwordx4 v[84:87], v133, s[32:33] offset:1024
  v_cvt_pk_bf16_f32 v58, v38, v39
  v_smfmac_f32_16x16x64_bf16 v[40:43], v[16:19], a[136:143], v132
  v_mov_b64 v[32:33], 0
  s_waitcnt lgkmcnt(2)
  v_smfmac_f32_16x16x64_bf16 v[156:159], v[24:27], v[124:131], v132
  ds_read_b128 v[124:127], v143 offset:14336
  ds_read_b128 v[128:131], v143 offset:15360
  v_mov_b64 v[34:35], 0
  v_smfmac_f32_16x16x64_bf16 v[40:43], v[20:23], a[144:151], v132
  v_smfmac_f32_16x16x64_bf16 v[40:43], v[24:27], a[152:159], v132
  global_load_dwordx4 v[88:91], v133, s[34:35] offset:1024
  v_smfmac_f32_16x16x64_bf16 v[40:43], v[28:31], a[160:167], v132
  s_waitcnt lgkmcnt(2)
  v_smfmac_f32_16x16x64_bf16 v[156:159], v[28:31], v[116:123], v132
  ds_read_b128 v[116:119], v143 offset:16384
  ds_read_b128 v[120:123], v143 offset:17408
  v_smfmac_f32_16x16x64_bf16 v[32:35], v[4:7], a[168:175], v132
  v_smfmac_f32_16x16x64_bf16 v[32:35], v[8:11], a[176:183], v132
  global_load_dwordx4 v[92:95], v133, s[36:37] offset:1024
  v_cvt_pk_bf16_f32 v49, v40, v41
  v_smfmac_f32_16x16x64_bf16 v[32:35], v[12:15], a[184:191], v132
  v_cvt_pk_bf16_f32 v51, v42, v43
  s_waitcnt lgkmcnt(2)
  v_smfmac_f32_16x16x64_bf16 v[160:163], v[4:7], v[124:131], v132
  ds_read_b128 v[124:127], v143 offset:18432
  ds_read_b128 v[128:131], v143 offset:19456
  v_cvt_pk_bf16_f32 v53, v156, v157
  v_smfmac_f32_16x16x64_bf16 v[32:35], v[16:19], a[192:199], v132
  v_cvt_pk_bf16_f32 v55, v158, v159
  v_smfmac_f32_16x16x64_bf16 v[32:35], v[20:23], a[200:207], v132
  v_mov_b64 v[36:37], 0
  v_smfmac_f32_16x16x64_bf16 v[32:35], v[24:27], a[208:215], v132
  v_mov_b64 v[38:39], 0
  s_waitcnt lgkmcnt(2)
  v_smfmac_f32_16x16x64_bf16 v[160:163], v[8:11], v[116:123], v132
  ds_read_b128 v[116:119], v143 offset:20480
  ds_read_b128 v[120:123], v143 offset:21504
  v_smfmac_f32_16x16x64_bf16 v[32:35], v[28:31], a[216:223], v132
  v_smfmac_f32_16x16x64_bf16 v[36:39], v[4:7], a[224:231], v132
  v_smfmac_f32_16x16x64_bf16 v[36:39], v[8:11], a[232:239], v132
  s_waitcnt lgkmcnt(2)
  v_smfmac_f32_16x16x64_bf16 v[160:163], v[12:15], v[124:131], v132
  ds_read_b128 v[124:127], v143 offset:22528
  ds_read_b128 v[128:131], v143 offset:23552
  v_cvt_pk_bf16_f32 v57, v32, v33
  v_smfmac_f32_16x16x64_bf16 v[36:39], v[12:15], a[240:247], v132
  v_cvt_pk_bf16_f32 v59, v34, v35
  v_smfmac_f32_16x16x64_bf16 v[36:39], v[16:19], a[248:255], v132
  v_mov_b64 v[40:41], 0
  v_smfmac_f32_16x16x64_bf16 v[36:39], v[20:23], v[176:183], v132
  v_mov_b64 v[42:43], 0
  s_waitcnt lgkmcnt(2)
  v_smfmac_f32_16x16x64_bf16 v[160:163], v[16:19], v[116:123], v132
  ds_read_b128 v[116:119], v143 offset:24576
  ds_read_b128 v[120:123], v143 offset:25600
  v_smfmac_f32_16x16x64_bf16 v[36:39], v[24:27], v[184:191], v132
  v_smfmac_f32_16x16x64_bf16 v[36:39], v[28:31], v[192:199], v132
  v_smfmac_f32_16x16x64_bf16 v[40:43], v[4:7], v[200:207], v132
  s_waitcnt lgkmcnt(2)
  v_smfmac_f32_16x16x64_bf16 v[160:163], v[20:23], v[124:131], v132
  ds_read_b128 v[124:127], v143 offset:26624
  ds_read_b128 v[128:131], v143 offset:27648
  v_smfmac_f32_16x16x64_bf16 v[40:43], v[8:11], v[208:215], v132
  v_cvt_pk_bf16_f32 v52, v36, v37
  v_smfmac_f32_16x16x64_bf16 v[40:43], v[12:15], v[216:223], v132
  v_cvt_pk_bf16_f32 v54, v38, v39
  v_smfmac_f32_16x16x64_bf16 v[40:43], v[16:19], v[224:231], v132
  s_waitcnt lgkmcnt(2)
  v_smfmac_f32_16x16x64_bf16 v[160:163], v[24:27], v[116:123], v132
  v_smfmac_f32_16x16x64_bf16 v[40:43], v[20:23], v[232:239], v132
  v_smfmac_f32_16x16x64_bf16 v[40:43], v[24:27], v[240:247], v132
  v_smfmac_f32_16x16x64_bf16 v[40:43], v[28:31], v[248:255], v132
  s_waitcnt lgkmcnt(0)
  v_smfmac_f32_16x16x64_bf16 v[160:163], v[28:31], v[124:131], v132
  s_nop 7
  v_cvt_pk_bf16_f32 v60, v40, v41
  v_cvt_pk_bf16_f32 v62, v42, v43
  v_cvt_pk_bf16_f32 v61, v160, v161
  v_cvt_pk_bf16_f32 v63, v162, v163
  s_add_u32 s30, s30, 458752
  s_addc_u32 s31, s31, 0
  s_add_u32 s32, s32, 458752
  s_addc_u32 s33, s33, 0
  s_add_u32 s34, s34, 458752
  s_addc_u32 s35, s35, 0
  s_add_u32 s36, s36, 458752
  s_addc_u32 s37, s37, 0
  v_mov_b32 v108, 0
  v_mov_b32 v109, 0
  v_mov_b32 v110, 0
  v_mov_b32 v111, 0
  v_mov_b32 v112, 0
  v_mov_b32 v113, 0
  v_mov_b32 v114, 0
  v_mov_b32 v115, 0
  s_add_u32 s14, s12, 7168
  s_addc_u32 s15, s13, 0
  global_load_dwordx4 v[144:147], v134, s[14:15] sc1
  global_load_dwordx4 v[148:151], v135, s[14:15] sc1
  s_mov_b32 s11, 0
L_Bp_pa_59:
  global_load_dwordx4 v[96:99], v133, s[22:23] sc1
  global_load_dwordx4 v[100:103], v133, s[22:23] offset:1024 sc1
  global_load_dwordx4 v[104:107], v136, s[24:25] sc1
  s_waitcnt vmcnt(0)
  v_max3_u32 v140, v96, v97, v98
  v_max3_u32 v140, v140, v99, v100
  v_max3_u32 v140, v140, v101, v102
  v_max3_u32 v140, v140, v103, v104
  v_max3_u32 v140, v140, v105, v106
  v_max_u32 v140, v140, v107
  v_cmp_eq_u32 vcc, -1, v140
  s_cbranch_vccz L_Bp_ga_60
  s_add_u32 s11, s11, 1
  s_cmp_gt_u32 s11, 262144
  s_cbranch_scc1 L_abort
  s_branch L_Bp_pa_59
L_Bp_ga_60:
  v_smfmac_f32_16x16x64_bf16 v[108:111], v[104:107], v[48:55], v132
  v_smfmac_f32_16x16x64_bf16 v[108:111], v[96:99], v[64:71], v132
  v_smfmac_f32_16x16x64_bf16 v[108:111], v[100:103], v[72:79], v132
  v_smfmac_f32_16x16x64_bf16 v[112:115], v[104:107], v[56:63], v132
  v_smfmac_f32_16x16x64_bf16 v[112:115], v[96:99], v[80:87], v132
  v_smfmac_f32_16x16x64_bf16 v[112:115], v[100:103], v[88:95], v132
  v_permlane32_swap_b32 v108, v109
  v_permlane32_swap_b32 v110, v111
  v_add_f32 v108, v108, v109
  v_add_f32 v110, v110, v111
  ds_write_b32 v137, v108 offset:0
  ds_write_b32 v137, v110 offset:288
  s_nop 0
  v_permlane32_swap_b32 v112, v113
  v_permlane32_swap_b32 v114, v115
  v_add_f32 v112, v112, v113
  v_add_f32 v114, v114, v115
  ds_write_b32 v137, v112 offset:64
  ds_write_b32 v137, v114 offset:352
  s_waitcnt lgkmcnt(0)
  s_barrier
  ds_read_b64 v[32:33], v138 offset:0
  ds_read_b64 v[34:35], v138 offset:1152
  ds_read_b64 v[36:37], v138 offset:2304
  ds_read_b64 v[38:39], v138 offset:3456
  s_waitcnt lgkmcnt(2)
  v_pk_add_f32 v[32:33], v[32:33], v[34:35]
  s_waitcnt lgkmcnt(0)
  v_pk_add_f32 v[36:37], v[36:37], v[38:39]
  v_pk_add_f32 v[32:33], v[32:33], v[36:37]
  v_cvt_pk_bf16_f32 v32, v32, v33
  v_min_u32 v32, -2, v32
  global_store_dword v139, v32, s[28:29]
  s_add_u32 s12, s12, 7168
  s_addc_u32 s13, s13, 0
  s_add_u32 s28, s28, 7168
  s_addc_u32 s29, s29, 0
  s_add_u32 s22, s22, 8192
  s_addc_u32 s23, s23, 0
  s_add_u32 s24, s24, 2048
  s_addc_u32 s25, s25, 0
  s_add_u32 s10, s10, 1
  s_cmp_lt_u32 s10, 64
  s_cbranch_scc1 L_B_loop_44
  s_branch L_pdone
L_qL:
  v_and_b32 v5, 31, v0
  v_lshlrev_b32 v5, 7, v5
  v_lshrrev_b32 v6, 5, v0
  v_lshl_add_u32 v6, v6, 2, v5
  v_add_u32 v6, 61513728, v6
  s_mov_b32 s11, 0
L_wa_63:
  global_load_dword v7, v6, s[4:5] sc1
  s_waitcnt vmcnt(0)
  v_cmp_ne_u32 vcc, s88, v7
  s_cbranch_vccz L_wag_64
  s_add_u32 s11, s11, 1
  s_cmp_gt_u32 s11, 262144
  s_cbranch_scc1 L_abort
  s_branch L_wa_63
L_wag_64:
  v_and_b32 v6, 31, v0
  v_lshlrev_b32 v6, 7, v6
  v_lshrrev_b32 v7, 5, v0
  v_lshl_add_u32 v7, v7, 2, v6
  v_add_u32 v7, 61513728, v7
  global_load_dword v7, v7, s[4:5] sc1
  v_and_b32 v4, 7, v0
  v_lshlrev_b32 v4, 5, v4
  global_load_dword v4, v4, s[6:7] sc1
  s_waitcnt vmcnt(0)
  v_cmp_ne_u32 vcc, 32, v4
  s_cbranch_vccnz L_cfbad_66
  v_cmp_ne_u32 vcc, s88, v7
  s_cbranch_vccnz L_cfbad_66
  s_branch L_cfok_65
L_cfbad_66:
  v_mov_b32 v4, 135168
  ds_write_b32 v4, v4
L_cfok_65:
  s_waitcnt lgkmcnt(0)
  s_barrier
  v_mov_b32 v4, 135168
  ds_read_b32 v4, v4
  s_waitcnt lgkmcnt(0)
  s_nop 0
  v_readfirstlane_b32 s14, v4
  s_nop 3
  s_cmp_lg_u32 s14, 0
  s_cbranch_scc1 L_recheck
  v_and_b32 v9, 31, v0
  v_min_u32 v9, 27, v9
  v_bfe_u32 v10, v0, 5, 1
  s_lshl_b32 s14, s8, 1
  v_add_u32 v10, s14, v10
  v_mul_u32_u24 v2, 896, v10
  v_lshl_add_u32 v2, v9, 4, v2
  v_mul_u32_u24 v3, 912, v10
  v_lshl_add_u32 v3, v9, 4, v3
  v_and_b32 v9, 31, v0
  v_cmp_gt_u32 s[62:63], 28, v9
  v_bfe_u32 v9, v0, 2, 2
  v_mul_u32_u24 v4, 912, v9
  v_and_b32 v9, 3, v0
  v_lshl_add_u32 v4, v9, 3, v4
  v_bfe_u32 v9, v0, 4, 2
  s_mul_i32 s14, s8, 7
  v_add_u32 v10, s14, v9
  v_lshl_add_u32 v4, v10, 5, v4
  v_lshlrev_b32 v5, 10, v10
  v_and_b32 v10, 15, v0
  v_lshl_add_u32 v5, v10, 4, v5
  s_lshl_b32 s14, s65, 8
  v_add_u32 v5, s14, v5
  v_cmp_eq_u32 vcc, 3, v9
  v_mov_b32 v8, 4
  v_mov_b32 v10, 3
  s_nop 0
  v_cndmask_b32 v8, v8, v10, vcc
  v_lshl_add_u32 v11, v8, 5, v4
  v_lshl_add_u32 v1, v8, 10, v5
  s_mul_i32 s14, s65, 458752
  s_add_u32 s12, s4, 54263808
  s_addc_u32 s13, s5, 0
  s_add_u32 s12, s12, s14
  s_addc_u32 s13, s13, 0
  s_mul_i32 s14, s65, 7168
  s_add_u32 s26, s70, s14
  s_addc_u32 s27, s71, 0
  s_add_u32 s22, s4, 57933824
  s_addc_u32 s23, s5, 0
  s_add_u32 s22, s22, s14
  s_addc_u32 s23, s23, 0
  s_add_u32 s24, s4, 56098816
  s_addc_u32 s25, s5, 0
  global_load_dwordx4 v[48:51], v2, s[26:27]
  global_load_dwordx4 v[52:55], v2, s[26:27] offset:448
  s_mov_b32 s10, 0
L_L_loop_67:
  s_mov_b32 s11, 0
L_L_poll_68:
  global_load_dwordx4 v[12:15], v2, s[12:13] sc1
  global_load_dwordx4 v[16:19], v2, s[12:13] offset:448 sc1
  s_waitcnt vmcnt(0)
  v_max3_u32 v9, v12, v13, v14
  v_max3_u32 v9, v9, v15, v16
  v_max3_u32 v9, v9, v17, v18
  v_max_u32 v9, v9, v19
  v_cmp_eq_u32 vcc, -1, v9
  s_cbranch_vccz L_L_got_69
  s_add_u32 s11, s11, 1
  s_cmp_gt_u32 s11, 262144
  s_cbranch_scc1 L_abort
  s_sleep 2
  s_branch L_L_poll_68
L_L_got_69:
  v_mov_b64 v[20:21], v[48:49]
  v_mov_b64 v[22:23], v[50:51]
  v_mov_b64 v[24:25], v[52:53]
  v_mov_b64 v[26:27], v[54:55]
  v_lshlrev_b32 v32, 16, v12
  v_and_b32 v33, 0xffff0000, v12
  v_lshlrev_b32 v9, 16, v20
  v_and_b32 v10, 0xffff0000, v20
  v_add_f32 v32, v32, v9
  v_add_f32 v33, v33, v10
  v_cvt_pk_bf16_f32 v12, v32, v33
  v_lshlrev_b32 v34, 16, v13
  v_and_b32 v35, 0xffff0000, v13
  v_lshlrev_b32 v9, 16, v21
  v_and_b32 v10, 0xffff0000, v21
  v_add_f32 v34, v34, v9
  v_add_f32 v35, v35, v10
  v_cvt_pk_bf16_f32 v13, v34, v35
  v_lshlrev_b32 v36, 16, v14
  v_and_b32 v37, 0xffff0000, v14
  v_lshlrev_b32 v9, 16, v22
  v_and_b32 v10, 0xffff0000, v22
  v_add_f32 v36, v36, v9
  v_add_f32 v37, v37, v10
  v_cvt_pk_bf16_f32 v14, v36, v37
  v_lshlrev_b32 v38, 16, v15
  v_and_b32 v39, 0xffff0000, v15
  v_lshlrev_b32 v9, 16, v23
  v_and_b32 v10, 0xffff0000, v23
  v_add_f32 v38, v38, v9
  v_add_f32 v39, v39, v10
  v_cvt_pk_bf16_f32 v15, v38, v39
  v_lshlrev_b32 v40, 16, v16
  v_and_b32 v41, 0xffff0000, v16
  v_lshlrev_b32 v9, 16, v24
  v_and_b32 v10, 0xffff0000, v24
  v_add_f32 v40, v40, v9
  v_add_f32 v41, v41, v10
  v_cvt_pk_bf16_f32 v16, v40, v41
  v_lshlrev_b32 v42, 16, v17
  v_and_b32 v43, 0xffff0000, v17
  v_lshlrev_b32 v9, 16, v25
  v_and_b32 v10, 0xffff0000, v25
  v_add_f32 v42, v42, v9
  v_add_f32 v43, v43, v10
  v_cvt_pk_bf16_f32 v17, v42, v43
  v_lshlrev_b32 v44, 16, v18
  v_and_b32 v45, 0xffff0000, v18
  v_lshlrev_b32 v9, 16, v26
  v_and_b32 v10, 0xffff0000, v26
  v_add_f32 v44, v44, v9
  v_add_f32 v45, v45, v10
  v_cvt_pk_bf16_f32 v18, v44, v45
  v_lshlrev_b32 v46, 16, v19
  v_and_b32 v47, 0xffff0000, v19
  v_lshlrev_b32 v9, 16, v27
  v_and_b32 v10, 0xffff0000, v27
  v_add_f32 v46, v46, v9
  v_add_f32 v47, v47, v10
  v_cvt_pk_bf16_f32 v19, v46, v47
  global_store_dwordx4 v2, v[12:15], s[22:23] sc1
  global_store_dwordx4 v2, v[16:19], s[22:23] offset:448 sc1
  v_lshlrev_b32 v32, 16, v12
  v_and_b32 v33, 0xffff0000, v12
  v_lshlrev_b32 v34, 16, v13
  v_and_b32 v35, 0xffff0000, v13
  v_lshlrev_b32 v36, 16, v14
  v_and_b32 v37, 0xffff0000, v14
  v_lshlrev_b32 v38, 16, v15
  v_and_b32 v39, 0xffff0000, v15
  v_lshlrev_b32 v40, 16, v16
  v_and_b32 v41, 0xffff0000, v16
  v_lshlrev_b32 v42, 16, v17
  v_and_b32 v43, 0xffff0000, v17
  v_lshlrev_b32 v44, 16, v18
  v_and_b32 v45, 0xffff0000, v18
  v_lshlrev_b32 v46, 16, v19
  v_and_b32 v47, 0xffff0000, v19
  v_add_f32 v9, v32, v33
  v_add_f32 v9, v9, v34
  v_add_f32 v9, v9, v35
  v_add_f32 v9, v9, v36
  v_add_f32 v9, v9, v37
  v_add_f32 v9, v9, v38
  v_add_f32 v9, v9, v39
  v_add_f32 v9, v9, v40
  v_add_f32 v9, v9, v41
  v_add_f32 v9, v9, v42
  v_add_f32 v9, v9, v43
  v_add_f32 v9, v9, v44
  v_add_f32 v9, v9, v45
  v_add_f32 v9, v9, v46
  v_add_f32 v9, v9, v47
  v_cndmask_b32 v9, 0, v9, s[62:63]
  s_nop 1
  v_add_f32_dpp v9, v9, v9 row_ror:8 row_mask:0xf bank_mask:0xf
  s_nop 1
  v_add_f32_dpp v9, v9, v9 row_ror:4 row_mask:0xf bank_mask:0xf
  s_nop 1
  v_add_f32_dpp v9, v9, v9 row_ror:2 row_mask:0xf bank_mask:0xf
  s_nop 1
  v_add_f32_dpp v9, v9, v9 row_ror:1 row_mask:0xf bank_mask:0xf
  v_mov_b32 v10, v9
  s_nop 1
  v_permlane16_swap_b32 v9, v10
  v_add_f32 v9, v9, v10
  v_mul_f32 v9, 0x3b124925, v9
  v_sub_f32 v32, v32, v9
  v_sub_f32 v33, v33, v9
  v_sub_f32 v34, v34, v9
  v_sub_f32 v35, v35, v9
  v_sub_f32 v36, v36, v9
  v_sub_f32 v37, v37, v9
  v_sub_f32 v38, v38, v9
  v_sub_f32 v39, v39, v9
  v_sub_f32 v40, v40, v9
  v_sub_f32 v41, v41, v9
  v_sub_f32 v42, v42, v9
  v_sub_f32 v43, v43, v9
  v_sub_f32 v44, v44, v9
  v_sub_f32 v45, v45, v9
  v_sub_f32 v46, v46, v9
  v_sub_f32 v47, v47, v9
  v_mul_f32 v9, v32, v32
  v_fmac_f32 v9, v33, v33
  v_fmac_f32 v9, v34, v34
  v_fmac_f32 v9, v35, v35
  v_fmac_f32 v9, v36, v36
  v_fmac_f32 v9, v37, v37
  v_fmac_f32 v9, v38, v38
  v_fmac_f32 v9, v39, v39
  v_fmac_f32 v9, v40, v40
  v_fmac_f32 v9, v41, v41
  v_fmac_f32 v9, v42, v42
  v_fmac_f32 v9, v43, v43
  v_fmac_f32 v9, v44, v44
  v_fmac_f32 v9, v45, v45
  v_fmac_f32 v9, v46, v46
  v_fmac_f32 v9, v47, v47
  v_cndmask_b32 v9, 0, v9, s[62:63]
  s_nop 1
  v_add_f32_dpp v9, v9, v9 row_ror:8 row_mask:0xf bank_mask:0xf
  s_nop 1
  v_add_f32_dpp v9, v9, v9 row_ror:4 row_mask:0xf bank_mask:0xf
  s_nop 1
  v_add_f32_dpp v9, v9, v9 row_ror:2 row_mask:0xf bank_mask:0xf
  s_nop 1
  v_add_f32_dpp v9, v9, v9 row_ror:1 row_mask:0xf bank_mask:0xf
  v_mov_b32 v10, v9
  s_nop 1
  v_permlane16_swap_b32 v9, v10
  v_add_f32 v9, v9, v10
  v_mov_b32 v10, 0x3727c5ac
  v_fmac_f32 v10, 0x3b124925, v9
  v_rsq_f32 v10, v10
  s_nop 0
  v_mul_f32 v32, v32, v10
  v_mul_f32 v33, v33, v10
  v_mul_f32 v34, v34, v10
  v_mul_f32 v35, v35, v10
  v_mul_f32 v36, v36, v10
  v_mul_f32 v37, v37, v10
  v_mul_f32 v38, v38, v10
  v_mul_f32 v39, v39, v10
  v_mul_f32 v40, v40, v10
  v_mul_f32 v41, v41, v10
  v_mul_f32 v42, v42, v10
  v_mul_f32 v43, v43, v10
  v_mul_f32 v44, v44, v10
  v_mul_f32 v45, v45, v10
  v_mul_f32 v46, v46, v10
  v_mul_f32 v47, v47, v10
  v_cvt_pk_bf16_f32 v20, v32, v33
  v_cvt_pk_bf16_f32 v21, v34, v35
  v_cvt_pk_bf16_f32 v22, v36, v37
  v_cvt_pk_bf16_f32 v23, v38, v39
  v_cvt_pk_bf16_f32 v24, v40, v41
  v_cvt_pk_bf16_f32 v25, v42, v43
  v_cvt_pk_bf16_f32 v26, v44, v45
  v_cvt_pk_bf16_f32 v27, v46, v47
  ds_write_b128 v3, v[20:23]
  ds_write_b128 v3, v[24:27] offset:448
  s_waitcnt lgkmcnt(0)
  s_barrier
  ds_read_b64_tr_b16 v[32:33], v4
  ds_read_b64_tr_b16 v[34:35], v4 offset:3648
  ds_read_b64_tr_b16 v[36:37], v11
  ds_read_b64_tr_b16 v[38:39], v11 offset:3648
  s_waitcnt lgkmcnt(0)
  v_min_u32 v32, -2, v32
  v_min_u32 v33, -2, v33
  v_min_u32 v34, -2, v34
  v_min_u32 v35, -2, v35
  v_min_u32 v36, -2, v36
  v_min_u32 v37, -2, v37
  v_min_u32 v38, -2, v38
  v_min_u32 v39, -2, v39
  global_store_dwordx4 v5, v[32:35], s[24:25] sc1
  global_store_dwordx4 v1, v[36:39], s[24:25] sc1
  s_cmp_ge_u32 s10, 63
  s_cbranch_scc1 L_L_nt_70
  s_add_u32 s26, s26, 28672
  s_addc_u32 s27, s27, 0
  global_load_dwordx4 v[48:51], v2, s[26:27]
  global_load_dwordx4 v[52:55], v2, s[26:27] offset:448
L_L_nt_70:
  v_xor_b32 v3, 8192, v3
  v_xor_b32 v4, 8192, v4
  v_xor_b32 v11, 8192, v11
  s_add_u32 s12, s12, 7168
  s_addc_u32 s13, s13, 0
  s_add_u32 s22, s22, 28672
  s_addc_u32 s23, s23, 0
  s_add_u32 s24, s24, 28672
  s_addc_u32 s25, s25, 0
  s_add_u32 s10, s10, 1
  s_cmp_lt_u32 s10, 64
  s_cbranch_scc1 L_L_loop_67
  s_waitcnt vmcnt(0)
  s_barrier
  v_cmp_gt_u32 vcc, 8, v0
  s_and_saveexec_b64 s[20:21], vcc
  s_cbranch_execz L_gfsig_71
  s_add_u32 s14, s65, 56
  s_and_b32 s15, s14, 7
  s_lshl_b32 s15, s15, 7
  s_lshr_b32 s14, s14, 3
  s_lshl_b32 s14, s14, 2
  s_add_u32 s14, s14, s15
  s_add_u32 s14, s14, 4096
  v_lshlrev_b32 v112, 10, v0
  v_add_u32 v112, s14, v112
  v_mov_b32 v113, 1
  global_store_dword v112, v113, s[86:87] sc1
L_gfsig_71:
  s_mov_b64 exec, s[20:21]
  s_branch L_done
L_qF:
  v_and_b32 v5, 31, v0
  v_lshlrev_b32 v5, 7, v5
  v_lshrrev_b32 v6, 5, v0
  v_lshl_add_u32 v6, v6, 2, v5
  v_add_u32 v6, 61513728, v6
  s_mov_b32 s11, 0
L_wa_72:
  global_load_dword v7, v6, s[4:5] sc1
  s_waitcnt vmcnt(0)
  v_cmp_ne_u32 vcc, s88, v7
  s_cbranch_vccz L_wag_73
  s_add_u32 s11, s11, 1
  s_cmp_gt_u32 s11, 262144
  s_cbranch_scc1 L_abort
  s_branch L_wa_72
L_wag_73:
  v_and_b32 v6, 31, v0
  v_lshlrev_b32 v6, 7, v6
  v_lshrrev_b32 v7, 5, v0
  v_lshl_add_u32 v7, v7, 2, v6
  v_add_u32 v7, 61513728, v7
  global_load_dword v7, v7, s[4:5] sc1
  v_and_b32 v4, 7, v0
  v_lshlrev_b32 v4, 5, v4
  global_load_dword v4, v4, s[6:7] sc1
  s_waitcnt vmcnt(0)
  v_cmp_ne_u32 vcc, 32, v4
  s_cbranch_vccnz L_cfbad_75
  v_cmp_ne_u32 vcc, s88, v7
  s_cbranch_vccnz L_cfbad_75
  s_branch L_cfok_74
L_cfbad_75:
  v_mov_b32 v4, 135168
  ds_write_b32 v4, v4
L_cfok_74:
  s_waitcnt lgkmcnt(0)
  s_barrier
  v_mov_b32 v4, 135168
  ds_read_b32 v4, v4
  s_waitcnt lgkmcnt(0)
  s_nop 0
  v_readfirstlane_b32 s14, v4
  s_nop 3
  s_cmp_lg_u32 s14, 0
  s_cbranch_scc1 L_recheck
  v_and_b32 v14, 63, v0
  v_lshlrev_b32 v10, 4, v14
  s_mul_i32 s14, s65, 458752
  s_add_u32 s60, s4, 49807360
  s_addc_u32 s61, s5, 0
  s_add_u32 s60, s60, s14
  s_addc_u32 s61, s61, 0
  s_mov_b32 s10, 0
  s_cmp_ge_u32 s8, 2
  s_cbranch_scc1 L_QF_warm_76
  s_mul_i32 s14, s8, 3072
  v_add_u32 v11, s14, v10
  s_add_u32 s12, s4, 48693248
  s_addc_u32 s13, s5, 0
L_QF_loop_77:
  s_mov_b32 s11, 0
L_QF_poll_78:
  global_load_dwordx4 v[16:19], v11, s[12:13] offset:0 sc1
  global_load_dwordx4 v[20:23], v11, s[12:13] offset:1024 sc1
  global_load_dwordx4 v[24:27], v11, s[12:13] offset:2048 sc1
  global_load_dwordx4 v[28:31], v11, s[12:13] offset:3072 sc1
  s_waitcnt vmcnt(0)
  v_max3_u32 v14, v16, v17, v18
  v_max3_u32 v14, v14, v19, v20
  v_max3_u32 v14, v14, v21, v22
  v_max3_u32 v14, v14, v23, v24
  v_max3_u32 v14, v14, v25, v26
  v_max3_u32 v14, v14, v27, v28
  v_max3_u32 v14, v14, v29, v30
  v_max_u32 v14, v14, v31
  v_cmp_eq_u32 vcc, -1, v14
  s_cbranch_vccz L_QF_got_79
  s_add_u32 s11, s11, 1
  s_cmp_gt_u32 s11, 262144
  s_cbranch_scc1 L_abort
  s_branch L_QF_poll_78
L_QF_got_79:
  global_store_dwordx4 v11, v[16:19], s[60:61] offset:0
  global_store_dwordx4 v11, v[20:23], s[60:61] offset:1024
  global_store_dwordx4 v11, v[24:27], s[60:61] offset:2048
  global_store_dwordx4 v11, v[28:31], s[60:61] offset:3072
  s_nop 1
  s_add_u32 s12, s12, 7168
  s_addc_u32 s13, s13, 0
  s_add_u32 s60, s60, 7168
  s_addc_u32 s61, s61, 0
  s_add_u32 s10, s10, 1
  s_cmp_lt_u32 s10, 64
  s_cbranch_scc1 L_QF_loop_77
  s_waitcnt vmcnt(0)
  s_branch L_done
L_QF_warm_76:
  v_and_b32 v14, 63, v0
  v_lshlrev_b32 v20, 7, v14
  v_min_u32 v21, 7040, v20
  v_min_u32 v22, 1920, v20
  s_sub_u32 s14, s8, 2
  s_lshl_b32 s14, s14, 14
  s_add_u32 s22, s4, 42205184
  s_addc_u32 s23, s5, 0
  s_add_u32 s22, s22, s14
  s_addc_u32 s23, s23, 0
  s_mul_i32 s14, s65, 7168
  s_add_u32 s24, s4, 46399488
  s_addc_u32 s25, s5, 0
  s_add_u32 s24, s24, s14
  s_addc_u32 s25, s25, 0
  s_mul_i32 s14, s65, 7168
  s_add_u32 s32, s70, s14
  s_addc_u32 s33, s71, 0
  s_lshl_b32 s14, s65, 19
  s_add_u32 s26, s4, 51642368
  s_addc_u32 s27, s5, 0
  s_add_u32 s26, s26, s14
  s_addc_u32 s27, s27, 0
  s_lshl_b32 s14, s65, 17
  s_add_u32 s28, s4, 53739520
  s_addc_u32 s29, s5, 0
  s_add_u32 s28, s28, s14
  s_addc_u32 s29, s29, 0
  s_mul_i32 s14, s65, 458752
  s_add_u32 s30, s4, 54263808
  s_addc_u32 s31, s5, 0
  s_add_u32 s30, s30, s14
  s_addc_u32 s31, s31, 0
  global_load_dword v23, v20, s[22:23]
  s_add_u32 s14, s22, 8192
  s_addc_u32 s15, s23, 0
  global_load_dword v23, v20, s[14:15]
  s_cmp_eq_u32 s8, 3
  s_cbranch_scc1 L_w3_80
  global_load_dword v23, v21, s[24:25]
  global_load_dword v23, v21, s[32:33]
  s_branch L_wj_81
L_w3_80:
  global_load_dword v23, v20, s[26:27]
  global_load_dword v23, v22, s[28:29]
  global_load_dword v23, v21, s[30:31]
L_wj_81:
  s_add_u32 s22, s22, 32768
  s_addc_u32 s23, s23, 0
  s_add_u32 s24, s24, 28672
  s_addc_u32 s25, s25, 0
  s_add_u32 s32, s32, 28672
  s_addc_u32 s33, s33, 0
  s_add_u32 s26, s26, 8192
  s_addc_u32 s27, s27, 0
  s_add_u32 s28, s28, 2048
  s_addc_u32 s29, s29, 0
  s_add_u32 s30, s30, 7168
  s_addc_u32 s31, s31, 0
  global_load_dword v23, v20, s[22:23]
  s_add_u32 s14, s22, 8192
  s_addc_u32 s15, s23, 0
  global_load_dword v23, v20, s[14:15]
  s_cmp_eq_u32 s8, 3
  s_cbranch_scc1 L_w3_82
  global_load_dword v23, v21, s[24:25]
  global_load_dword v23, v21, s[32:33]
  s_branch L_wj_83
L_w3_82:
  global_load_dword v23, v20, s[26:27]
  global_load_dword v23, v22, s[28:29]
  global_load_dword v23, v21, s[30:31]
L_wj_83:
  s_add_u32 s22, s22, 32768
  s_addc_u32 s23, s23, 0
  s_add_u32 s24, s24, 28672
  s_addc_u32 s25, s25, 0
  s_add_u32 s32, s32, 28672
  s_addc_u32 s33, s33, 0
  s_add_u32 s26, s26, 8192
  s_addc_u32 s27, s27, 0
  s_add_u32 s28, s28, 2048
  s_addc_u32 s29, s29, 0
  s_add_u32 s30, s30, 7168
  s_addc_u32 s31, s31, 0
  v_mov_b32 v24, 0
L_QW_loop_84:
  s_mov_b32 s11, 0
L_QW_poll_85:
  global_load_dword v25, v24, s[60:61] sc1
  s_waitcnt vmcnt(0)
  v_cmp_eq_u32 vcc, -1, v25
  s_cbranch_vccz L_QW_got_86
  s_add_u32 s11, s11, 1
  s_cmp_gt_u32 s11, 262144
  s_cbranch_scc1 L_abort
  s_sleep 4
  s_branch L_QW_poll_85
L_QW_got_86:
  global_load_dword v23, v20, s[22:23]
  s_add_u32 s14, s22, 8192
  s_addc_u32 s15, s23, 0
  global_load_dword v23, v20, s[14:15]
  s_cmp_eq_u32 s8, 3
  s_cbranch_scc1 L_w3_87
  global_load_dword v23, v21, s[24:25]
  global_load_dword v23, v21, s[32:33]
  s_branch L_wj_88
L_w3_87:
  global_load_dword v23, v20, s[26:27]
  global_load_dword v23, v22, s[28:29]
  global_load_dword v23, v21, s[30:31]
L_wj_88:
  s_add_u32 s22, s22, 32768
  s_addc_u32 s23, s23, 0
  s_add_u32 s24, s24, 28672
  s_addc_u32 s25, s25, 0
  s_add_u32 s32, s32, 28672
  s_addc_u32 s33, s33, 0
  s_add_u32 s26, s26, 8192
  s_addc_u32 s27, s27, 0
  s_add_u32 s28, s28, 2048
  s_addc_u32 s29, s29, 0
  s_add_u32 s30, s30, 7168
  s_addc_u32 s31, s31, 0
  s_add_u32 s60, s60, 7168
  s_addc_u32 s61, s61, 0
  s_add_u32 s10, s10, 1
  s_cmp_lt_u32 s10, 62
  s_cbranch_scc1 L_QW_loop_84
  s_waitcnt vmcnt(0)
  s_branch L_done
L_free:
  s_sub_u32 s69, s68, 5
  s_lshl_b32 s69, s69, 5
  s_add_u32 s69, s69, s9
  s_cmp_ge_u32 s69, 84
  s_cbranch_scc1 L_pref
  v_and_b32 v5, 31, v0
  v_lshlrev_b32 v5, 7, v5
  v_lshrrev_b32 v6, 5, v0
  v_lshl_add_u32 v6, v6, 2, v5
  v_add_u32 v6, 61513728, v6
  s_mov_b32 s11, 0
L_wa_89:
  global_load_dword v7, v6, s[4:5] sc1
  s_waitcnt vmcnt(0)
  v_cmp_ne_u32 vcc, s88, v7
  s_cbranch_vccz L_wag_90
  s_add_u32 s11, s11, 1
  s_cmp_gt_u32 s11, 262144
  s_cbranch_scc1 L_abort
  s_branch L_wa_89
L_wag_90:
  v_and_b32 v6, 31, v0
  v_lshlrev_b32 v6, 7, v6
  v_lshrrev_b32 v7, 5, v0
  v_lshl_add_u32 v7, v7, 2, v6
  v_add_u32 v7, 61513728, v7
  global_load_dword v7, v7, s[4:5] sc1
  v_and_b32 v4, 7, v0
  v_lshlrev_b32 v4, 5, v4
  global_load_dword v4, v4, s[6:7] sc1
  s_waitcnt vmcnt(0)
  v_cmp_ne_u32 vcc, 32, v4
  s_cbranch_vccnz L_cfbad_92
  v_cmp_ne_u32 vcc, s88, v7
  s_cbranch_vccnz L_cfbad_92
  s_branch L_cfok_91
L_cfbad_92:
  v_mov_b32 v4, 135168
  ds_write_b32 v4, v4
L_cfok_91:
  s_waitcnt lgkmcnt(0)
  s_barrier
  v_mov_b32 v4, 135168
  ds_read_b32 v4, v4
  s_waitcnt lgkmcnt(0)
  s_nop 0
  v_readfirstlane_b32 s14, v4
  s_nop 3
  s_cmp_lg_u32 s14, 0
  s_cbranch_scc1 L_recheck
  s_mul_i32 s82, s69, 2341
  s_lshr_b32 s82, s82, 16
  s_mul_i32 s72, s82, 28
  s_sub_u32 s83, s69, s72
  v_and_b32 v1, 63, v0
  v_lshlrev_b32 v2, 4, v1
  v_add_u32 v3, 0, v2
  s_mul_i32 s72, s82, 28672
  s_mul_i32 s73, s8, 7168
  s_add_u32 s72, s72, s73
  s_add_u32 s72, s72, 4096
  s_add_u32 s76, s4, 44564480
  s_addc_u32 s77, s5, 0
  s_add_u32 s76, s76, s72
  s_addc_u32 s77, s77, 0
  s_add_u32 s80, s73, 4096
  s_mov_b32 s81, 0
  s_add_u32 s72, s80, 0
  s_mov_b32 m0, s72
  s_nop 0
  global_load_lds_dwordx4 v2, s[76:77] offset:-4096
  global_load_lds_dwordx4 v2, s[76:77] offset:-3072
  global_load_lds_dwordx4 v2, s[76:77] offset:-2048
  global_load_lds_dwordx4 v2, s[76:77] offset:-1024
  global_load_lds_dwordx4 v2, s[76:77] offset:0
  global_load_lds_dwordx4 v2, s[76:77] offset:1024
  global_load_lds_dwordx4 v2, s[76:77] offset:2048
  s_sub_u32 s84, 3, s82
  s_cmp_eq_u32 s81, 20
  s_cselect_b32 s84, s84, 3
  s_mul_i32 s84, s84, 28672
  s_add_u32 s76, s76, s84
  s_addc_u32 s77, s77, 0
  s_lshl_b32 s72, s83, 4
  s_lshl_b32 s73, s8, 2
  s_add_u32 s72, s72, s73
  s_lshl_b32 s78, s72, 10
  s_mul_i32 s72, s72, 14336
  s_add_u32 s74, s4, 6422528
  s_addc_u32 s75, s5, 0
  s_add_u32 s74, s74, s72
  s_addc_u32 s75, s75, 0
  global_load_dwordx4 a[0:3], v2, s[74:75] offset:0
  global_load_dwordx4 a[4:7], v2, s[74:75] offset:1024
  global_load_dwordx4 a[8:11], v2, s[74:75] offset:2048
  global_load_dwordx4 a[12:15], v2, s[74:75] offset:3072
  s_add_u32 s74, s74, 4096
  s_addc_u32 s75, s75, 0
  global_load_dwordx4 a[16:19], v2, s[74:75] offset:0
  global_load_dwordx4 a[20:23], v2, s[74:75] offset:1024
  global_load_dwordx4 a[24:27], v2, s[74:75] offset:2048
  global_load_dwordx4 a[28:31], v2, s[74:75] offset:3072
  s_add_u32 s74, s74, 4096
  s_addc_u32 s75, s75, 0
  global_load_dwordx4 a[32:35], v2, s[74:75] offset:0
  global_load_dwordx4 a[36:39], v2, s[74:75] offset:1024
  global_load_dwordx4 a[40:43], v2, s[74:75] offset:2048
  global_load_dwordx4 a[44:47], v2, s[74:75] offset:3072
  s_add_u32 s74, s74, 4096
  s_addc_u32 s75, s75, 0
  global_load_dwordx4 a[48:51], v2, s[74:75] offset:0
  global_load_dwordx4 a[52:55], v2, s[74:75] offset:1024
  s_add_u32 s74, s74, 2048
  s_addc_u32 s75, s75, 0
  global_load_dwordx4 a[56:59], v2, s[74:75] offset:0
  global_load_dwordx4 a[60:63], v2, s[74:75] offset:1024
  global_load_dwordx4 a[64:67], v2, s[74:75] offset:2048
  global_load_dwordx4 a[68:71], v2, s[74:75] offset:3072
  s_add_u32 s74, s74, 4096
  s_addc_u32 s75, s75, 0
  global_load_dwordx4 a[72:75], v2, s[74:75] offset:0
  global_load_dwordx4 a[76:79], v2, s[74:75] offset:1024
  global_load_dwordx4 a[80:83], v2, s[74:75] offset:2048
  global_load_dwordx4 a[84:87], v2, s[74:75] offset:3072
  s_add_u32 s74, s74, 4096
  s_addc_u32 s75, s75, 0
  global_load_dwordx4 a[88:91], v2, s[74:75] offset:0
  global_load_dwordx4 a[92:95], v2, s[74:75] offset:1024
  global_load_dwordx4 a[96:99], v2, s[74:75] offset:2048
  global_load_dwordx4 a[100:103], v2, s[74:75] offset:3072
  s_add_u32 s74, s74, 4096
  s_addc_u32 s75, s75, 0
  global_load_dwordx4 a[104:107], v2, s[74:75] offset:0
  global_load_dwordx4 a[108:111], v2, s[74:75] offset:1024
  s_add_u32 s74, s74, 2048
  s_addc_u32 s75, s75, 0
  global_load_dwordx4 a[112:115], v2, s[74:75] offset:0
  global_load_dwordx4 a[116:119], v2, s[74:75] offset:1024
  global_load_dwordx4 a[120:123], v2, s[74:75] offset:2048
  global_load_dwordx4 a[124:127], v2, s[74:75] offset:3072
  s_add_u32 s74, s74, 4096
  s_addc_u32 s75, s75, 0
  global_load_dwordx4 a[128:131], v2, s[74:75] offset:0
  global_load_dwordx4 a[132:135], v2, s[74:75] offset:1024
  global_load_dwordx4 a[136:139], v2, s[74:75] offset:2048
  global_load_dwordx4 a[140:143], v2, s[74:75] offset:3072
  s_add_u32 s74, s74, 4096
  s_addc_u32 s75, s75, 0
  global_load_dwordx4 a[144:147], v2, s[74:75] offset:0
  global_load_dwordx4 a[148:151], v2, s[74:75] offset:1024
  global_load_dwordx4 a[152:155], v2, s[74:75] offset:2048
  global_load_dwordx4 a[156:159], v2, s[74:75] offset:3072
  s_add_u32 s74, s74, 4096
  s_addc_u32 s75, s75, 0
  global_load_dwordx4 a[160:163], v2, s[74:75] offset:0
  global_load_dwordx4 a[164:167], v2, s[74:75] offset:1024
  s_add_u32 s74, s74, 2048
  s_addc_u32 s75, s75, 0
  global_load_dwordx4 a[168:171], v2, s[74:75] offset:0
  global_load_dwordx4 a[172:175], v2, s[74:75] offset:1024
  global_load_dwordx4 a[176:179], v2, s[74:75] offset:2048
  global_load_dwordx4 a[180:183], v2, s[74:75] offset:3072
  s_add_u32 s74, s74, 4096
  s_addc_u32 s75, s75, 0
  global_load_dwordx4 a[184:187], v2, s[74:75] offset:0
  global_load_dwordx4 a[188:191], v2, s[74:75] offset:1024
  global_load_dwordx4 a[192:195], v2, s[74:75] offset:2048
  global_load_dwordx4 a[196:199], v2, s[74:75] offset:3072
  s_add_u32 s74, s74, 4096
  s_addc_u32 s75, s75, 0
  global_load_dwordx4 a[200:203], v2, s[74:75] offset:0
  global_load_dwordx4 a[204:207], v2, s[74:75] offset:1024
  global_load_dwordx4 a[208:211], v2, s[74:75] offset:2048
  global_load_dwordx4 a[212:215], v2, s[74:75] offset:3072
  s_add_u32 s74, s74, 4096
  s_addc_u32 s75, s75, 0
  global_load_dwordx4 a[216:219], v2, s[74:75] offset:0
  global_load_dwordx4 a[220:223], v2, s[74:75] offset:1024
  s_add_u32 s74, s74, 2048
  s_addc_u32 s75, s75, 0
  s_mul_i32 s72, s82, 458752
  s_add_u32 s72, s72, s78
  s_add_u32 s78, s4, 12845056
  s_addc_u32 s79, s5, 0
  s_add_u32 s78, s78, s72
  s_addc_u32 s79, s79, 0
  s_waitcnt vmcnt(0)
  s_barrier
  ds_read_b128 v[8:11], v3 offset:0
  ds_read_b128 v[12:15], v3 offset:14336
  ds_read_b128 v[16:19], v3 offset:1024
  ds_read_b128 v[20:23], v3 offset:15360
  ds_read_b128 v[24:27], v3 offset:2048
  ds_read_b128 v[28:31], v3 offset:16384
  s_add_u32 s72, s80, 28672
  s_mov_b32 m0, s72
  s_nop 0
  global_load_lds_dwordx4 v2, s[76:77] offset:-4096
  global_load_lds_dwordx4 v2, s[76:77] offset:-3072
  global_load_lds_dwordx4 v2, s[76:77] offset:-2048
  global_load_lds_dwordx4 v2, s[76:77] offset:-1024
  global_load_lds_dwordx4 v2, s[76:77] offset:0
  global_load_lds_dwordx4 v2, s[76:77] offset:1024
  global_load_lds_dwordx4 v2, s[76:77] offset:2048
  s_sub_u32 s84, 3, s82
  s_cmp_eq_u32 s81, 19
  s_cselect_b32 s84, s84, 3
  s_mul_i32 s84, s84, 28672
  s_add_u32 s76, s76, s84
  s_addc_u32 s77, s77, 0
  ds_read_b128 v[32:35], v3 offset:3072
  ds_read_b128 v[36:39], v3 offset:17408
  s_waitcnt lgkmcnt(6)
  v_mfma_f32_16x16x32_bf16 v[40:43], v[8:11], a[0:3], 0
  v_mfma_f32_16x16x32_bf16 v[44:47], v[8:11], a[56:59], 0
  v_mfma_f32_16x16x32_bf16 v[48:51], v[8:11], a[112:115], 0
  v_mfma_f32_16x16x32_bf16 v[52:55], v[8:11], a[168:171], 0
  v_mfma_f32_16x16x32_bf16 v[56:59], v[12:15], a[0:3], 0
  v_mfma_f32_16x16x32_bf16 v[60:63], v[12:15], a[56:59], 0
  v_mfma_f32_16x16x32_bf16 v[64:67], v[12:15], a[112:115], 0
  v_mfma_f32_16x16x32_bf16 v[68:71], v[12:15], a[168:171], 0
  ds_read_b128 v[8:11], v3 offset:4096
  ds_read_b128 v[12:15], v3 offset:18432
  s_waitcnt lgkmcnt(6)
  v_mfma_f32_16x16x32_bf16 v[40:43], v[16:19], a[4:7], v[40:43]
  v_mfma_f32_16x16x32_bf16 v[44:47], v[16:19], a[60:63], v[44:47]
  v_mfma_f32_16x16x32_bf16 v[48:51], v[16:19], a[116:119], v[48:51]
  v_mfma_f32_16x16x32_bf16 v[52:55], v[16:19], a[172:175], v[52:55]
  v_mfma_f32_16x16x32_bf16 v[56:59], v[20:23], a[4:7], v[56:59]
  v_mfma_f32_16x16x32_bf16 v[60:63], v[20:23], a[60:63], v[60:63]
  v_mfma_f32_16x16x32_bf16 v[64:67], v[20:23], a[116:119], v[64:67]
  v_mfma_f32_16x16x32_bf16 v[68:71], v[20:23], a[172:175], v[68:71]
  ds_read_b128 v[16:19], v3 offset:5120
  ds_read_b128 v[20:23], v3 offset:19456
  s_waitcnt lgkmcnt(6)
  v_mfma_f32_16x16x32_bf16 v[40:43], v[24:27], a[8:11], v[40:43]
  v_mfma_f32_16x16x32_bf16 v[44:47], v[24:27], a[64:67], v[44:47]
  v_mfma_f32_16x16x32_bf16 v[48:51], v[24:27], a[120:123], v[48:51]
  v_mfma_f32_16x16x32_bf16 v[52:55], v[24:27], a[176:179], v[52:55]
  v_mfma_f32_16x16x32_bf16 v[56:59], v[28:31], a[8:11], v[56:59]
  v_mfma_f32_16x16x32_bf16 v[60:63], v[28:31], a[64:67], v[60:63]
  v_mfma_f32_16x16x32_bf16 v[64:67], v[28:31], a[120:123], v[64:67]
  v_mfma_f32_16x16x32_bf16 v[68:71], v[28:31], a[176:179], v[68:71]
  ds_read_b128 v[24:27], v3 offset:6144
  ds_read_b128 v[28:31], v3 offset:20480
  s_waitcnt lgkmcnt(6)
  v_mfma_f32_16x16x32_bf16 v[40:43], v[32:35], a[12:15], v[40:43]
  v_mfma_f32_16x16x32_bf16 v[44:47], v[32:35], a[68:71], v[44:47]
  v_mfma_f32_16x16x32_bf16 v[48:51], v[32:35], a[124:127], v[48:51]
  v_mfma_f32_16x16x32_bf16 v[52:55], v[32:35], a[180:183], v[52:55]
  v_mfma_f32_16x16x32_bf16 v[56:59], v[36:39], a[12:15], v[56:59]
  v_mfma_f32_16x16x32_bf16 v[60:63], v[36:39], a[68:71], v[60:63]
  v_mfma_f32_16x16x32_bf16 v[64:67], v[36:39], a[124:127], v[64:67]
  v_mfma_f32_16x16x32_bf16 v[68:71], v[36:39], a[180:183], v[68:71]
  ds_read_b128 v[32:35], v3 offset:7168
  ds_read_b128 v[36:39], v3 offset:21504
  s_waitcnt lgkmcnt(6)
  v_mfma_f32_16x16x32_bf16 v[40:43], v[8:11], a[16:19], v[40:43]
  v_mfma_f32_16x16x32_bf16 v[44:47], v[8:11], a[72:75], v[44:47]
  v_mfma_f32_16x16x32_bf16 v[48:51], v[8:11], a[128:131], v[48:51]
  v_mfma_f32_16x16x32_bf16 v[52:55], v[8:11], a[184:187], v[52:55]
  v_mfma_f32_16x16x32_bf16 v[56:59], v[12:15], a[16:19], v[56:59]
  v_mfma_f32_16x16x32_bf16 v[60:63], v[12:15], a[72:75], v[60:63]
  v_mfma_f32_16x16x32_bf16 v[64:67], v[12:15], a[128:131], v[64:67]
  v_mfma_f32_16x16x32_bf16 v[68:71], v[12:15], a[184:187], v[68:71]
  ds_read_b128 v[8:11], v3 offset:8192
  ds_read_b128 v[12:15], v3 offset:22528
  s_waitcnt lgkmcnt(6)
  v_mfma_f32_16x16x32_bf16 v[40:43], v[16:19], a[20:23], v[40:43]
  v_mfma_f32_16x16x32_bf16 v[44:47], v[16:19], a[76:79], v[44:47]
  v_mfma_f32_16x16x32_bf16 v[48:51], v[16:19], a[132:135], v[48:51]
  v_mfma_f32_16x16x32_bf16 v[52:55], v[16:19], a[188:191], v[52:55]
  v_mfma_f32_16x16x32_bf16 v[56:59], v[20:23], a[20:23], v[56:59]
  v_mfma_f32_16x16x32_bf16 v[60:63], v[20:23], a[76:79], v[60:63]
  v_mfma_f32_16x16x32_bf16 v[64:67], v[20:23], a[132:135], v[64:67]
  v_mfma_f32_16x16x32_bf16 v[68:71], v[20:23], a[188:191], v[68:71]
  ds_read_b128 v[16:19], v3 offset:9216
  ds_read_b128 v[20:23], v3 offset:23552
  s_waitcnt lgkmcnt(6)
  v_mfma_f32_16x16x32_bf16 v[40:43], v[24:27], a[24:27], v[40:43]
  v_mfma_f32_16x16x32_bf16 v[44:47], v[24:27], a[80:83], v[44:47]
  v_mfma_f32_16x16x32_bf16 v[48:51], v[24:27], a[136:139], v[48:51]
  v_mfma_f32_16x16x32_bf16 v[52:55], v[24:27], a[192:195], v[52:55]
  v_mfma_f32_16x16x32_bf16 v[56:59], v[28:31], a[24:27], v[56:59]
  v_mfma_f32_16x16x32_bf16 v[60:63], v[28:31], a[80:83], v[60:63]
  v_mfma_f32_16x16x32_bf16 v[64:67], v[28:31], a[136:139], v[64:67]
  v_mfma_f32_16x16x32_bf16 v[68:71], v[28:31], a[192:195], v[68:71]
  ds_read_b128 v[24:27], v3 offset:10240
  ds_read_b128 v[28:31], v3 offset:24576
  s_waitcnt lgkmcnt(6)
  v_mfma_f32_16x16x32_bf16 v[40:43], v[32:35], a[28:31], v[40:43]
  v_mfma_f32_16x16x32_bf16 v[44:47], v[32:35], a[84:87], v[44:47]
  v_mfma_f32_16x16x32_bf16 v[48:51], v[32:35], a[140:143], v[48:51]
  v_mfma_f32_16x16x32_bf16 v[52:55], v[32:35], a[196:199], v[52:55]
  v_mfma_f32_16x16x32_bf16 v[56:59], v[36:39], a[28:31], v[56:59]
  v_mfma_f32_16x16x32_bf16 v[60:63], v[36:39], a[84:87], v[60:63]
  v_mfma_f32_16x16x32_bf16 v[64:67], v[36:39], a[140:143], v[64:67]
  v_mfma_f32_16x16x32_bf16 v[68:71], v[36:39], a[196:199], v[68:71]
  ds_read_b128 v[32:35], v3 offset:11264
  ds_read_b128 v[36:39], v3 offset:25600
  s_waitcnt lgkmcnt(6)
  v_mfma_f32_16x16x32_bf16 v[40:43], v[8:11], a[32:35], v[40:43]
  v_mfma_f32_16x16x32_bf16 v[44:47], v[8:11], a[88:91], v[44:47]
  v_mfma_f32_16x16x32_bf16 v[48:51], v[8:11], a[144:147], v[48:51]
  v_mfma_f32_16x16x32_bf16 v[52:55], v[8:11], a[200:203], v[52:55]
  v_mfma_f32_16x16x32_bf16 v[56:59], v[12:15], a[32:35], v[56:59]
  v_mfma_f32_16x16x32_bf16 v[60:63], v[12:15], a[88:91], v[60:63]
  v_mfma_f32_16x16x32_bf16 v[64:67], v[12:15], a[144:147], v[64:67]
  v_mfma_f32_16x16x32_bf16 v[68:71], v[12:15], a[200:203], v[68:71]
  ds_read_b128 v[8:11], v3 offset:12288
  ds_read_b128 v[12:15], v3 offset:26624
  s_waitcnt lgkmcnt(6)
  v_mfma_f32_16x16x32_bf16 v[40:43], v[16:19], a[36:39], v[40:43]
  v_mfma_f32_16x16x32_bf16 v[44:47], v[16:19], a[92:95], v[44:47]
  v_mfma_f32_16x16x32_bf16 v[48:51], v[16:19], a[148:151], v[48:51]
  v_mfma_f32_16x16x32_bf16 v[52:55], v[16:19], a[204:207], v[52:55]
  v_mfma_f32_16x16x32_bf16 v[56:59], v[20:23], a[36:39], v[56:59]
  v_mfma_f32_16x16x32_bf16 v[60:63], v[20:23], a[92:95], v[60:63]
  v_mfma_f32_16x16x32_bf16 v[64:67], v[20:23], a[148:151], v[64:67]
  v_mfma_f32_16x16x32_bf16 v[68:71], v[20:23], a[204:207], v[68:71]
  ds_read_b128 v[16:19], v3 offset:13312
  ds_read_b128 v[20:23], v3 offset:27648
  s_waitcnt lgkmcnt(6)
  v_mfma_f32_16x16x32_bf16 v[40:43], v[24:27], a[40:43], v[40:43]
  v_mfma_f32_16x16x32_bf16 v[44:47], v[24:27], a[96:99], v[44:47]
  v_mfma_f32_16x16x32_bf16 v[48:51], v[24:27], a[152:155], v[48:51]
  v_mfma_f32_16x16x32_bf16 v[52:55], v[24:27], a[208:211], v[52:55]
  v_mfma_f32_16x16x32_bf16 v[56:59], v[28:31], a[40:43], v[56:59]
  v_mfma_f32_16x16x32_bf16 v[60:63], v[28:31], a[96:99], v[60:63]
  v_mfma_f32_16x16x32_bf16 v[64:67], v[28:31], a[152:155], v[64:67]
  v_mfma_f32_16x16x32_bf16 v[68:71], v[28:31], a[208:211], v[68:71]
  s_waitcnt lgkmcnt(4)
  v_mfma_f32_16x16x32_bf16 v[40:43], v[32:35], a[44:47], v[40:43]
  v_mfma_f32_16x16x32_bf16 v[44:47], v[32:35], a[100:103], v[44:47]
  v_mfma_f32_16x16x32_bf16 v[48:51], v[32:35], a[156:159], v[48:51]
  v_mfma_f32_16x16x32_bf16 v[52:55], v[32:35], a[212:215], v[52:55]
  v_mfma_f32_16x16x32_bf16 v[56:59], v[36:39], a[44:47], v[56:59]
  v_mfma_f32_16x16x32_bf16 v[60:63], v[36:39], a[100:103], v[60:63]
  v_mfma_f32_16x16x32_bf16 v[64:67], v[36:39], a[156:159], v[64:67]
  v_mfma_f32_16x16x32_bf16 v[68:71], v[36:39], a[212:215], v[68:71]
  s_waitcnt lgkmcnt(2)
  v_mfma_f32_16x16x32_bf16 v[40:43], v[8:11], a[48:51], v[40:43]
  v_mfma_f32_16x16x32_bf16 v[44:47], v[8:11], a[104:107], v[44:47]
  v_mfma_f32_16x16x32_bf16 v[48:51], v[8:11], a[160:163], v[48:51]
  v_mfma_f32_16x16x32_bf16 v[52:55], v[8:11], a[216:219], v[52:55]
  v_mfma_f32_16x16x32_bf16 v[56:59], v[12:15], a[48:51], v[56:59]
  v_mfma_f32_16x16x32_bf16 v[60:63], v[12:15], a[104:107], v[60:63]
  v_mfma_f32_16x16x32_bf16 v[64:67], v[12:15], a[160:163], v[64:67]
  v_mfma_f32_16x16x32_bf16 v[68:71], v[12:15], a[216:219], v[68:71]
  s_waitcnt lgkmcnt(0)
  v_mfma_f32_16x16x32_bf16 v[40:43], v[16:19], a[52:55], v[40:43]
  v_mfma_f32_16x16x32_bf16 v[44:47], v[16:19], a[108:111], v[44:47]
  v_mfma_f32_16x16x32_bf16 v[48:51], v[16:19], a[164:167], v[48:51]
  v_mfma_f32_16x16x32_bf16 v[52:55], v[16:19], a[220:223], v[52:55]
  v_mfma_f32_16x16x32_bf16 v[56:59], v[20:23], a[52:55], v[56:59]
  v_mfma_f32_16x16x32_bf16 v[60:63], v[20:23], a[108:111], v[60:63]
  v_mfma_f32_16x16x32_bf16 v[64:67], v[20:23], a[164:167], v[64:67]
  v_mfma_f32_16x16x32_bf16 v[68:71], v[20:23], a[220:223], v[68:71]
  s_waitcnt vmcnt(0)
  s_barrier
  s_cmp_lg_u32 s81, 1
  s_cbranch_scc1 L_ns_93
  v_cmp_eq_u32 vcc, 0, v0
  s_and_saveexec_b64 s[20:21], vcc
  s_cbranch_execz L_sig_94
  v_mov_b32 v112, 1024
  v_mov_b32 v113, 1
  global_atomic_add v112, v113, s[86:87] sc1
L_sig_94:
  s_mov_b64 exec, s[20:21]
L_ns_93:
  s_cmp_lg_u32 s81, 6
  s_cbranch_scc1 L_ns_95
  v_cmp_eq_u32 vcc, 0, v0
  s_and_saveexec_b64 s[20:21], vcc
  s_cbranch_execz L_sig_96
  v_mov_b32 v112, 1152
  v_mov_b32 v113, 1
  global_atomic_add v112, v113, s[86:87] sc1
L_sig_96:
  s_mov_b64 exec, s[20:21]
L_ns_95:
  s_add_u32 s81, s81, 1
L_vxl_97:
  ds_read_b128 v[8:11], v3 offset:28672
  ds_read_b128 v[12:15], v3 offset:43008
  ds_read_b128 v[16:19], v3 offset:29696
  ds_read_b128 v[20:23], v3 offset:44032
  ds_read_b128 v[24:27], v3 offset:30720
  ds_read_b128 v[28:31], v3 offset:45056
  s_add_u32 s72, s80, 0
  s_mov_b32 m0, s72
  s_nop 0
  global_load_lds_dwordx4 v2, s[76:77] offset:-4096
  global_load_lds_dwordx4 v2, s[76:77] offset:-3072
  global_load_lds_dwordx4 v2, s[76:77] offset:-2048
  global_load_lds_dwordx4 v2, s[76:77] offset:-1024
  global_load_lds_dwordx4 v2, s[76:77] offset:0
  global_load_lds_dwordx4 v2, s[76:77] offset:1024
  global_load_lds_dwordx4 v2, s[76:77] offset:2048
  s_sub_u32 s84, 3, s82
  s_cmp_eq_u32 s81, 19
  s_cselect_b32 s84, s84, 3
  s_mul_i32 s84, s84, 28672
  s_add_u32 s76, s76, s84
  s_addc_u32 s77, s77, 0
  ds_read_b128 v[32:35], v3 offset:31744
  ds_read_b128 v[36:39], v3 offset:46080
  s_waitcnt lgkmcnt(6)
  v_mfma_f32_16x16x32_bf16 v[72:75], v[8:11], a[0:3], 0
  v_mfma_f32_16x16x32_bf16 v[76:79], v[8:11], a[56:59], 0
  v_mfma_f32_16x16x32_bf16 v[80:83], v[8:11], a[112:115], 0
  v_mfma_f32_16x16x32_bf16 v[84:87], v[8:11], a[168:171], 0
  v_mfma_f32_16x16x32_bf16 v[88:91], v[12:15], a[0:3], 0
  v_mfma_f32_16x16x32_bf16 v[92:95], v[12:15], a[56:59], 0
  v_mfma_f32_16x16x32_bf16 v[96:99], v[12:15], a[112:115], 0
  v_mfma_f32_16x16x32_bf16 v[100:103], v[12:15], a[168:171], 0
  ds_read_b128 v[8:11], v3 offset:32768
  ds_read_b128 v[12:15], v3 offset:47104
  s_waitcnt lgkmcnt(6)
  v_mfma_f32_16x16x32_bf16 v[72:75], v[16:19], a[4:7], v[72:75]
  v_mfma_f32_16x16x32_bf16 v[76:79], v[16:19], a[60:63], v[76:79]
  v_mfma_f32_16x16x32_bf16 v[80:83], v[16:19], a[116:119], v[80:83]
  v_mfma_f32_16x16x32_bf16 v[84:87], v[16:19], a[172:175], v[84:87]
  v_mfma_f32_16x16x32_bf16 v[88:91], v[20:23], a[4:7], v[88:91]
  v_mfma_f32_16x16x32_bf16 v[92:95], v[20:23], a[60:63], v[92:95]
  v_mfma_f32_16x16x32_bf16 v[96:99], v[20:23], a[116:119], v[96:99]
  v_mfma_f32_16x16x32_bf16 v[100:103], v[20:23], a[172:175], v[100:103]
  ds_read_b128 v[16:19], v3 offset:33792
  ds_read_b128 v[20:23], v3 offset:48128
  s_waitcnt lgkmcnt(6)
  v_mfma_f32_16x16x32_bf16 v[72:75], v[24:27], a[8:11], v[72:75]
  v_mfma_f32_16x16x32_bf16 v[76:79], v[24:27], a[64:67], v[76:79]
  v_cvt_pk_bf16_f32 v104, v40, v41
  v_mfma_f32_16x16x32_bf16 v[80:83], v[24:27], a[120:123], v[80:83]
  v_mfma_f32_16x16x32_bf16 v[84:87], v[24:27], a[176:179], v[84:87]
  v_cvt_pk_bf16_f32 v105, v42, v43
  v_mfma_f32_16x16x32_bf16 v[88:91], v[28:31], a[8:11], v[88:91]
  v_mfma_f32_16x16x32_bf16 v[92:95], v[28:31], a[64:67], v[92:95]
  v_cvt_pk_bf16_f32 v106, v56, v57
  v_mfma_f32_16x16x32_bf16 v[96:99], v[28:31], a[120:123], v[96:99]
  v_mfma_f32_16x16x32_bf16 v[100:103], v[28:31], a[176:179], v[100:103]
  v_cvt_pk_bf16_f32 v107, v58, v59
  ds_read_b128 v[24:27], v3 offset:34816
  ds_read_b128 v[28:31], v3 offset:49152
  s_waitcnt lgkmcnt(6)
  v_mfma_f32_16x16x32_bf16 v[72:75], v[32:35], a[12:15], v[72:75]
  v_mfma_f32_16x16x32_bf16 v[76:79], v[32:35], a[68:71], v[76:79]
  global_store_dwordx4 v2, v[104:107], s[78:79] offset:0 sc1
  v_mfma_f32_16x16x32_bf16 v[80:83], v[32:35], a[124:127], v[80:83]
  v_mfma_f32_16x16x32_bf16 v[84:87], v[32:35], a[180:183], v[84:87]
  v_cvt_pk_bf16_f32 v108, v44, v45
  v_mfma_f32_16x16x32_bf16 v[88:91], v[36:39], a[12:15], v[88:91]
  v_mfma_f32_16x16x32_bf16 v[92:95], v[36:39], a[68:71], v[92:95]
  v_cvt_pk_bf16_f32 v109, v46, v47
  v_mfma_f32_16x16x32_bf16 v[96:99], v[36:39], a[124:127], v[96:99]
  v_mfma_f32_16x16x32_bf16 v[100:103], v[36:39], a[180:183], v[100:103]
  v_cvt_pk_bf16_f32 v110, v60, v61
  ds_read_b128 v[32:35], v3 offset:35840
  ds_read_b128 v[36:39], v3 offset:50176
  s_waitcnt lgkmcnt(6)
  v_mfma_f32_16x16x32_bf16 v[72:75], v[8:11], a[16:19], v[72:75]
  v_mfma_f32_16x16x32_bf16 v[76:79], v[8:11], a[72:75], v[76:79]
  v_cvt_pk_bf16_f32 v111, v62, v63
  v_mfma_f32_16x16x32_bf16 v[80:83], v[8:11], a[128:131], v[80:83]
  v_mfma_f32_16x16x32_bf16 v[84:87], v[8:11], a[184:187], v[84:87]
  global_store_dwordx4 v2, v[108:111], s[78:79] offset:1024 sc1
  v_mfma_f32_16x16x32_bf16 v[88:91], v[12:15], a[16:19], v[88:91]
  v_mfma_f32_16x16x32_bf16 v[92:95], v[12:15], a[72:75], v[92:95]
  v_cvt_pk_bf16_f32 v104, v48, v49
  v_mfma_f32_16x16x32_bf16 v[96:99], v[12:15], a[128:131], v[96:99]
  v_mfma_f32_16x16x32_bf16 v[100:103], v[12:15], a[184:187], v[100:103]
  v_cvt_pk_bf16_f32 v105, v50, v51
  ds_read_b128 v[8:11], v3 offset:36864
  ds_read_b128 v[12:15], v3 offset:51200
  s_waitcnt lgkmcnt(6)
  v_mfma_f32_16x16x32_bf16 v[72:75], v[16:19], a[20:23], v[72:75]
  v_mfma_f32_16x16x32_bf16 v[76:79], v[16:19], a[76:79], v[76:79]
  v_cvt_pk_bf16_f32 v106, v64, v65
  v_mfma_f32_16x16x32_bf16 v[80:83], v[16:19], a[132:135], v[80:83]
  v_mfma_f32_16x16x32_bf16 v[84:87], v[16:19], a[188:191], v[84:87]
  v_cvt_pk_bf16_f32 v107, v66, v67
  v_mfma_f32_16x16x32_bf16 v[88:91], v[20:23], a[20:23], v[88:91]
  v_mfma_f32_16x16x32_bf16 v[92:95], v[20:23], a[76:79], v[92:95]
  global_store_dwordx4 v2, v[104:107], s[78:79] offset:2048 sc1
  v_mfma_f32_16x16x32_bf16 v[96:99], v[20:23], a[132:135], v[96:99]
  v_mfma_f32_16x16x32_bf16 v[100:103], v[20:23], a[188:191], v[100:103]
  v_cvt_pk_bf16_f32 v108, v52, v53
  ds_read_b128 v[16:19], v3 offset:37888
  ds_read_b128 v[20:23], v3 offset:52224
  s_waitcnt lgkmcnt(6)
  v_mfma_f32_16x16x32_bf16 v[72:75], v[24:27], a[24:27], v[72:75]
  v_mfma_f32_16x16x32_bf16 v[76:79], v[24:27], a[80:83], v[76:79]
  v_cvt_pk_bf16_f32 v109, v54, v55
  v_mfma_f32_16x16x32_bf16 v[80:83], v[24:27], a[136:139], v[80:83]
  v_mfma_f32_16x16x32_bf16 v[84:87], v[24:27], a[192:195], v[84:87]
  v_cvt_pk_bf16_f32 v110, v68, v69
  v_mfma_f32_16x16x32_bf16 v[88:91], v[28:31], a[24:27], v[88:91]
  v_mfma_f32_16x16x32_bf16 v[92:95], v[28:31], a[80:83], v[92:95]
  v_cvt_pk_bf16_f32 v111, v70, v71
  v_mfma_f32_16x16x32_bf16 v[96:99], v[28:31], a[136:139], v[96:99]
  v_mfma_f32_16x16x32_bf16 v[100:103], v[28:31], a[192:195], v[100:103]
  global_store_dwordx4 v2, v[108:111], s[78:79] offset:3072 sc1
  ds_read_b128 v[24:27], v3 offset:38912
  ds_read_b128 v[28:31], v3 offset:53248
  s_waitcnt lgkmcnt(6)
  v_mfma_f32_16x16x32_bf16 v[72:75], v[32:35], a[28:31], v[72:75]
  v_mfma_f32_16x16x32_bf16 v[76:79], v[32:35], a[84:87], v[76:79]
  s_sub_u32 s85, 3, s82
  s_cmp_eq_u32 s81, 21
  s_cselect_b32 s85, s85, 3
  s_mul_i32 s85, s85, 458752
  s_add_u32 s78, s78, s85
  s_addc_u32 s79, s79, 0
  v_mfma_f32_16x16x32_bf16 v[80:83], v[32:35], a[140:143], v[80:83]
  v_mfma_f32_16x16x32_bf16 v[84:87], v[32:35], a[196:199], v[84:87]
  v_mfma_f32_16x16x32_bf16 v[88:91], v[36:39], a[28:31], v[88:91]
  v_mfma_f32_16x16x32_bf16 v[92:95], v[36:39], a[84:87], v[92:95]
  v_mfma_f32_16x16x32_bf16 v[96:99], v[36:39], a[140:143], v[96:99]
  v_mfma_f32_16x16x32_bf16 v[100:103], v[36:39], a[196:199], v[100:103]
  ds_read_b128 v[32:35], v3 offset:39936
  ds_read_b128 v[36:39], v3 offset:54272
  s_waitcnt lgkmcnt(6)
  v_mfma_f32_16x16x32_bf16 v[72:75], v[8:11], a[32:35], v[72:75]
  v_mfma_f32_16x16x32_bf16 v[76:79], v[8:11], a[88:91], v[76:79]
  v_mfma_f32_16x16x32_bf16 v[80:83], v[8:11], a[144:147], v[80:83]
  v_mfma_f32_16x16x32_bf16 v[84:87], v[8:11], a[200:203], v[84:87]
  v_mfma_f32_16x16x32_bf16 v[88:91], v[12:15], a[32:35], v[88:91]
  v_mfma_f32_16x16x32_bf16 v[92:95], v[12:15], a[88:91], v[92:95]
  v_mfma_f32_16x16x32_bf16 v[96:99], v[12:15], a[144:147], v[96:99]
  v_mfma_f32_16x16x32_bf16 v[100:103], v[12:15], a[200:203], v[100:103]
  ds_read_b128 v[8:11], v3 offset:40960
  ds_read_b128 v[12:15], v3 offset:55296
  s_waitcnt lgkmcnt(6)
  v_mfma_f32_16x16x32_bf16 v[72:75], v[16:19], a[36:39], v[72:75]
  v_mfma_f32_16x16x32_bf16 v[76:79], v[16:19], a[92:95], v[76:79]
  v_mfma_f32_16x16x32_bf16 v[80:83], v[16:19], a[148:151], v[80:83]
  v_mfma_f32_16x16x32_bf16 v[84:87], v[16:19], a[204:207], v[84:87]
  v_mfma_f32_16x16x32_bf16 v[88:91], v[20:23], a[36:39], v[88:91]
  v_mfma_f32_16x16x32_bf16 v[92:95], v[20:23], a[92:95], v[92:95]
  v_mfma_f32_16x16x32_bf16 v[96:99], v[20:23], a[148:151], v[96:99]
  v_mfma_f32_16x16x32_bf16 v[100:103], v[20:23], a[204:207], v[100:103]
  ds_read_b128 v[16:19], v3 offset:41984
  ds_read_b128 v[20:23], v3 offset:56320
  s_waitcnt lgkmcnt(6)
  v_mfma_f32_16x16x32_bf16 v[72:75], v[24:27], a[40:43], v[72:75]
  v_mfma_f32_16x16x32_bf16 v[76:79], v[24:27], a[96:99], v[76:79]
  v_mfma_f32_16x16x32_bf16 v[80:83], v[24:27], a[152:155], v[80:83]
  v_mfma_f32_16x16x32_bf16 v[84:87], v[24:27], a[208:211], v[84:87]
  v_mfma_f32_16x16x32_bf16 v[88:91], v[28:31], a[40:43], v[88:91]
  v_mfma_f32_16x16x32_bf16 v[92:95], v[28:31], a[96:99], v[92:95]
  v_mfma_f32_16x16x32_bf16 v[96:99], v[28:31], a[152:155], v[96:99]
  v_mfma_f32_16x16x32_bf16 v[100:103], v[28:31], a[208:211], v[100:103]
  s_waitcnt lgkmcnt(4)
  v_mfma_f32_16x16x32_bf16 v[72:75], v[32:35], a[44:47], v[72:75]
  v_mfma_f32_16x16x32_bf16 v[76:79], v[32:35], a[100:103], v[76:79]
  v_mfma_f32_16x16x32_bf16 v[80:83], v[32:35], a[156:159], v[80:83]
  v_mfma_f32_16x16x32_bf16 v[84:87], v[32:35], a[212:215], v[84:87]
  v_mfma_f32_16x16x32_bf16 v[88:91], v[36:39], a[44:47], v[88:91]
  v_mfma_f32_16x16x32_bf16 v[92:95], v[36:39], a[100:103], v[92:95]
  v_mfma_f32_16x16x32_bf16 v[96:99], v[36:39], a[156:159], v[96:99]
  v_mfma_f32_16x16x32_bf16 v[100:103], v[36:39], a[212:215], v[100:103]
  s_waitcnt lgkmcnt(2)
  v_mfma_f32_16x16x32_bf16 v[72:75], v[8:11], a[48:51], v[72:75]
  v_mfma_f32_16x16x32_bf16 v[76:79], v[8:11], a[104:107], v[76:79]
  v_mfma_f32_16x16x32_bf16 v[80:83], v[8:11], a[160:163], v[80:83]
  v_mfma_f32_16x16x32_bf16 v[84:87], v[8:11], a[216:219], v[84:87]
  v_mfma_f32_16x16x32_bf16 v[88:91], v[12:15], a[48:51], v[88:91]
  v_mfma_f32_16x16x32_bf16 v[92:95], v[12:15], a[104:107], v[92:95]
  v_mfma_f32_16x16x32_bf16 v[96:99], v[12:15], a[160:163], v[96:99]
  v_mfma_f32_16x16x32_bf16 v[100:103], v[12:15], a[216:219], v[100:103]
  s_waitcnt lgkmcnt(0)
  v_mfma_f32_16x16x32_bf16 v[72:75], v[16:19], a[52:55], v[72:75]
  v_mfma_f32_16x16x32_bf16 v[76:79], v[16:19], a[108:111], v[76:79]
  v_mfma_f32_16x16x32_bf16 v[80:83], v[16:19], a[164:167], v[80:83]
  v_mfma_f32_16x16x32_bf16 v[84:87], v[16:19], a[220:223], v[84:87]
  v_mfma_f32_16x16x32_bf16 v[88:91], v[20:23], a[52:55], v[88:91]
  v_mfma_f32_16x16x32_bf16 v[92:95], v[20:23], a[108:111], v[92:95]
  v_mfma_f32_16x16x32_bf16 v[96:99], v[20:23], a[164:167], v[96:99]
  v_mfma_f32_16x16x32_bf16 v[100:103], v[20:23], a[220:223], v[100:103]
  s_waitcnt vmcnt(4)
  s_cmp_lg_u32 s81, 1
  s_cbranch_scc1 L_vx1_98
  s_waitcnt vmcnt(0)
L_vx1_98:
  s_barrier
  s_cmp_lg_u32 s81, 1
  s_cbranch_scc1 L_ns_99
  v_cmp_eq_u32 vcc, 0, v0
  s_and_saveexec_b64 s[20:21], vcc
  s_cbranch_execz L_sig_100
  v_mov_b32 v112, 1024
  v_mov_b32 v113, 1
  global_atomic_add v112, v113, s[86:87] sc1
L_sig_100:
  s_mov_b64 exec, s[20:21]
L_ns_99:
  s_cmp_lg_u32 s81, 6
  s_cbranch_scc1 L_ns_101
  v_cmp_eq_u32 vcc, 0, v0
  s_and_saveexec_b64 s[20:21], vcc
  s_cbranch_execz L_sig_102
  v_mov_b32 v112, 1152
  v_mov_b32 v113, 1
  global_atomic_add v112, v113, s[86:87] sc1
L_sig_102:
  s_mov_b64 exec, s[20:21]
L_ns_101:
  s_add_u32 s81, s81, 1
  ds_read_b128 v[8:11], v3 offset:0
  ds_read_b128 v[12:15], v3 offset:14336
  ds_read_b128 v[16:19], v3 offset:1024
  ds_read_b128 v[20:23], v3 offset:15360
  ds_read_b128 v[24:27], v3 offset:2048
  ds_read_b128 v[28:31], v3 offset:16384
  s_add_u32 s72, s80, 28672
  s_mov_b32 m0, s72
  s_nop 0
  global_load_lds_dwordx4 v2, s[76:77] offset:-4096
  global_load_lds_dwordx4 v2, s[76:77] offset:-3072
  global_load_lds_dwordx4 v2, s[76:77] offset:-2048
  global_load_lds_dwordx4 v2, s[76:77] offset:-1024
  global_load_lds_dwordx4 v2, s[76:77] offset:0
  global_load_lds_dwordx4 v2, s[76:77] offset:1024
  global_load_lds_dwordx4 v2, s[76:77] offset:2048
  s_sub_u32 s84, 3, s82
  s_cmp_eq_u32 s81, 19
  s_cselect_b32 s84, s84, 3
  s_mul_i32 s84, s84, 28672
  s_add_u32 s76, s76, s84
  s_addc_u32 s77, s77, 0
  ds_read_b128 v[32:35], v3 offset:3072
  ds_read_b128 v[36:39], v3 offset:17408
  s_waitcnt lgkmcnt(6)
  v_mfma_f32_16x16x32_bf16 v[40:43], v[8:11], a[0:3], 0
  v_mfma_f32_16x16x32_bf16 v[44:47], v[8:11], a[56:59], 0
  v_mfma_f32_16x16x32_bf16 v[48:51], v[8:11], a[112:115], 0
  v_mfma_f32_16x16x32_bf16 v[52:55], v[8:11], a[168:171], 0
  v_mfma_f32_16x16x32_bf16 v[56:59], v[12:15], a[0:3], 0
  v_mfma_f32_16x16x32_bf16 v[60:63], v[12:15], a[56:59], 0
  v_mfma_f32_16x16x32_bf16 v[64:67], v[12:15], a[112:115], 0
  v_mfma_f32_16x16x32_bf16 v[68:71], v[12:15], a[168:171], 0
  ds_read_b128 v[8:11], v3 offset:4096
  ds_read_b128 v[12:15], v3 offset:18432
  s_waitcnt lgkmcnt(6)
  v_mfma_f32_16x16x32_bf16 v[40:43], v[16:19], a[4:7], v[40:43]
  v_mfma_f32_16x16x32_bf16 v[44:47], v[16:19], a[60:63], v[44:47]
  v_mfma_f32_16x16x32_bf16 v[48:51], v[16:19], a[116:119], v[48:51]
  v_mfma_f32_16x16x32_bf16 v[52:55], v[16:19], a[172:175], v[52:55]
  v_mfma_f32_16x16x32_bf16 v[56:59], v[20:23], a[4:7], v[56:59]
  v_mfma_f32_16x16x32_bf16 v[60:63], v[20:23], a[60:63], v[60:63]
  v_mfma_f32_16x16x32_bf16 v[64:67], v[20:23], a[116:119], v[64:67]
  v_mfma_f32_16x16x32_bf16 v[68:71], v[20:23], a[172:175], v[68:71]
  ds_read_b128 v[16:19], v3 offset:5120
  ds_read_b128 v[20:23], v3 offset:19456
  s_waitcnt lgkmcnt(6)
  v_mfma_f32_16x16x32_bf16 v[40:43], v[24:27], a[8:11], v[40:43]
  v_mfma_f32_16x16x32_bf16 v[44:47], v[24:27], a[64:67], v[44:47]
  v_cvt_pk_bf16_f32 v104, v72, v73
  v_mfma_f32_16x16x32_bf16 v[48:51], v[24:27], a[120:123], v[48:51]
  v_mfma_f32_16x16x32_bf16 v[52:55], v[24:27], a[176:179], v[52:55]
  v_cvt_pk_bf16_f32 v105, v74, v75
  v_mfma_f32_16x16x32_bf16 v[56:59], v[28:31], a[8:11], v[56:59]
  v_mfma_f32_16x16x32_bf16 v[60:63], v[28:31], a[64:67], v[60:63]
  v_cvt_pk_bf16_f32 v106, v88, v89
  v_mfma_f32_16x16x32_bf16 v[64:67], v[28:31], a[120:123], v[64:67]
  v_mfma_f32_16x16x32_bf16 v[68:71], v[28:31], a[176:179], v[68:71]
  v_cvt_pk_bf16_f32 v107, v90, v91
  ds_read_b128 v[24:27], v3 offset:6144
  ds_read_b128 v[28:31], v3 offset:20480
  s_waitcnt lgkmcnt(6)
  v_mfma_f32_16x16x32_bf16 v[40:43], v[32:35], a[12:15], v[40:43]
  v_mfma_f32_16x16x32_bf16 v[44:47], v[32:35], a[68:71], v[44:47]
  global_store_dwordx4 v2, v[104:107], s[78:79] offset:0 sc1
  v_mfma_f32_16x16x32_bf16 v[48:51], v[32:35], a[124:127], v[48:51]
  v_mfma_f32_16x16x32_bf16 v[52:55], v[32:35], a[180:183], v[52:55]
  v_cvt_pk_bf16_f32 v108, v76, v77
  v_mfma_f32_16x16x32_bf16 v[56:59], v[36:39], a[12:15], v[56:59]
  v_mfma_f32_16x16x32_bf16 v[60:63], v[36:39], a[68:71], v[60:63]
  v_cvt_pk_bf16_f32 v109, v78, v79
  v_mfma_f32_16x16x32_bf16 v[64:67], v[36:39], a[124:127], v[64:67]
  v_mfma_f32_16x16x32_bf16 v[68:71], v[36:39], a[180:183], v[68:71]
  v_cvt_pk_bf16_f32 v110, v92, v93
  ds_read_b128 v[32:35], v3 offset:7168
  ds_read_b128 v[36:39], v3 offset:21504
  s_waitcnt lgkmcnt(6)
  v_mfma_f32_16x16x32_bf16 v[40:43], v[8:11], a[16:19], v[40:43]
  v_mfma_f32_16x16x32_bf16 v[44:47], v[8:11], a[72:75], v[44:47]
  v_cvt_pk_bf16_f32 v111, v94, v95
  v_mfma_f32_16x16x32_bf16 v[48:51], v[8:11], a[128:131], v[48:51]
  v_mfma_f32_16x16x32_bf16 v[52:55], v[8:11], a[184:187], v[52:55]
  global_store_dwordx4 v2, v[108:111], s[78:79] offset:1024 sc1
  v_mfma_f32_16x16x32_bf16 v[56:59], v[12:15], a[16:19], v[56:59]
  v_mfma_f32_16x16x32_bf16 v[60:63], v[12:15], a[72:75], v[60:63]
  v_cvt_pk_bf16_f32 v104, v80, v81
  v_mfma_f32_16x16x32_bf16 v[64:67], v[12:15], a[128:131], v[64:67]
  v_mfma_f32_16x16x32_bf16 v[68:71], v[12:15], a[184:187], v[68:71]
  v_cvt_pk_bf16_f32 v105, v82, v83
  ds_read_b128 v[8:11], v3 offset:8192
  ds_read_b128 v[12:15], v3 offset:22528
  s_waitcnt lgkmcnt(6)
  v_mfma_f32_16x16x32_bf16 v[40:43], v[16:19], a[20:23], v[40:43]
  v_mfma_f32_16x16x32_bf16 v[44:47], v[16:19], a[76:79], v[44:47]
  v_cvt_pk_bf16_f32 v106, v96, v97
  v_mfma_f32_16x16x32_bf16 v[48:51], v[16:19], a[132:135], v[48:51]
  v_mfma_f32_16x16x32_bf16 v[52:55], v[16:19], a[188:191], v[52:55]
  v_cvt_pk_bf16_f32 v107, v98, v99
  v_mfma_f32_16x16x32_bf16 v[56:59], v[20:23], a[20:23], v[56:59]
  v_mfma_f32_16x16x32_bf16 v[60:63], v[20:23], a[76:79], v[60:63]
  global_store_dwordx4 v2, v[104:107], s[78:79] offset:2048 sc1
  v_mfma_f32_16x16x32_bf16 v[64:67], v[20:23], a[132:135], v[64:67]
  v_mfma_f32_16x16x32_bf16 v[68:71], v[20:23], a[188:191], v[68:71]
  v_cvt_pk_bf16_f32 v108, v84, v85
  ds_read_b128 v[16:19], v3 offset:9216
  ds_read_b128 v[20:23], v3 offset:23552
  s_waitcnt lgkmcnt(6)
  v_mfma_f32_16x16x32_bf16 v[40:43], v[24:27], a[24:27], v[40:43]
  v_mfma_f32_16x16x32_bf16 v[44:47], v[24:27], a[80:83], v[44:47]
  v_cvt_pk_bf16_f32 v109, v86, v87
  v_mfma_f32_16x16x32_bf16 v[48:51], v[24:27], a[136:139], v[48:51]
  v_mfma_f32_16x16x32_bf16 v[52:55], v[24:27], a[192:195], v[52:55]
  v_cvt_pk_bf16_f32 v110, v100, v101
  v_mfma_f32_16x16x32_bf16 v[56:59], v[28:31], a[24:27], v[56:59]
  v_mfma_f32_16x16x32_bf16 v[60:63], v[28:31], a[80:83], v[60:63]
  v_cvt_pk_bf16_f32 v111, v102, v103
  v_mfma_f32_16x16x32_bf16 v[64:67], v[28:31], a[136:139], v[64:67]
  v_mfma_f32_16x16x32_bf16 v[68:71], v[28:31], a[192:195], v[68:71]
  global_store_dwordx4 v2, v[108:111], s[78:79] offset:3072 sc1
  ds_read_b128 v[24:27], v3 offset:10240
  ds_read_b128 v[28:31], v3 offset:24576
  s_waitcnt lgkmcnt(6)
  v_mfma_f32_16x16x32_bf16 v[40:43], v[32:35], a[28:31], v[40:43]
  v_mfma_f32_16x16x32_bf16 v[44:47], v[32:35], a[84:87], v[44:47]
  s_sub_u32 s85, 3, s82
  s_cmp_eq_u32 s81, 21
  s_cselect_b32 s85, s85, 3
  s_mul_i32 s85, s85, 458752
  s_add_u32 s78, s78, s85
  s_addc_u32 s79, s79, 0
  v_mfma_f32_16x16x32_bf16 v[48:51], v[32:35], a[140:143], v[48:51]
  v_mfma_f32_16x16x32_bf16 v[52:55], v[32:35], a[196:199], v[52:55]
  v_mfma_f32_16x16x32_bf16 v[56:59], v[36:39], a[28:31], v[56:59]
  v_mfma_f32_16x16x32_bf16 v[60:63], v[36:39], a[84:87], v[60:63]
  v_mfma_f32_16x16x32_bf16 v[64:67], v[36:39], a[140:143], v[64:67]
  v_mfma_f32_16x16x32_bf16 v[68:71], v[36:39], a[196:199], v[68:71]
  ds_read_b128 v[32:35], v3 offset:11264
  ds_read_b128 v[36:39], v3 offset:25600
  s_waitcnt lgkmcnt(6)
  v_mfma_f32_16x16x32_bf16 v[40:43], v[8:11], a[32:35], v[40:43]
  v_mfma_f32_16x16x32_bf16 v[44:47], v[8:11], a[88:91], v[44:47]
  v_mfma_f32_16x16x32_bf16 v[48:51], v[8:11], a[144:147], v[48:51]
  v_mfma_f32_16x16x32_bf16 v[52:55], v[8:11], a[200:203], v[52:55]
  v_mfma_f32_16x16x32_bf16 v[56:59], v[12:15], a[32:35], v[56:59]
  v_mfma_f32_16x16x32_bf16 v[60:63], v[12:15], a[88:91], v[60:63]
  v_mfma_f32_16x16x32_bf16 v[64:67], v[12:15], a[144:147], v[64:67]
  v_mfma_f32_16x16x32_bf16 v[68:71], v[12:15], a[200:203], v[68:71]
  ds_read_b128 v[8:11], v3 offset:12288
  ds_read_b128 v[12:15], v3 offset:26624
  s_waitcnt lgkmcnt(6)
  v_mfma_f32_16x16x32_bf16 v[40:43], v[16:19], a[36:39], v[40:43]
  v_mfma_f32_16x16x32_bf16 v[44:47], v[16:19], a[92:95], v[44:47]
  v_mfma_f32_16x16x32_bf16 v[48:51], v[16:19], a[148:151], v[48:51]
  v_mfma_f32_16x16x32_bf16 v[52:55], v[16:19], a[204:207], v[52:55]
  v_mfma_f32_16x16x32_bf16 v[56:59], v[20:23], a[36:39], v[56:59]
  v_mfma_f32_16x16x32_bf16 v[60:63], v[20:23], a[92:95], v[60:63]
  v_mfma_f32_16x16x32_bf16 v[64:67], v[20:23], a[148:151], v[64:67]
  v_mfma_f32_16x16x32_bf16 v[68:71], v[20:23], a[204:207], v[68:71]
  ds_read_b128 v[16:19], v3 offset:13312
  ds_read_b128 v[20:23], v3 offset:27648
  s_waitcnt lgkmcnt(6)
  v_mfma_f32_16x16x32_bf16 v[40:43], v[24:27], a[40:43], v[40:43]
  v_mfma_f32_16x16x32_bf16 v[44:47], v[24:27], a[96:99], v[44:47]
  v_mfma_f32_16x16x32_bf16 v[48:51], v[24:27], a[152:155], v[48:51]
  v_mfma_f32_16x16x32_bf16 v[52:55], v[24:27], a[208:211], v[52:55]
  v_mfma_f32_16x16x32_bf16 v[56:59], v[28:31], a[40:43], v[56:59]
  v_mfma_f32_16x16x32_bf16 v[60:63], v[28:31], a[96:99], v[60:63]
  v_mfma_f32_16x16x32_bf16 v[64:67], v[28:31], a[152:155], v[64:67]
  v_mfma_f32_16x16x32_bf16 v[68:71], v[28:31], a[208:211], v[68:71]
  s_waitcnt lgkmcnt(4)
  v_mfma_f32_16x16x32_bf16 v[40:43], v[32:35], a[44:47], v[40:43]
  v_mfma_f32_16x16x32_bf16 v[44:47], v[32:35], a[100:103], v[44:47]
  v_mfma_f32_16x16x32_bf16 v[48:51], v[32:35], a[156:159], v[48:51]
  v_mfma_f32_16x16x32_bf16 v[52:55], v[32:35], a[212:215], v[52:55]
  v_mfma_f32_16x16x32_bf16 v[56:59], v[36:39], a[44:47], v[56:59]
  v_mfma_f32_16x16x32_bf16 v[60:63], v[36:39], a[100:103], v[60:63]
  v_mfma_f32_16x16x32_bf16 v[64:67], v[36:39], a[156:159], v[64:67]
  v_mfma_f32_16x16x32_bf16 v[68:71], v[36:39], a[212:215], v[68:71]
  s_waitcnt lgkmcnt(2)
  v_mfma_f32_16x16x32_bf16 v[40:43], v[8:11], a[48:51], v[40:43]
  v_mfma_f32_16x16x32_bf16 v[44:47], v[8:11], a[104:107], v[44:47]
  v_mfma_f32_16x16x32_bf16 v[48:51], v[8:11], a[160:163], v[48:51]
  v_mfma_f32_16x16x32_bf16 v[52:55], v[8:11], a[216:219], v[52:55]
  v_mfma_f32_16x16x32_bf16 v[56:59], v[12:15], a[48:51], v[56:59]
  v_mfma_f32_16x16x32_bf16 v[60:63], v[12:15], a[104:107], v[60:63]
  v_mfma_f32_16x16x32_bf16 v[64:67], v[12:15], a[160:163], v[64:67]
  v_mfma_f32_16x16x32_bf16 v[68:71], v[12:15], a[216:219], v[68:71]
  s_waitcnt lgkmcnt(0)
  v_mfma_f32_16x16x32_bf16 v[40:43], v[16:19], a[52:55], v[40:43]
  v_mfma_f32_16x16x32_bf16 v[44:47], v[16:19], a[108:111], v[44:47]
  v_mfma_f32_16x16x32_bf16 v[48:51], v[16:19], a[164:167], v[48:51]
  v_mfma_f32_16x16x32_bf16 v[52:55], v[16:19], a[220:223], v[52:55]
  v_mfma_f32_16x16x32_bf16 v[56:59], v[20:23], a[52:55], v[56:59]
  v_mfma_f32_16x16x32_bf16 v[60:63], v[20:23], a[108:111], v[60:63]
  v_mfma_f32_16x16x32_bf16 v[64:67], v[20:23], a[164:167], v[64:67]
  v_mfma_f32_16x16x32_bf16 v[68:71], v[20:23], a[220:223], v[68:71]
  s_waitcnt vmcnt(4)
  s_cmp_lg_u32 s81, 1
  s_cbranch_scc1 L_vx1_103
  s_waitcnt vmcnt(0)
L_vx1_103:
  s_barrier
  s_cmp_lg_u32 s81, 1
  s_cbranch_scc1 L_ns_104
  v_cmp_eq_u32 vcc, 0, v0
  s_and_saveexec_b64 s[20:21], vcc
  s_cbranch_execz L_sig_105
  v_mov_b32 v112, 1024
  v_mov_b32 v113, 1
  global_atomic_add v112, v113, s[86:87] sc1
L_sig_105:
  s_mov_b64 exec, s[20:21]
L_ns_104:
  s_cmp_lg_u32 s81, 6
  s_cbranch_scc1 L_ns_106
  v_cmp_eq_u32 vcc, 0, v0
  s_and_saveexec_b64 s[20:21], vcc
  s_cbranch_execz L_sig_107
  v_mov_b32 v112, 1152
  v_mov_b32 v113, 1
  global_atomic_add v112, v113, s[86:87] sc1
L_sig_107:
  s_mov_b64 exec, s[20:21]
L_ns_106:
  s_add_u32 s81, s81, 1
  s_cmp_lt_u32 s81, 21
  s_cbranch_scc1 L_vxl_97
  ds_read_b128 v[8:11], v3 offset:28672
  ds_read_b128 v[12:15], v3 offset:43008
  ds_read_b128 v[16:19], v3 offset:29696
  ds_read_b128 v[20:23], v3 offset:44032
  ds_read_b128 v[24:27], v3 offset:30720
  ds_read_b128 v[28:31], v3 offset:45056
  ds_read_b128 v[32:35], v3 offset:31744
  ds_read_b128 v[36:39], v3 offset:46080
  s_waitcnt lgkmcnt(6)
  v_mfma_f32_16x16x32_bf16 v[72:75], v[8:11], a[0:3], 0
  v_mfma_f32_16x16x32_bf16 v[76:79], v[8:11], a[56:59], 0
  v_mfma_f32_16x16x32_bf16 v[80:83], v[8:11], a[112:115], 0
  v_mfma_f32_16x16x32_bf16 v[84:87], v[8:11], a[168:171], 0
  v_mfma_f32_16x16x32_bf16 v[88:91], v[12:15], a[0:3], 0
  v_mfma_f32_16x16x32_bf16 v[92:95], v[12:15], a[56:59], 0
  v_mfma_f32_16x16x32_bf16 v[96:99], v[12:15], a[112:115], 0
  v_mfma_f32_16x16x32_bf16 v[100:103], v[12:15], a[168:171], 0
  ds_read_b128 v[8:11], v3 offset:32768
  ds_read_b128 v[12:15], v3 offset:47104
  s_waitcnt lgkmcnt(6)
  v_mfma_f32_16x16x32_bf16 v[72:75], v[16:19], a[4:7], v[72:75]
  v_mfma_f32_16x16x32_bf16 v[76:79], v[16:19], a[60:63], v[76:79]
  v_mfma_f32_16x16x32_bf16 v[80:83], v[16:19], a[116:119], v[80:83]
  v_mfma_f32_16x16x32_bf16 v[84:87], v[16:19], a[172:175], v[84:87]
  v_mfma_f32_16x16x32_bf16 v[88:91], v[20:23], a[4:7], v[88:91]
  v_mfma_f32_16x16x32_bf16 v[92:95], v[20:23], a[60:63], v[92:95]
  v_mfma_f32_16x16x32_bf16 v[96:99], v[20:23], a[116:119], v[96:99]
  v_mfma_f32_16x16x32_bf16 v[100:103], v[20:23], a[172:175], v[100:103]
  ds_read_b128 v[16:19], v3 offset:33792
  ds_read_b128 v[20:23], v3 offset:48128
  s_waitcnt lgkmcnt(6)
  v_mfma_f32_16x16x32_bf16 v[72:75], v[24:27], a[8:11], v[72:75]
  v_mfma_f32_16x16x32_bf16 v[76:79], v[24:27], a[64:67], v[76:79]
  v_cvt_pk_bf16_f32 v104, v40, v41
  v_mfma_f32_16x16x32_bf16 v[80:83], v[24:27], a[120:123], v[80:83]
  v_mfma_f32_16x16x32_bf16 v[84:87], v[24:27], a[176:179], v[84:87]
  v_cvt_pk_bf16_f32 v105, v42, v43
  v_mfma_f32_16x16x32_bf16 v[88:91], v[28:31], a[8:11], v[88:91]
  v_mfma_f32_16x16x32_bf16 v[92:95], v[28:31], a[64:67], v[92:95]
  v_cvt_pk_bf16_f32 v106, v56, v57
  v_mfma_f32_16x16x32_bf16 v[96:99], v[28:31], a[120:123], v[96:99]
  v_mfma_f32_16x16x32_bf16 v[100:103], v[28:31], a[176:179], v[100:103]
  v_cvt_pk_bf16_f32 v107, v58, v59
  ds_read_b128 v[24:27], v3 offset:34816
  ds_read_b128 v[28:31], v3 offset:49152
  s_waitcnt lgkmcnt(6)
  v_mfma_f32_16x16x32_bf16 v[72:75], v[32:35], a[12:15], v[72:75]
  v_mfma_f32_16x16x32_bf16 v[76:79], v[32:35], a[68:71], v[76:79]
  global_store_dwordx4 v2, v[104:107], s[78:79] offset:0 sc1
  v_mfma_f32_16x16x32_bf16 v[80:83], v[32:35], a[124:127], v[80:83]
  v_mfma_f32_16x16x32_bf16 v[84:87], v[32:35], a[180:183], v[84:87]
  v_cvt_pk_bf16_f32 v108, v44, v45
  v_mfma_f32_16x16x32_bf16 v[88:91], v[36:39], a[12:15], v[88:91]
  v_mfma_f32_16x16x32_bf16 v[92:95], v[36:39], a[68:71], v[92:95]
  v_cvt_pk_bf16_f32 v109, v46, v47
  v_mfma_f32_16x16x32_bf16 v[96:99], v[36:39], a[124:127], v[96:99]
  v_mfma_f32_16x16x32_bf16 v[100:103], v[36:39], a[180:183], v[100:103]
  v_cvt_pk_bf16_f32 v110, v60, v61
  ds_read_b128 v[32:35], v3 offset:35840
  ds_read_b128 v[36:39], v3 offset:50176
  s_waitcnt lgkmcnt(6)
  v_mfma_f32_16x16x32_bf16 v[72:75], v[8:11], a[16:19], v[72:75]
  v_mfma_f32_16x16x32_bf16 v[76:79], v[8:11], a[72:75], v[76:79]
  v_cvt_pk_bf16_f32 v111, v62, v63
  v_mfma_f32_16x16x32_bf16 v[80:83], v[8:11], a[128:131], v[80:83]
  v_mfma_f32_16x16x32_bf16 v[84:87], v[8:11], a[184:187], v[84:87]
  global_store_dwordx4 v2, v[108:111], s[78:79] offset:1024 sc1
  v_mfma_f32_16x16x32_bf16 v[88:91], v[12:15], a[16:19], v[88:91]
  v_mfma_f32_16x16x32_bf16 v[92:95], v[12:15], a[72:75], v[92:95]
  v_cvt_pk_bf16_f32 v104, v48, v49
  v_mfma_f32_16x16x32_bf16 v[96:99], v[12:15], a[128:131], v[96:99]
  v_mfma_f32_16x16x32_bf16 v[100:103], v[12:15], a[184:187], v[100:103]
  v_cvt_pk_bf16_f32 v105, v50, v51
  ds_read_b128 v[8:11], v3 offset:36864
  ds_read_b128 v[12:15], v3 offset:51200
  s_waitcnt lgkmcnt(6)
  v_mfma_f32_16x16x32_bf16 v[72:75], v[16:19], a[20:23], v[72:75]
  v_mfma_f32_16x16x32_bf16 v[76:79], v[16:19], a[76:79], v[76:79]
  v_cvt_pk_bf16_f32 v106, v64, v65
  v_mfma_f32_16x16x32_bf16 v[80:83], v[16:19], a[132:135], v[80:83]
  v_mfma_f32_16x16x32_bf16 v[84:87], v[16:19], a[188:191], v[84:87]
  v_cvt_pk_bf16_f32 v107, v66, v67
  v_mfma_f32_16x16x32_bf16 v[88:91], v[20:23], a[20:23], v[88:91]
  v_mfma_f32_16x16x32_bf16 v[92:95], v[20:23], a[76:79], v[92:95]
  global_store_dwordx4 v2, v[104:107], s[78:79] offset:2048 sc1
  v_mfma_f32_16x16x32_bf16 v[96:99], v[20:23], a[132:135], v[96:99]
  v_mfma_f32_16x16x32_bf16 v[100:103], v[20:23], a[188:191], v[100:103]
  v_cvt_pk_bf16_f32 v108, v52, v53
  ds_read_b128 v[16:19], v3 offset:37888
  ds_read_b128 v[20:23], v3 offset:52224
  s_waitcnt lgkmcnt(6)
  v_mfma_f32_16x16x32_bf16 v[72:75], v[24:27], a[24:27], v[72:75]
  v_mfma_f32_16x16x32_bf16 v[76:79], v[24:27], a[80:83], v[76:79]
  v_cvt_pk_bf16_f32 v109, v54, v55
  v_mfma_f32_16x16x32_bf16 v[80:83], v[24:27], a[136:139], v[80:83]
  v_mfma_f32_16x16x32_bf16 v[84:87], v[24:27], a[192:195], v[84:87]
  v_cvt_pk_bf16_f32 v110, v68, v69
  v_mfma_f32_16x16x32_bf16 v[88:91], v[28:31], a[24:27], v[88:91]
  v_mfma_f32_16x16x32_bf16 v[92:95], v[28:31], a[80:83], v[92:95]
  v_cvt_pk_bf16_f32 v111, v70, v71
  v_mfma_f32_16x16x32_bf16 v[96:99], v[28:31], a[136:139], v[96:99]
  v_mfma_f32_16x16x32_bf16 v[100:103], v[28:31], a[192:195], v[100:103]
  global_store_dwordx4 v2, v[108:111], s[78:79] offset:3072 sc1
  ds_read_b128 v[24:27], v3 offset:38912
  ds_read_b128 v[28:31], v3 offset:53248
  s_waitcnt lgkmcnt(6)
  v_mfma_f32_16x16x32_bf16 v[72:75], v[32:35], a[28:31], v[72:75]
  v_mfma_f32_16x16x32_bf16 v[76:79], v[32:35], a[84:87], v[76:79]
  s_sub_u32 s85, 3, s82
  s_cmp_eq_u32 s81, 21
  s_cselect_b32 s85, s85, 3
  s_mul_i32 s85, s85, 458752
  s_add_u32 s78, s78, s85
  s_addc_u32 s79, s79, 0
  v_mfma_f32_16x16x32_bf16 v[80:83], v[32:35], a[140:143], v[80:83]
  v_mfma_f32_16x16x32_bf16 v[84:87], v[32:35], a[196:199], v[84:87]
  v_mfma_f32_16x16x32_bf16 v[88:91], v[36:39], a[28:31], v[88:91]
  v_mfma_f32_16x16x32_bf16 v[92:95], v[36:39], a[84:87], v[92:95]
  v_mfma_f32_16x16x32_bf16 v[96:99], v[36:39], a[140:143], v[96:99]
  v_mfma_f32_16x16x32_bf16 v[100:103], v[36:39], a[196:199], v[100:103]
  ds_read_b128 v[32:35], v3 offset:39936
  ds_read_b128 v[36:39], v3 offset:54272
  s_waitcnt lgkmcnt(6)
  v_mfma_f32_16x16x32_bf16 v[72:75], v[8:11], a[32:35], v[72:75]
  v_mfma_f32_16x16x32_bf16 v[76:79], v[8:11], a[88:91], v[76:79]
  v_mfma_f32_16x16x32_bf16 v[80:83], v[8:11], a[144:147], v[80:83]
  v_mfma_f32_16x16x32_bf16 v[84:87], v[8:11], a[200:203], v[84:87]
  v_mfma_f32_16x16x32_bf16 v[88:91], v[12:15], a[32:35], v[88:91]
  v_mfma_f32_16x16x32_bf16 v[92:95], v[12:15], a[88:91], v[92:95]
  v_mfma_f32_16x16x32_bf16 v[96:99], v[12:15], a[144:147], v[96:99]
  v_mfma_f32_16x16x32_bf16 v[100:103], v[12:15], a[200:203], v[100:103]
  ds_read_b128 v[8:11], v3 offset:40960
  ds_read_b128 v[12:15], v3 offset:55296
  s_waitcnt lgkmcnt(6)
  v_mfma_f32_16x16x32_bf16 v[72:75], v[16:19], a[36:39], v[72:75]
  v_mfma_f32_16x16x32_bf16 v[76:79], v[16:19], a[92:95], v[76:79]
  v_mfma_f32_16x16x32_bf16 v[80:83], v[16:19], a[148:151], v[80:83]
  v_mfma_f32_16x16x32_bf16 v[84:87], v[16:19], a[204:207], v[84:87]
  v_mfma_f32_16x16x32_bf16 v[88:91], v[20:23], a[36:39], v[88:91]
  v_mfma_f32_16x16x32_bf16 v[92:95], v[20:23], a[92:95], v[92:95]
  v_mfma_f32_16x16x32_bf16 v[96:99], v[20:23], a[148:151], v[96:99]
  v_mfma_f32_16x16x32_bf16 v[100:103], v[20:23], a[204:207], v[100:103]
  ds_read_b128 v[16:19], v3 offset:41984
  ds_read_b128 v[20:23], v3 offset:56320
  s_waitcnt lgkmcnt(6)
  v_mfma_f32_16x16x32_bf16 v[72:75], v[24:27], a[40:43], v[72:75]
  v_mfma_f32_16x16x32_bf16 v[76:79], v[24:27], a[96:99], v[76:79]
  v_mfma_f32_16x16x32_bf16 v[80:83], v[24:27], a[152:155], v[80:83]
  v_mfma_f32_16x16x32_bf16 v[84:87], v[24:27], a[208:211], v[84:87]
  v_mfma_f32_16x16x32_bf16 v[88:91], v[28:31], a[40:43], v[88:91]
  v_mfma_f32_16x16x32_bf16 v[92:95], v[28:31], a[96:99], v[92:95]
  v_mfma_f32_16x16x32_bf16 v[96:99], v[28:31], a[152:155], v[96:99]
  v_mfma_f32_16x16x32_bf16 v[100:103], v[28:31], a[208:211], v[100:103]
  s_waitcnt lgkmcnt(4)
  v_mfma_f32_16x16x32_bf16 v[72:75], v[32:35], a[44:47], v[72:75]
  v_mfma_f32_16x16x32_bf16 v[76:79], v[32:35], a[100:103], v[76:79]
  v_mfma_f32_16x16x32_bf16 v[80:83], v[32:35], a[156:159], v[80:83]
  v_mfma_f32_16x16x32_bf16 v[84:87], v[32:35], a[212:215], v[84:87]
  v_mfma_f32_16x16x32_bf16 v[88:91], v[36:39], a[44:47], v[88:91]
  v_mfma_f32_16x16x32_bf16 v[92:95], v[36:39], a[100:103], v[92:95]
  v_mfma_f32_16x16x32_bf16 v[96:99], v[36:39], a[156:159], v[96:99]
  v_mfma_f32_16x16x32_bf16 v[100:103], v[36:39], a[212:215], v[100:103]
  s_waitcnt lgkmcnt(2)
  v_mfma_f32_16x16x32_bf16 v[72:75], v[8:11], a[48:51], v[72:75]
  v_mfma_f32_16x16x32_bf16 v[76:79], v[8:11], a[104:107], v[76:79]
  v_mfma_f32_16x16x32_bf16 v[80:83], v[8:11], a[160:163], v[80:83]
  v_mfma_f32_16x16x32_bf16 v[84:87], v[8:11], a[216:219], v[84:87]
  v_mfma_f32_16x16x32_bf16 v[88:91], v[12:15], a[48:51], v[88:91]
  v_mfma_f32_16x16x32_bf16 v[92:95], v[12:15], a[104:107], v[92:95]
  v_mfma_f32_16x16x32_bf16 v[96:99], v[12:15], a[160:163], v[96:99]
  v_mfma_f32_16x16x32_bf16 v[100:103], v[12:15], a[216:219], v[100:103]
  s_waitcnt lgkmcnt(0)
  v_mfma_f32_16x16x32_bf16 v[72:75], v[16:19], a[52:55], v[72:75]
  v_mfma_f32_16x16x32_bf16 v[76:79], v[16:19], a[108:111], v[76:79]
  v_mfma_f32_16x16x32_bf16 v[80:83], v[16:19], a[164:167], v[80:83]
  v_mfma_f32_16x16x32_bf16 v[84:87], v[16:19], a[220:223], v[84:87]
  v_mfma_f32_16x16x32_bf16 v[88:91], v[20:23], a[52:55], v[88:91]
  v_mfma_f32_16x16x32_bf16 v[92:95], v[20:23], a[108:111], v[92:95]
  v_mfma_f32_16x16x32_bf16 v[96:99], v[20:23], a[164:167], v[96:99]
  v_mfma_f32_16x16x32_bf16 v[100:103], v[20:23], a[220:223], v[100:103]
  s_add_u32 s81, s81, 1
  s_nop 7
  v_cvt_pk_bf16_f32 v104, v72, v73
  v_cvt_pk_bf16_f32 v105, v74, v75
  v_cvt_pk_bf16_f32 v106, v88, v89
  v_cvt_pk_bf16_f32 v107, v90, v91
  global_store_dwordx4 v2, v[104:107], s[78:79] offset:0 sc1
  v_cvt_pk_bf16_f32 v108, v76, v77
  v_cvt_pk_bf16_f32 v109, v78, v79
  v_cvt_pk_bf16_f32 v110, v92, v93
  v_cvt_pk_bf16_f32 v111, v94, v95
  global_store_dwordx4 v2, v[108:111], s[78:79] offset:1024 sc1
  v_cvt_pk_bf16_f32 v104, v80, v81
  v_cvt_pk_bf16_f32 v105, v82, v83
  v_cvt_pk_bf16_f32 v106, v96, v97
  v_cvt_pk_bf16_f32 v107, v98, v99
  global_store_dwordx4 v2, v[104:107], s[78:79] offset:2048 sc1
  v_cvt_pk_bf16_f32 v108, v84, v85
  v_cvt_pk_bf16_f32 v109, v86, v87
  v_cvt_pk_bf16_f32 v110, v100, v101
  v_cvt_pk_bf16_f32 v111, v102, v103
  global_store_dwordx4 v2, v[108:111], s[78:79] offset:3072 sc1
  s_sub_u32 s85, 3, s82
  s_cmp_eq_u32 s81, 21
  s_cselect_b32 s85, s85, 3
  s_mul_i32 s85, s85, 458752
  s_add_u32 s78, s78, s85
  s_addc_u32 s79, s79, 0
  s_waitcnt vmcnt(0)
  s_barrier
  v_cmp_eq_u32 vcc, 0, v0
  s_and_saveexec_b64 s[20:21], vcc
  s_cbranch_execz L_sig_108
  v_mov_b32 v112, 1280
  v_mov_b32 v113, 1
  global_atomic_add v112, v113, s[86:87] sc1
L_sig_108:
  s_mov_b64 exec, s[20:21]
  s_cmp_ge_u32 s69, 56
  s_cbranch_scc1 L_done
  s_cmp_ge_u32 s9, 28
  s_cbranch_scc1 L_g1np_109
  s_mul_i32 s36, s9, 9363
  s_lshr_b32 s36, s36, 16
  s_mul_i32 s37, s36, 7
  s_sub_u32 s37, s9, s37
  s_lshl_b32 s14, s68, 2
  s_add_u32 s36, s36, s14
  s_load_dwordx2 s[22:23], s[0:1], 80
  s_load_dwordx2 s[24:25], s[0:1], 88
  s_load_dwordx2 s[26:27], s[0:1], 96
  s_waitcnt lgkmcnt(0)
  v_and_b32 v10, 63, v0
  v_lshrrev_b32 v11, 3, v10
  s_lshl_b32 s30, s8, 3
  v_add_u32 v11, s30, v11
  v_lshlrev_b32 v8, 12, v11
  v_and_b32 v10, 7, v0
  v_lshl_add_u32 v8, v10, 4, v8
  s_lshl_b32 s30, s36, 7
  s_add_u32 s32, s22, s30
  s_addc_u32 s33, s23, 0
  v_bfe_u32 v10, v0, 4, 2
  v_lshlrev_b32 v10, 3, v10
  v_bfe_u32 v11, v0, 2, 2
  v_add_u32 v10, v10, v11
  v_lshlrev_b32 v9, 7, v10
  v_and_b32 v10, 3, v0
  v_lshl_add_u32 v9, v10, 3, v9
  s_lshl_b32 s30, s8, 5
  v_add_u32 v9, s30, v9
  s_lshl_b32 s34, s8, 10
  s_barrier
  s_add_u32 s30, s34, 0
  s_mov_b32 m0, s30
  s_nop 0
  global_load_lds_dwordx4 v8, s[32:33]
  s_add_u32 s32, s32, 131072
  s_addc_u32 s33, s33, 0
  s_add_u32 s30, s34, 4096
  s_mov_b32 m0, s30
  s_nop 0
  global_load_lds_dwordx4 v8, s[32:33]
  s_add_u32 s32, s32, 131072
  s_addc_u32 s33, s33, 0
  s_add_u32 s30, s34, 8192
  s_mov_b32 m0, s30
  s_nop 0
  global_load_lds_dwordx4 v8, s[32:33]
  s_add_u32 s32, s32, 131072
  s_addc_u32 s33, s33, 0
  s_add_u32 s30, s34, 12288
  s_mov_b32 m0, s30
  s_nop 0
  global_load_lds_dwordx4 v8, s[32:33]
  s_add_u32 s32, s32, 131072
  s_addc_u32 s33, s33, 0
  s_add_u32 s30, s34, 16384
  s_mov_b32 m0, s30
  s_nop 0
  global_load_lds_dwordx4 v8, s[32:33]
  s_add_u32 s32, s32, 131072
  s_addc_u32 s33, s33, 0
  s_add_u32 s30, s34, 20480
  s_mov_b32 m0, s30
  s_nop 0
  global_load_lds_dwordx4 v8, s[32:33]
  s_add_u32 s32, s32, 131072
  s_addc_u32 s33, s33, 0
  s_add_u32 s30, s34, 24576
  s_mov_b32 m0, s30
  s_nop 0
  global_load_lds_dwordx4 v8, s[32:33]
  s_add_u32 s32, s32, 131072
  s_addc_u32 s33, s33, 0
  s_add_u32 s30, s34, 28672
  s_mov_b32 m0, s30
  s_nop 0
  global_load_lds_dwordx4 v8, s[32:33]
  s_add_u32 s32, s32, 131072
  s_addc_u32 s33, s33, 0
  s_add_u32 s30, s34, 32768
  s_mov_b32 m0, s30
  s_nop 0
  global_load_lds_dwordx4 v8, s[32:33]
  s_add_u32 s32, s32, 131072
  s_addc_u32 s33, s33, 0
  s_add_u32 s30, s34, 36864
  s_mov_b32 m0, s30
  s_nop 0
  global_load_lds_dwordx4 v8, s[32:33]
  s_add_u32 s32, s32, 131072
  s_addc_u32 s33, s33, 0
  s_add_u32 s30, s34, 40960
  s_mov_b32 m0, s30
  s_nop 0
  global_load_lds_dwordx4 v8, s[32:33]
  s_add_u32 s32, s32, 131072
  s_addc_u32 s33, s33, 0
  s_add_u32 s30, s34, 45056
  s_mov_b32 m0, s30
  s_nop 0
  global_load_lds_dwordx4 v8, s[32:33]
  s_add_u32 s32, s32, 131072
  s_addc_u32 s33, s33, 0
  s_add_u32 s30, s34, 49152
  s_mov_b32 m0, s30
  s_nop 0
  global_load_lds_dwordx4 v8, s[32:33]
  s_add_u32 s32, s32, 131072
  s_addc_u32 s33, s33, 0
  s_add_u32 s30, s34, 53248
  s_mov_b32 m0, s30
  s_nop 0
  global_load_lds_dwordx4 v8, s[32:33]
  s_add_u32 s32, s32, 131072
  s_addc_u32 s33, s33, 0
  s_add_u32 s30, s34, 57344
  s_mov_b32 m0, s30
  s_nop 0
  global_load_lds_dwordx4 v8, s[32:33]
  s_add_u32 s32, s32, 131072
  s_addc_u32 s33, s33, 0
  s_add_u32 s30, s34, 61440
  s_mov_b32 m0, s30
  s_nop 0
  global_load_lds_dwordx4 v8, s[32:33]
  s_add_u32 s32, s32, 131072
  s_addc_u32 s33, s33, 0
  s_add_u32 s30, s34, 65536
  s_mov_b32 m0, s30
  s_nop 0
  global_load_lds_dwordx4 v8, s[32:33]
  s_add_u32 s32, s32, 131072
  s_addc_u32 s33, s33, 0
  s_add_u32 s30, s34, 69632
  s_mov_b32 m0, s30
  s_nop 0
  global_load_lds_dwordx4 v8, s[32:33]
  s_add_u32 s32, s32, 131072
  s_addc_u32 s33, s33, 0
  s_add_u32 s30, s34, 73728
  s_mov_b32 m0, s30
  s_nop 0
  global_load_lds_dwordx4 v8, s[32:33]
  s_add_u32 s32, s32, 131072
  s_addc_u32 s33, s33, 0
  s_add_u32 s30, s34, 77824
  s_mov_b32 m0, s30
  s_nop 0
  global_load_lds_dwordx4 v8, s[32:33]
  s_add_u32 s32, s32, 131072
  s_addc_u32 s33, s33, 0
  s_add_u32 s30, s34, 81920
  s_mov_b32 m0, s30
  s_nop 0
  global_load_lds_dwordx4 v8, s[32:33]
  s_add_u32 s32, s32, 131072
  s_addc_u32 s33, s33, 0
  s_add_u32 s30, s34, 86016
  s_mov_b32 m0, s30
  s_nop 0
  global_load_lds_dwordx4 v8, s[32:33]
  s_add_u32 s32, s32, 131072
  s_addc_u32 s33, s33, 0
  s_add_u32 s30, s34, 90112
  s_mov_b32 m0, s30
  s_nop 0
  global_load_lds_dwordx4 v8, s[32:33]
  s_add_u32 s32, s32, 131072
  s_addc_u32 s33, s33, 0
  s_add_u32 s30, s34, 94208
  s_mov_b32 m0, s30
  s_nop 0
  global_load_lds_dwordx4 v8, s[32:33]
  s_add_u32 s32, s32, 131072
  s_addc_u32 s33, s33, 0
  s_add_u32 s30, s34, 98304
  s_mov_b32 m0, s30
  s_nop 0
  global_load_lds_dwordx4 v8, s[32:33]
  s_add_u32 s32, s32, 131072
  s_addc_u32 s33, s33, 0
  s_add_u32 s30, s34, 102400
  s_mov_b32 m0, s30
  s_nop 0
  global_load_lds_dwordx4 v8, s[32:33]
  s_add_u32 s32, s32, 131072
  s_addc_u32 s33, s33, 0
  s_add_u32 s30, s34, 106496
  s_mov_b32 m0, s30
  s_nop 0
  global_load_lds_dwordx4 v8, s[32:33]
  s_add_u32 s32, s32, 131072
  s_addc_u32 s33, s33, 0
  s_add_u32 s30, s34, 110592
  s_mov_b32 m0, s30
  s_nop 0
  global_load_lds_dwordx4 v8, s[32:33]
  s_add_u32 s32, s32, 131072
  s_addc_u32 s33, s33, 0
  v_add_u32 v10, 57344, v9
  s_waitcnt vmcnt(14)
  s_barrier
  ds_read_b64_tr_b16 a[0:1], v9 offset:0
  ds_read_b64_tr_b16 a[2:3], v9 offset:512
  ds_read_b64_tr_b16 a[4:5], v9 offset:4096
  ds_read_b64_tr_b16 a[6:7], v9 offset:4608
  ds_read_b64_tr_b16 a[8:9], v9 offset:8192
  ds_read_b64_tr_b16 a[10:11], v9 offset:8704
  ds_read_b64_tr_b16 a[12:13], v9 offset:12288
  ds_read_b64_tr_b16 a[14:15], v9 offset:12800
  ds_read_b64_tr_b16 a[16:17], v9 offset:16384
  ds_read_b64_tr_b16 a[18:19], v9 offset:16896
  ds_read_b64_tr_b16 a[20:21], v9 offset:20480
  ds_read_b64_tr_b16 a[22:23], v9 offset:20992
  ds_read_b64_tr_b16 a[24:25], v9 offset:24576
  ds_read_b64_tr_b16 a[26:27], v9 offset:25088
  s_waitcnt lgkmcnt(0)
  ds_read_b64_tr_b16 a[28:29], v9 offset:28672
  ds_read_b64_tr_b16 a[30:31], v9 offset:29184
  ds_read_b64_tr_b16 a[32:33], v9 offset:32768
  ds_read_b64_tr_b16 a[34:35], v9 offset:33280
  ds_read_b64_tr_b16 a[36:37], v9 offset:36864
  ds_read_b64_tr_b16 a[38:39], v9 offset:37376
  ds_read_b64_tr_b16 a[40:41], v9 offset:40960
  ds_read_b64_tr_b16 a[42:43], v9 offset:41472
  ds_read_b64_tr_b16 a[44:45], v9 offset:45056
  ds_read_b64_tr_b16 a[46:47], v9 offset:45568
  ds_read_b64_tr_b16 a[48:49], v9 offset:49152
  ds_read_b64_tr_b16 a[50:51], v9 offset:49664
  ds_read_b64_tr_b16 a[52:53], v9 offset:53248
  ds_read_b64_tr_b16 a[54:55], v9 offset:53760
  s_waitcnt lgkmcnt(0)
  s_barrier
  s_add_u32 s30, s34, 0
  s_mov_b32 m0, s30
  s_nop 0
  global_load_lds_dwordx4 v8, s[32:33]
  s_add_u32 s32, s32, 131072
  s_addc_u32 s33, s33, 0
  s_add_u32 s30, s34, 4096
  s_mov_b32 m0, s30
  s_nop 0
  global_load_lds_dwordx4 v8, s[32:33]
  s_add_u32 s32, s32, 131072
  s_addc_u32 s33, s33, 0
  s_add_u32 s30, s34, 8192
  s_mov_b32 m0, s30
  s_nop 0
  global_load_lds_dwordx4 v8, s[32:33]
  s_add_u32 s32, s32, 131072
  s_addc_u32 s33, s33, 0
  s_add_u32 s30, s34, 12288
  s_mov_b32 m0, s30
  s_nop 0
  global_load_lds_dwordx4 v8, s[32:33]
  s_add_u32 s32, s32, 131072
  s_addc_u32 s33, s33, 0
  s_add_u32 s30, s34, 16384
  s_mov_b32 m0, s30
  s_nop 0
  global_load_lds_dwordx4 v8, s[32:33]
  s_add_u32 s32, s32, 131072
  s_addc_u32 s33, s33, 0
  s_add_u32 s30, s34, 20480
  s_mov_b32 m0, s30
  s_nop 0
  global_load_lds_dwordx4 v8, s[32:33]
  s_add_u32 s32, s32, 131072
  s_addc_u32 s33, s33, 0
  s_add_u32 s30, s34, 24576
  s_mov_b32 m0, s30
  s_nop 0
  global_load_lds_dwordx4 v8, s[32:33]
  s_add_u32 s32, s32, 131072
  s_addc_u32 s33, s33, 0
  s_add_u32 s30, s34, 28672
  s_mov_b32 m0, s30
  s_nop 0
  global_load_lds_dwordx4 v8, s[32:33]
  s_add_u32 s32, s32, 131072
  s_addc_u32 s33, s33, 0
  s_add_u32 s30, s34, 32768
  s_mov_b32 m0, s30
  s_nop 0
  global_load_lds_dwordx4 v8, s[32:33]
  s_add_u32 s32, s32, 131072
  s_addc_u32 s33, s33, 0
  s_add_u32 s30, s34, 36864
  s_mov_b32 m0, s30
  s_nop 0
  global_load_lds_dwordx4 v8, s[32:33]
  s_add_u32 s32, s32, 131072
  s_addc_u32 s33, s33, 0
  s_add_u32 s30, s34, 40960
  s_mov_b32 m0, s30
  s_nop 0
  global_load_lds_dwordx4 v8, s[32:33]
  s_add_u32 s32, s32, 131072
  s_addc_u32 s33, s33, 0
  s_add_u32 s30, s34, 45056
  s_mov_b32 m0, s30
  s_nop 0
  global_load_lds_dwordx4 v8, s[32:33]
  s_add_u32 s32, s32, 131072
  s_addc_u32 s33, s33, 0
  s_add_u32 s30, s34, 49152
  s_mov_b32 m0, s30
  s_nop 0
  global_load_lds_dwordx4 v8, s[32:33]
  s_add_u32 s32, s32, 131072
  s_addc_u32 s33, s33, 0
  s_add_u32 s30, s34, 53248
  s_mov_b32 m0, s30
  s_nop 0
  global_load_lds_dwordx4 v8, s[32:33]
  s_add_u32 s32, s32, 131072
  s_addc_u32 s33, s33, 0
  s_waitcnt vmcnt(14)
  s_barrier
  ds_read_b64_tr_b16 a[56:57], v10 offset:0
  ds_read_b64_tr_b16 a[58:59], v10 offset:512
  ds_read_b64_tr_b16 a[60:61], v10 offset:4096
  ds_read_b64_tr_b16 a[62:63], v10 offset:4608
  ds_read_b64_tr_b16 a[64:65], v10 offset:8192
  ds_read_b64_tr_b16 a[66:67], v10 offset:8704
  ds_read_b64_tr_b16 a[68:69], v10 offset:12288
  ds_read_b64_tr_b16 a[70:71], v10 offset:12800
  ds_read_b64_tr_b16 a[72:73], v10 offset:16384
  ds_read_b64_tr_b16 a[74:75], v10 offset:16896
  ds_read_b64_tr_b16 a[76:77], v10 offset:20480
  ds_read_b64_tr_b16 a[78:79], v10 offset:20992
  ds_read_b64_tr_b16 a[80:81], v10 offset:24576
  ds_read_b64_tr_b16 a[82:83], v10 offset:25088
  s_waitcnt lgkmcnt(0)
  ds_read_b64_tr_b16 a[84:85], v10 offset:28672
  ds_read_b64_tr_b16 a[86:87], v10 offset:29184
  ds_read_b64_tr_b16 a[88:89], v10 offset:32768
  ds_read_b64_tr_b16 a[90:91], v10 offset:33280
  ds_read_b64_tr_b16 a[92:93], v10 offset:36864
  ds_read_b64_tr_b16 a[94:95], v10 offset:37376
  ds_read_b64_tr_b16 a[96:97], v10 offset:40960
  ds_read_b64_tr_b16 a[98:99], v10 offset:41472
  ds_read_b64_tr_b16 a[100:101], v10 offset:45056
  ds_read_b64_tr_b16 a[102:103], v10 offset:45568
  ds_read_b64_tr_b16 a[104:105], v10 offset:49152
  ds_read_b64_tr_b16 a[106:107], v10 offset:49664
  ds_read_b64_tr_b16 a[108:109], v10 offset:53248
  ds_read_b64_tr_b16 a[110:111], v10 offset:53760
  s_waitcnt lgkmcnt(0)
  s_barrier
  s_add_u32 s30, s34, 57344
  s_mov_b32 m0, s30
  s_nop 0
  global_load_lds_dwordx4 v8, s[32:33]
  s_add_u32 s32, s32, 131072
  s_addc_u32 s33, s33, 0
  s_add_u32 s30, s34, 61440
  s_mov_b32 m0, s30
  s_nop 0
  global_load_lds_dwordx4 v8, s[32:33]
  s_add_u32 s32, s32, 131072
  s_addc_u32 s33, s33, 0
  s_add_u32 s30, s34, 65536
  s_mov_b32 m0, s30
  s_nop 0
  global_load_lds_dwordx4 v8, s[32:33]
  s_add_u32 s32, s32, 131072
  s_addc_u32 s33, s33, 0
  s_add_u32 s30, s34, 69632
  s_mov_b32 m0, s30
  s_nop 0
  global_load_lds_dwordx4 v8, s[32:33]
  s_add_u32 s32, s32, 131072
  s_addc_u32 s33, s33, 0
  s_add_u32 s30, s34, 73728
  s_mov_b32 m0, s30
  s_nop 0
  global_load_lds_dwordx4 v8, s[32:33]
  s_add_u32 s32, s32, 131072
  s_addc_u32 s33, s33, 0
  s_add_u32 s30, s34, 77824
  s_mov_b32 m0, s30
  s_nop 0
  global_load_lds_dwordx4 v8, s[32:33]
  s_add_u32 s32, s32, 131072
  s_addc_u32 s33, s33, 0
  s_add_u32 s30, s34, 81920
  s_mov_b32 m0, s30
  s_nop 0
  global_load_lds_dwordx4 v8, s[32:33]
  s_add_u32 s32, s32, 131072
  s_addc_u32 s33, s33, 0
  s_add_u32 s30, s34, 86016
  s_mov_b32 m0, s30
  s_nop 0
  global_load_lds_dwordx4 v8, s[32:33]
  s_add_u32 s32, s32, 131072
  s_addc_u32 s33, s33, 0
  s_add_u32 s30, s34, 90112
  s_mov_b32 m0, s30
  s_nop 0
  global_load_lds_dwordx4 v8, s[32:33]
  s_add_u32 s32, s32, 131072
  s_addc_u32 s33, s33, 0
  s_add_u32 s30, s34, 94208
  s_mov_b32 m0, s30
  s_nop 0
  global_load_lds_dwordx4 v8, s[32:33]
  s_add_u32 s32, s32, 131072
  s_addc_u32 s33, s33, 0
  s_add_u32 s30, s34, 98304
  s_mov_b32 m0, s30
  s_nop 0
  global_load_lds_dwordx4 v8, s[32:33]
  s_add_u32 s32, s32, 131072
  s_addc_u32 s33, s33, 0
  s_add_u32 s30, s34, 102400
  s_mov_b32 m0, s30
  s_nop 0
  global_load_lds_dwordx4 v8, s[32:33]
  s_add_u32 s32, s32, 131072
  s_addc_u32 s33, s33, 0
  s_add_u32 s30, s34, 106496
  s_mov_b32 m0, s30
  s_nop 0
  global_load_lds_dwordx4 v8, s[32:33]
  s_add_u32 s32, s32, 131072
  s_addc_u32 s33, s33, 0
  s_add_u32 s30, s34, 110592
  s_mov_b32 m0, s30
  s_nop 0
  global_load_lds_dwordx4 v8, s[32:33]
  s_add_u32 s32, s32, 131072
  s_addc_u32 s33, s33, 0
  s_waitcnt vmcnt(14)
  s_barrier
  ds_read_b64_tr_b16 a[112:113], v9 offset:0
  ds_read_b64_tr_b16 a[114:115], v9 offset:512
  ds_read_b64_tr_b16 a[116:117], v9 offset:4096
  ds_read_b64_tr_b16 a[118:119], v9 offset:4608
  ds_read_b64_tr_b16 a[120:121], v9 offset:8192
  ds_read_b64_tr_b16 a[122:123], v9 offset:8704
  ds_read_b64_tr_b16 a[124:125], v9 offset:12288
  ds_read_b64_tr_b16 a[126:127], v9 offset:12800
  ds_read_b64_tr_b16 a[128:129], v9 offset:16384
  ds_read_b64_tr_b16 a[130:131], v9 offset:16896
  ds_read_b64_tr_b16 a[132:133], v9 offset:20480
  ds_read_b64_tr_b16 a[134:135], v9 offset:20992
  ds_read_b64_tr_b16 a[136:137], v9 offset:24576
  ds_read_b64_tr_b16 a[138:139], v9 offset:25088
  s_waitcnt lgkmcnt(0)
  ds_read_b64_tr_b16 a[140:141], v9 offset:28672
  ds_read_b64_tr_b16 a[142:143], v9 offset:29184
  ds_read_b64_tr_b16 a[144:145], v9 offset:32768
  ds_read_b64_tr_b16 a[146:147], v9 offset:33280
  ds_read_b64_tr_b16 a[148:149], v9 offset:36864
  ds_read_b64_tr_b16 a[150:151], v9 offset:37376
  ds_read_b64_tr_b16 a[152:153], v9 offset:40960
  ds_read_b64_tr_b16 a[154:155], v9 offset:41472
  ds_read_b64_tr_b16 a[156:157], v9 offset:45056
  ds_read_b64_tr_b16 a[158:159], v9 offset:45568
  ds_read_b64_tr_b16 a[160:161], v9 offset:49152
  ds_read_b64_tr_b16 a[162:163], v9 offset:49664
  ds_read_b64_tr_b16 a[164:165], v9 offset:53248
  ds_read_b64_tr_b16 a[166:167], v9 offset:53760
  s_waitcnt lgkmcnt(0)
  s_waitcnt vmcnt(0)
  s_barrier
  ds_read_b64_tr_b16 a[168:169], v10 offset:0
  ds_read_b64_tr_b16 a[170:171], v10 offset:512
  ds_read_b64_tr_b16 a[172:173], v10 offset:4096
  ds_read_b64_tr_b16 a[174:175], v10 offset:4608
  ds_read_b64_tr_b16 a[176:177], v10 offset:8192
  ds_read_b64_tr_b16 a[178:179], v10 offset:8704
  ds_read_b64_tr_b16 a[180:181], v10 offset:12288
  ds_read_b64_tr_b16 a[182:183], v10 offset:12800
  ds_read_b64_tr_b16 a[184:185], v10 offset:16384
  ds_read_b64_tr_b16 a[186:187], v10 offset:16896
  ds_read_b64_tr_b16 a[188:189], v10 offset:20480
  ds_read_b64_tr_b16 a[190:191], v10 offset:20992
  ds_read_b64_tr_b16 a[192:193], v10 offset:24576
  ds_read_b64_tr_b16 a[194:195], v10 offset:25088
  s_waitcnt lgkmcnt(0)
  ds_read_b64_tr_b16 a[196:197], v10 offset:28672
  ds_read_b64_tr_b16 a[198:199], v10 offset:29184
  ds_read_b64_tr_b16 a[200:201], v10 offset:32768
  ds_read_b64_tr_b16 a[202:203], v10 offset:33280
  ds_read_b64_tr_b16 a[204:205], v10 offset:36864
  ds_read_b64_tr_b16 a[206:207], v10 offset:37376
  ds_read_b64_tr_b16 a[208:209], v10 offset:40960
  ds_read_b64_tr_b16 a[210:211], v10 offset:41472
  ds_read_b64_tr_b16 a[212:213], v10 offset:45056
  ds_read_b64_tr_b16 a[214:215], v10 offset:45568
  ds_read_b64_tr_b16 a[216:217], v10 offset:49152
  ds_read_b64_tr_b16 a[218:219], v10 offset:49664
  ds_read_b64_tr_b16 a[220:221], v10 offset:53248
  ds_read_b64_tr_b16 a[222:223], v10 offset:53760
  s_waitcnt lgkmcnt(0)
  s_mov_b32 s38, 1
  s_barrier
L_g1np_109:
  s_load_dwordx2 s[78:79], s[0:1], 64
  s_load_dwordx2 s[80:81], s[0:1], 72
  v_and_b32 v7, 63, v0
  v_lshlrev_b32 v2, 4, v7
  v_lshrrev_b32 v8, 2, v7
  v_mul_u32_u24 v3, 3584, v8
  v_and_b32 v7, 3, v0
  v_lshl_add_u32 v3, v7, 4, v3
  v_mul_u32_u24 v4, 80, v8
  v_lshl_add_u32 v4, v7, 4, v4
  s_mul_i32 s72, s8, 2560
  v_add_u32 v4, s72, v4
  v_bfe_u32 v7, v0, 4, 2
  v_lshlrev_b32 v7, 3, v7
  v_bfe_u32 v8, v0, 2, 2
  v_add_u32 v7, v7, v8
  v_mul_u32_u24 v5, 80, v7
  v_and_b32 v7, 3, v0
  v_lshl_add_u32 v5, v7, 4, v5
  v_add_u32 v5, s72, v5
  v_and_b32 v7, 63, v0
  v_min_u32 v7, 27, v7
  v_lshrrev_b32 v9, 2, v7
  v_lshlrev_b32 v9, 10, v9
  v_and_b32 v7, 3, v7
  v_lshl_add_u32 v9, v7, 8, v9
  v_add_u32 v9, 252, v9
  s_waitcnt lgkmcnt(0)
  s_lshl_b32 s72, s69, 6
  s_add_u32 s78, s78, s72
  s_addc_u32 s79, s79, 0
  s_add_u32 s80, s80, s72
  s_addc_u32 s81, s81, 0
  s_mul_i32 s72, s8, 7168
  s_add_u32 s76, s4, 56102912
  s_addc_u32 s77, s5, 0
  s_add_u32 s76, s76, s72
  s_addc_u32 s77, s77, 0
  v_bfe_u32 v7, v0, 4, 2
  v_lshlrev_b32 v7, 4, v7
  global_load_dwordx4 v[28:31], v7, s[80:81]
  s_waitcnt vmcnt(0)
  v_lshlrev_b32 v120, 16, v28
  v_and_b32 v121, 0xffff0000, v28
  v_lshlrev_b32 v122, 16, v29
  v_and_b32 v123, 0xffff0000, v29
  v_lshlrev_b32 v124, 16, v30
  v_and_b32 v125, 0xffff0000, v30
  v_lshlrev_b32 v126, 16, v31
  v_and_b32 v127, 0xffff0000, v31
  v_mov_b32 v64, 0
  v_mov_b32 v65, 0
  v_mov_b32 v66, 0
  v_mov_b32 v67, 0
  v_mov_b32 v68, 0
  v_mov_b32 v69, 0
  v_mov_b32 v70, 0
  v_mov_b32 v71, 0
  v_mov_b32 v72, 0
  v_mov_b32 v73, 0
  v_mov_b32 v74, 0
  v_mov_b32 v75, 0
  v_mov_b32 v76, 0
  v_mov_b32 v77, 0
  v_mov_b32 v78, 0
  v_mov_b32 v79, 0
  v_mov_b32 v80, 0
  v_mov_b32 v81, 0
  v_mov_b32 v82, 0
  v_mov_b32 v83, 0
  v_mov_b32 v84, 0
  v_mov_b32 v85, 0
  v_mov_b32 v86, 0
  v_mov_b32 v87, 0
  v_mov_b32 v88, 0
  v_mov_b32 v89, 0
  v_mov_b32 v90, 0
  v_mov_b32 v91, 0
  v_mov_b32 v92, 0
  v_mov_b32 v93, 0
  v_mov_b32 v94, 0
  v_mov_b32 v95, 0
  v_mov_b32 v96, 0
  v_mov_b32 v97, 0
  v_mov_b32 v98, 0
  v_mov_b32 v99, 0
  v_mov_b32 v100, 0
  v_mov_b32 v101, 0
  v_mov_b32 v102, 0
  v_mov_b32 v103, 0
  v_mov_b32 v104, 0
  v_mov_b32 v105, 0
  v_mov_b32 v106, 0
  v_mov_b32 v107, 0
  v_mov_b32 v108, 0
  v_mov_b32 v109, 0
  v_mov_b32 v110, 0
  v_mov_b32 v111, 0
  v_mov_b32 v112, 0
  v_mov_b32 v113, 0
  v_mov_b32 v114, 0
  v_mov_b32 v115, 0
  v_mov_b32 v116, 0
  v_mov_b32 v117, 0
  v_mov_b32 v118, 0
  v_mov_b32 v119, 0
  global_load_dwordx4 v[12:15], v3, s[78:79]
  s_add_u32 s74, s78, 57344
  s_addc_u32 s75, s79, 0
  global_load_dwordx4 v[16:19], v3, s[74:75]
  s_add_u32 s78, s78, 114688
  s_addc_u32 s79, s79, 0
  s_mov_b32 s85, 0
L_G1_loop_110:
  s_waitcnt vmcnt(0)
  ds_write_b128 v4, v[12:15]
  ds_write_b128 v4, v[16:19] offset:1280
  ds_read_b64_tr_b16 v[20:21], v5 offset:0
  ds_read_b64_tr_b16 v[22:23], v5 offset:320
  ds_read_b64_tr_b16 v[24:25], v5 offset:8
  ds_read_b64_tr_b16 v[26:27], v5 offset:328
  s_cmp_ge_u32 s85, 63
  s_cbranch_scc1 L_G1_nw_111
  global_load_dwordx4 v[12:15], v3, s[78:79]
  s_add_u32 s74, s78, 57344
  s_addc_u32 s75, s79, 0
  global_load_dwordx4 v[16:19], v3, s[74:75]
  s_add_u32 s78, s78, 114688
  s_addc_u32 s79, s79, 0
L_G1_nw_111:
  s_mov_b32 s84, 0
L_G1_poll_112:
  global_load_dwordx4 v[28:31], v2, s[76:77] offset:-4096 sc1
  global_load_dwordx4 v[32:35], v2, s[76:77] offset:-3072 sc1
  global_load_dwordx4 v[36:39], v2, s[76:77] offset:-2048 sc1
  global_load_dwordx4 v[40:43], v2, s[76:77] offset:-1024 sc1
  global_load_dwordx4 v[44:47], v2, s[76:77] offset:0 sc1
  global_load_dwordx4 v[48:51], v2, s[76:77] offset:1024 sc1
  global_load_dwordx4 v[52:55], v2, s[76:77] offset:2048 sc1
  s_waitcnt vmcnt(0)
  v_max3_u32 v7, v28, v29, v30
  v_max3_u32 v7, v7, v31, v32
  v_max3_u32 v7, v7, v33, v34
  v_max3_u32 v7, v7, v35, v36
  v_max3_u32 v7, v7, v37, v38
  v_max3_u32 v7, v7, v39, v40
  v_max3_u32 v7, v7, v41, v42
  v_max3_u32 v7, v7, v43, v44
  v_max3_u32 v7, v7, v45, v46
  v_max3_u32 v7, v7, v47, v48
  v_max3_u32 v7, v7, v49, v50
  v_max3_u32 v7, v7, v51, v52
  v_max3_u32 v7, v7, v53, v54
  v_max_u32 v7, v7, v55
  v_cmp_eq_u32 vcc, -1, v7
  s_cbranch_vccz L_G1_got_113
L_G1_ipoll_114:
  s_add_u32 s84, s84, 1
  s_cmp_gt_u32 s84, 262144
  s_cbranch_scc1 L_abort
  global_load_dword v7, v9, s[76:77] offset:-4096 sc1
  s_waitcnt vmcnt(0)
  v_cmp_eq_u32 vcc, -1, v7
  s_cbranch_vccz L_G1_poll_112
  s_sleep 1
  s_branch L_G1_ipoll_114
L_G1_got_113:
  s_waitcnt lgkmcnt(0)
  v_mfma_f32_16x16x32_bf16 v[64:67], v[20:23], v[28:31], v[64:67]
  v_mfma_f32_16x16x32_bf16 v[92:95], v[24:27], v[28:31], v[92:95]
  v_mfma_f32_16x16x32_bf16 v[68:71], v[20:23], v[32:35], v[68:71]
  v_mfma_f32_16x16x32_bf16 v[96:99], v[24:27], v[32:35], v[96:99]
  v_mfma_f32_16x16x32_bf16 v[72:75], v[20:23], v[36:39], v[72:75]
  v_mfma_f32_16x16x32_bf16 v[100:103], v[24:27], v[36:39], v[100:103]
  v_mfma_f32_16x16x32_bf16 v[76:79], v[20:23], v[40:43], v[76:79]
  v_mfma_f32_16x16x32_bf16 v[104:107], v[24:27], v[40:43], v[104:107]
  v_mfma_f32_16x16x32_bf16 v[80:83], v[20:23], v[44:47], v[80:83]
  v_mfma_f32_16x16x32_bf16 v[108:111], v[24:27], v[44:47], v[108:111]
  v_mfma_f32_16x16x32_bf16 v[84:87], v[20:23], v[48:51], v[84:87]
  v_mfma_f32_16x16x32_bf16 v[112:115], v[24:27], v[48:51], v[112:115]
  v_mfma_f32_16x16x32_bf16 v[88:91], v[20:23], v[52:55], v[88:91]
  v_mfma_f32_16x16x32_bf16 v[116:119], v[24:27], v[52:55], v[116:119]
  s_add_u32 s76, s76, 28672
  s_addc_u32 s77, s77, 0
  s_add_u32 s85, s85, 1
  s_cmp_lt_u32 s85, 64
  s_cbranch_scc1 L_G1_loop_110
  v_bfe_u32 v7, v0, 2, 1
  v_mul_u32_u24 v6, 57344, v7
  v_bfe_u32 v7, v0, 3, 1
  v_lshlrev_b32 v7, 2, v7
  v_and_b32 v8, 3, v0
  v_add_u32 v7, v7, v8
  v_bfe_u32 v8, v0, 4, 2
  v_lshl_add_u32 v7, v8, 4, v7
  v_lshl_add_u32 v6, v7, 4, v6
  s_lshl_b32 s72, s69, 10
  s_add_u32 s82, s4, 59768832
  s_addc_u32 s83, s5, 0
  s_add_u32 s82, s82, s72
  s_addc_u32 s83, s83, 0
  v_mov_b32 v40, 0xbdd2d3e8
  v_mov_b32 v41, 0xbdd2d3e8
  v_mov_b32 v42, 0xc0135761
  v_mov_b32 v43, 0xc0135761
  v_mov_b32 v44, 1.0
  v_mov_b32 v45, 1.0
  v_pk_add_f32 v[64:65], v[64:65], v[120:121]
  v_pk_add_f32 v[66:67], v[66:67], v[122:123]
  v_pk_mul_f32 v[36:37], v[64:65], v[64:65]
  v_pk_mul_f32 v[38:39], v[66:67], v[66:67]
  v_pk_fma_f32 v[36:37], v[36:37], v[40:41], v[42:43]
  v_pk_fma_f32 v[38:39], v[38:39], v[40:41], v[42:43]
  v_pk_mul_f32 v[36:37], v[36:37], v[64:65]
  v_pk_mul_f32 v[38:39], v[38:39], v[66:67]
  v_exp_f32 v36, v36
  v_exp_f32 v37, v37
  v_exp_f32 v38, v38
  v_exp_f32 v39, v39
  v_pk_add_f32 v[36:37], v[36:37], v[44:45]
  v_pk_add_f32 v[38:39], v[38:39], v[44:45]
  v_rcp_f32 v36, v36
  v_rcp_f32 v37, v37
  v_rcp_f32 v38, v38
  v_rcp_f32 v39, v39
  s_nop 0
  v_pk_mul_f32 v[64:65], v[64:65], v[36:37]
  v_pk_mul_f32 v[66:67], v[66:67], v[38:39]
  v_cvt_pk_bf16_f32 v32, v64, v65
  v_cvt_pk_bf16_f32 v33, v66, v67
  v_pk_add_f32 v[92:93], v[92:93], v[124:125]
  v_pk_add_f32 v[94:95], v[94:95], v[126:127]
  v_pk_mul_f32 v[36:37], v[92:93], v[92:93]
  v_pk_mul_f32 v[38:39], v[94:95], v[94:95]
  v_pk_fma_f32 v[36:37], v[36:37], v[40:41], v[42:43]
  v_pk_fma_f32 v[38:39], v[38:39], v[40:41], v[42:43]
  v_pk_mul_f32 v[36:37], v[36:37], v[92:93]
  v_pk_mul_f32 v[38:39], v[38:39], v[94:95]
  v_exp_f32 v36, v36
  v_exp_f32 v37, v37
  v_exp_f32 v38, v38
  v_exp_f32 v39, v39
  v_pk_add_f32 v[36:37], v[36:37], v[44:45]
  v_pk_add_f32 v[38:39], v[38:39], v[44:45]
  v_rcp_f32 v36, v36
  v_rcp_f32 v37, v37
  v_rcp_f32 v38, v38
  v_rcp_f32 v39, v39
  s_nop 0
  v_pk_mul_f32 v[92:93], v[92:93], v[36:37]
  v_pk_mul_f32 v[94:95], v[94:95], v[38:39]
  v_cvt_pk_bf16_f32 v34, v92, v93
  v_cvt_pk_bf16_f32 v35, v94, v95
  s_mul_i32 s72, s8, 7
  s_add_u32 s72, s72, 0
  s_lshr_b32 s73, s72, 1
  s_mul_i32 s73, s73, 114688
  s_and_b32 s72, s72, 1
  s_lshl_b32 s72, s72, 7
  s_add_u32 s72, s72, s73
  s_add_u32 s74, s82, s72
  s_addc_u32 s75, s83, 0
  global_store_dwordx4 v6, v[32:35], s[74:75] sc1
  s_nop 1
  v_pk_add_f32 v[68:69], v[68:69], v[120:121]
  v_pk_add_f32 v[70:71], v[70:71], v[122:123]
  v_pk_mul_f32 v[36:37], v[68:69], v[68:69]
  v_pk_mul_f32 v[38:39], v[70:71], v[70:71]
  v_pk_fma_f32 v[36:37], v[36:37], v[40:41], v[42:43]
  v_pk_fma_f32 v[38:39], v[38:39], v[40:41], v[42:43]
  v_pk_mul_f32 v[36:37], v[36:37], v[68:69]
  v_pk_mul_f32 v[38:39], v[38:39], v[70:71]
  v_exp_f32 v36, v36
  v_exp_f32 v37, v37
  v_exp_f32 v38, v38
  v_exp_f32 v39, v39
  v_pk_add_f32 v[36:37], v[36:37], v[44:45]
  v_pk_add_f32 v[38:39], v[38:39], v[44:45]
  v_rcp_f32 v36, v36
  v_rcp_f32 v37, v37
  v_rcp_f32 v38, v38
  v_rcp_f32 v39, v39
  s_nop 0
  v_pk_mul_f32 v[68:69], v[68:69], v[36:37]
  v_pk_mul_f32 v[70:71], v[70:71], v[38:39]
  v_cvt_pk_bf16_f32 v32, v68, v69
  v_cvt_pk_bf16_f32 v33, v70, v71
  v_pk_add_f32 v[96:97], v[96:97], v[124:125]
  v_pk_add_f32 v[98:99], v[98:99], v[126:127]
  v_pk_mul_f32 v[36:37], v[96:97], v[96:97]
  v_pk_mul_f32 v[38:39], v[98:99], v[98:99]
  v_pk_fma_f32 v[36:37], v[36:37], v[40:41], v[42:43]
  v_pk_fma_f32 v[38:39], v[38:39], v[40:41], v[42:43]
  v_pk_mul_f32 v[36:37], v[36:37], v[96:97]
  v_pk_mul_f32 v[38:39], v[38:39], v[98:99]
  v_exp_f32 v36, v36
  v_exp_f32 v37, v37
  v_exp_f32 v38, v38
  v_exp_f32 v39, v39
  v_pk_add_f32 v[36:37], v[36:37], v[44:45]
  v_pk_add_f32 v[38:39], v[38:39], v[44:45]
  v_rcp_f32 v36, v36
  v_rcp_f32 v37, v37
  v_rcp_f32 v38, v38
  v_rcp_f32 v39, v39
  s_nop 0
  v_pk_mul_f32 v[96:97], v[96:97], v[36:37]
  v_pk_mul_f32 v[98:99], v[98:99], v[38:39]
  v_cvt_pk_bf16_f32 v34, v96, v97
  v_cvt_pk_bf16_f32 v35, v98, v99
  s_mul_i32 s72, s8, 7
  s_add_u32 s72, s72, 1
  s_lshr_b32 s73, s72, 1
  s_mul_i32 s73, s73, 114688
  s_and_b32 s72, s72, 1
  s_lshl_b32 s72, s72, 7
  s_add_u32 s72, s72, s73
  s_add_u32 s74, s82, s72
  s_addc_u32 s75, s83, 0
  global_store_dwordx4 v6, v[32:35], s[74:75] sc1
  s_nop 1
  v_pk_add_f32 v[72:73], v[72:73], v[120:121]
  v_pk_add_f32 v[74:75], v[74:75], v[122:123]
  v_pk_mul_f32 v[36:37], v[72:73], v[72:73]
  v_pk_mul_f32 v[38:39], v[74:75], v[74:75]
  v_pk_fma_f32 v[36:37], v[36:37], v[40:41], v[42:43]
  v_pk_fma_f32 v[38:39], v[38:39], v[40:41], v[42:43]
  v_pk_mul_f32 v[36:37], v[36:37], v[72:73]
  v_pk_mul_f32 v[38:39], v[38:39], v[74:75]
  v_exp_f32 v36, v36
  v_exp_f32 v37, v37
  v_exp_f32 v38, v38
  v_exp_f32 v39, v39
  v_pk_add_f32 v[36:37], v[36:37], v[44:45]
  v_pk_add_f32 v[38:39], v[38:39], v[44:45]
  v_rcp_f32 v36, v36
  v_rcp_f32 v37, v37
  v_rcp_f32 v38, v38
  v_rcp_f32 v39, v39
  s_nop 0
  v_pk_mul_f32 v[72:73], v[72:73], v[36:37]
  v_pk_mul_f32 v[74:75], v[74:75], v[38:39]
  v_cvt_pk_bf16_f32 v32, v72, v73
  v_cvt_pk_bf16_f32 v33, v74, v75
  v_pk_add_f32 v[100:101], v[100:101], v[124:125]
  v_pk_add_f32 v[102:103], v[102:103], v[126:127]
  v_pk_mul_f32 v[36:37], v[100:101], v[100:101]
  v_pk_mul_f32 v[38:39], v[102:103], v[102:103]
  v_pk_fma_f32 v[36:37], v[36:37], v[40:41], v[42:43]
  v_pk_fma_f32 v[38:39], v[38:39], v[40:41], v[42:43]
  v_pk_mul_f32 v[36:37], v[36:37], v[100:101]
  v_pk_mul_f32 v[38:39], v[38:39], v[102:103]
  v_exp_f32 v36, v36
  v_exp_f32 v37, v37
  v_exp_f32 v38, v38
  v_exp_f32 v39, v39
  v_pk_add_f32 v[36:37], v[36:37], v[44:45]
  v_pk_add_f32 v[38:39], v[38:39], v[44:45]
  v_rcp_f32 v36, v36
  v_rcp_f32 v37, v37
  v_rcp_f32 v38, v38
  v_rcp_f32 v39, v39
  s_nop 0
  v_pk_mul_f32 v[100:101], v[100:101], v[36:37]
  v_pk_mul_f32 v[102:103], v[102:103], v[38:39]
  v_cvt_pk_bf16_f32 v34, v100, v101
  v_cvt_pk_bf16_f32 v35, v102, v103
  s_mul_i32 s72, s8, 7
  s_add_u32 s72, s72, 2
  s_lshr_b32 s73, s72, 1
  s_mul_i32 s73, s73, 114688
  s_and_b32 s72, s72, 1
  s_lshl_b32 s72, s72, 7
  s_add_u32 s72, s72, s73
  s_add_u32 s74, s82, s72
  s_addc_u32 s75, s83, 0
  global_store_dwordx4 v6, v[32:35], s[74:75] sc1
  s_nop 1
  v_pk_add_f32 v[76:77], v[76:77], v[120:121]
  v_pk_add_f32 v[78:79], v[78:79], v[122:123]
  v_pk_mul_f32 v[36:37], v[76:77], v[76:77]
  v_pk_mul_f32 v[38:39], v[78:79], v[78:79]
  v_pk_fma_f32 v[36:37], v[36:37], v[40:41], v[42:43]
  v_pk_fma_f32 v[38:39], v[38:39], v[40:41], v[42:43]
  v_pk_mul_f32 v[36:37], v[36:37], v[76:77]
  v_pk_mul_f32 v[38:39], v[38:39], v[78:79]
  v_exp_f32 v36, v36
  v_exp_f32 v37, v37
  v_exp_f32 v38, v38
  v_exp_f32 v39, v39
  v_pk_add_f32 v[36:37], v[36:37], v[44:45]
  v_pk_add_f32 v[38:39], v[38:39], v[44:45]
  v_rcp_f32 v36, v36
  v_rcp_f32 v37, v37
  v_rcp_f32 v38, v38
  v_rcp_f32 v39, v39
  s_nop 0
  v_pk_mul_f32 v[76:77], v[76:77], v[36:37]
  v_pk_mul_f32 v[78:79], v[78:79], v[38:39]
  v_cvt_pk_bf16_f32 v32, v76, v77
  v_cvt_pk_bf16_f32 v33, v78, v79
  v_pk_add_f32 v[104:105], v[104:105], v[124:125]
  v_pk_add_f32 v[106:107], v[106:107], v[126:127]
  v_pk_mul_f32 v[36:37], v[104:105], v[104:105]
  v_pk_mul_f32 v[38:39], v[106:107], v[106:107]
  v_pk_fma_f32 v[36:37], v[36:37], v[40:41], v[42:43]
  v_pk_fma_f32 v[38:39], v[38:39], v[40:41], v[42:43]
  v_pk_mul_f32 v[36:37], v[36:37], v[104:105]
  v_pk_mul_f32 v[38:39], v[38:39], v[106:107]
  v_exp_f32 v36, v36
  v_exp_f32 v37, v37
  v_exp_f32 v38, v38
  v_exp_f32 v39, v39
  v_pk_add_f32 v[36:37], v[36:37], v[44:45]
  v_pk_add_f32 v[38:39], v[38:39], v[44:45]
  v_rcp_f32 v36, v36
  v_rcp_f32 v37, v37
  v_rcp_f32 v38, v38
  v_rcp_f32 v39, v39
  s_nop 0
  v_pk_mul_f32 v[104:105], v[104:105], v[36:37]
  v_pk_mul_f32 v[106:107], v[106:107], v[38:39]
  v_cvt_pk_bf16_f32 v34, v104, v105
  v_cvt_pk_bf16_f32 v35, v106, v107
  s_mul_i32 s72, s8, 7
  s_add_u32 s72, s72, 3
  s_lshr_b32 s73, s72, 1
  s_mul_i32 s73, s73, 114688
  s_and_b32 s72, s72, 1
  s_lshl_b32 s72, s72, 7
  s_add_u32 s72, s72, s73
  s_add_u32 s74, s82, s72
  s_addc_u32 s75, s83, 0
  global_store_dwordx4 v6, v[32:35], s[74:75] sc1
  s_nop 1
  v_pk_add_f32 v[80:81], v[80:81], v[120:121]
  v_pk_add_f32 v[82:83], v[82:83], v[122:123]
  v_pk_mul_f32 v[36:37], v[80:81], v[80:81]
  v_pk_mul_f32 v[38:39], v[82:83], v[82:83]
  v_pk_fma_f32 v[36:37], v[36:37], v[40:41], v[42:43]
  v_pk_fma_f32 v[38:39], v[38:39], v[40:41], v[42:43]
  v_pk_mul_f32 v[36:37], v[36:37], v[80:81]
  v_pk_mul_f32 v[38:39], v[38:39], v[82:83]
  v_exp_f32 v36, v36
  v_exp_f32 v37, v37
  v_exp_f32 v38, v38
  v_exp_f32 v39, v39
  v_pk_add_f32 v[36:37], v[36:37], v[44:45]
  v_pk_add_f32 v[38:39], v[38:39], v[44:45]
  v_rcp_f32 v36, v36
  v_rcp_f32 v37, v37
  v_rcp_f32 v38, v38
  v_rcp_f32 v39, v39
  s_nop 0
  v_pk_mul_f32 v[80:81], v[80:81], v[36:37]
  v_pk_mul_f32 v[82:83], v[82:83], v[38:39]
  v_cvt_pk_bf16_f32 v32, v80, v81
  v_cvt_pk_bf16_f32 v33, v82, v83
  v_pk_add_f32 v[108:109], v[108:109], v[124:125]
  v_pk_add_f32 v[110:111], v[110:111], v[126:127]
  v_pk_mul_f32 v[36:37], v[108:109], v[108:109]
  v_pk_mul_f32 v[38:39], v[110:111], v[110:111]
  v_pk_fma_f32 v[36:37], v[36:37], v[40:41], v[42:43]
  v_pk_fma_f32 v[38:39], v[38:39], v[40:41], v[42:43]
  v_pk_mul_f32 v[36:37], v[36:37], v[108:109]
  v_pk_mul_f32 v[38:39], v[38:39], v[110:111]
  v_exp_f32 v36, v36
  v_exp_f32 v37, v37
  v_exp_f32 v38, v38
  v_exp_f32 v39, v39
  v_pk_add_f32 v[36:37], v[36:37], v[44:45]
  v_pk_add_f32 v[38:39], v[38:39], v[44:45]
  v_rcp_f32 v36, v36
  v_rcp_f32 v37, v37
  v_rcp_f32 v38, v38
  v_rcp_f32 v39, v39
  s_nop 0
  v_pk_mul_f32 v[108:109], v[108:109], v[36:37]
  v_pk_mul_f32 v[110:111], v[110:111], v[38:39]
  v_cvt_pk_bf16_f32 v34, v108, v109
  v_cvt_pk_bf16_f32 v35, v110, v111
  s_mul_i32 s72, s8, 7
  s_add_u32 s72, s72, 4
  s_lshr_b32 s73, s72, 1
  s_mul_i32 s73, s73, 114688
  s_and_b32 s72, s72, 1
  s_lshl_b32 s72, s72, 7
  s_add_u32 s72, s72, s73
  s_add_u32 s74, s82, s72
  s_addc_u32 s75, s83, 0
  global_store_dwordx4 v6, v[32:35], s[74:75] sc1
  s_nop 1
  v_pk_add_f32 v[84:85], v[84:85], v[120:121]
  v_pk_add_f32 v[86:87], v[86:87], v[122:123]
  v_pk_mul_f32 v[36:37], v[84:85], v[84:85]
  v_pk_mul_f32 v[38:39], v[86:87], v[86:87]
  v_pk_fma_f32 v[36:37], v[36:37], v[40:41], v[42:43]
  v_pk_fma_f32 v[38:39], v[38:39], v[40:41], v[42:43]
  v_pk_mul_f32 v[36:37], v[36:37], v[84:85]
  v_pk_mul_f32 v[38:39], v[38:39], v[86:87]
  v_exp_f32 v36, v36
  v_exp_f32 v37, v37
  v_exp_f32 v38, v38
  v_exp_f32 v39, v39
  v_pk_add_f32 v[36:37], v[36:37], v[44:45]
  v_pk_add_f32 v[38:39], v[38:39], v[44:45]
  v_rcp_f32 v36, v36
  v_rcp_f32 v37, v37
  v_rcp_f32 v38, v38
  v_rcp_f32 v39, v39
  s_nop 0
  v_pk_mul_f32 v[84:85], v[84:85], v[36:37]
  v_pk_mul_f32 v[86:87], v[86:87], v[38:39]
  v_cvt_pk_bf16_f32 v32, v84, v85
  v_cvt_pk_bf16_f32 v33, v86, v87
  v_pk_add_f32 v[112:113], v[112:113], v[124:125]
  v_pk_add_f32 v[114:115], v[114:115], v[126:127]
  v_pk_mul_f32 v[36:37], v[112:113], v[112:113]
  v_pk_mul_f32 v[38:39], v[114:115], v[114:115]
  v_pk_fma_f32 v[36:37], v[36:37], v[40:41], v[42:43]
  v_pk_fma_f32 v[38:39], v[38:39], v[40:41], v[42:43]
  v_pk_mul_f32 v[36:37], v[36:37], v[112:113]
  v_pk_mul_f32 v[38:39], v[38:39], v[114:115]
  v_exp_f32 v36, v36
  v_exp_f32 v37, v37
  v_exp_f32 v38, v38
  v_exp_f32 v39, v39
  v_pk_add_f32 v[36:37], v[36:37], v[44:45]
  v_pk_add_f32 v[38:39], v[38:39], v[44:45]
  v_rcp_f32 v36, v36
  v_rcp_f32 v37, v37
  v_rcp_f32 v38, v38
  v_rcp_f32 v39, v39
  s_nop 0
  v_pk_mul_f32 v[112:113], v[112:113], v[36:37]
  v_pk_mul_f32 v[114:115], v[114:115], v[38:39]
  v_cvt_pk_bf16_f32 v34, v112, v113
  v_cvt_pk_bf16_f32 v35, v114, v115
  s_mul_i32 s72, s8, 7
  s_add_u32 s72, s72, 5
  s_lshr_b32 s73, s72, 1
  s_mul_i32 s73, s73, 114688
  s_and_b32 s72, s72, 1
  s_lshl_b32 s72, s72, 7
  s_add_u32 s72, s72, s73
  s_add_u32 s74, s82, s72
  s_addc_u32 s75, s83, 0
  global_store_dwordx4 v6, v[32:35], s[74:75] sc1
  s_nop 1
  v_pk_add_f32 v[88:89], v[88:89], v[120:121]
  v_pk_add_f32 v[90:91], v[90:91], v[122:123]
  v_pk_mul_f32 v[36:37], v[88:89], v[88:89]
  v_pk_mul_f32 v[38:39], v[90:91], v[90:91]
  v_pk_fma_f32 v[36:37], v[36:37], v[40:41], v[42:43]
  v_pk_fma_f32 v[38:39], v[38:39], v[40:41], v[42:43]
  v_pk_mul_f32 v[36:37], v[36:37], v[88:89]
  v_pk_mul_f32 v[38:39], v[38:39], v[90:91]
  v_exp_f32 v36, v36
  v_exp_f32 v37, v37
  v_exp_f32 v38, v38
  v_exp_f32 v39, v39
  v_pk_add_f32 v[36:37], v[36:37], v[44:45]
  v_pk_add_f32 v[38:39], v[38:39], v[44:45]
  v_rcp_f32 v36, v36
  v_rcp_f32 v37, v37
  v_rcp_f32 v38, v38
  v_rcp_f32 v39, v39
  s_nop 0
  v_pk_mul_f32 v[88:89], v[88:89], v[36:37]
  v_pk_mul_f32 v[90:91], v[90:91], v[38:39]
  v_cvt_pk_bf16_f32 v32, v88, v89
  v_cvt_pk_bf16_f32 v33, v90, v91
  v_pk_add_f32 v[116:117], v[116:117], v[124:125]
  v_pk_add_f32 v[118:119], v[118:119], v[126:127]
  v_pk_mul_f32 v[36:37], v[116:117], v[116:117]
  v_pk_mul_f32 v[38:39], v[118:119], v[118:119]
  v_pk_fma_f32 v[36:37], v[36:37], v[40:41], v[42:43]
  v_pk_fma_f32 v[38:39], v[38:39], v[40:41], v[42:43]
  v_pk_mul_f32 v[36:37], v[36:37], v[116:117]
  v_pk_mul_f32 v[38:39], v[38:39], v[118:119]
  v_exp_f32 v36, v36
  v_exp_f32 v37, v37
  v_exp_f32 v38, v38
  v_exp_f32 v39, v39
  v_pk_add_f32 v[36:37], v[36:37], v[44:45]
  v_pk_add_f32 v[38:39], v[38:39], v[44:45]
  v_rcp_f32 v36, v36
  v_rcp_f32 v37, v37
  v_rcp_f32 v38, v38
  v_rcp_f32 v39, v39
  s_nop 0
  v_pk_mul_f32 v[116:117], v[116:117], v[36:37]
  v_pk_mul_f32 v[118:119], v[118:119], v[38:39]
  v_cvt_pk_bf16_f32 v34, v116, v117
  v_cvt_pk_bf16_f32 v35, v118, v119
  s_mul_i32 s72, s8, 7
  s_add_u32 s72, s72, 6
  s_lshr_b32 s73, s72, 1
  s_mul_i32 s73, s73, 114688
  s_and_b32 s72, s72, 1
  s_lshl_b32 s72, s72, 7
  s_add_u32 s72, s72, s73
  s_add_u32 s74, s82, s72
  s_addc_u32 s75, s83, 0
  global_store_dwordx4 v6, v[32:35], s[74:75] sc1
  s_nop 1
  s_waitcnt vmcnt(0)
  s_barrier
  v_cmp_gt_u32 vcc, 8, v0
  s_and_saveexec_b64 s[20:21], vcc
  s_cbranch_execz L_gfsig_115
  s_add_u32 s14, s69, 0
  s_and_b32 s15, s14, 7
  s_lshl_b32 s15, s15, 7
  s_lshr_b32 s14, s14, 3
  s_lshl_b32 s14, s14, 2
  s_add_u32 s14, s14, s15
  s_add_u32 s14, s14, 4096
  v_lshlrev_b32 v112, 10, v0
  v_add_u32 v112, s14, v112
  v_mov_b32 v113, 1
  global_store_dword v112, v113, s[86:87] sc1
L_gfsig_115:
  s_mov_b64 exec, s[20:21]
  s_branch L_done
L_pref:
  v_and_b32 v5, 31, v0
  v_lshlrev_b32 v5, 7, v5
  v_lshrrev_b32 v6, 5, v0
  v_lshl_add_u32 v6, v6, 2, v5
  v_add_u32 v6, 61513728, v6
  s_mov_b32 s11, 0
L_wa_116:
  global_load_dword v7, v6, s[4:5] sc1
  s_waitcnt vmcnt(0)
  v_cmp_ne_u32 vcc, s88, v7
  s_cbranch_vccz L_wag_117
  s_add_u32 s11, s11, 1
  s_cmp_gt_u32 s11, 262144
  s_cbranch_scc1 L_abort
  s_branch L_wa_116
L_wag_117:
  v_and_b32 v6, 31, v0
  v_lshlrev_b32 v6, 7, v6
  v_lshrrev_b32 v7, 5, v0
  v_lshl_add_u32 v7, v7, 2, v6
  v_add_u32 v7, 61513728, v7
  global_load_dword v7, v7, s[4:5] sc1
  v_and_b32 v4, 7, v0
  v_lshlrev_b32 v4, 5, v4
  global_load_dword v4, v4, s[6:7] sc1
  s_waitcnt vmcnt(0)
  v_cmp_ne_u32 vcc, 32, v4
  s_cbranch_vccnz L_cfbad_119
  v_cmp_ne_u32 vcc, s88, v7
  s_cbranch_vccnz L_cfbad_119
  s_branch L_cfok_118
L_cfbad_119:
  v_mov_b32 v4, 135168
  ds_write_b32 v4, v4
L_cfok_118:
  s_waitcnt lgkmcnt(0)
  s_barrier
  v_mov_b32 v4, 135168
  ds_read_b32 v4, v4
  s_waitcnt lgkmcnt(0)
  s_nop 0
  v_readfirstlane_b32 s14, v4
  s_nop 3
  s_cmp_lg_u32 s14, 0
  s_cbranch_scc1 L_recheck
  s_load_dwordx2 s[72:73], s[0:1], 80
  s_sub_u32 s74, s69, 84
  s_mul_i32 s74, s74, 614400
  v_lshlrev_b32 v2, 4, v0
  s_waitcnt lgkmcnt(0)
  s_mov_b32 s75, 0
L_pref_120:
  s_add_u32 s76, s74, s75
  s_min_u32 s76, s76, 7335936
  s_add_u32 s78, s72, s76
  s_addc_u32 s79, s73, 0
  global_load_dwordx4 v[4:7], v2, s[78:79]
  s_add_u32 s75, s75, 4096
  s_cmp_lt_u32 s75, 614400
  s_cbranch_scc1 L_pref_120
  s_waitcnt vmcnt(0)
  s_branch L_done
L_chain:
  s_cmp_eq_u32 s9, 31
  s_cbranch_scc1 L_cidle
  s_cmp_eq_u32 s9, 30
  s_cbranch_scc1 L_roleF
  s_cmp_ge_u32 s9, 16
  s_cbranch_scc1 L_roleB
  v_and_b32 v4, 63, v0
  v_min_u32 v4, 6, v4
  s_and_b32 s24, s9, 3
  s_mul_i32 s24, s24, 7
  v_add_u32 v4, s24, v4
  s_lshr_b32 s24, s9, 2
  v_lshl_add_u32 v4, v4, 3, s24
  v_and_b32 v5, 31, v4
  v_lshlrev_b32 v5, 7, v5
  v_lshrrev_b32 v6, 5, v4
  v_lshl_add_u32 v6, v6, 2, v5
  v_add_u32 v6, 61513728, v6
  s_mov_b32 s11, 0
L_wt_121:
  global_load_dword v7, v6, s[4:5] sc1
  s_waitcnt vmcnt(0)
  v_cmp_ne_u32 vcc, s88, v7
  s_cbranch_vccz L_wtg_122
  s_add_u32 s11, s11, 1
  s_cmp_gt_u32 s11, 262144
  s_cbranch_scc1 L_abort
  s_branch L_wt_121
L_wtg_122:
  v_and_b32 v78, 63, v0
  v_lshlrev_b32 v113, 4, v78
  s_lshl_b32 s14, s8, 10
  v_add_u32 v114, s14, v113
  s_add_u32 s14, s8, 4
  s_min_u32 s14, s14, 6
  s_lshl_b32 s14, s14, 10
  v_add_u32 v115, s14, v113
  v_and_b32 v78, 8, v0
  v_cmp_eq_u32 vcc, 0, v78
  v_mov_b32 v112, 0xeeeeeeee
  v_mov_b32 v78, 0x44444444
  s_nop 1
  v_cndmask_b32 v112, v112, v78, vcc
  s_lshl_b32 s14, s8, 11
  s_add_u32 s15, s14, 1024
  s_cmp_eq_u32 s8, 3
  s_cselect_b32 s15, 5120, s15
  v_add_u32 v114, s14, v113
  v_add_u32 v115, s15, v113
  s_mul_i32 s14, s9, 401408
  s_mul_i32 s15, s8, 100352
  s_add_u32 s14, s14, s15
  s_add_u32 s16, s4, 0
  s_addc_u32 s17, s5, 0
  s_add_u32 s16, s16, s14
  s_addc_u32 s17, s17, 0
  s_cmp_lg_u32 s8, 0
  s_cbranch_scc1 L_wl_n_124
  s_add_u32 s18, s16, 0
  s_addc_u32 s19, s17, 0
  global_load_dwordx4 a[0:3], v113, s[18:19]
  global_load_dwordx4 a[4:7], v113, s[18:19] offset:1024
  s_add_u32 s18, s16, 2048
  s_addc_u32 s19, s17, 0
  global_load_dwordx4 a[8:11], v113, s[18:19]
  global_load_dwordx4 a[12:15], v113, s[18:19] offset:1024
  s_add_u32 s18, s16, 4096
  s_addc_u32 s19, s17, 0
  global_load_dwordx4 a[16:19], v113, s[18:19]
  global_load_dwordx4 a[20:23], v113, s[18:19] offset:1024
  s_add_u32 s18, s16, 6144
  s_addc_u32 s19, s17, 0
  global_load_dwordx4 a[24:27], v113, s[18:19]
  global_load_dwordx4 a[28:31], v113, s[18:19] offset:1024
  s_add_u32 s18, s16, 8192
  s_addc_u32 s19, s17, 0
  global_load_dwordx4 a[32:35], v113, s[18:19]
  global_load_dwordx4 a[36:39], v113, s[18:19] offset:1024
  s_add_u32 s18, s16, 10240
  s_addc_u32 s19, s17, 0
  global_load_dwordx4 a[40:43], v113, s[18:19]
  global_load_dwordx4 a[44:47], v113, s[18:19] offset:1024
  s_add_u32 s18, s16, 12288
  s_addc_u32 s19, s17, 0
  global_load_dwordx4 a[48:51], v113, s[18:19]
  global_load_dwordx4 a[52:55], v113, s[18:19] offset:1024
  s_add_u32 s18, s16, 14336
  s_addc_u32 s19, s17, 0
  global_load_dwordx4 a[56:59], v113, s[18:19]
  global_load_dwordx4 a[60:63], v113, s[18:19] offset:1024
  s_add_u32 s18, s16, 16384
  s_addc_u32 s19, s17, 0
  global_load_dwordx4 a[64:67], v113, s[18:19]
  global_load_dwordx4 a[68:71], v113, s[18:19] offset:1024
  s_add_u32 s18, s16, 18432
  s_addc_u32 s19, s17, 0
  global_load_dwordx4 a[72:75], v113, s[18:19]
  global_load_dwordx4 a[76:79], v113, s[18:19] offset:1024
  s_add_u32 s18, s16, 20480
  s_addc_u32 s19, s17, 0
  global_load_dwordx4 a[80:83], v113, s[18:19]
  global_load_dwordx4 a[84:87], v113, s[18:19] offset:1024
  s_add_u32 s18, s16, 22528
  s_addc_u32 s19, s17, 0
  global_load_dwordx4 a[88:91], v113, s[18:19]
  global_load_dwordx4 a[92:95], v113, s[18:19] offset:1024
  s_add_u32 s18, s16, 24576
  s_addc_u32 s19, s17, 0
  global_load_dwordx4 a[96:99], v113, s[18:19]
  global_load_dwordx4 a[100:103], v113, s[18:19] offset:1024
  s_add_u32 s18, s16, 26624
  s_addc_u32 s19, s17, 0
  global_load_dwordx4 a[104:107], v113, s[18:19]
  global_load_dwordx4 a[108:111], v113, s[18:19] offset:1024
  s_add_u32 s18, s16, 28672
  s_addc_u32 s19, s17, 0
  global_load_dwordx4 a[112:115], v113, s[18:19]
  global_load_dwordx4 a[116:119], v113, s[18:19] offset:1024
  s_add_u32 s18, s16, 30720
  s_addc_u32 s19, s17, 0
  global_load_dwordx4 a[120:123], v113, s[18:19]
  global_load_dwordx4 a[124:127], v113, s[18:19] offset:1024
  s_add_u32 s18, s16, 32768
  s_addc_u32 s19, s17, 0
  global_load_dwordx4 a[128:131], v113, s[18:19]
  global_load_dwordx4 a[132:135], v113, s[18:19] offset:1024
  s_add_u32 s18, s16, 34816
  s_addc_u32 s19, s17, 0
  global_load_dwordx4 a[136:139], v113, s[18:19]
  global_load_dwordx4 a[140:143], v113, s[18:19] offset:1024
  s_add_u32 s18, s16, 36864
  s_addc_u32 s19, s17, 0
  global_load_dwordx4 a[144:147], v113, s[18:19]
  global_load_dwordx4 a[148:151], v113, s[18:19] offset:1024
  s_add_u32 s18, s16, 38912
  s_addc_u32 s19, s17, 0
  global_load_dwordx4 a[152:155], v113, s[18:19]
  global_load_dwordx4 a[156:159], v113, s[18:19] offset:1024
  s_add_u32 s18, s16, 40960
  s_addc_u32 s19, s17, 0
  global_load_dwordx4 a[160:163], v113, s[18:19]
  global_load_dwordx4 a[164:167], v113, s[18:19] offset:1024
  s_add_u32 s18, s16, 43008
  s_addc_u32 s19, s17, 0
  global_load_dwordx4 a[168:171], v113, s[18:19]
  global_load_dwordx4 a[172:175], v113, s[18:19] offset:1024
  s_add_u32 s18, s16, 45056
  s_addc_u32 s19, s17, 0
  global_load_dwordx4 a[176:179], v113, s[18:19]
  global_load_dwordx4 a[180:183], v113, s[18:19] offset:1024
  s_add_u32 s18, s16, 47104
  s_addc_u32 s19, s17, 0
  global_load_dwordx4 a[184:187], v113, s[18:19]
  global_load_dwordx4 a[188:191], v113, s[18:19] offset:1024
  s_add_u32 s18, s16, 49152
  s_addc_u32 s19, s17, 0
  global_load_dwordx4 a[192:195], v113, s[18:19]
  global_load_dwordx4 a[196:199], v113, s[18:19] offset:1024
  s_add_u32 s18, s16, 51200
  s_addc_u32 s19, s17, 0
  global_load_dwordx4 a[200:203], v113, s[18:19]
  global_load_dwordx4 a[204:207], v113, s[18:19] offset:1024
  s_add_u32 s18, s16, 53248
  s_addc_u32 s19, s17, 0
  global_load_dwordx4 a[208:211], v113, s[18:19]
  global_load_dwordx4 a[212:215], v113, s[18:19] offset:1024
  s_add_u32 s18, s16, 55296
  s_addc_u32 s19, s17, 0
  global_load_dwordx4 a[216:219], v113, s[18:19]
  global_load_dwordx4 a[220:223], v113, s[18:19] offset:1024
  s_add_u32 s18, s16, 57344
  s_addc_u32 s19, s17, 0
  global_load_dwordx4 a[224:227], v113, s[18:19]
  global_load_dwordx4 a[228:231], v113, s[18:19] offset:1024
  s_add_u32 s18, s16, 59392
  s_addc_u32 s19, s17, 0
  global_load_dwordx4 a[232:235], v113, s[18:19]
  global_load_dwordx4 a[236:239], v113, s[18:19] offset:1024
  s_add_u32 s18, s16, 61440
  s_addc_u32 s19, s17, 0
  global_load_dwordx4 a[240:243], v113, s[18:19]
  global_load_dwordx4 a[244:247], v113, s[18:19] offset:1024
  s_add_u32 s18, s16, 63488
  s_addc_u32 s19, s17, 0
  global_load_dwordx4 a[248:251], v113, s[18:19]
  global_load_dwordx4 a[252:255], v113, s[18:19] offset:1024
  s_add_u32 s18, s16, 65536
  s_addc_u32 s19, s17, 0
  global_load_dwordx4 v[120:123], v113, s[18:19]
  global_load_dwordx4 v[124:127], v113, s[18:19] offset:1024
  s_add_u32 s18, s16, 67584
  s_addc_u32 s19, s17, 0
  global_load_dwordx4 v[128:131], v113, s[18:19]
  global_load_dwordx4 v[132:135], v113, s[18:19] offset:1024
  s_add_u32 s18, s16, 69632
  s_addc_u32 s19, s17, 0
  global_load_dwordx4 v[136:139], v113, s[18:19]
  global_load_dwordx4 v[140:143], v113, s[18:19] offset:1024
  s_add_u32 s18, s16, 71680
  s_addc_u32 s19, s17, 0
  global_load_dwordx4 v[144:147], v113, s[18:19]
  global_load_dwordx4 v[148:151], v113, s[18:19] offset:1024
  s_add_u32 s18, s16, 73728
  s_addc_u32 s19, s17, 0
  global_load_dwordx4 v[152:155], v113, s[18:19]
  global_load_dwordx4 v[156:159], v113, s[18:19] offset:1024
  s_add_u32 s18, s16, 75776
  s_addc_u32 s19, s17, 0
  global_load_dwordx4 v[160:163], v113, s[18:19]
  global_load_dwordx4 v[164:167], v113, s[18:19] offset:1024
  s_add_u32 s18, s16, 77824
  s_addc_u32 s19, s17, 0
  global_load_dwordx4 v[168:171], v113, s[18:19]
  global_load_dwordx4 v[172:175], v113, s[18:19] offset:1024
  s_add_u32 s18, s16, 79872
  s_addc_u32 s19, s17, 0
  global_load_dwordx4 v[176:179], v113, s[18:19]
  global_load_dwordx4 v[180:183], v113, s[18:19] offset:1024
  s_add_u32 s18, s16, 81920
  s_addc_u32 s19, s17, 0
  global_load_dwordx4 v[184:187], v113, s[18:19]
  global_load_dwordx4 v[188:191], v113, s[18:19] offset:1024
  s_add_u32 s18, s16, 83968
  s_addc_u32 s19, s17, 0
  global_load_dwordx4 v[192:195], v113, s[18:19]
  global_load_dwordx4 v[196:199], v113, s[18:19] offset:1024
  s_add_u32 s18, s16, 86016
  s_addc_u32 s19, s17, 0
  global_load_dwordx4 v[200:203], v113, s[18:19]
  global_load_dwordx4 v[204:207], v113, s[18:19] offset:1024
  s_add_u32 s18, s16, 88064
  s_addc_u32 s19, s17, 0
  global_load_dwordx4 v[208:211], v113, s[18:19]
  global_load_dwordx4 v[212:215], v113, s[18:19] offset:1024
  s_add_u32 s18, s16, 90112
  s_addc_u32 s19, s17, 0
  global_load_dwordx4 v[216:219], v113, s[18:19]
  global_load_dwordx4 v[220:223], v113, s[18:19] offset:1024
  s_add_u32 s18, s16, 92160
  s_addc_u32 s19, s17, 0
  global_load_dwordx4 v[224:227], v113, s[18:19]
  global_load_dwordx4 v[228:231], v113, s[18:19] offset:1024
  s_add_u32 s18, s16, 94208
  s_addc_u32 s19, s17, 0
  global_load_dwordx4 v[232:235], v113, s[18:19]
  global_load_dwordx4 v[236:239], v113, s[18:19] offset:1024
  s_add_u32 s18, s16, 96256
  s_addc_u32 s19, s17, 0
  global_load_dwordx4 v[240:243], v113, s[18:19]
  global_load_dwordx4 v[244:247], v113, s[18:19] offset:1024
  s_add_u32 s18, s16, 98304
  s_addc_u32 s19, s17, 0
  global_load_dwordx4 v[248:251], v113, s[18:19]
  global_load_dwordx4 v[252:255], v113, s[18:19] offset:1024
  s_branch L_wl_j_123
L_wl_n_124:
  s_cmp_lg_u32 s8, 1
  s_cbranch_scc1 L_wl_n_125
  s_add_u32 s18, s16, 4096
  s_addc_u32 s19, s17, 0
  global_load_dwordx4 a[0:3], v113, s[18:19]
  global_load_dwordx4 a[4:7], v113, s[18:19] offset:1024
  s_add_u32 s18, s16, 6144
  s_addc_u32 s19, s17, 0
  global_load_dwordx4 a[8:11], v113, s[18:19]
  global_load_dwordx4 a[12:15], v113, s[18:19] offset:1024
  s_add_u32 s18, s16, 0
  s_addc_u32 s19, s17, 0
  global_load_dwordx4 a[16:19], v113, s[18:19]
  global_load_dwordx4 a[20:23], v113, s[18:19] offset:1024
  s_add_u32 s18, s16, 2048
  s_addc_u32 s19, s17, 0
  global_load_dwordx4 a[24:27], v113, s[18:19]
  global_load_dwordx4 a[28:31], v113, s[18:19] offset:1024
  s_add_u32 s18, s16, 8192
  s_addc_u32 s19, s17, 0
  global_load_dwordx4 a[32:35], v113, s[18:19]
  global_load_dwordx4 a[36:39], v113, s[18:19] offset:1024
  s_add_u32 s18, s16, 10240
  s_addc_u32 s19, s17, 0
  global_load_dwordx4 a[40:43], v113, s[18:19]
  global_load_dwordx4 a[44:47], v113, s[18:19] offset:1024
  s_add_u32 s18, s16, 12288
  s_addc_u32 s19, s17, 0
  global_load_dwordx4 a[48:51], v113, s[18:19]
  global_load_dwordx4 a[52:55], v113, s[18:19] offset:1024
  s_add_u32 s18, s16, 18432
  s_addc_u32 s19, s17, 0
  global_load_dwordx4 a[56:59], v113, s[18:19]
  global_load_dwordx4 a[60:63], v113, s[18:19] offset:1024
  s_add_u32 s18, s16, 20480
  s_addc_u32 s19, s17, 0
  global_load_dwordx4 a[64:67], v113, s[18:19]
  global_load_dwordx4 a[68:71], v113, s[18:19] offset:1024
  s_add_u32 s18, s16, 14336
  s_addc_u32 s19, s17, 0
  global_load_dwordx4 a[72:75], v113, s[18:19]
  global_load_dwordx4 a[76:79], v113, s[18:19] offset:1024
  s_add_u32 s18, s16, 16384
  s_addc_u32 s19, s17, 0
  global_load_dwordx4 a[80:83], v113, s[18:19]
  global_load_dwordx4 a[84:87], v113, s[18:19] offset:1024
  s_add_u32 s18, s16, 22528
  s_addc_u32 s19, s17, 0
  global_load_dwordx4 a[88:91], v113, s[18:19]
  global_load_dwordx4 a[92:95], v113, s[18:19] offset:1024
  s_add_u32 s18, s16, 24576
  s_addc_u32 s19, s17, 0
  global_load_dwordx4 a[96:99], v113, s[18:19]
  global_load_dwordx4 a[100:103], v113, s[18:19] offset:1024
  s_add_u32 s18, s16, 26624
  s_addc_u32 s19, s17, 0
  global_load_dwordx4 a[104:107], v113, s[18:19]
  global_load_dwordx4 a[108:111], v113, s[18:19] offset:1024
  s_add_u32 s18, s16, 32768
  s_addc_u32 s19, s17, 0
  global_load_dwordx4 a[112:115], v113, s[18:19]
  global_load_dwordx4 a[116:119], v113, s[18:19] offset:1024
  s_add_u32 s18, s16, 34816
  s_addc_u32 s19, s17, 0
  global_load_dwordx4 a[120:123], v113, s[18:19]
  global_load_dwordx4 a[124:127], v113, s[18:19] offset:1024
  s_add_u32 s18, s16, 28672
  s_addc_u32 s19, s17, 0
  global_load_dwordx4 a[128:131], v113, s[18:19]
  global_load_dwordx4 a[132:135], v113, s[18:19] offset:1024
  s_add_u32 s18, s16, 30720
  s_addc_u32 s19, s17, 0
  global_load_dwordx4 a[136:139], v113, s[18:19]
  global_load_dwordx4 a[140:143], v113, s[18:19] offset:1024
  s_add_u32 s18, s16, 36864
  s_addc_u32 s19, s17, 0
  global_load_dwordx4 a[144:147], v113, s[18:19]
  global_load_dwordx4 a[148:151], v113, s[18:19] offset:1024
  s_add_u32 s18, s16, 38912
  s_addc_u32 s19, s17, 0
  global_load_dwordx4 a[152:155], v113, s[18:19]
  global_load_dwordx4 a[156:159], v113, s[18:19] offset:1024
  s_add_u32 s18, s16, 40960
  s_addc_u32 s19, s17, 0
  global_load_dwordx4 a[160:163], v113, s[18:19]
  global_load_dwordx4 a[164:167], v113, s[18:19] offset:1024
  s_add_u32 s18, s16, 47104
  s_addc_u32 s19, s17, 0
  global_load_dwordx4 a[168:171], v113, s[18:19]
  global_load_dwordx4 a[172:175], v113, s[18:19] offset:1024
  s_add_u32 s18, s16, 49152
  s_addc_u32 s19, s17, 0
  global_load_dwordx4 a[176:179], v113, s[18:19]
  global_load_dwordx4 a[180:183], v113, s[18:19] offset:1024
  s_add_u32 s18, s16, 43008
  s_addc_u32 s19, s17, 0
  global_load_dwordx4 a[184:187], v113, s[18:19]
  global_load_dwordx4 a[188:191], v113, s[18:19] offset:1024
  s_add_u32 s18, s16, 45056
  s_addc_u32 s19, s17, 0
  global_load_dwordx4 a[192:195], v113, s[18:19]
  global_load_dwordx4 a[196:199], v113, s[18:19] offset:1024
  s_add_u32 s18, s16, 51200
  s_addc_u32 s19, s17, 0
  global_load_dwordx4 a[200:203], v113, s[18:19]
  global_load_dwordx4 a[204:207], v113, s[18:19] offset:1024
  s_add_u32 s18, s16, 53248
  s_addc_u32 s19, s17, 0
  global_load_dwordx4 a[208:211], v113, s[18:19]
  global_load_dwordx4 a[212:215], v113, s[18:19] offset:1024
  s_add_u32 s18, s16, 55296
  s_addc_u32 s19, s17, 0
  global_load_dwordx4 a[216:219], v113, s[18:19]
  global_load_dwordx4 a[220:223], v113, s[18:19] offset:1024
  s_add_u32 s18, s16, 61440
  s_addc_u32 s19, s17, 0
  global_load_dwordx4 a[224:227], v113, s[18:19]
  global_load_dwordx4 a[228:231], v113, s[18:19] offset:1024
  s_add_u32 s18, s16, 63488
  s_addc_u32 s19, s17, 0
  global_load_dwordx4 a[232:235], v113, s[18:19]
  global_load_dwordx4 a[236:239], v113, s[18:19] offset:1024
  s_add_u32 s18, s16, 57344
  s_addc_u32 s19, s17, 0
  global_load_dwordx4 a[240:243], v113, s[18:19]
  global_load_dwordx4 a[244:247], v113, s[18:19] offset:1024
  s_add_u32 s18, s16, 59392
  s_addc_u32 s19, s17, 0
  global_load_dwordx4 a[248:251], v113, s[18:19]
  global_load_dwordx4 a[252:255], v113, s[18:19] offset:1024
  s_add_u32 s18, s16, 65536
  s_addc_u32 s19, s17, 0
  global_load_dwordx4 v[120:123], v113, s[18:19]
  global_load_dwordx4 v[124:127], v113, s[18:19] offset:1024
  s_add_u32 s18, s16, 67584
  s_addc_u32 s19, s17, 0
  global_load_dwordx4 v[128:131], v113, s[18:19]
  global_load_dwordx4 v[132:135], v113, s[18:19] offset:1024
  s_add_u32 s18, s16, 69632
  s_addc_u32 s19, s17, 0
  global_load_dwordx4 v[136:139], v113, s[18:19]
  global_load_dwordx4 v[140:143], v113, s[18:19] offset:1024
  s_add_u32 s18, s16, 75776
  s_addc_u32 s19, s17, 0
  global_load_dwordx4 v[144:147], v113, s[18:19]
  global_load_dwordx4 v[148:151], v113, s[18:19] offset:1024
  s_add_u32 s18, s16, 77824
  s_addc_u32 s19, s17, 0
  global_load_dwordx4 v[152:155], v113, s[18:19]
  global_load_dwordx4 v[156:159], v113, s[18:19] offset:1024
  s_add_u32 s18, s16, 71680
  s_addc_u32 s19, s17, 0
  global_load_dwordx4 v[160:163], v113, s[18:19]
  global_load_dwordx4 v[164:167], v113, s[18:19] offset:1024
  s_add_u32 s18, s16, 73728
  s_addc_u32 s19, s17, 0
  global_load_dwordx4 v[168:171], v113, s[18:19]
  global_load_dwordx4 v[172:175], v113, s[18:19] offset:1024
  s_add_u32 s18, s16, 79872
  s_addc_u32 s19, s17, 0
  global_load_dwordx4 v[176:179], v113, s[18:19]
  global_load_dwordx4 v[180:183], v113, s[18:19] offset:1024
  s_add_u32 s18, s16, 81920
  s_addc_u32 s19, s17, 0
  global_load_dwordx4 v[184:187], v113, s[18:19]
  global_load_dwordx4 v[188:191], v113, s[18:19] offset:1024
  s_add_u32 s18, s16, 83968
  s_addc_u32 s19, s17, 0
  global_load_dwordx4 v[192:195], v113, s[18:19]
  global_load_dwordx4 v[196:199], v113, s[18:19] offset:1024
  s_add_u32 s18, s16, 90112
  s_addc_u32 s19, s17, 0
  global_load_dwordx4 v[200:203], v113, s[18:19]
  global_load_dwordx4 v[204:207], v113, s[18:19] offset:1024
  s_add_u32 s18, s16, 92160
  s_addc_u32 s19, s17, 0
  global_load_dwordx4 v[208:211], v113, s[18:19]
  global_load_dwordx4 v[212:215], v113, s[18:19] offset:1024
  s_add_u32 s18, s16, 86016
  s_addc_u32 s19, s17, 0
  global_load_dwordx4 v[216:219], v113, s[18:19]
  global_load_dwordx4 v[220:223], v113, s[18:19] offset:1024
  s_add_u32 s18, s16, 88064
  s_addc_u32 s19, s17, 0
  global_load_dwordx4 v[224:227], v113, s[18:19]
  global_load_dwordx4 v[228:231], v113, s[18:19] offset:1024
  s_add_u32 s18, s16, 94208
  s_addc_u32 s19, s17, 0
  global_load_dwordx4 v[232:235], v113, s[18:19]
  global_load_dwordx4 v[236:239], v113, s[18:19] offset:1024
  s_add_u32 s18, s16, 96256
  s_addc_u32 s19, s17, 0
  global_load_dwordx4 v[240:243], v113, s[18:19]
  global_load_dwordx4 v[244:247], v113, s[18:19] offset:1024
  s_add_u32 s18, s16, 98304
  s_addc_u32 s19, s17, 0
  global_load_dwordx4 v[248:251], v113, s[18:19]
  global_load_dwordx4 v[252:255], v113, s[18:19] offset:1024
  s_branch L_wl_j_123
L_wl_n_125:
  s_cmp_lg_u32 s8, 2
  s_cbranch_scc1 L_wl_n_126
  s_add_u32 s18, s16, 8192
  s_addc_u32 s19, s17, 0
  global_load_dwordx4 a[0:3], v113, s[18:19]
  global_load_dwordx4 a[4:7], v113, s[18:19] offset:1024
  s_add_u32 s18, s16, 10240
  s_addc_u32 s19, s17, 0
  global_load_dwordx4 a[8:11], v113, s[18:19]
  global_load_dwordx4 a[12:15], v113, s[18:19] offset:1024
  s_add_u32 s18, s16, 0
  s_addc_u32 s19, s17, 0
  global_load_dwordx4 a[16:19], v113, s[18:19]
  global_load_dwordx4 a[20:23], v113, s[18:19] offset:1024
  s_add_u32 s18, s16, 2048
  s_addc_u32 s19, s17, 0
  global_load_dwordx4 a[24:27], v113, s[18:19]
  global_load_dwordx4 a[28:31], v113, s[18:19] offset:1024
  s_add_u32 s18, s16, 4096
  s_addc_u32 s19, s17, 0
  global_load_dwordx4 a[32:35], v113, s[18:19]
  global_load_dwordx4 a[36:39], v113, s[18:19] offset:1024
  s_add_u32 s18, s16, 6144
  s_addc_u32 s19, s17, 0
  global_load_dwordx4 a[40:43], v113, s[18:19]
  global_load_dwordx4 a[44:47], v113, s[18:19] offset:1024
  s_add_u32 s18, s16, 12288
  s_addc_u32 s19, s17, 0
  global_load_dwordx4 a[48:51], v113, s[18:19]
  global_load_dwordx4 a[52:55], v113, s[18:19] offset:1024
  s_add_u32 s18, s16, 22528
  s_addc_u32 s19, s17, 0
  global_load_dwordx4 a[56:59], v113, s[18:19]
  global_load_dwordx4 a[60:63], v113, s[18:19] offset:1024
  s_add_u32 s18, s16, 24576
  s_addc_u32 s19, s17, 0
  global_load_dwordx4 a[64:67], v113, s[18:19]
  global_load_dwordx4 a[68:71], v113, s[18:19] offset:1024
  s_add_u32 s18, s16, 14336
  s_addc_u32 s19, s17, 0
  global_load_dwordx4 a[72:75], v113, s[18:19]
  global_load_dwordx4 a[76:79], v113, s[18:19] offset:1024
  s_add_u32 s18, s16, 16384
  s_addc_u32 s19, s17, 0
  global_load_dwordx4 a[80:83], v113, s[18:19]
  global_load_dwordx4 a[84:87], v113, s[18:19] offset:1024
  s_add_u32 s18, s16, 18432
  s_addc_u32 s19, s17, 0
  global_load_dwordx4 a[88:91], v113, s[18:19]
  global_load_dwordx4 a[92:95], v113, s[18:19] offset:1024
  s_add_u32 s18, s16, 20480
  s_addc_u32 s19, s17, 0
  global_load_dwordx4 a[96:99], v113, s[18:19]
  global_load_dwordx4 a[100:103], v113, s[18:19] offset:1024
  s_add_u32 s18, s16, 26624
  s_addc_u32 s19, s17, 0
  global_load_dwordx4 a[104:107], v113, s[18:19]
  global_load_dwordx4 a[108:111], v113, s[18:19] offset:1024
  s_add_u32 s18, s16, 36864
  s_addc_u32 s19, s17, 0
  global_load_dwordx4 a[112:115], v113, s[18:19]
  global_load_dwordx4 a[116:119], v113, s[18:19] offset:1024
  s_add_u32 s18, s16, 38912
  s_addc_u32 s19, s17, 0
  global_load_dwordx4 a[120:123], v113, s[18:19]
  global_load_dwordx4 a[124:127], v113, s[18:19] offset:1024
  s_add_u32 s18, s16, 28672
  s_addc_u32 s19, s17, 0
  global_load_dwordx4 a[128:131], v113, s[18:19]
  global_load_dwordx4 a[132:135], v113, s[18:19] offset:1024
  s_add_u32 s18, s16, 30720
  s_addc_u32 s19, s17, 0
  global_load_dwordx4 a[136:139], v113, s[18:19]
  global_load_dwordx4 a[140:143], v113, s[18:19] offset:1024
  s_add_u32 s18, s16, 32768
  s_addc_u32 s19, s17, 0
  global_load_dwordx4 a[144:147], v113, s[18:19]
  global_load_dwordx4 a[148:151], v113, s[18:19] offset:1024
  s_add_u32 s18, s16, 34816
  s_addc_u32 s19, s17, 0
  global_load_dwordx4 a[152:155], v113, s[18:19]
  global_load_dwordx4 a[156:159], v113, s[18:19] offset:1024
  s_add_u32 s18, s16, 40960
  s_addc_u32 s19, s17, 0
  global_load_dwordx4 a[160:163], v113, s[18:19]
  global_load_dwordx4 a[164:167], v113, s[18:19] offset:1024
  s_add_u32 s18, s16, 51200
  s_addc_u32 s19, s17, 0
  global_load_dwordx4 a[168:171], v113, s[18:19]
  global_load_dwordx4 a[172:175], v113, s[18:19] offset:1024
  s_add_u32 s18, s16, 53248
  s_addc_u32 s19, s17, 0
  global_load_dwordx4 a[176:179], v113, s[18:19]
  global_load_dwordx4 a[180:183], v113, s[18:19] offset:1024
  s_add_u32 s18, s16, 43008
  s_addc_u32 s19, s17, 0
  global_load_dwordx4 a[184:187], v113, s[18:19]
  global_load_dwordx4 a[188:191], v113, s[18:19] offset:1024
  s_add_u32 s18, s16, 45056
  s_addc_u32 s19, s17, 0
  global_load_dwordx4 a[192:195], v113, s[18:19]
  global_load_dwordx4 a[196:199], v113, s[18:19] offset:1024
  s_add_u32 s18, s16, 47104
  s_addc_u32 s19, s17, 0
  global_load_dwordx4 a[200:203], v113, s[18:19]
  global_load_dwordx4 a[204:207], v113, s[18:19] offset:1024
  s_add_u32 s18, s16, 49152
  s_addc_u32 s19, s17, 0
  global_load_dwordx4 a[208:211], v113, s[18:19]
  global_load_dwordx4 a[212:215], v113, s[18:19] offset:1024
  s_add_u32 s18, s16, 55296
  s_addc_u32 s19, s17, 0
  global_load_dwordx4 a[216:219], v113, s[18:19]
  global_load_dwordx4 a[220:223], v113, s[18:19] offset:1024
  s_add_u32 s18, s16, 65536
  s_addc_u32 s19, s17, 0
  global_load_dwordx4 a[224:227], v113, s[18:19]
  global_load_dwordx4 a[228:231], v113, s[18:19] offset:1024
  s_add_u32 s18, s16, 67584
  s_addc_u32 s19, s17, 0
  global_load_dwordx4 a[232:235], v113, s[18:19]
  global_load_dwordx4 a[236:239], v113, s[18:19] offset:1024
  s_add_u32 s18, s16, 57344
  s_addc_u32 s19, s17, 0
  global_load_dwordx4 a[240:243], v113, s[18:19]
  global_load_dwordx4 a[244:247], v113, s[18:19] offset:1024
  s_add_u32 s18, s16, 59392
  s_addc_u32 s19, s17, 0
  global_load_dwordx4 a[248:251], v113, s[18:19]
  global_load_dwordx4 a[252:255], v113, s[18:19] offset:1024
  s_add_u32 s18, s16, 61440
  s_addc_u32 s19, s17, 0
  global_load_dwordx4 v[120:123], v113, s[18:19]
  global_load_dwordx4 v[124:127], v113, s[18:19] offset:1024
  s_add_u32 s18, s16, 63488
  s_addc_u32 s19, s17, 0
  global_load_dwordx4 v[128:131], v113, s[18:19]
  global_load_dwordx4 v[132:135], v113, s[18:19] offset:1024
  s_add_u32 s18, s16, 69632
  s_addc_u32 s19, s17, 0
  global_load_dwordx4 v[136:139], v113, s[18:19]
  global_load_dwordx4 v[140:143], v113, s[18:19] offset:1024
  s_add_u32 s18, s16, 79872
  s_addc_u32 s19, s17, 0
  global_load_dwordx4 v[144:147], v113, s[18:19]
  global_load_dwordx4 v[148:151], v113, s[18:19] offset:1024
  s_add_u32 s18, s16, 81920
  s_addc_u32 s19, s17, 0
  global_load_dwordx4 v[152:155], v113, s[18:19]
  global_load_dwordx4 v[156:159], v113, s[18:19] offset:1024
  s_add_u32 s18, s16, 71680
  s_addc_u32 s19, s17, 0
  global_load_dwordx4 v[160:163], v113, s[18:19]
  global_load_dwordx4 v[164:167], v113, s[18:19] offset:1024
  s_add_u32 s18, s16, 73728
  s_addc_u32 s19, s17, 0
  global_load_dwordx4 v[168:171], v113, s[18:19]
  global_load_dwordx4 v[172:175], v113, s[18:19] offset:1024
  s_add_u32 s18, s16, 75776
  s_addc_u32 s19, s17, 0
  global_load_dwordx4 v[176:179], v113, s[18:19]
  global_load_dwordx4 v[180:183], v113, s[18:19] offset:1024
  s_add_u32 s18, s16, 77824
  s_addc_u32 s19, s17, 0
  global_load_dwordx4 v[184:187], v113, s[18:19]
  global_load_dwordx4 v[188:191], v113, s[18:19] offset:1024
  s_add_u32 s18, s16, 83968
  s_addc_u32 s19, s17, 0
  global_load_dwordx4 v[192:195], v113, s[18:19]
  global_load_dwordx4 v[196:199], v113, s[18:19] offset:1024
  s_add_u32 s18, s16, 94208
  s_addc_u32 s19, s17, 0
  global_load_dwordx4 v[200:203], v113, s[18:19]
  global_load_dwordx4 v[204:207], v113, s[18:19] offset:1024
  s_add_u32 s18, s16, 96256
  s_addc_u32 s19, s17, 0
  global_load_dwordx4 v[208:211], v113, s[18:19]
  global_load_dwordx4 v[212:215], v113, s[18:19] offset:1024
  s_add_u32 s18, s16, 86016
  s_addc_u32 s19, s17, 0
  global_load_dwordx4 v[216:219], v113, s[18:19]
  global_load_dwordx4 v[220:223], v113, s[18:19] offset:1024
  s_add_u32 s18, s16, 88064
  s_addc_u32 s19, s17, 0
  global_load_dwordx4 v[224:227], v113, s[18:19]
  global_load_dwordx4 v[228:231], v113, s[18:19] offset:1024
  s_add_u32 s18, s16, 90112
  s_addc_u32 s19, s17, 0
  global_load_dwordx4 v[232:235], v113, s[18:19]
  global_load_dwordx4 v[236:239], v113, s[18:19] offset:1024
  s_add_u32 s18, s16, 92160
  s_addc_u32 s19, s17, 0
  global_load_dwordx4 v[240:243], v113, s[18:19]
  global_load_dwordx4 v[244:247], v113, s[18:19] offset:1024
  s_add_u32 s18, s16, 98304
  s_addc_u32 s19, s17, 0
  global_load_dwordx4 v[248:251], v113, s[18:19]
  global_load_dwordx4 v[252:255], v113, s[18:19] offset:1024
  s_branch L_wl_j_123
L_wl_n_126:
  s_add_u32 s18, s16, 12288
  s_addc_u32 s19, s17, 0
  global_load_dwordx4 a[0:3], v113, s[18:19]
  global_load_dwordx4 a[4:7], v113, s[18:19] offset:1024
  s_add_u32 s18, s16, 10240
  s_addc_u32 s19, s17, 0
  global_load_dwordx4 a[8:11], v113, s[18:19]
  global_load_dwordx4 a[12:15], v113, s[18:19] offset:1024
  s_add_u32 s18, s16, 0
  s_addc_u32 s19, s17, 0
  global_load_dwordx4 a[16:19], v113, s[18:19]
  global_load_dwordx4 a[20:23], v113, s[18:19] offset:1024
  s_add_u32 s18, s16, 2048
  s_addc_u32 s19, s17, 0
  global_load_dwordx4 a[24:27], v113, s[18:19]
  global_load_dwordx4 a[28:31], v113, s[18:19] offset:1024
  s_add_u32 s18, s16, 4096
  s_addc_u32 s19, s17, 0
  global_load_dwordx4 a[32:35], v113, s[18:19]
  global_load_dwordx4 a[36:39], v113, s[18:19] offset:1024
  s_add_u32 s18, s16, 6144
  s_addc_u32 s19, s17, 0
  global_load_dwordx4 a[40:43], v113, s[18:19]
  global_load_dwordx4 a[44:47], v113, s[18:19] offset:1024
  s_add_u32 s18, s16, 8192
  s_addc_u32 s19, s17, 0
  global_load_dwordx4 a[48:51], v113, s[18:19]
  global_load_dwordx4 a[52:55], v113, s[18:19] offset:1024
  s_add_u32 s18, s16, 26624
  s_addc_u32 s19, s17, 0
  global_load_dwordx4 a[56:59], v113, s[18:19]
  global_load_dwordx4 a[60:63], v113, s[18:19] offset:1024
  s_add_u32 s18, s16, 24576
  s_addc_u32 s19, s17, 0
  global_load_dwordx4 a[64:67], v113, s[18:19]
  global_load_dwordx4 a[68:71], v113, s[18:19] offset:1024
  s_add_u32 s18, s16, 14336
  s_addc_u32 s19, s17, 0
  global_load_dwordx4 a[72:75], v113, s[18:19]
  global_load_dwordx4 a[76:79], v113, s[18:19] offset:1024
  s_add_u32 s18, s16, 16384
  s_addc_u32 s19, s17, 0
  global_load_dwordx4 a[80:83], v113, s[18:19]
  global_load_dwordx4 a[84:87], v113, s[18:19] offset:1024
  s_add_u32 s18, s16, 18432
  s_addc_u32 s19, s17, 0
  global_load_dwordx4 a[88:91], v113, s[18:19]
  global_load_dwordx4 a[92:95], v113, s[18:19] offset:1024
  s_add_u32 s18, s16, 20480
  s_addc_u32 s19, s17, 0
  global_load_dwordx4 a[96:99], v113, s[18:19]
  global_load_dwordx4 a[100:103], v113, s[18:19] offset:1024
  s_add_u32 s18, s16, 22528
  s_addc_u32 s19, s17, 0
  global_load_dwordx4 a[104:107], v113, s[18:19]
  global_load_dwordx4 a[108:111], v113, s[18:19] offset:1024
  s_add_u32 s18, s16, 40960
  s_addc_u32 s19, s17, 0
  global_load_dwordx4 a[112:115], v113, s[18:19]
  global_load_dwordx4 a[116:119], v113, s[18:19] offset:1024
  s_add_u32 s18, s16, 38912
  s_addc_u32 s19, s17, 0
  global_load_dwordx4 a[120:123], v113, s[18:19]
  global_load_dwordx4 a[124:127], v113, s[18:19] offset:1024
  s_add_u32 s18, s16, 28672
  s_addc_u32 s19, s17, 0
  global_load_dwordx4 a[128:131], v113, s[18:19]
  global_load_dwordx4 a[132:135], v113, s[18:19] offset:1024
  s_add_u32 s18, s16, 30720
  s_addc_u32 s19, s17, 0
  global_load_dwordx4 a[136:139], v113, s[18:19]
  global_load_dwordx4 a[140:143], v113, s[18:19] offset:1024
  s_add_u32 s18, s16, 32768
  s_addc_u32 s19, s17, 0
  global_load_dwordx4 a[144:147], v113, s[18:19]
  global_load_dwordx4 a[148:151], v113, s[18:19] offset:1024
  s_add_u32 s18, s16, 34816
  s_addc_u32 s19, s17, 0
  global_load_dwordx4 a[152:155], v113, s[18:19]
  global_load_dwordx4 a[156:159], v113, s[18:19] offset:1024
  s_add_u32 s18, s16, 36864
  s_addc_u32 s19, s17, 0
  global_load_dwordx4 a[160:163], v113, s[18:19]
  global_load_dwordx4 a[164:167], v113, s[18:19] offset:1024
  s_add_u32 s18, s16, 55296
  s_addc_u32 s19, s17, 0
  global_load_dwordx4 a[168:171], v113, s[18:19]
  global_load_dwordx4 a[172:175], v113, s[18:19] offset:1024
  s_add_u32 s18, s16, 53248
  s_addc_u32 s19, s17, 0
  global_load_dwordx4 a[176:179], v113, s[18:19]
  global_load_dwordx4 a[180:183], v113, s[18:19] offset:1024
  s_add_u32 s18, s16, 43008
  s_addc_u32 s19, s17, 0
  global_load_dwordx4 a[184:187], v113, s[18:19]
  global_load_dwordx4 a[188:191], v113, s[18:19] offset:1024
  s_add_u32 s18, s16, 45056
  s_addc_u32 s19, s17, 0
  global_load_dwordx4 a[192:195], v113, s[18:19]
  global_load_dwordx4 a[196:199], v113, s[18:19] offset:1024
  s_add_u32 s18, s16, 47104
  s_addc_u32 s19, s17, 0
  global_load_dwordx4 a[200:203], v113, s[18:19]
  global_load_dwordx4 a[204:207], v113, s[18:19] offset:1024
  s_add_u32 s18, s16, 49152
  s_addc_u32 s19, s17, 0
  global_load_dwordx4 a[208:211], v113, s[18:19]
  global_load_dwordx4 a[212:215], v113, s[18:19] offset:1024
  s_add_u32 s18, s16, 51200
  s_addc_u32 s19, s17, 0
  global_load_dwordx4 a[216:219], v113, s[18:19]
  global_load_dwordx4 a[220:223], v113, s[18:19] offset:1024
  s_add_u32 s18, s16, 69632
  s_addc_u32 s19, s17, 0
  global_load_dwordx4 a[224:227], v113, s[18:19]
  global_load_dwordx4 a[228:231], v113, s[18:19] offset:1024
  s_add_u32 s18, s16, 67584
  s_addc_u32 s19, s17, 0
  global_load_dwordx4 a[232:235], v113, s[18:19]
  global_load_dwordx4 a[236:239], v113, s[18:19] offset:1024
  s_add_u32 s18, s16, 57344
  s_addc_u32 s19, s17, 0
  global_load_dwordx4 a[240:243], v113, s[18:19]
  global_load_dwordx4 a[244:247], v113, s[18:19] offset:1024
  s_add_u32 s18, s16, 59392
  s_addc_u32 s19, s17, 0
  global_load_dwordx4 a[248:251], v113, s[18:19]
  global_load_dwordx4 a[252:255], v113, s[18:19] offset:1024
  s_add_u32 s18, s16, 61440
  s_addc_u32 s19, s17, 0
  global_load_dwordx4 v[120:123], v113, s[18:19]
  global_load_dwordx4 v[124:127], v113, s[18:19] offset:1024
  s_add_u32 s18, s16, 63488
  s_addc_u32 s19, s17, 0
  global_load_dwordx4 v[128:131], v113, s[18:19]
  global_load_dwordx4 v[132:135], v113, s[18:19] offset:1024
  s_add_u32 s18, s16, 65536
  s_addc_u32 s19, s17, 0
  global_load_dwordx4 v[136:139], v113, s[18:19]
  global_load_dwordx4 v[140:143], v113, s[18:19] offset:1024
  s_add_u32 s18, s16, 83968
  s_addc_u32 s19, s17, 0
  global_load_dwordx4 v[144:147], v113, s[18:19]
  global_load_dwordx4 v[148:151], v113, s[18:19] offset:1024
  s_add_u32 s18, s16, 81920
  s_addc_u32 s19, s17, 0
  global_load_dwordx4 v[152:155], v113, s[18:19]
  global_load_dwordx4 v[156:159], v113, s[18:19] offset:1024
  s_add_u32 s18, s16, 71680
  s_addc_u32 s19, s17, 0
  global_load_dwordx4 v[160:163], v113, s[18:19]
  global_load_dwordx4 v[164:167], v113, s[18:19] offset:1024
  s_add_u32 s18, s16, 73728
  s_addc_u32 s19, s17, 0
  global_load_dwordx4 v[168:171], v113, s[18:19]
  global_load_dwordx4 v[172:175], v113, s[18:19] offset:1024
  s_add_u32 s18, s16, 75776
  s_addc_u32 s19, s17, 0
  global_load_dwordx4 v[176:179], v113, s[18:19]
  global_load_dwordx4 v[180:183], v113, s[18:19] offset:1024
  s_add_u32 s18, s16, 77824
  s_addc_u32 s19, s17, 0
  global_load_dwordx4 v[184:187], v113, s[18:19]
  global_load_dwordx4 v[188:191], v113, s[18:19] offset:1024
  s_add_u32 s18, s16, 79872
  s_addc_u32 s19, s17, 0
  global_load_dwordx4 v[192:195], v113, s[18:19]
  global_load_dwordx4 v[196:199], v113, s[18:19] offset:1024
  s_add_u32 s18, s16, 98304
  s_addc_u32 s19, s17, 0
  global_load_dwordx4 v[200:203], v113, s[18:19]
  global_load_dwordx4 v[204:207], v113, s[18:19] offset:1024
  s_add_u32 s18, s16, 96256
  s_addc_u32 s19, s17, 0
  global_load_dwordx4 v[208:211], v113, s[18:19]
  global_load_dwordx4 v[212:215], v113, s[18:19] offset:1024
  s_add_u32 s18, s16, 86016
  s_addc_u32 s19, s17, 0
  global_load_dwordx4 v[216:219], v113, s[18:19]
  global_load_dwordx4 v[220:223], v113, s[18:19] offset:1024
  s_add_u32 s18, s16, 88064
  s_addc_u32 s19, s17, 0
  global_load_dwordx4 v[224:227], v113, s[18:19]
  global_load_dwordx4 v[228:231], v113, s[18:19] offset:1024
  s_add_u32 s18, s16, 90112
  s_addc_u32 s19, s17, 0
  global_load_dwordx4 v[232:235], v113, s[18:19]
  global_load_dwordx4 v[236:239], v113, s[18:19] offset:1024
  s_add_u32 s18, s16, 92160
  s_addc_u32 s19, s17, 0
  global_load_dwordx4 v[240:243], v113, s[18:19]
  global_load_dwordx4 v[244:247], v113, s[18:19] offset:1024
  s_add_u32 s18, s16, 94208
  s_addc_u32 s19, s17, 0
  global_load_dwordx4 v[248:251], v113, s[18:19]
  global_load_dwordx4 v[252:255], v113, s[18:19] offset:1024
L_wl_j_123:
  v_and_b32 v78, 15, v0
  v_bfe_u32 v79, v0, 4, 2
  s_mul_i32 s14, s8, 5120
  s_add_u32 s14, s14, 8192
  v_mul_u32_u24 v116, 40, v78
  v_lshl_add_u32 v116, v79, 3, v116
  v_add_u32 v116, s14, v116
  v_bfe_u32 v88, v0, 2, 1
  v_bfe_u32 v117, v0, 3, 1
  v_lshl_add_u32 v88, v117, 2, v88
  v_lshl_add_u32 v88, v79, 3, v88
  v_mul_u32_u24 v88, 40, v88
  v_and_b32 v117, 3, v0
  v_lshl_add_u32 v117, v117, 3, v88
  v_add_u32 v117, s14, v117
  s_mul_i32 s14, s8, 112
  v_lshl_add_u32 v88, v79, 3, s14
  v_lshrrev_b32 v118, 6, v88
  v_lshlrev_b32 v118, 10, v118
  v_bfe_u32 v119, v88, 4, 2
  v_lshl_add_u32 v118, v119, 8, v118
  v_bfe_u32 v119, v88, 3, 1
  v_lshl_add_u32 v118, v119, 3, v118
  v_and_b32 v119, 7, v0
  v_lshl_add_u32 v118, v119, 4, v118
  s_mul_i32 s14, s8, 1664
  s_add_u32 s14, s14, 28672
  v_mul_u32_u24 v119, 288, v79
  v_lshl_add_u32 v119, v78, 4, v119
  v_add_u32 v119, s14, v119
  v_lshlrev_b32 v1, 7, v79
  v_lshl_add_u32 v1, v78, 3, v1
  v_add_u32 v1, s14, v1
  v_add_u32 v1, 1152, v1
  v_and_b32 v88, 1, v79
  v_lshlrev_b32 v88, 2, v88
  v_sub_u32 v88, v78, v88
  v_and_b32 v60, 1, v88
  v_lshlrev_b32 v60, 4, v60
  v_mov_b32 v61, 0x3f80
  v_lshlrev_b32 v62, v60, v61
  v_cmp_gt_u32 vcc, 4, v88
  v_cmp_gt_u32 s[16:17], 8, v78
  s_nop 1
  s_and_b64 vcc, vcc, s[16:17]
  v_cndmask_b32 v62, 0, v62, vcc
  v_bfe_u32 v88, v88, 1, 1
  v_cmp_eq_u32 vcc, 0, v88
  s_nop 1
  v_cndmask_b32 v60, 0, v62, vcc
  v_cndmask_b32 v61, v62, 0, vcc
  v_lshrrev_b32 v62, 1, v113
  s_mul_i32 s14, s8, 112
  s_add_u32 s14, s14, 96
  v_lshl_add_u32 v88, v79, 2, s14
  v_lshrrev_b32 v63, 6, v88
  v_lshlrev_b32 v63, 10, v63
  v_bfe_u32 v89, v88, 4, 2
  v_lshl_add_u32 v63, v89, 8, v63
  v_bfe_u32 v89, v88, 2, 2
  v_lshl_add_u32 v63, v89, 2, v63
  v_and_b32 v89, 7, v0
  v_lshl_add_u32 v63, v89, 4, v63
  s_lshl_b32 s14, s8, 10
  s_add_u32 s66, s4, 44302336
  s_addc_u32 s67, s5, 0
  s_add_u32 s66, s66, s14
  s_addc_u32 s67, s67, 0
  s_and_b32 s14, s8, 1
  s_lshl_b32 s14, s14, 2
  v_add_u32 v78, s14, v79
  v_and_b32 v79, 15, v0
  v_lshrrev_b32 v88, 2, v79
  v_mul_u32_u24 v2, 288, v88
  v_lshl_add_u32 v2, v78, 4, v2
  v_and_b32 v88, 1, v79
  v_lshl_add_u32 v2, v88, 7, v2
  v_bfe_u32 v88, v79, 1, 1
  v_lshl_add_u32 v2, v88, 3, v2
  v_add_u32 v2, 28672, v2
  v_lshrrev_b32 v88, 1, v79
  v_lshlrev_b32 v3, 7, v88
  v_lshl_add_u32 v3, v78, 3, v3
  v_and_b32 v88, 1, v79
  v_lshl_add_u32 v3, v88, 6, v3
  v_add_u32 v3, 29824, v3
  v_mov_b32 v88, 36864
  v_cmp_gt_u32 vcc, 4, v79
  s_nop 1
  v_cndmask_b32 v3, v88, v3, vcc
  v_lshrrev_b32 v88, 3, v79
  v_lshlrev_b32 v77, 8, v88
  v_and_b32 v88, 1, v79
  v_lshl_add_u32 v77, v88, 7, v77
  v_lshl_add_u32 v77, v78, 4, v77
  v_bfe_u32 v88, v79, 1, 2
  v_lshl_add_u32 v77, v88, 2, v77
  v_lshlrev_b32 v76, 2, v79
  v_lshl_add_u32 v76, v78, 4, v76
  v_cmp_gt_u32 s[62:63], 4, v79
  v_lshlrev_b32 v78, 4, v0
  v_add_u32 v78, 7168, v78
  v_mov_b32 v80, 0
  v_mov_b32 v81, 0
  v_mov_b32 v82, 0
  v_mov_b32 v83, 0
  ds_write_b128 v78, v[80:83] offset:0
  ds_write_b128 v78, v[80:83] offset:4096
  ds_write_b128 v78, v[80:83] offset:8192
  ds_write_b128 v78, v[80:83] offset:12288
  ds_write_b128 v78, v[80:83] offset:16384
  ds_write_b128 v78, v[80:83] offset:20480
  v_mov_b32 v84, 0xf149f2ca
  v_mov_b32 v85, v84
  v_mov_b32 v78, 36864
  ds_write_b64 v78, v[84:85] offset:0
  ds_write_b64 v78, v[84:85] offset:1664
  ds_write_b64 v78, v[84:85] offset:3328
  ds_write_b64 v78, v[84:85] offset:4992
  s_mov_b32 s10, 0
  s_add_u32 s12, s4, 48234496
  s_addc_u32 s13, s5, 0
  s_lshl_b32 s14, s8, 13
  s_add_u32 s14, s14, 4096
  s_add_u32 s26, s4, 42205184
  s_addc_u32 s27, s5, 0
  s_add_u32 s26, s26, s14
  s_addc_u32 s27, s27, 0
  s_lshr_b32 s14, s9, 1
  s_lshl_b32 s14, s14, 10
  s_and_b32 s15, s9, 1
  s_lshl_b32 s15, s15, 9
  s_add_u32 s14, s14, s15
  s_add_u32 s22, s4, 49152000
  s_addc_u32 s23, s5, 0
  s_add_u32 s22, s22, s14
  s_addc_u32 s23, s23, 0
  s_lshl_b32 s14, s9, 7
  s_add_u32 s24, s4, 49676288
  s_addc_u32 s25, s5, 0
  s_add_u32 s24, s24, s14
  s_addc_u32 s25, s25, 0
  v_mov_b64 v[80:81], 0
  v_mov_b64 v[82:83], 0
  v_mov_b64 v[84:85], 0
  v_mov_b64 v[86:87], 0
  v_mov_b64 v[88:89], 0
  v_mov_b64 v[90:91], 0
  v_and_b32 v94, 31, v0
  v_lshlrev_b32 v94, 7, v94
  v_lshrrev_b32 v95, 5, v0
  v_lshl_add_u32 v95, v95, 2, v94
  v_add_u32 v95, 61513728, v95
  global_load_dword v95, v95, s[4:5] sc1
  v_and_b32 v92, 7, v0
  v_lshlrev_b32 v92, 5, v92
  global_load_dword v92, v92, s[6:7] sc1
  s_waitcnt vmcnt(0) lgkmcnt(0)
  v_cmp_ne_u32 vcc, 32, v92
  s_cbranch_vccnz L_cfbad_129
  v_cmp_ne_u32 vcc, s88, v95
  s_cbranch_vccnz L_cfbad_129
  s_branch L_cfok_128
L_cfbad_129:
  v_mov_b32 v92, 135168
  ds_write_b32 v92, v92
L_cfok_128:
  s_waitcnt lgkmcnt(0)
  s_barrier
  v_mov_b32 v92, 135168
  ds_read_b32 v92, v92
  s_waitcnt lgkmcnt(0)
  s_nop 0
  v_readfirstlane_b32 s14, v92
  s_nop 3
  s_cmp_lg_u32 s14, 0
  s_cbranch_scc1 L_recheck
  s_barrier
L_A_loop_130:
  s_mov_b32 s11, 0
L_A_poll_131:
  global_load_dwordx4 v[4:7], v114, s[12:13] sc1
  global_load_dwordx4 v[8:11], v115, s[12:13] sc1
  s_waitcnt vmcnt(0)
  v_max3_u32 v100, v4, v5, v6
  v_max3_u32 v100, v100, v7, v8
  v_max3_u32 v100, v100, v9, v10
  v_max_u32 v100, v100, v11
  v_cmp_eq_u32 vcc, -1, v100
  s_cbranch_vccz L_A_got_132
  s_add_u32 s11, s11, 1
  s_cmp_gt_u32 s11, 262144
  s_cbranch_scc1 L_abort
  s_branch L_A_poll_131
L_A_got_132:
  ds_write_b128 v114, v[4:7]
  ds_write_b128 v115, v[8:11]
  v_smfmac_f32_16x16x64_bf16 v[80:83], v[4:7], a[0:7], v112
  v_smfmac_f32_16x16x64_bf16 v[80:83], v[8:11], a[8:15], v112
  v_smfmac_f32_16x16x64_bf16 v[84:87], v[4:7], a[56:63], v112
  v_smfmac_f32_16x16x64_bf16 v[84:87], v[8:11], a[64:71], v112
  v_smfmac_f32_16x16x64_bf16 v[88:91], v[4:7], a[112:119], v112
  v_smfmac_f32_16x16x64_bf16 v[88:91], v[8:11], a[120:127], v112
  s_waitcnt lgkmcnt(0)
  s_barrier
  s_cmp_lg_u32 s8, 0
  s_cbranch_scc1 L_mar_n_134
  ds_read_b128 v[12:15], v113 offset:2048
  ds_read_b128 v[16:19], v113 offset:3072
  ds_read_b128 v[20:23], v113 offset:4096
  ds_read_b128 v[24:27], v113 offset:5120
  ds_read_b128 v[28:31], v113 offset:6144
  s_branch L_mar_j_133
L_mar_n_134:
  s_cmp_lg_u32 s8, 1
  s_cbranch_scc1 L_mar_n_135
  ds_read_b128 v[12:15], v113 offset:0
  ds_read_b128 v[16:19], v113 offset:1024
  ds_read_b128 v[20:23], v113 offset:4096
  ds_read_b128 v[24:27], v113 offset:5120
  ds_read_b128 v[28:31], v113 offset:6144
  s_branch L_mar_j_133
L_mar_n_135:
  s_cmp_lg_u32 s8, 2
  s_cbranch_scc1 L_mar_n_136
  ds_read_b128 v[12:15], v113 offset:0
  ds_read_b128 v[16:19], v113 offset:1024
  ds_read_b128 v[20:23], v113 offset:2048
  ds_read_b128 v[24:27], v113 offset:3072
  ds_read_b128 v[28:31], v113 offset:6144
  s_branch L_mar_j_133
L_mar_n_136:
  ds_read_b128 v[12:15], v113 offset:0
  ds_read_b128 v[16:19], v113 offset:1024
  ds_read_b128 v[20:23], v113 offset:2048
  ds_read_b128 v[24:27], v113 offset:3072
  ds_read_b128 v[28:31], v113 offset:4096
L_mar_j_133:
  s_waitcnt lgkmcnt(4)
  v_smfmac_f32_16x16x64_bf16 v[80:83], v[12:15], a[16:23], v112
  s_waitcnt lgkmcnt(3)
  v_smfmac_f32_16x16x64_bf16 v[80:83], v[16:19], a[24:31], v112
  global_load_dwordx4 v[32:35], v113, s[26:27] offset:-4096
  s_waitcnt lgkmcnt(2)
  v_smfmac_f32_16x16x64_bf16 v[80:83], v[20:23], a[32:39], v112
  s_waitcnt lgkmcnt(1)
  v_smfmac_f32_16x16x64_bf16 v[80:83], v[24:27], a[40:47], v112
  s_waitcnt lgkmcnt(0)
  v_smfmac_f32_16x16x64_bf16 v[80:83], v[28:31], a[48:55], v112
  v_smfmac_f32_16x16x64_bf16 v[84:87], v[12:15], a[72:79], v112
  global_load_dwordx4 v[36:39], v113, s[26:27] offset:-3072
  v_smfmac_f32_16x16x64_bf16 v[84:87], v[16:19], a[80:87], v112
  v_cvt_pk_bf16_f32 v72, v80, v81
  v_smfmac_f32_16x16x64_bf16 v[84:87], v[20:23], a[88:95], v112
  v_cvt_pk_bf16_f32 v73, v82, v83
  v_smfmac_f32_16x16x64_bf16 v[84:87], v[24:27], a[96:103], v112
  ds_write_b64 v116, v[72:73] offset:0
  v_smfmac_f32_16x16x64_bf16 v[84:87], v[28:31], a[104:111], v112
  v_mov_b64 v[80:81], 0
  global_load_dwordx4 v[40:43], v113, s[26:27] offset:-2048
  v_smfmac_f32_16x16x64_bf16 v[88:91], v[12:15], a[128:135], v112
  v_mov_b64 v[82:83], 0
  v_smfmac_f32_16x16x64_bf16 v[88:91], v[16:19], a[136:143], v112
  v_cvt_pk_bf16_f32 v74, v84, v85
  v_smfmac_f32_16x16x64_bf16 v[88:91], v[20:23], a[144:151], v112
  v_cvt_pk_bf16_f32 v75, v86, v87
  v_smfmac_f32_16x16x64_bf16 v[88:91], v[24:27], a[152:159], v112
  ds_write_b64 v116, v[74:75] offset:640
  global_load_dwordx4 v[44:47], v113, s[26:27] offset:-1024
  v_smfmac_f32_16x16x64_bf16 v[88:91], v[28:31], a[160:167], v112
  v_mov_b64 v[84:85], 0
  v_smfmac_f32_16x16x64_bf16 v[80:83], v[4:7], a[168:175], v112
  v_mov_b64 v[86:87], 0
  v_smfmac_f32_16x16x64_bf16 v[80:83], v[8:11], a[176:183], v112
  v_cvt_pk_bf16_f32 v72, v88, v89
  ds_read_b64_tr_b16 v[92:93], v117 offset:0
  ds_read_b64_tr_b16 v[94:95], v117 offset:80
  v_smfmac_f32_16x16x64_bf16 v[80:83], v[12:15], a[184:191], v112
  v_cvt_pk_bf16_f32 v73, v90, v91
  ds_read_b64 v[64:65], v118 offset:0
  ds_read_b64 v[66:67], v118 offset:128
  global_load_dwordx4 v[48:51], v113, s[26:27] offset:0
  v_smfmac_f32_16x16x64_bf16 v[80:83], v[16:19], a[192:199], v112
  ds_write_b64 v116, v[72:73] offset:1280
  v_smfmac_f32_16x16x64_bf16 v[80:83], v[20:23], a[200:207], v112
  v_mov_b64 v[88:89], 0
  v_smfmac_f32_16x16x64_bf16 v[80:83], v[24:27], a[208:215], v112
  v_mov_b64 v[90:91], 0
  v_smfmac_f32_16x16x64_bf16 v[80:83], v[28:31], a[216:223], v112
  global_load_dwordx4 v[52:55], v113, s[26:27] offset:1024
  v_smfmac_f32_16x16x64_bf16 v[84:87], v[4:7], a[224:231], v112
  v_smfmac_f32_16x16x64_bf16 v[84:87], v[8:11], a[232:239], v112
  v_cvt_pk_bf16_f32 v74, v80, v81
  v_smfmac_f32_16x16x64_bf16 v[84:87], v[12:15], a[240:247], v112
  v_cvt_pk_bf16_f32 v75, v82, v83
  v_smfmac_f32_16x16x64_bf16 v[84:87], v[16:19], a[248:255], v112
  ds_write_b64 v116, v[74:75] offset:1920
  s_waitcnt lgkmcnt(2)
  v_mfma_f32_16x16x32_bf16 v[100:103], v[64:67], v[92:95], 0
  global_load_dwordx2 v[56:57], v62, s[66:67] offset:0
  v_smfmac_f32_16x16x64_bf16 v[84:87], v[20:23], v[120:127], v112
  v_mov_b64 v[80:81], 0
  s_waitcnt vmcnt(5)
  v_mfma_f32_16x16x32_bf16 v[104:107], v[32:35], v[92:95], 0
  v_smfmac_f32_16x16x64_bf16 v[84:87], v[24:27], v[128:135], v112
  v_mov_b64 v[82:83], 0
  v_mfma_f32_16x16x32_bf16 v[108:111], v[36:39], v[92:95], 0
  v_smfmac_f32_16x16x64_bf16 v[84:87], v[28:31], v[136:143], v112
  ds_read_b64_tr_b16 v[96:97], v117 offset:1280
  ds_read_b64_tr_b16 v[98:99], v117 offset:1360
  v_smfmac_f32_16x16x64_bf16 v[88:91], v[4:7], v[144:151], v112
  ds_read_b64 v[68:69], v118 offset:512
  ds_read_b64 v[70:71], v118 offset:640
  global_load_dwordx2 v[58:59], v62, s[66:67] offset:512
  v_smfmac_f32_16x16x64_bf16 v[88:91], v[8:11], v[152:159], v112
  v_cvt_pk_bf16_f32 v72, v84, v85
  v_smfmac_f32_16x16x64_bf16 v[88:91], v[12:15], v[160:167], v112
  v_cvt_pk_bf16_f32 v73, v86, v87
  v_smfmac_f32_16x16x64_bf16 v[88:91], v[16:19], v[168:175], v112
  ds_write_b64 v116, v[72:73] offset:2560
  v_smfmac_f32_16x16x64_bf16 v[88:91], v[20:23], v[176:183], v112
  v_smfmac_f32_16x16x64_bf16 v[88:91], v[24:27], v[184:191], v112
  v_smfmac_f32_16x16x64_bf16 v[88:91], v[28:31], v[192:199], v112
  v_smfmac_f32_16x16x64_bf16 v[80:83], v[4:7], v[200:207], v112
  ds_read_b64 v[64:65], v118 offset:1024
  ds_read_b64 v[66:67], v118 offset:1152
  v_smfmac_f32_16x16x64_bf16 v[80:83], v[8:11], v[208:215], v112
  v_cvt_pk_bf16_f32 v74, v88, v89
  s_waitcnt lgkmcnt(3)
  v_mfma_f32_16x16x32_bf16 v[100:103], v[68:71], v[96:99], v[100:103]
  v_smfmac_f32_16x16x64_bf16 v[80:83], v[12:15], v[216:223], v112
  v_cvt_pk_bf16_f32 v75, v90, v91
  s_waitcnt vmcnt(4)
  v_mfma_f32_16x16x32_bf16 v[104:107], v[40:43], v[96:99], v[104:107]
  v_smfmac_f32_16x16x64_bf16 v[80:83], v[16:19], v[224:231], v112
  ds_write_b64 v116, v[74:75] offset:3200
  v_mfma_f32_16x16x32_bf16 v[108:111], v[44:47], v[96:99], v[108:111]
  v_smfmac_f32_16x16x64_bf16 v[80:83], v[20:23], v[232:239], v112
  ds_read_b64_tr_b16 v[92:93], v117 offset:2560
  ds_read_b64_tr_b16 v[94:95], v117 offset:2640
  v_smfmac_f32_16x16x64_bf16 v[80:83], v[24:27], v[240:247], v112
  ds_read2_b32 v[68:69], v63 offset0:0 offset1:32
  v_smfmac_f32_16x16x64_bf16 v[80:83], v[28:31], v[248:255], v112
  s_waitcnt lgkmcnt(1)
  v_mfma_f32_16x16x32_bf16 v[100:103], v[64:67], v[92:95], v[100:103]
  s_waitcnt vmcnt(2)
  v_mfma_f32_16x16x32_bf16 v[104:107], v[48:51], v[92:95], v[104:107]
  v_cvt_pk_bf16_f32 v72, v80, v81
  v_cvt_pk_bf16_f32 v73, v82, v83
  s_nop 1
  v_mfma_f32_16x16x16_bf16 v[96:99], v[72:73], v[60:61], 0
  v_mfma_f32_16x16x32_bf16 v[108:111], v[52:55], v[92:95], v[108:111]
  s_waitcnt lgkmcnt(0)
  s_waitcnt vmcnt(0)
  s_nop 3
  v_cvt_pk_bf16_f32 v74, v96, v97
  v_cvt_pk_bf16_f32 v75, v98, v99
  s_nop 1
  v_mfma_f32_16x16x16_bf16 v[104:107], v[56:57], v[74:75], v[104:107]
  v_mfma_f32_16x16x16_bf16 v[108:111], v[58:59], v[74:75], v[108:111]
  v_mfma_f32_16x16x16_bf16 v[100:103], v[68:69], v[74:75], v[100:103]
  s_nop 1
  v_add_f32_dpp v84, v104, v104 row_ror:8 row_mask:0xf bank_mask:0x3
  v_add_f32_dpp v84, v106, v106 row_ror:8 row_mask:0xf bank_mask:0xc
  v_add_f32_dpp v85, v105, v105 row_ror:8 row_mask:0xf bank_mask:0x3
  v_add_f32_dpp v85, v107, v107 row_ror:8 row_mask:0xf bank_mask:0xc
  v_add_f32_dpp v86, v108, v108 row_ror:8 row_mask:0xf bank_mask:0x3
  v_add_f32_dpp v86, v110, v110 row_ror:8 row_mask:0xf bank_mask:0xc
  v_add_f32_dpp v87, v109, v109 row_ror:8 row_mask:0xf bank_mask:0x3
  v_add_f32_dpp v87, v111, v111 row_ror:8 row_mask:0xf bank_mask:0xc
  ds_write_b128 v119, v[84:87]
  v_add_f32_dpp v88, v100, v100 row_ror:8 row_mask:0xf bank_mask:0x3
  v_add_f32_dpp v88, v102, v102 row_ror:8 row_mask:0xf bank_mask:0xc
  v_add_f32_dpp v89, v101, v101 row_ror:8 row_mask:0xf bank_mask:0x3
  v_add_f32_dpp v89, v103, v103 row_ror:8 row_mask:0xf bank_mask:0xc
  ds_write_b64 v1, v[88:89]
  v_mov_b64 v[80:81], 0
  v_mov_b64 v[82:83], 0
  s_waitcnt lgkmcnt(0)
  s_barrier
  s_add_u32 s26, s26, 32768
  s_addc_u32 s27, s27, 0
  s_add_u32 s66, s66, 4096
  s_addc_u32 s67, s67, 0
  s_cmp_ge_u32 s8, 2
  s_cbranch_scc1 L_A_nosm_138
  ds_read_b64 v[84:85], v2 offset:0
  ds_read_b64 v[86:87], v3 offset:0
  ds_read_b64 v[88:89], v2 offset:1664
  ds_read_b64 v[90:91], v3 offset:1664
  ds_read_b64 v[92:93], v2 offset:3328
  ds_read_b64 v[94:95], v3 offset:3328
  ds_read_b64 v[96:97], v2 offset:4992
  ds_read_b64 v[98:99], v3 offset:4992
  s_waitcnt lgkmcnt(4)
  v_pk_add_f32 v[84:85], v[84:85], v[88:89]
  v_pk_add_f32 v[86:87], v[86:87], v[90:91]
  s_waitcnt lgkmcnt(0)
  v_pk_add_f32 v[92:93], v[92:93], v[96:97]
  v_pk_add_f32 v[94:95], v[94:95], v[98:99]
  v_pk_add_f32 v[84:85], v[84:85], v[92:93]
  v_pk_add_f32 v[86:87], v[86:87], v[94:95]
  v_max3_f32 v88, v84, v85, v86
  v_max_f32 v88, v88, v87
  s_nop 1
  v_max_f32_dpp v88, v88, v88 row_ror:8 row_mask:0xf bank_mask:0xf
  s_nop 1
  v_max_f32_dpp v88, v88, v88 row_ror:4 row_mask:0xf bank_mask:0xf
  s_nop 1
  v_max_f32_dpp v88, v88, v88 row_ror:2 row_mask:0xf bank_mask:0xf
  s_nop 1
  v_max_f32_dpp v88, v88, v88 row_ror:1 row_mask:0xf bank_mask:0xf
  v_pk_add_f32 v[84:85], v[84:85], v[88:89] op_sel_hi:[1,0] neg_lo:[0,1] neg_hi:[0,1]
  v_pk_add_f32 v[86:87], v[86:87], v[88:89] op_sel_hi:[1,0] neg_lo:[0,1] neg_hi:[0,1]
  v_exp_f32 v84, v84
  v_exp_f32 v85, v85
  v_exp_f32 v86, v86
  v_exp_f32 v87, v87
  v_add_f32 v91, v84, v85
  v_add_f32 v90, v86, v87
  v_add_f32 v90, v90, v91
  s_nop 1
  v_add_f32_dpp v90, v90, v90 row_ror:8 row_mask:0xf bank_mask:0xf
  s_nop 1
  v_add_f32_dpp v90, v90, v90 row_ror:4 row_mask:0xf bank_mask:0xf
  s_nop 1
  v_add_f32_dpp v90, v90, v90 row_ror:2 row_mask:0xf bank_mask:0xf
  s_nop 1
  v_add_f32_dpp v90, v90, v90 row_ror:1 row_mask:0xf bank_mask:0xf
  v_rcp_f32 v90, v90
  s_nop 0
  v_pk_mul_f32 v[84:85], v[84:85], v[90:91] op_sel_hi:[1,0]
  v_pk_mul_f32 v[86:87], v[86:87], v[90:91] op_sel_hi:[1,0]
  v_cvt_pk_bf16_f32 v84, v84, v85
  v_cvt_pk_bf16_f32 v86, v86, v87
  global_store_dword v77, v84, s[22:23]
  s_mov_b64 exec, s[62:63]
  global_store_dword v76, v86, s[24:25]
  s_mov_b64 exec, -1
L_A_nosm_138:
  s_cmp_ge_u32 s8, 2
  s_cbranch_scc1 L_ps_139
  s_sleep 15
  s_branch L_ps_140
L_ps_139:
  s_sleep 21
L_ps_140:
  v_mov_b64 v[84:85], 0
  v_mov_b64 v[86:87], 0
  v_mov_b64 v[88:89], 0
  v_mov_b64 v[90:91], 0
  s_add_u32 s12, s12, 7168
  s_addc_u32 s13, s13, 0
  s_add_u32 s22, s22, 8192
  s_addc_u32 s23, s23, 0
  s_add_u32 s24, s24, 2048
  s_addc_u32 s25, s25, 0
  s_add_u32 s10, s10, 1
  s_cmp_lt_u32 s10, 63
  s_cbranch_scc1 L_A_loop_130
  s_branch L_pdone
L_roleB:
  v_and_b32 v4, 63, v0
  v_min_u32 v4, 15, v4
  v_and_b32 v5, 3, v4
  v_mul_u32_u24 v5, 7, v5
  s_sub_u32 s24, s9, 16
  s_lshr_b32 s24, s24, 1
  v_add_u32 v5, s24, v5
  v_lshrrev_b32 v4, 2, v4
  v_add_u32 v4, 4, v4
  v_lshl_add_u32 v4, v5, 3, v4
  v_and_b32 v5, 31, v4
  v_lshlrev_b32 v5, 7, v5
  v_lshrrev_b32 v6, 5, v4
  v_lshl_add_u32 v6, v6, 2, v5
  v_add_u32 v6, 61513728, v6
  s_mov_b32 s11, 0
L_wt_141:
  global_load_dword v7, v6, s[4:5] sc1
  s_waitcnt vmcnt(0)
  v_cmp_ne_u32 vcc, s88, v7
  s_cbranch_vccz L_wtg_142
  s_add_u32 s11, s11, 1
  s_cmp_gt_u32 s11, 262144
  s_cbranch_scc1 L_abort
  s_branch L_wt_141
L_wtg_142:
  s_sub_u32 s43, s9, 16
  v_and_b32 v140, 63, v0
  v_lshlrev_b32 v133, 4, v140
  s_lshl_b32 s14, s8, 10
  v_add_u32 v134, s14, v133
  s_add_u32 s14, s8, 4
  s_min_u32 s14, s14, 6
  s_lshl_b32 s14, s14, 10
  v_add_u32 v135, s14, v133
  v_and_b32 v140, 8, v0
  v_cmp_eq_u32 vcc, 0, v140
  v_mov_b32 v132, 0xeeeeeeee
  v_mov_b32 v140, 0x44444444
  s_nop 1
  v_cndmask_b32 v132, v132, v140, vcc
  s_mul_i32 s14, s8, 1605632
  s_mul_i32 s15, s43, 28672
  s_add_u32 s14, s14, s15
  s_add_u32 s18, s4, 6422528
  s_addc_u32 s19, s5, 0
  s_add_u32 s18, s18, s14
  s_addc_u32 s19, s19, 0
  s_add_u32 s16, s18, 1204224
  s_addc_u32 s17, s19, 0
  s_mul_i32 s14, s8, 28672
  s_add_u32 s14, s14, 16384
  v_add_u32 v143, s14, v133
  s_add_u32 s15, s14, 0
  s_mov_b32 m0, s15
  s_nop 0
  global_load_lds_dwordx4 v133, s[16:17] offset:0
  global_load_lds_dwordx4 v133, s[16:17] offset:1024
  global_load_lds_dwordx4 v133, s[16:17] offset:2048
  global_load_lds_dwordx4 v133, s[16:17] offset:3072
  s_add_u32 s16, s16, 4096
  s_addc_u32 s17, s17, 0
  s_add_u32 s15, s14, 4096
  s_mov_b32 m0, s15
  s_nop 0
  global_load_lds_dwordx4 v133, s[16:17] offset:0
  global_load_lds_dwordx4 v133, s[16:17] offset:1024
  global_load_lds_dwordx4 v133, s[16:17] offset:2048
  global_load_lds_dwordx4 v133, s[16:17] offset:3072
  s_add_u32 s16, s16, 4096
  s_addc_u32 s17, s17, 0
  s_add_u32 s15, s14, 8192
  s_mov_b32 m0, s15
  s_nop 0
  global_load_lds_dwordx4 v133, s[16:17] offset:0
  global_load_lds_dwordx4 v133, s[16:17] offset:1024
  global_load_lds_dwordx4 v133, s[16:17] offset:2048
  global_load_lds_dwordx4 v133, s[16:17] offset:3072
  s_add_u32 s16, s16, 4096
  s_addc_u32 s17, s17, 0
  s_add_u32 s15, s14, 12288
  s_mov_b32 m0, s15
  s_nop 0
  global_load_lds_dwordx4 v133, s[16:17] offset:0
  global_load_lds_dwordx4 v133, s[16:17] offset:1024
  global_load_lds_dwordx4 v133, s[16:17] offset:2048
  global_load_lds_dwordx4 v133, s[16:17] offset:3072
  s_add_u32 s16, s16, 4096
  s_addc_u32 s17, s17, 0
  s_add_u32 s15, s14, 16384
  s_mov_b32 m0, s15
  s_nop 0
  global_load_lds_dwordx4 v133, s[16:17] offset:0
  global_load_lds_dwordx4 v133, s[16:17] offset:1024
  global_load_lds_dwordx4 v133, s[16:17] offset:2048
  global_load_lds_dwordx4 v133, s[16:17] offset:3072
  s_add_u32 s16, s16, 4096
  s_addc_u32 s17, s17, 0
  s_add_u32 s15, s14, 20480
  s_mov_b32 m0, s15
  s_nop 0
  global_load_lds_dwordx4 v133, s[16:17] offset:0
  global_load_lds_dwordx4 v133, s[16:17] offset:1024
  global_load_lds_dwordx4 v133, s[16:17] offset:2048
  global_load_lds_dwordx4 v133, s[16:17] offset:3072
  s_add_u32 s16, s16, 4096
  s_addc_u32 s17, s17, 0
  s_add_u32 s15, s14, 24576
  s_mov_b32 m0, s15
  s_nop 0
  global_load_lds_dwordx4 v133, s[16:17] offset:0
  global_load_lds_dwordx4 v133, s[16:17] offset:1024
  global_load_lds_dwordx4 v133, s[16:17] offset:2048
  global_load_lds_dwordx4 v133, s[16:17] offset:3072
  s_add_u32 s16, s16, 4096
  s_addc_u32 s17, s17, 0
  s_add_u32 s16, s18, 0
  s_addc_u32 s17, s19, 0
  global_load_dwordx4 a[0:3], v133, s[16:17] offset:0
  global_load_dwordx4 a[4:7], v133, s[16:17] offset:1024
  global_load_dwordx4 a[8:11], v133, s[16:17] offset:2048
  global_load_dwordx4 a[12:15], v133, s[16:17] offset:3072
  s_add_u32 s16, s16, 4096
  s_addc_u32 s17, s17, 0
  global_load_dwordx4 a[16:19], v133, s[16:17] offset:0
  global_load_dwordx4 a[20:23], v133, s[16:17] offset:1024
  global_load_dwordx4 a[24:27], v133, s[16:17] offset:2048
  global_load_dwordx4 a[28:31], v133, s[16:17] offset:3072
  s_add_u32 s16, s16, 4096
  s_addc_u32 s17, s17, 0
  global_load_dwordx4 a[32:35], v133, s[16:17] offset:0
  global_load_dwordx4 a[36:39], v133, s[16:17] offset:1024
  global_load_dwordx4 a[40:43], v133, s[16:17] offset:2048
  global_load_dwordx4 a[44:47], v133, s[16:17] offset:3072
  s_add_u32 s16, s16, 4096
  s_addc_u32 s17, s17, 0
  global_load_dwordx4 a[48:51], v133, s[16:17] offset:0
  global_load_dwordx4 a[52:55], v133, s[16:17] offset:1024
  global_load_dwordx4 a[56:59], v133, s[16:17] offset:2048
  global_load_dwordx4 a[60:63], v133, s[16:17] offset:3072
  s_add_u32 s16, s16, 4096
  s_addc_u32 s17, s17, 0
  global_load_dwordx4 a[64:67], v133, s[16:17] offset:0
  global_load_dwordx4 a[68:71], v133, s[16:17] offset:1024
  global_load_dwordx4 a[72:75], v133, s[16:17] offset:2048
  global_load_dwordx4 a[76:79], v133, s[16:17] offset:3072
  s_add_u32 s16, s16, 4096
  s_addc_u32 s17, s17, 0
  global_load_dwordx4 a[80:83], v133, s[16:17] offset:0
  global_load_dwordx4 a[84:87], v133, s[16:17] offset:1024
  global_load_dwordx4 a[88:91], v133, s[16:17] offset:2048
  global_load_dwordx4 a[92:95], v133, s[16:17] offset:3072
  s_add_u32 s16, s16, 4096
  s_addc_u32 s17, s17, 0
  global_load_dwordx4 a[96:99], v133, s[16:17] offset:0
  global_load_dwordx4 a[100:103], v133, s[16:17] offset:1024
  global_load_dwordx4 a[104:107], v133, s[16:17] offset:2048
  global_load_dwordx4 a[108:111], v133, s[16:17] offset:3072
  s_add_u32 s16, s16, 4096
  s_addc_u32 s17, s17, 0
  s_add_u32 s16, s18, 401408
  s_addc_u32 s17, s19, 0
  global_load_dwordx4 a[112:115], v133, s[16:17] offset:0
  global_load_dwordx4 a[116:119], v133, s[16:17] offset:1024
  global_load_dwordx4 a[120:123], v133, s[16:17] offset:2048
  global_load_dwordx4 a[124:127], v133, s[16:17] offset:3072
  s_add_u32 s16, s16, 4096
  s_addc_u32 s17, s17, 0
  global_load_dwordx4 a[128:131], v133, s[16:17] offset:0
  global_load_dwordx4 a[132:135], v133, s[16:17] offset:1024
  global_load_dwordx4 a[136:139], v133, s[16:17] offset:2048
  global_load_dwordx4 a[140:143], v133, s[16:17] offset:3072
  s_add_u32 s16, s16, 4096
  s_addc_u32 s17, s17, 0
  global_load_dwordx4 a[144:147], v133, s[16:17] offset:0
  global_load_dwordx4 a[148:151], v133, s[16:17] offset:1024
  global_load_dwordx4 a[152:155], v133, s[16:17] offset:2048
  global_load_dwordx4 a[156:159], v133, s[16:17] offset:3072
  s_add_u32 s16, s16, 4096
  s_addc_u32 s17, s17, 0
  global_load_dwordx4 a[160:163], v133, s[16:17] offset:0
  global_load_dwordx4 a[164:167], v133, s[16:17] offset:1024
  global_load_dwordx4 a[168:171], v133, s[16:17] offset:2048
  global_load_dwordx4 a[172:175], v133, s[16:17] offset:3072
  s_add_u32 s16, s16, 4096
  s_addc_u32 s17, s17, 0
  global_load_dwordx4 a[176:179], v133, s[16:17] offset:0
  global_load_dwordx4 a[180:183], v133, s[16:17] offset:1024
  global_load_dwordx4 a[184:187], v133, s[16:17] offset:2048
  global_load_dwordx4 a[188:191], v133, s[16:17] offset:3072
  s_add_u32 s16, s16, 4096
  s_addc_u32 s17, s17, 0
  global_load_dwordx4 a[192:195], v133, s[16:17] offset:0
  global_load_dwordx4 a[196:199], v133, s[16:17] offset:1024
  global_load_dwordx4 a[200:203], v133, s[16:17] offset:2048
  global_load_dwordx4 a[204:207], v133, s[16:17] offset:3072
  s_add_u32 s16, s16, 4096
  s_addc_u32 s17, s17, 0
  global_load_dwordx4 a[208:211], v133, s[16:17] offset:0
  global_load_dwordx4 a[212:215], v133, s[16:17] offset:1024
  global_load_dwordx4 a[216:219], v133, s[16:17] offset:2048
  global_load_dwordx4 a[220:223], v133, s[16:17] offset:3072
  s_add_u32 s16, s16, 4096
  s_addc_u32 s17, s17, 0
  s_add_u32 s16, s18, 802816
  s_addc_u32 s17, s19, 0
  global_load_dwordx4 a[224:227], v133, s[16:17] offset:0
  global_load_dwordx4 a[228:231], v133, s[16:17] offset:1024
  global_load_dwordx4 a[232:235], v133, s[16:17] offset:2048
  global_load_dwordx4 a[236:239], v133, s[16:17] offset:3072
  s_add_u32 s16, s16, 4096
  s_addc_u32 s17, s17, 0
  global_load_dwordx4 a[240:243], v133, s[16:17] offset:0
  global_load_dwordx4 a[244:247], v133, s[16:17] offset:1024
  global_load_dwordx4 a[248:251], v133, s[16:17] offset:2048
  global_load_dwordx4 a[252:255], v133, s[16:17] offset:3072
  s_add_u32 s16, s16, 4096
  s_addc_u32 s17, s17, 0
  global_load_dwordx4 v[176:179], v133, s[16:17] offset:0
  global_load_dwordx4 v[180:183], v133, s[16:17] offset:1024
  global_load_dwordx4 v[184:187], v133, s[16:17] offset:2048
  global_load_dwordx4 v[188:191], v133, s[16:17] offset:3072
  s_add_u32 s16, s16, 4096
  s_addc_u32 s17, s17, 0
  global_load_dwordx4 v[192:195], v133, s[16:17] offset:0
  global_load_dwordx4 v[196:199], v133, s[16:17] offset:1024
  global_load_dwordx4 v[200:203], v133, s[16:17] offset:2048
  global_load_dwordx4 v[204:207], v133, s[16:17] offset:3072
  s_add_u32 s16, s16, 4096
  s_addc_u32 s17, s17, 0
  global_load_dwordx4 v[208:211], v133, s[16:17] offset:0
  global_load_dwordx4 v[212:215], v133, s[16:17] offset:1024
  global_load_dwordx4 v[216:219], v133, s[16:17] offset:2048
  global_load_dwordx4 v[220:223], v133, s[16:17] offset:3072
  s_add_u32 s16, s16, 4096
  s_addc_u32 s17, s17, 0
  global_load_dwordx4 v[224:227], v133, s[16:17] offset:0
  global_load_dwordx4 v[228:231], v133, s[16:17] offset:1024
  global_load_dwordx4 v[232:235], v133, s[16:17] offset:2048
  global_load_dwordx4 v[236:239], v133, s[16:17] offset:3072
  s_add_u32 s16, s16, 4096
  s_addc_u32 s17, s17, 0
  global_load_dwordx4 v[240:243], v133, s[16:17] offset:0
  global_load_dwordx4 v[244:247], v133, s[16:17] offset:1024
  global_load_dwordx4 v[248:251], v133, s[16:17] offset:2048
  global_load_dwordx4 v[252:255], v133, s[16:17] offset:3072
  s_add_u32 s16, s16, 4096
  s_addc_u32 s17, s17, 0
  v_and_b32 v140, 15, v0
  v_bfe_u32 v141, v0, 4, 2
  v_bfe_u32 v142, v0, 5, 1
  v_lshlrev_b32 v136, 8, v142
  v_bfe_u32 v142, v0, 3, 1
  v_lshl_add_u32 v136, v142, 7, v136
  v_and_b32 v142, 7, v0
  v_lshl_add_u32 v136, v142, 4, v136
  s_lshl_b32 s14, s8, 9
  v_add_u32 v136, s14, v136
  v_and_b32 v142, 1, v141
  v_mul_u32_u24 v137, 576, v142
  v_lshrrev_b32 v142, 1, v141
  v_mul_u32_u24 v142, 144, v142
  v_add_u32 v137, v137, v142
  s_mul_i32 s14, s8, 1152
  v_add_u32 v137, s14, v137
  v_bfe_u32 v142, v0, 1, 1
  v_lshl_add_u32 v137, v142, 5, v137
  v_bfe_u32 v142, v0, 3, 1
  v_lshl_add_u32 v137, v142, 4, v137
  v_bfe_u32 v142, v0, 2, 1
  v_lshl_add_u32 v137, v142, 3, v137
  v_and_b32 v142, 1, v0
  v_lshl_add_u32 v137, v142, 2, v137
  v_add_u32 v137, 8192, v137
  v_and_b32 v140, 31, v0
  s_lshl_b32 s14, s8, 5
  v_add_u32 v140, s14, v140
  v_lshlrev_b32 v139, 2, v140
  v_bfe_u32 v142, v140, 2, 3
  v_mul_u32_u24 v138, 144, v142
  v_bfe_u32 v142, v140, 5, 2
  v_lshl_add_u32 v138, v142, 5, v138
  v_and_b32 v142, 3, v140
  v_lshl_add_u32 v138, v142, 3, v138
  v_add_u32 v138, 8192, v138
  s_mov_b32 s10, 0
  s_add_u32 s12, s4, 48234496
  s_addc_u32 s13, s5, 0
  s_lshr_b32 s14, s43, 1
  s_lshl_b32 s14, s14, 10
  s_and_b32 s15, s43, 1
  s_lshl_b32 s15, s15, 9
  s_add_u32 s14, s14, s15
  s_add_u32 s28, s4, 48241664
  s_addc_u32 s29, s5, 0
  s_add_u32 s28, s28, s14
  s_addc_u32 s29, s29, 0
  s_lshl_b32 s14, s8, 11
  s_add_u32 s22, s4, 49152000
  s_addc_u32 s23, s5, 0
  s_add_u32 s22, s22, s14
  s_addc_u32 s23, s23, 0
  s_add_u32 s24, s4, 49676288
  s_addc_u32 s25, s5, 0
  s_mul_i32 s14, s8, 114688
  s_lshl_b32 s15, s43, 11
  s_add_u32 s14, s14, s15
  s_add_u32 s30, s4, 12845056
  s_addc_u32 s31, s5, 0
  s_add_u32 s30, s30, s14
  s_addc_u32 s31, s31, 0
  s_add_u32 s32, s30, 28672
  s_addc_u32 s33, s31, 0
  s_add_u32 s34, s30, 57344
  s_addc_u32 s35, s31, 0
  s_add_u32 s36, s30, 86016
  s_addc_u32 s37, s31, 0
  v_and_b32 v166, 31, v0
  v_lshlrev_b32 v166, 7, v166
  v_lshrrev_b32 v167, 5, v0
  v_lshl_add_u32 v167, v167, 2, v166
  v_add_u32 v167, 61513728, v167
  global_load_dword v167, v167, s[4:5] sc1
  v_and_b32 v164, 7, v0
  v_lshlrev_b32 v164, 5, v164
  global_load_dword v164, v164, s[6:7] sc1
  s_waitcnt vmcnt(0) lgkmcnt(0)
  v_cmp_ne_u32 vcc, 32, v164
  s_cbranch_vccnz L_cfbad_144
  v_cmp_ne_u32 vcc, s88, v167
  s_cbranch_vccnz L_cfbad_144
  s_branch L_cfok_143
L_cfbad_144:
  v_mov_b32 v164, 135168
  ds_write_b32 v164, v164
L_cfok_143:
  s_waitcnt lgkmcnt(0)
  s_barrier
  v_mov_b32 v164, 135168
  ds_read_b32 v164, v164
  s_waitcnt lgkmcnt(0)
  s_nop 0
  v_readfirstlane_b32 s14, v164
  s_nop 3
  s_cmp_lg_u32 s14, 0
  s_cbranch_scc1 L_recheck
  s_mov_b32 s11, 0
  v_mov_b32 v1, 1024
L_vxw_145:
  global_load_dword v2, v1, s[86:87] sc1
  s_waitcnt vmcnt(0)
  v_cmp_gt_u32 vcc, 84, v2
  s_cbranch_vccz L_vxg_146
  s_add_u32 s11, s11, 1
  s_cmp_gt_u32 s11, 262144
  s_cbranch_scc1 L_abort
  s_sleep 8
  s_branch L_vxw_145
L_vxg_146:
  s_barrier
L_B_loop_147:
  s_mov_b32 s11, 0
L_B_pa_148:
  global_load_dwordx4 v[36:39], v134, s[12:13] sc1
  global_load_dwordx4 v[40:43], v135, s[12:13] sc1
  s_waitcnt vmcnt(0)
  v_max3_u32 v44, v36, v37, v38
  v_max3_u32 v44, v44, v39, v40
  v_max3_u32 v44, v44, v41, v42
  v_max_u32 v44, v44, v43
  v_cmp_eq_u32 vcc, -1, v44
  s_cbranch_vccz L_B_ga_149
  s_add_u32 s11, s11, 1
  s_cmp_gt_u32 s11, 262144
  s_cbranch_scc1 L_abort
  s_branch L_B_pa_148
L_B_ga_149:
  ds_write_b128 v134, v[36:39]
  ds_write_b128 v135, v[40:43]
  s_waitcnt lgkmcnt(0)
  s_barrier
  ds_read_b128 v[4:7], v133 offset:0
  ds_read_b128 v[8:11], v133 offset:1024
  ds_read_b128 v[12:15], v133 offset:2048
  ds_read_b128 v[16:19], v133 offset:3072
  ds_read_b128 v[20:23], v133 offset:4096
  ds_read_b128 v[24:27], v133 offset:5120
  ds_read_b128 v[28:31], v133 offset:6144
  s_waitcnt vmcnt(0)
  s_cmp_lg_u32 s10, 3
  s_cbranch_scc1 L_n8_152
  v_cmp_gt_u32 vcc, 84, v164
  s_cbranch_vccz L_n8_152
  s_mov_b32 s11, 0
  v_mov_b32 v1, 1152
L_vxw_153:
  global_load_dword v2, v1, s[86:87] sc1
  s_waitcnt vmcnt(0)
  v_cmp_gt_u32 vcc, 84, v2
  s_cbranch_vccz L_vxg_154
  s_add_u32 s11, s11, 1
  s_cmp_gt_u32 s11, 262144
  s_cbranch_scc1 L_abort
  s_sleep 8
  s_branch L_vxw_153
L_vxg_154:
L_n8_152:
  s_cmp_lg_u32 s10, 15
  s_cbranch_scc1 L_n8_155
  v_cmp_gt_u32 vcc, 84, v164
  s_cbranch_vccz L_n8_155
  s_mov_b32 s11, 0
  v_mov_b32 v1, 1280
L_vxw_156:
  global_load_dword v2, v1, s[86:87] sc1
  s_waitcnt vmcnt(0)
  v_cmp_gt_u32 vcc, 84, v2
  s_cbranch_vccz L_vxg_157
  s_add_u32 s11, s11, 1
  s_cmp_gt_u32 s11, 262144
  s_cbranch_scc1 L_abort
  s_sleep 8
  s_branch L_vxw_156
L_vxg_157:
L_n8_155:
  s_cmp_lg_u32 s10, 2
  s_cbranch_scc1 L_n9_158
  v_mov_b32 v164, 1152
  global_load_dword v164, v164, s[86:87] sc1
L_n9_158:
  s_cmp_lg_u32 s10, 14
  s_cbranch_scc1 L_n9_159
  v_mov_b32 v164, 1280
  global_load_dword v164, v164, s[86:87] sc1
L_n9_159:
  v_mov_b64 v[32:33], 0
  v_mov_b64 v[34:35], 0
  v_mov_b64 v[156:157], 0
  v_mov_b64 v[158:159], 0
  v_mov_b64 v[160:161], 0
  v_mov_b64 v[162:163], 0
  ds_read_b128 v[116:119], v143 offset:0
  ds_read_b128 v[120:123], v143 offset:1024
  ds_read_b128 v[124:127], v143 offset:2048
  ds_read_b128 v[128:131], v143 offset:3072
  s_waitcnt lgkmcnt(10)
  v_smfmac_f32_16x16x64_bf16 v[32:35], v[4:7], a[0:7], v132
  s_waitcnt lgkmcnt(9)
  v_smfmac_f32_16x16x64_bf16 v[32:35], v[8:11], a[8:15], v132
  global_load_dwordx4 v[64:67], v133, s[30:31] offset:0
  s_waitcnt lgkmcnt(8)
  v_smfmac_f32_16x16x64_bf16 v[32:35], v[12:15], a[16:23], v132
  s_waitcnt lgkmcnt(2)
  v_smfmac_f32_16x16x64_bf16 v[156:159], v[4:7], v[116:123], v132
  ds_read_b128 v[116:119], v143 offset:4096
  ds_read_b128 v[120:123], v143 offset:5120
  v_mov_b64 v[36:37], 0
  v_smfmac_f32_16x16x64_bf16 v[32:35], v[16:19], a[24:31], v132
  v_mov_b64 v[38:39], 0
  v_smfmac_f32_16x16x64_bf16 v[32:35], v[20:23], a[32:39], v132
  global_load_dwordx4 v[68:71], v133, s[32:33] offset:0
  v_smfmac_f32_16x16x64_bf16 v[32:35], v[24:27], a[40:47], v132
  s_waitcnt lgkmcnt(2)
  v_smfmac_f32_16x16x64_bf16 v[156:159], v[8:11], v[124:131], v132
  ds_read_b128 v[124:127], v143 offset:6144
  ds_read_b128 v[128:131], v143 offset:7168
  v_smfmac_f32_16x16x64_bf16 v[32:35], v[28:31], a[48:55], v132
  v_smfmac_f32_16x16x64_bf16 v[36:39], v[4:7], a[56:63], v132
  global_load_dwordx4 v[72:75], v133, s[34:35] offset:0
  v_smfmac_f32_16x16x64_bf16 v[36:39], v[8:11], a[64:71], v132
  s_waitcnt lgkmcnt(2)
  v_smfmac_f32_16x16x64_bf16 v[156:159], v[12:15], v[116:123], v132
  ds_read_b128 v[116:119], v143 offset:8192
  ds_read_b128 v[120:123], v143 offset:9216
  v_cvt_pk_bf16_f32 v48, v32, v33
  v_smfmac_f32_16x16x64_bf16 v[36:39], v[12:15], a[72:79], v132
  v_cvt_pk_bf16_f32 v50, v34, v35
  v_smfmac_f32_16x16x64_bf16 v[36:39], v[16:19], a[80:87], v132
  global_load_dwordx4 v[76:79], v133, s[36:37] offset:0
  v_mov_b64 v[40:41], 0
  v_smfmac_f32_16x16x64_bf16 v[36:39], v[20:23], a[88:95], v132
  v_mov_b64 v[42:43], 0
  s_waitcnt lgkmcnt(2)
  v_smfmac_f32_16x16x64_bf16 v[156:159], v[16:19], v[124:131], v132
  ds_read_b128 v[124:127], v143 offset:10240
  ds_read_b128 v[128:131], v143 offset:11264
  v_smfmac_f32_16x16x64_bf16 v[36:39], v[24:27], a[96:103], v132
  v_smfmac_f32_16x16x64_bf16 v[36:39], v[28:31], a[104:111], v132
  global_load_dwordx4 v[80:83], v133, s[30:31] offset:1024
  v_smfmac_f32_16x16x64_bf16 v[40:43], v[4:7], a[112:119], v132
  s_waitcnt lgkmcnt(2)
  v_smfmac_f32_16x16x64_bf16 v[156:159], v[20:23], v[116:123], v132
  ds_read_b128 v[116:119], v143 offset:12288
  ds_read_b128 v[120:123], v143 offset:13312
  v_smfmac_f32_16x16x64_bf16 v[40:43], v[8:11], a[120:127], v132
  v_cvt_pk_bf16_f32 v56, v36, v37
  v_smfmac_f32_16x16x64_bf16 v[40:43], v[12:15], a[128:135], v132
  global_load_dwordx4 v[84:87], v133, s[32:33] offset:1024
  v_cvt_pk_bf16_f32 v58, v38, v39
  v_smfmac_f32_16x16x64_bf16 v[40:43], v[16:19], a[136:143], v132
  v_mov_b64 v[32:33], 0
  s_waitcnt lgkmcnt(2)
  v_smfmac_f32_16x16x64_bf16 v[156:159], v[24:27], v[124:131], v132
  ds_read_b128 v[124:127], v143 offset:14336
  ds_read_b128 v[128:131], v143 offset:15360
  v_mov_b64 v[34:35], 0
  v_smfmac_f32_16x16x64_bf16 v[40:43], v[20:23], a[144:151], v132
  v_smfmac_f32_16x16x64_bf16 v[40:43], v[24:27], a[152:159], v132
  global_load_dwordx4 v[88:91], v133, s[34:35] offset:1024
  v_smfmac_f32_16x16x64_bf16 v[40:43], v[28:31], a[160:167], v132
  s_waitcnt lgkmcnt(2)
  v_smfmac_f32_16x16x64_bf16 v[156:159], v[28:31], v[116:123], v132
  ds_read_b128 v[116:119], v143 offset:16384
  ds_read_b128 v[120:123], v143 offset:17408
  v_smfmac_f32_16x16x64_bf16 v[32:35], v[4:7], a[168:175], v132
  v_smfmac_f32_16x16x64_bf16 v[32:35], v[8:11], a[176:183], v132
  global_load_dwordx4 v[92:95], v133, s[36:37] offset:1024
  v_cvt_pk_bf16_f32 v49, v40, v41
  v_smfmac_f32_16x16x64_bf16 v[32:35], v[12:15], a[184:191], v132
  v_cvt_pk_bf16_f32 v51, v42, v43
  s_waitcnt lgkmcnt(2)
  v_smfmac_f32_16x16x64_bf16 v[160:163], v[4:7], v[124:131], v132
  ds_read_b128 v[124:127], v143 offset:18432
  ds_read_b128 v[128:131], v143 offset:19456
  v_cvt_pk_bf16_f32 v53, v156, v157
  v_smfmac_f32_16x16x64_bf16 v[32:35], v[16:19], a[192:199], v132
  v_cvt_pk_bf16_f32 v55, v158, v159
  v_smfmac_f32_16x16x64_bf16 v[32:35], v[20:23], a[200:207], v132
  v_mov_b64 v[36:37], 0
  v_smfmac_f32_16x16x64_bf16 v[32:35], v[24:27], a[208:215], v132
  v_mov_b64 v[38:39], 0
  s_waitcnt lgkmcnt(2)
  v_smfmac_f32_16x16x64_bf16 v[160:163], v[8:11], v[116:123], v132
  ds_read_b128 v[116:119], v143 offset:20480
  ds_read_b128 v[120:123], v143 offset:21504
  v_smfmac_f32_16x16x64_bf16 v[32:35], v[28:31], a[216:223], v132
  v_smfmac_f32_16x16x64_bf16 v[36:39], v[4:7], a[224:231], v132
  v_smfmac_f32_16x16x64_bf16 v[36:39], v[8:11], a[232:239], v132
  s_waitcnt lgkmcnt(2)
  v_smfmac_f32_16x16x64_bf16 v[160:163], v[12:15], v[124:131], v132
  ds_read_b128 v[124:127], v143 offset:22528
  ds_read_b128 v[128:131], v143 offset:23552
  v_cvt_pk_bf16_f32 v57, v32, v33
  v_smfmac_f32_16x16x64_bf16 v[36:39], v[12:15], a[240:247], v132
  v_cvt_pk_bf16_f32 v59, v34, v35
  v_smfmac_f32_16x16x64_bf16 v[36:39], v[16:19], a[248:255], v132
  v_mov_b64 v[40:41], 0
  v_smfmac_f32_16x16x64_bf16 v[36:39], v[20:23], v[176:183], v132
  v_mov_b64 v[42:43], 0
  s_waitcnt lgkmcnt(2)
  v_smfmac_f32_16x16x64_bf16 v[160:163], v[16:19], v[116:123], v132
  ds_read_b128 v[116:119], v143 offset:24576
  ds_read_b128 v[120:123], v143 offset:25600
  v_smfmac_f32_16x16x64_bf16 v[36:39], v[24:27], v[184:191], v132
  v_smfmac_f32_16x16x64_bf16 v[36:39], v[28:31], v[192:199], v132
  v_smfmac_f32_16x16x64_bf16 v[40:43], v[4:7], v[200:207], v132
  s_waitcnt lgkmcnt(2)
  v_smfmac_f32_16x16x64_bf16 v[160:163], v[20:23], v[124:131], v132
  ds_read_b128 v[124:127], v143 offset:26624
  ds_read_b128 v[128:131], v143 offset:27648
  v_smfmac_f32_16x16x64_bf16 v[40:43], v[8:11], v[208:215], v132
  v_cvt_pk_bf16_f32 v52, v36, v37
  v_smfmac_f32_16x16x64_bf16 v[40:43], v[12:15], v[216:223], v132
  v_cvt_pk_bf16_f32 v54, v38, v39
  v_smfmac_f32_16x16x64_bf16 v[40:43], v[16:19], v[224:231], v132
  s_waitcnt lgkmcnt(2)
  v_smfmac_f32_16x16x64_bf16 v[160:163], v[24:27], v[116:123], v132
  v_smfmac_f32_16x16x64_bf16 v[40:43], v[20:23], v[232:239], v132
  v_smfmac_f32_16x16x64_bf16 v[40:43], v[24:27], v[240:247], v132
  v_smfmac_f32_16x16x64_bf16 v[40:43], v[28:31], v[248:255], v132
  s_waitcnt lgkmcnt(0)
  v_smfmac_f32_16x16x64_bf16 v[160:163], v[28:31], v[124:131], v132
  s_nop 7
  v_cvt_pk_bf16_f32 v60, v40, v41
  v_cvt_pk_bf16_f32 v62, v42, v43
  v_cvt_pk_bf16_f32 v61, v160, v161
  v_cvt_pk_bf16_f32 v63, v162, v163
  s_add_u32 s30, s30, 458752
  s_addc_u32 s31, s31, 0
  s_add_u32 s32, s32, 458752
  s_addc_u32 s33, s33, 0
  s_add_u32 s34, s34, 458752
  s_addc_u32 s35, s35, 0
  s_add_u32 s36, s36, 458752
  s_addc_u32 s37, s37, 0
  v_mov_b32 v108, 0
  v_mov_b32 v109, 0
  v_mov_b32 v110, 0
  v_mov_b32 v111, 0
  v_mov_b32 v112, 0
  v_mov_b32 v113, 0
  v_mov_b32 v114, 0
  v_mov_b32 v115, 0
  s_mov_b32 s11, 0
  s_sleep 11
L_Bp_pa_160:
  global_load_dwordx4 v[96:99], v133, s[22:23] sc1
  global_load_dwordx4 v[100:103], v133, s[22:23] offset:1024 sc1
  global_load_dwordx4 v[104:107], v136, s[24:25] sc1
  s_waitcnt vmcnt(0)
  v_max3_u32 v140, v96, v97, v98
  v_max3_u32 v140, v140, v99, v100
  v_max3_u32 v140, v140, v101, v102
  v_max3_u32 v140, v140, v103, v104
  v_max3_u32 v140, v140, v105, v106
  v_max_u32 v140, v140, v107
  v_cmp_eq_u32 vcc, -1, v140
  s_cbranch_vccz L_Bp_ga_161
  s_add_u32 s11, s11, 1
  s_cmp_gt_u32 s11, 262144
  s_cbranch_scc1 L_abort
  s_branch L_Bp_pa_160
L_Bp_ga_161:
  v_smfmac_f32_16x16x64_bf16 v[108:111], v[104:107], v[48:55], v132
  v_smfmac_f32_16x16x64_bf16 v[108:111], v[96:99], v[64:71], v132
  v_smfmac_f32_16x16x64_bf16 v[108:111], v[100:103], v[72:79], v132
  v_smfmac_f32_16x16x64_bf16 v[112:115], v[104:107], v[56:63], v132
  v_smfmac_f32_16x16x64_bf16 v[112:115], v[96:99], v[80:87], v132
  v_smfmac_f32_16x16x64_bf16 v[112:115], v[100:103], v[88:95], v132
  v_permlane32_swap_b32 v108, v109
  v_permlane32_swap_b32 v110, v111
  v_add_f32 v108, v108, v109
  v_add_f32 v110, v110, v111
  ds_write_b32 v137, v108 offset:0
  ds_write_b32 v137, v110 offset:288
  s_nop 0
  v_permlane32_swap_b32 v112, v113
  v_permlane32_swap_b32 v114, v115
  v_add_f32 v112, v112, v113
  v_add_f32 v114, v114, v115
  ds_write_b32 v137, v112 offset:64
  ds_write_b32 v137, v114 offset:352
  s_waitcnt lgkmcnt(0)
  s_barrier
  ds_read_b64 v[32:33], v138 offset:0
  ds_read_b64 v[34:35], v138 offset:1152
  ds_read_b64 v[36:37], v138 offset:2304
  ds_read_b64 v[38:39], v138 offset:3456
  s_waitcnt lgkmcnt(2)
  v_pk_add_f32 v[32:33], v[32:33], v[34:35]
  s_waitcnt lgkmcnt(0)
  v_pk_add_f32 v[36:37], v[36:37], v[38:39]
  v_pk_add_f32 v[32:33], v[32:33], v[36:37]
  v_cvt_pk_bf16_f32 v32, v32, v33
  v_min_u32 v32, -2, v32
  global_store_dword v139, v32, s[28:29]
  s_cmp_lg_u32 s10, 62
  s_cbranch_scc1 L_Blast_164
  s_add_u32 s14, s28, 458752
  s_addc_u32 s15, s29, 0
  global_store_dword v139, v32, s[14:15] sc1
L_Blast_164:
  s_add_u32 s12, s12, 7168
  s_addc_u32 s13, s13, 0
  s_add_u32 s28, s28, 7168
  s_addc_u32 s29, s29, 0
  s_add_u32 s22, s22, 8192
  s_addc_u32 s23, s23, 0
  s_add_u32 s24, s24, 2048
  s_addc_u32 s25, s25, 0
  s_add_u32 s10, s10, 1
  s_cmp_lt_u32 s10, 63
  s_cbranch_scc1 L_B_loop_147
  s_branch L_pdone
L_roleF:
  v_and_b32 v5, 31, v0
  v_lshlrev_b32 v5, 7, v5
  v_lshrrev_b32 v6, 5, v0
  v_lshl_add_u32 v6, v6, 2, v5
  v_add_u32 v6, 61513728, v6
  s_mov_b32 s11, 0
L_wa_165:
  global_load_dword v7, v6, s[4:5] sc1
  s_waitcnt vmcnt(0)
  v_cmp_ne_u32 vcc, s88, v7
  s_cbranch_vccz L_wag_166
  s_add_u32 s11, s11, 1
  s_cmp_gt_u32 s11, 262144
  s_cbranch_scc1 L_abort
  s_branch L_wa_165
L_wag_166:
  v_and_b32 v6, 31, v0
  v_lshlrev_b32 v6, 7, v6
  v_lshrrev_b32 v7, 5, v0
  v_lshl_add_u32 v7, v7, 2, v6
  v_add_u32 v7, 61513728, v7
  global_load_dword v7, v7, s[4:5] sc1
  v_and_b32 v4, 7, v0
  v_lshlrev_b32 v4, 5, v4
  global_load_dword v4, v4, s[6:7] sc1
  s_waitcnt vmcnt(0)
  v_cmp_ne_u32 vcc, 32, v4
  s_cbranch_vccnz L_cfbad_168
  v_cmp_ne_u32 vcc, s88, v7
  s_cbranch_vccnz L_cfbad_168
  s_branch L_cfok_167
L_cfbad_168:
  v_mov_b32 v4, 135168
  ds_write_b32 v4, v4
L_cfok_167:
  s_waitcnt lgkmcnt(0)
  s_barrier
  v_mov_b32 v4, 135168
  ds_read_b32 v4, v4
  s_waitcnt lgkmcnt(0)
  s_nop 0
  v_readfirstlane_b32 s14, v4
  s_nop 3
  s_cmp_lg_u32 s14, 0
  s_cbranch_scc1 L_recheck
  v_and_b32 v14, 63, v0
  v_lshlrev_b32 v10, 4, v14
  s_lshl_b32 s14, s8, 10
  v_add_u32 v11, s14, v10
  s_add_u32 s14, s8, 4
  s_min_u32 s14, s14, 6
  s_lshl_b32 s14, s14, 10
  v_add_u32 v12, s14, v10
  v_and_b32 v14, 8, v0
  v_cmp_eq_u32 vcc, 0, v14
  v_mov_b32 v13, 0xeeeeeeee
  v_mov_b32 v14, 0x44444444
  s_nop 1
  v_cndmask_b32 v13, v13, v14, vcc
  s_add_u32 s12, s4, 48234496
  s_addc_u32 s13, s5, 0
  s_add_u32 s60, s4, 48693248
  s_addc_u32 s61, s5, 0
  v_and_b32 v30, 63, v0
  v_lshlrev_b32 v30, 7, v30
  s_lshl_b32 s14, s8, 13
  s_add_u32 s26, s4, 42205184
  s_addc_u32 s27, s5, 0
  s_add_u32 s26, s26, s14
  s_addc_u32 s27, s27, 0
  v_mov_b32 v31, v30
  s_mov_b32 s18, 49676288
  s_mov_b32 s19, 2048
  s_mov_b32 s20, 1920
  s_cmp_eq_u32 s8, 1
  s_cselect_b32 s18, 49152000, s18
  s_cselect_b32 s19, 8192, s19
  s_cselect_b32 s20, 8064, s20
  s_cmp_eq_u32 s8, 3
  s_cselect_b32 s18, 44302336, s18
  s_cselect_b32 s19, 4096, s19
  s_cselect_b32 s20, 3968, s20
  s_cmp_eq_u32 s8, 0
  s_cselect_b32 s18, 48234496, s18
  s_cselect_b32 s19, 7168, s19
  s_cselect_b32 s20, 7040, s20
  v_min_u32 v31, s20, v30
  s_add_u32 s22, s4, s18
  s_addc_u32 s23, s5, 0
  s_mov_b32 s43, s19
  s_mov_b32 s11, 0
  v_mov_b32 v1, 1024
L_vxw_169:
  global_load_dword v2, v1, s[86:87] sc1
  s_waitcnt vmcnt(0)
  v_cmp_gt_u32 vcc, 84, v2
  s_cbranch_vccz L_vxg_170
  s_add_u32 s11, s11, 1
  s_cmp_gt_u32 s11, 262144
  s_cbranch_scc1 L_abort
  s_sleep 8
  s_branch L_vxw_169
L_vxg_170:
  global_load_dword v33, v30, s[26:27]
  global_load_dword v34, v31, s[22:23]
  s_add_u32 s26, s26, 32768
  s_addc_u32 s27, s27, 0
  s_add_u32 s22, s22, s43
  s_addc_u32 s23, s23, 0
  global_load_dword v33, v30, s[26:27]
  global_load_dword v34, v31, s[22:23]
  s_add_u32 s26, s26, 32768
  s_addc_u32 s27, s27, 0
  s_add_u32 s22, s22, s43
  s_addc_u32 s23, s23, 0
  global_load_dword v33, v30, s[26:27]
  global_load_dword v34, v31, s[22:23]
  s_add_u32 s26, s26, 32768
  s_addc_u32 s27, s27, 0
  s_add_u32 s22, s22, s43
  s_addc_u32 s23, s23, 0
  global_load_dword v33, v30, s[26:27]
  global_load_dword v34, v31, s[22:23]
  s_add_u32 s26, s26, 32768
  s_addc_u32 s27, s27, 0
  s_add_u32 s22, s22, s43
  s_addc_u32 s23, s23, 0
  s_mov_b32 s10, 0
L_F_loop_171:
  s_cmp_ge_u32 s10, 60
  s_cbranch_scc1 L_F_nt_172
  global_load_dword v33, v30, s[26:27]
  global_load_dword v34, v31, s[22:23]
  s_add_u32 s26, s26, 32768
  s_addc_u32 s27, s27, 0
  s_add_u32 s22, s22, s43
  s_addc_u32 s23, s23, 0
L_F_nt_172:
  s_mov_b32 s11, 0
L_F_poll_173:
  global_load_dwordx4 v[16:19], v11, s[12:13] sc1
  global_load_dwordx4 v[20:23], v12, s[12:13] sc1
  s_waitcnt vmcnt(0)
  v_max3_u32 v14, v16, v17, v18
  v_max3_u32 v14, v14, v19, v20
  v_max3_u32 v14, v14, v21, v22
  v_max_u32 v14, v14, v23
  v_cmp_eq_u32 vcc, -1, v14
  s_cbranch_vccz L_F_got_174
  s_add_u32 s11, s11, 1
  s_cmp_gt_u32 s11, 262144
  s_cbranch_scc1 L_abort
  s_sleep 4
  s_branch L_F_poll_173
L_F_got_174:
  global_store_dwordx4 v11, v[16:19], s[60:61] sc1
  global_store_dwordx4 v12, v[20:23], s[60:61] sc1
  s_waitcnt vmcnt(0)
  s_add_u32 s12, s12, 7168
  s_addc_u32 s13, s13, 0
  s_add_u32 s60, s60, 7168
  s_addc_u32 s61, s61, 0
  s_add_u32 s10, s10, 1
  s_cmp_lt_u32 s10, 64
  s_cbranch_scc1 L_F_loop_171
  s_branch L_done
L_cidle:
  v_and_b32 v5, 31, v0
  v_lshlrev_b32 v5, 7, v5
  v_lshrrev_b32 v6, 5, v0
  v_lshl_add_u32 v6, v6, 2, v5
  v_add_u32 v6, 61513728, v6
  s_mov_b32 s11, 0
L_wa_175:
  global_load_dword v7, v6, s[4:5] sc1
  s_waitcnt vmcnt(0)
  v_cmp_ne_u32 vcc, s88, v7
  s_cbranch_vccz L_wag_176
  s_add_u32 s11, s11, 1
  s_cmp_gt_u32 s11, 262144
  s_cbranch_scc1 L_abort
  s_branch L_wa_175
L_wag_176:
  v_and_b32 v6, 31, v0
  v_lshlrev_b32 v6, 7, v6
  v_lshrrev_b32 v7, 5, v0
  v_lshl_add_u32 v7, v7, 2, v6
  v_add_u32 v7, 61513728, v7
  global_load_dword v7, v7, s[4:5] sc1
  v_and_b32 v4, 7, v0
  v_lshlrev_b32 v4, 5, v4
  global_load_dword v4, v4, s[6:7] sc1
  s_waitcnt vmcnt(0)
  v_cmp_ne_u32 vcc, 32, v4
  s_cbranch_vccnz L_cfbad_178
  v_cmp_ne_u32 vcc, s88, v7
  s_cbranch_vccnz L_cfbad_178
  s_branch L_cfok_177
L_cfbad_178:
  v_mov_b32 v4, 135168
  ds_write_b32 v4, v4
L_cfok_177:
  s_waitcnt lgkmcnt(0)
  s_barrier
  v_mov_b32 v4, 135168
  ds_read_b32 v4, v4
  s_waitcnt lgkmcnt(0)
  s_nop 0
  v_readfirstlane_b32 s14, v4
  s_nop 3
  s_cmp_lg_u32 s14, 0
  s_cbranch_scc1 L_recheck
  s_branch L_done
L_recheck:
  s_waitcnt vmcnt(0) lgkmcnt(0)
  s_mov_b64 exec, -1
  s_mov_b32 s11, 0
L_recheck_poll:
  v_and_b32 v4, 7, v0
  v_lshlrev_b32 v4, 5, v4
  global_load_dword v4, v4, s[6:7] sc1
  v_and_b32 v10, 63, v0
  v_add_u32 v10, 0, v10
  v_and_b32 v11, 31, v10
  v_lshlrev_b32 v11, 7, v11
  v_lshrrev_b32 v6, 5, v10
  v_lshl_add_u32 v6, v6, 2, v11
  v_add_u32 v6, 61513728, v6
  global_load_dword v6, v6, s[4:5] sc1
  v_and_b32 v10, 63, v0
  v_add_u32 v10, 64, v10
  v_and_b32 v11, 31, v10
  v_lshlrev_b32 v11, 7, v11
  v_lshrrev_b32 v7, 5, v10
  v_lshl_add_u32 v7, v7, 2, v11
  v_add_u32 v7, 61513728, v7
  global_load_dword v7, v7, s[4:5] sc1
  v_and_b32 v10, 63, v0
  v_add_u32 v10, 128, v10
  v_and_b32 v11, 31, v10
  v_lshlrev_b32 v11, 7, v11
  v_lshrrev_b32 v8, 5, v10
  v_lshl_add_u32 v8, v8, 2, v11
  v_add_u32 v8, 61513728, v8
  global_load_dword v8, v8, s[4:5] sc1
  v_and_b32 v10, 63, v0
  v_add_u32 v10, 192, v10
  v_and_b32 v11, 31, v10
  v_lshlrev_b32 v11, 7, v11
  v_lshrrev_b32 v9, 5, v10
  v_lshl_add_u32 v9, v9, 2, v11
  v_add_u32 v9, 61513728, v9
  global_load_dword v9, v9, s[4:5] sc1
  s_waitcnt vmcnt(0)
  s_nop 0
  v_cmp_ne_u32 vcc, s88, v6
  s_cbranch_vccnz L_recheck_again
  v_cmp_ne_u32 vcc, s88, v7
  s_cbranch_vccnz L_recheck_again
  v_cmp_ne_u32 vcc, s88, v8
  s_cbranch_vccnz L_recheck_again
  v_cmp_ne_u32 vcc, s88, v9
  s_cbranch_vccnz L_recheck_again
  s_getreg_b32 s15, hwreg(HW_REG_XCC_ID)
  s_and_b32 s15, s15, 7
  s_mov_b32 s12, 0
  s_mov_b32 s13, 0
  s_mov_b32 s14, 0
  v_readlane_b32 s16, v4, 0
  s_nop 3
  s_add_u32 s12, s12, s16
  s_cmp_gt_u32 s15, 0
  s_cselect_b32 s17, s16, 0
  s_add_u32 s13, s13, s17
  s_cmp_eq_u32 s16, 32
  s_cselect_b32 s17, 1, 0
  s_add_u32 s14, s14, s17
  v_readlane_b32 s16, v4, 1
  s_nop 3
  s_add_u32 s12, s12, s16
  s_cmp_gt_u32 s15, 1
  s_cselect_b32 s17, s16, 0
  s_add_u32 s13, s13, s17
  s_cmp_eq_u32 s16, 32
  s_cselect_b32 s17, 1, 0
  s_add_u32 s14, s14, s17
  v_readlane_b32 s16, v4, 2
  s_nop 3
  s_add_u32 s12, s12, s16
  s_cmp_gt_u32 s15, 2
  s_cselect_b32 s17, s16, 0
  s_add_u32 s13, s13, s17
  s_cmp_eq_u32 s16, 32
  s_cselect_b32 s17, 1, 0
  s_add_u32 s14, s14, s17
  v_readlane_b32 s16, v4, 3
  s_nop 3
  s_add_u32 s12, s12, s16
  s_cmp_gt_u32 s15, 3
  s_cselect_b32 s17, s16, 0
  s_add_u32 s13, s13, s17
  s_cmp_eq_u32 s16, 32
  s_cselect_b32 s17, 1, 0
  s_add_u32 s14, s14, s17
  v_readlane_b32 s16, v4, 4
  s_nop 3
  s_add_u32 s12, s12, s16
  s_cmp_gt_u32 s15, 4
  s_cselect_b32 s17, s16, 0
  s_add_u32 s13, s13, s17
  s_cmp_eq_u32 s16, 32
  s_cselect_b32 s17, 1, 0
  s_add_u32 s14, s14, s17
  v_readlane_b32 s16, v4, 5
  s_nop 3
  s_add_u32 s12, s12, s16
  s_cmp_gt_u32 s15, 5
  s_cselect_b32 s17, s16, 0
  s_add_u32 s13, s13, s17
  s_cmp_eq_u32 s16, 32
  s_cselect_b32 s17, 1, 0
  s_add_u32 s14, s14, s17
  v_readlane_b32 s16, v4, 6
  s_nop 3
  s_add_u32 s12, s12, s16
  s_cmp_gt_u32 s15, 6
  s_cselect_b32 s17, s16, 0
  s_add_u32 s13, s13, s17
  s_cmp_eq_u32 s16, 32
  s_cselect_b32 s17, 1, 0
  s_add_u32 s14, s14, s17
  v_readlane_b32 s16, v4, 7
  s_nop 3
  s_add_u32 s12, s12, s16
  s_cmp_gt_u32 s15, 7
  s_cselect_b32 s17, s16, 0
  s_add_u32 s13, s13, s17
  s_cmp_eq_u32 s16, 32
  s_cselect_b32 s17, 1, 0
  s_add_u32 s14, s14, s17
  s_cmp_ge_u32 s12, 256
  s_cbranch_scc1 L_recheck_all
L_recheck_again:
  s_add_u32 s11, s11, 1
  s_cmp_gt_u32 s11, 262144
  s_cbranch_scc1 L_abort
  s_sleep 2
  s_branch L_recheck_poll
L_recheck_all:
  s_cmp_eq_u32 s14, 8
  s_cbranch_scc0 L_slow
  s_barrier
  v_mov_b32 v2, 135168
  v_mov_b32 v1, 0
  ds_write_b32 v2, v1
  s_waitcnt lgkmcnt(0)
  s_barrier
  s_branch L_fast_entry
L_slow:
  s_add_u32 s13, s13, s64
  s_lshr_b32 s68, s13, 5
  s_and_b32 s9, s13, 31
  s_mov_b32 s38, 0
  s_barrier
  s_cmp_eq_u32 s68, 0
  s_cbranch_scc1 L_chain_s
  s_cmp_ge_u32 s68, 5
  s_cbranch_scc1 L_free_s
  s_sub_u32 s65, s68, 1
  s_cmp_eq_u32 s9, 31
  s_cbranch_scc1 L_qF_s
  s_cmp_eq_u32 s9, 30
  s_cbranch_scc1 L_qL_s
  s_cmp_ge_u32 s9, 16
  s_cbranch_scc1 L_qB_s
  s_mov_b32 s11, 0
  v_mov_b32 v1, 1024
L_vxw_180:
  global_load_dword v2, v1, s[86:87] sc1
  s_waitcnt vmcnt(0)
  v_cmp_gt_u32 vcc, 84, v2
  s_cbranch_vccz L_vxg_181
  s_add_u32 s11, s11, 1
  s_cmp_gt_u32 s11, 262144
  s_cbranch_scc1 L_abort
  s_sleep 8
  s_branch L_vxw_180
L_vxg_181:
  s_cmp_lt_u32 s65, 2
  s_cbranch_scc1 L_stg_182
  s_add_u32 s16, s4, 48721920
  s_addc_u32 s17, s5, 0
  s_mov_b32 s11, 0
  v_mov_b32 v1, 0
L_stgp_183:
  global_load_dword v2, v1, s[16:17] sc1
  s_waitcnt vmcnt(0)
  v_cmp_eq_u32 vcc, -1, v2
  s_cbranch_vccz L_stg_182
  s_add_u32 s11, s11, 1
  s_cmp_gt_u32 s11, 262144
  s_cbranch_scc1 L_abort
  s_sleep 8
  s_branch L_stgp_183
L_stg_182:
  v_and_b32 v78, 63, v0
  v_lshlrev_b32 v113, 4, v78
  s_lshl_b32 s14, s8, 10
  v_add_u32 v114, s14, v113
  s_add_u32 s14, s8, 4
  s_min_u32 s14, s14, 6
  s_lshl_b32 s14, s14, 10
  v_add_u32 v115, s14, v113
  v_and_b32 v78, 8, v0
  v_cmp_eq_u32 vcc, 0, v78
  v_mov_b32 v112, 0xeeeeeeee
  v_mov_b32 v78, 0x44444444
  s_nop 1
  v_cndmask_b32 v112, v112, v78, vcc
  s_and_b32 s14, s8, 1
  s_mul_i32 s14, s14, 3072
  v_add_u32 v114, s14, v113
  s_mul_i32 s14, s9, 401408
  s_mul_i32 s15, s8, 100352
  s_add_u32 s14, s14, s15
  s_add_u32 s16, s4, 0
  s_addc_u32 s17, s5, 0
  s_add_u32 s16, s16, s14
  s_addc_u32 s17, s17, 0
  global_load_dwordx4 a[0:3], v113, s[16:17] offset:0
  global_load_dwordx4 a[4:7], v113, s[16:17] offset:1024
  global_load_dwordx4 a[8:11], v113, s[16:17] offset:2048
  global_load_dwordx4 a[12:15], v113, s[16:17] offset:3072
  s_add_u32 s16, s16, 4096
  s_addc_u32 s17, s17, 0
  global_load_dwordx4 a[16:19], v113, s[16:17] offset:0
  global_load_dwordx4 a[20:23], v113, s[16:17] offset:1024
  global_load_dwordx4 a[24:27], v113, s[16:17] offset:2048
  global_load_dwordx4 a[28:31], v113, s[16:17] offset:3072
  s_add_u32 s16, s16, 4096
  s_addc_u32 s17, s17, 0
  global_load_dwordx4 a[32:35], v113, s[16:17] offset:0
  global_load_dwordx4 a[36:39], v113, s[16:17] offset:1024
  global_load_dwordx4 a[40:43], v113, s[16:17] offset:2048
  global_load_dwordx4 a[44:47], v113, s[16:17] offset:3072
  s_add_u32 s16, s16, 4096
  s_addc_u32 s17, s17, 0
  global_load_dwordx4 a[48:51], v113, s[16:17] offset:0
  global_load_dwordx4 a[52:55], v113, s[16:17] offset:1024
  global_load_dwordx4 a[56:59], v113, s[16:17] offset:2048
  global_load_dwordx4 a[60:63], v113, s[16:17] offset:3072
  s_add_u32 s16, s16, 4096
  s_addc_u32 s17, s17, 0
  global_load_dwordx4 a[64:67], v113, s[16:17] offset:0
  global_load_dwordx4 a[68:71], v113, s[16:17] offset:1024
  global_load_dwordx4 a[72:75], v113, s[16:17] offset:2048
  global_load_dwordx4 a[76:79], v113, s[16:17] offset:3072
  s_add_u32 s16, s16, 4096
  s_addc_u32 s17, s17, 0
  global_load_dwordx4 a[80:83], v113, s[16:17] offset:0
  global_load_dwordx4 a[84:87], v113, s[16:17] offset:1024
  global_load_dwordx4 a[88:91], v113, s[16:17] offset:2048
  global_load_dwordx4 a[92:95], v113, s[16:17] offset:3072
  s_add_u32 s16, s16, 4096
  s_addc_u32 s17, s17, 0
  global_load_dwordx4 a[96:99], v113, s[16:17] offset:0
  global_load_dwordx4 a[100:103], v113, s[16:17] offset:1024
  global_load_dwordx4 a[104:107], v113, s[16:17] offset:2048
  global_load_dwordx4 a[108:111], v113, s[16:17] offset:3072
  s_add_u32 s16, s16, 4096
  s_addc_u32 s17, s17, 0
  global_load_dwordx4 a[112:115], v113, s[16:17] offset:0
  global_load_dwordx4 a[116:119], v113, s[16:17] offset:1024
  global_load_dwordx4 a[120:123], v113, s[16:17] offset:2048
  global_load_dwordx4 a[124:127], v113, s[16:17] offset:3072
  s_add_u32 s16, s16, 4096
  s_addc_u32 s17, s17, 0
  global_load_dwordx4 a[128:131], v113, s[16:17] offset:0
  global_load_dwordx4 a[132:135], v113, s[16:17] offset:1024
  global_load_dwordx4 a[136:139], v113, s[16:17] offset:2048
  global_load_dwordx4 a[140:143], v113, s[16:17] offset:3072
  s_add_u32 s16, s16, 4096
  s_addc_u32 s17, s17, 0
  global_load_dwordx4 a[144:147], v113, s[16:17] offset:0
  global_load_dwordx4 a[148:151], v113, s[16:17] offset:1024
  global_load_dwordx4 a[152:155], v113, s[16:17] offset:2048
  global_load_dwordx4 a[156:159], v113, s[16:17] offset:3072
  s_add_u32 s16, s16, 4096
  s_addc_u32 s17, s17, 0
  global_load_dwordx4 a[160:163], v113, s[16:17] offset:0
  global_load_dwordx4 a[164:167], v113, s[16:17] offset:1024
  global_load_dwordx4 a[168:171], v113, s[16:17] offset:2048
  global_load_dwordx4 a[172:175], v113, s[16:17] offset:3072
  s_add_u32 s16, s16, 4096
  s_addc_u32 s17, s17, 0
  global_load_dwordx4 a[176:179], v113, s[16:17] offset:0
  global_load_dwordx4 a[180:183], v113, s[16:17] offset:1024
  global_load_dwordx4 a[184:187], v113, s[16:17] offset:2048
  global_load_dwordx4 a[188:191], v113, s[16:17] offset:3072
  s_add_u32 s16, s16, 4096
  s_addc_u32 s17, s17, 0
  global_load_dwordx4 a[192:195], v113, s[16:17] offset:0
  global_load_dwordx4 a[196:199], v113, s[16:17] offset:1024
  global_load_dwordx4 a[200:203], v113, s[16:17] offset:2048
  global_load_dwordx4 a[204:207], v113, s[16:17] offset:3072
  s_add_u32 s16, s16, 4096
  s_addc_u32 s17, s17, 0
  global_load_dwordx4 a[208:211], v113, s[16:17] offset:0
  global_load_dwordx4 a[212:215], v113, s[16:17] offset:1024
  global_load_dwordx4 a[216:219], v113, s[16:17] offset:2048
  global_load_dwordx4 a[220:223], v113, s[16:17] offset:3072
  s_add_u32 s16, s16, 4096
  s_addc_u32 s17, s17, 0
  global_load_dwordx4 a[224:227], v113, s[16:17] offset:0
  global_load_dwordx4 a[228:231], v113, s[16:17] offset:1024
  global_load_dwordx4 a[232:235], v113, s[16:17] offset:2048
  global_load_dwordx4 a[236:239], v113, s[16:17] offset:3072
  s_add_u32 s16, s16, 4096
  s_addc_u32 s17, s17, 0
  global_load_dwordx4 a[240:243], v113, s[16:17] offset:0
  global_load_dwordx4 a[244:247], v113, s[16:17] offset:1024
  global_load_dwordx4 a[248:251], v113, s[16:17] offset:2048
  global_load_dwordx4 a[252:255], v113, s[16:17] offset:3072
  s_add_u32 s16, s16, 4096
  s_addc_u32 s17, s17, 0
  global_load_dwordx4 v[120:123], v113, s[16:17] offset:0
  global_load_dwordx4 v[124:127], v113, s[16:17] offset:1024
  global_load_dwordx4 v[128:131], v113, s[16:17] offset:2048
  global_load_dwordx4 v[132:135], v113, s[16:17] offset:3072
  s_add_u32 s16, s16, 4096
  s_addc_u32 s17, s17, 0
  global_load_dwordx4 v[136:139], v113, s[16:17] offset:0
  global_load_dwordx4 v[140:143], v113, s[16:17] offset:1024
  global_load_dwordx4 v[144:147], v113, s[16:17] offset:2048
  global_load_dwordx4 v[148:151], v113, s[16:17] offset:3072
  s_add_u32 s16, s16, 4096
  s_addc_u32 s17, s17, 0
  global_load_dwordx4 v[152:155], v113, s[16:17] offset:0
  global_load_dwordx4 v[156:159], v113, s[16:17] offset:1024
  global_load_dwordx4 v[160:163], v113, s[16:17] offset:2048
  global_load_dwordx4 v[164:167], v113, s[16:17] offset:3072
  s_add_u32 s16, s16, 4096
  s_addc_u32 s17, s17, 0
  global_load_dwordx4 v[168:171], v113, s[16:17] offset:0
  global_load_dwordx4 v[172:175], v113, s[16:17] offset:1024
  global_load_dwordx4 v[176:179], v113, s[16:17] offset:2048
  global_load_dwordx4 v[180:183], v113, s[16:17] offset:3072
  s_add_u32 s16, s16, 4096
  s_addc_u32 s17, s17, 0
  global_load_dwordx4 v[184:187], v113, s[16:17] offset:0
  global_load_dwordx4 v[188:191], v113, s[16:17] offset:1024
  global_load_dwordx4 v[192:195], v113, s[16:17] offset:2048
  global_load_dwordx4 v[196:199], v113, s[16:17] offset:3072
  s_add_u32 s16, s16, 4096
  s_addc_u32 s17, s17, 0
  global_load_dwordx4 v[200:203], v113, s[16:17] offset:0
  global_load_dwordx4 v[204:207], v113, s[16:17] offset:1024
  global_load_dwordx4 v[208:211], v113, s[16:17] offset:2048
  global_load_dwordx4 v[212:215], v113, s[16:17] offset:3072
  s_add_u32 s16, s16, 4096
  s_addc_u32 s17, s17, 0
  global_load_dwordx4 v[216:219], v113, s[16:17] offset:0
  global_load_dwordx4 v[220:223], v113, s[16:17] offset:1024
  global_load_dwordx4 v[224:227], v113, s[16:17] offset:2048
  global_load_dwordx4 v[228:231], v113, s[16:17] offset:3072
  s_add_u32 s16, s16, 4096
  s_addc_u32 s17, s17, 0
  global_load_dwordx4 v[232:235], v113, s[16:17] offset:0
  global_load_dwordx4 v[236:239], v113, s[16:17] offset:1024
  global_load_dwordx4 v[240:243], v113, s[16:17] offset:2048
  global_load_dwordx4 v[244:247], v113, s[16:17] offset:3072
  s_add_u32 s16, s16, 4096
  s_addc_u32 s17, s17, 0
  global_load_dwordx4 v[248:251], v113, s[16:17] offset:0
  global_load_dwordx4 v[252:255], v113, s[16:17] offset:1024
  v_and_b32 v78, 15, v0
  v_bfe_u32 v79, v0, 4, 2
  s_mul_i32 s14, s8, 5120
  s_add_u32 s14, s14, 8192
  v_mul_u32_u24 v116, 40, v78
  v_lshl_add_u32 v116, v79, 3, v116
  v_add_u32 v116, s14, v116
  v_bfe_u32 v88, v0, 2, 1
  v_bfe_u32 v117, v0, 3, 1
  v_lshl_add_u32 v88, v117, 2, v88
  v_lshl_add_u32 v88, v79, 3, v88
  v_mul_u32_u24 v88, 40, v88
  v_and_b32 v117, 3, v0
  v_lshl_add_u32 v117, v117, 3, v88
  v_add_u32 v117, s14, v117
  s_mul_i32 s14, s8, 112
  v_lshl_add_u32 v88, v79, 3, s14
  v_lshrrev_b32 v118, 6, v88
  v_lshlrev_b32 v118, 10, v118
  v_bfe_u32 v119, v88, 4, 2
  v_lshl_add_u32 v118, v119, 8, v118
  v_bfe_u32 v119, v88, 3, 1
  v_lshl_add_u32 v118, v119, 3, v118
  v_and_b32 v119, 7, v0
  v_lshl_add_u32 v118, v119, 4, v118
  s_mul_i32 s14, s8, 1664
  s_add_u32 s14, s14, 28672
  v_mul_u32_u24 v119, 288, v79
  v_lshl_add_u32 v119, v78, 4, v119
  v_add_u32 v119, s14, v119
  v_lshlrev_b32 v1, 7, v79
  v_lshl_add_u32 v1, v78, 3, v1
  v_add_u32 v1, s14, v1
  v_add_u32 v1, 1152, v1
  s_and_b32 s14, s8, 1
  s_lshl_b32 s14, s14, 2
  v_add_u32 v78, s14, v79
  v_and_b32 v79, 15, v0
  v_lshrrev_b32 v88, 2, v79
  v_mul_u32_u24 v2, 288, v88
  v_lshlrev_b32 v90, 2, v88
  v_bfe_u32 v91, v79, 1, 1
  v_lshl_add_u32 v90, v91, 4, v90
  v_and_b32 v91, 1, v79
  v_lshl_add_u32 v90, v91, 1, v90
  s_lshl_b32 s14, s65, 3
  v_add_u32 v88, s14, v78
  v_add_u32 v91, 1, v90
  v_cmp_gt_u32 vcc, v90, v88
  v_mov_b32 v90, 0
  v_mov_b32 v89, 0xf149f2ca
  s_nop 0
  v_cndmask_b32 v90, v90, v89, vcc
  v_cmp_gt_u32 vcc, v91, v88
  v_mov_b32 v91, 0
  s_nop 1
  v_cndmask_b32 v91, v91, v89, vcc
  v_lshl_add_u32 v2, v78, 4, v2
  v_and_b32 v88, 1, v79
  v_lshl_add_u32 v2, v88, 7, v2
  v_bfe_u32 v88, v79, 1, 1
  v_lshl_add_u32 v2, v88, 3, v2
  v_add_u32 v2, 28672, v2
  v_lshrrev_b32 v88, 1, v79
  v_lshlrev_b32 v3, 7, v88
  v_lshl_add_u32 v3, v78, 3, v3
  v_and_b32 v88, 1, v79
  v_lshl_add_u32 v3, v88, 6, v3
  v_add_u32 v3, 29824, v3
  v_mov_b32 v88, 36864
  v_cmp_gt_u32 vcc, 4, v79
  s_nop 1
  v_cndmask_b32 v3, v88, v3, vcc
  v_lshrrev_b32 v88, 3, v79
  v_lshlrev_b32 v77, 8, v88
  v_and_b32 v88, 1, v79
  v_lshl_add_u32 v77, v88, 7, v77
  v_lshl_add_u32 v77, v78, 4, v77
  v_bfe_u32 v88, v79, 1, 2
  v_lshl_add_u32 v77, v88, 2, v77
  v_lshlrev_b32 v76, 2, v79
  v_lshl_add_u32 v76, v78, 4, v76
  v_cmp_gt_u32 s[62:63], 4, v79
  v_lshlrev_b32 v78, 4, v0
  v_add_u32 v78, 7168, v78
  v_mov_b32 v80, 0
  v_mov_b32 v81, 0
  v_mov_b32 v82, 0
  v_mov_b32 v83, 0
  ds_write_b128 v78, v[80:83] offset:0
  ds_write_b128 v78, v[80:83] offset:4096
  ds_write_b128 v78, v[80:83] offset:8192
  ds_write_b128 v78, v[80:83] offset:12288
  ds_write_b128 v78, v[80:83] offset:16384
  ds_write_b128 v78, v[80:83] offset:20480
  v_mov_b32 v84, 0xf149f2ca
  v_mov_b32 v85, v84
  v_mov_b32 v78, 36864
  ds_write_b64 v78, v[84:85] offset:0
  ds_write_b64 v78, v[84:85] offset:1664
  ds_write_b64 v78, v[84:85] offset:3328
  ds_write_b64 v78, v[84:85] offset:4992
  v_mov_b32 v78, v90
  v_mov_b32 v79, v91
  s_mov_b32 s10, 0
  s_add_u32 s12, s4, 49807360
  s_addc_u32 s13, s5, 0
  s_mul_i32 s14, s65, 458752
  s_add_u32 s12, s12, s14
  s_addc_u32 s13, s13, 0
  s_mul_i32 s14, s65, 7168
  s_add_u32 s66, s4, 46403584
  s_addc_u32 s67, s5, 0
  s_add_u32 s66, s66, s14
  s_addc_u32 s67, s67, 0
  s_lshl_b32 s14, s8, 13
  s_add_u32 s14, s14, 4096
  s_add_u32 s26, s4, 42205184
  s_addc_u32 s27, s5, 0
  s_add_u32 s26, s26, s14
  s_addc_u32 s27, s27, 0
  s_lshr_b32 s14, s9, 1
  s_lshl_b32 s14, s14, 10
  s_and_b32 s15, s9, 1
  s_lshl_b32 s15, s15, 9
  s_add_u32 s14, s14, s15
  s_add_u32 s22, s4, 51642368
  s_addc_u32 s23, s5, 0
  s_add_u32 s22, s22, s14
  s_addc_u32 s23, s23, 0
  s_lshl_b32 s14, s9, 7
  s_add_u32 s24, s4, 53739520
  s_addc_u32 s25, s5, 0
  s_add_u32 s24, s24, s14
  s_addc_u32 s25, s25, 0
  s_lshl_b32 s14, s65, 19
  s_add_u32 s22, s22, s14
  s_addc_u32 s23, s23, 0
  s_lshl_b32 s14, s65, 17
  s_add_u32 s24, s24, s14
  s_addc_u32 s25, s25, 0
  global_load_dwordx4 v[4:7], v113, s[66:67] offset:-4096
  global_load_dwordx4 v[8:11], v113, s[66:67] offset:-3072
  global_load_dwordx4 v[12:15], v113, s[66:67] offset:-2048
  global_load_dwordx4 v[16:19], v113, s[66:67] offset:-1024
  global_load_dwordx4 v[20:23], v113, s[66:67] offset:0
  global_load_dwordx4 v[24:27], v113, s[66:67] offset:1024
  global_load_dwordx4 v[28:31], v113, s[66:67] offset:2048
  s_add_u32 s66, s66, 28672
  s_addc_u32 s67, s67, 0
  v_mov_b32 v80, 0
  v_mov_b32 v81, 0
  v_mov_b32 v82, 0
  v_mov_b32 v83, 0
  s_waitcnt vmcnt(0) lgkmcnt(0)
  s_barrier
L_A_loop_184:
  s_cmp_lt_u32 s8, 2
  s_cbranch_scc1 L_A_b1_185
  s_mov_b32 s11, 0
L_A_poll_186:
  global_load_dwordx4 v[84:87], v114, s[12:13] offset:0 sc1
  global_load_dwordx4 v[88:91], v114, s[12:13] offset:1024 sc1
  global_load_dwordx4 v[92:95], v114, s[12:13] offset:2048 sc1
  global_load_dwordx4 v[96:99], v114, s[12:13] offset:3072 sc1
  s_waitcnt vmcnt(0)
  v_max3_u32 v100, v84, v85, v86
  v_max3_u32 v100, v100, v87, v88
  v_max3_u32 v100, v100, v89, v90
  v_max3_u32 v100, v100, v91, v92
  v_max3_u32 v100, v100, v93, v94
  v_max3_u32 v100, v100, v95, v96
  v_max3_u32 v100, v100, v97, v98
  v_max_u32 v100, v100, v99
  v_cmp_eq_u32 vcc, -1, v100
  s_cbranch_vccz L_A_got_187
  s_add_u32 s11, s11, 1
  s_cmp_gt_u32 s11, 262144
  s_cbranch_scc1 L_abort
  s_branch L_A_poll_186
L_A_got_187:
  ds_write_b128 v114, v[84:87] offset:0
  ds_write_b128 v114, v[88:91] offset:1024
  ds_write_b128 v114, v[92:95] offset:2048
  ds_write_b128 v114, v[96:99] offset:3072
L_A_b1_185:
  s_waitcnt vmcnt(0) lgkmcnt(0)
  s_barrier
  v_smfmac_f32_16x16x64_bf16 v[80:83], v[4:7], a[0:7], v112
  v_smfmac_f32_16x16x64_bf16 v[80:83], v[8:11], a[8:15], v112
  v_smfmac_f32_16x16x64_bf16 v[80:83], v[12:15], a[16:23], v112
  s_waitcnt vmcnt(0)
  global_load_dwordx4 v[32:35], v113, s[26:27] offset:-4096
  v_smfmac_f32_16x16x64_bf16 v[80:83], v[16:19], a[24:31], v112
  v_smfmac_f32_16x16x64_bf16 v[80:83], v[20:23], a[32:39], v112
  v_mov_b64 v[84:85], 0
  v_smfmac_f32_16x16x64_bf16 v[80:83], v[24:27], a[40:47], v112
  v_mov_b64 v[86:87], 0
  v_smfmac_f32_16x16x64_bf16 v[80:83], v[28:31], a[48:55], v112
  global_load_dwordx4 v[36:39], v113, s[26:27] offset:-3072
  v_smfmac_f32_16x16x64_bf16 v[84:87], v[4:7], a[56:63], v112
  v_smfmac_f32_16x16x64_bf16 v[84:87], v[8:11], a[64:71], v112
  v_cvt_pk_bf16_f32 v72, v80, v81
  v_smfmac_f32_16x16x64_bf16 v[84:87], v[12:15], a[72:79], v112
  v_cvt_pk_bf16_f32 v73, v82, v83
  v_smfmac_f32_16x16x64_bf16 v[84:87], v[16:19], a[80:87], v112
  ds_write_b64 v116, v[72:73] offset:0
  global_load_dwordx4 v[40:43], v113, s[26:27] offset:-2048
  v_smfmac_f32_16x16x64_bf16 v[84:87], v[20:23], a[88:95], v112
  v_mov_b64 v[88:89], 0
  v_smfmac_f32_16x16x64_bf16 v[84:87], v[24:27], a[96:103], v112
  v_mov_b64 v[90:91], 0
  v_smfmac_f32_16x16x64_bf16 v[84:87], v[28:31], a[104:111], v112
  v_smfmac_f32_16x16x64_bf16 v[88:91], v[4:7], a[112:119], v112
  global_load_dwordx4 v[44:47], v113, s[26:27] offset:-1024
  v_smfmac_f32_16x16x64_bf16 v[88:91], v[8:11], a[120:127], v112
  v_cvt_pk_bf16_f32 v74, v84, v85
  v_smfmac_f32_16x16x64_bf16 v[88:91], v[12:15], a[128:135], v112
  v_cvt_pk_bf16_f32 v75, v86, v87
  v_smfmac_f32_16x16x64_bf16 v[88:91], v[16:19], a[136:143], v112
  ds_write_b64 v116, v[74:75] offset:640
  v_smfmac_f32_16x16x64_bf16 v[88:91], v[20:23], a[144:151], v112
  v_mov_b64 v[80:81], 0
  global_load_dwordx4 v[48:51], v113, s[26:27] offset:0
  v_smfmac_f32_16x16x64_bf16 v[88:91], v[24:27], a[152:159], v112
  v_mov_b64 v[82:83], 0
  ds_read_b64_tr_b16 v[92:93], v117 offset:0
  ds_read_b64_tr_b16 v[94:95], v117 offset:80
  v_smfmac_f32_16x16x64_bf16 v[88:91], v[28:31], a[160:167], v112
  ds_read_b64 v[64:65], v118 offset:0
  ds_read_b64 v[66:67], v118 offset:128
  v_smfmac_f32_16x16x64_bf16 v[80:83], v[4:7], a[168:175], v112
  v_smfmac_f32_16x16x64_bf16 v[80:83], v[8:11], a[176:183], v112
  v_cvt_pk_bf16_f32 v72, v88, v89
  global_load_dwordx4 v[52:55], v113, s[26:27] offset:1024
  v_smfmac_f32_16x16x64_bf16 v[80:83], v[12:15], a[184:191], v112
  v_cvt_pk_bf16_f32 v73, v90, v91
  v_smfmac_f32_16x16x64_bf16 v[80:83], v[16:19], a[192:199], v112
  ds_write_b64 v116, v[72:73] offset:1280
  v_smfmac_f32_16x16x64_bf16 v[80:83], v[20:23], a[200:207], v112
  v_mov_b64 v[84:85], 0
  v_smfmac_f32_16x16x64_bf16 v[80:83], v[24:27], a[208:215], v112
  v_mov_b64 v[86:87], 0
  global_load_dwordx4 v[56:59], v113, s[26:27] offset:2048
  v_smfmac_f32_16x16x64_bf16 v[80:83], v[28:31], a[216:223], v112
  s_waitcnt lgkmcnt(1)
  v_mfma_f32_16x16x32_bf16 v[100:103], v[64:67], v[92:95], 0
  v_smfmac_f32_16x16x64_bf16 v[84:87], v[4:7], a[224:231], v112
  s_waitcnt vmcnt(5)
  v_mfma_f32_16x16x32_bf16 v[104:107], v[32:35], v[92:95], 0
  v_smfmac_f32_16x16x64_bf16 v[84:87], v[8:11], a[232:239], v112
  v_cvt_pk_bf16_f32 v74, v80, v81
  v_mfma_f32_16x16x32_bf16 v[108:111], v[36:39], v[92:95], 0
  v_smfmac_f32_16x16x64_bf16 v[84:87], v[12:15], a[240:247], v112
  v_cvt_pk_bf16_f32 v75, v82, v83
  global_load_dwordx4 v[60:63], v113, s[26:27] offset:3072
  v_smfmac_f32_16x16x64_bf16 v[84:87], v[16:19], a[248:255], v112
  ds_write_b64 v116, v[74:75] offset:1920
  v_smfmac_f32_16x16x64_bf16 v[84:87], v[20:23], v[120:127], v112
  v_mov_b64 v[88:89], 0
  v_smfmac_f32_16x16x64_bf16 v[84:87], v[24:27], v[128:135], v112
  v_mov_b64 v[90:91], 0
  ds_read_b64_tr_b16 v[96:97], v117 offset:1280
  ds_read_b64_tr_b16 v[98:99], v117 offset:1360
  v_smfmac_f32_16x16x64_bf16 v[84:87], v[28:31], v[136:143], v112
  ds_read_b64 v[68:69], v118 offset:512
  ds_read_b64 v[70:71], v118 offset:640
  v_smfmac_f32_16x16x64_bf16 v[88:91], v[4:7], v[144:151], v112
  v_smfmac_f32_16x16x64_bf16 v[88:91], v[8:11], v[152:159], v112
  v_cvt_pk_bf16_f32 v72, v84, v85
  v_smfmac_f32_16x16x64_bf16 v[88:91], v[12:15], v[160:167], v112
  v_cvt_pk_bf16_f32 v73, v86, v87
  v_smfmac_f32_16x16x64_bf16 v[88:91], v[16:19], v[168:175], v112
  ds_write_b64 v116, v[72:73] offset:2560
  v_smfmac_f32_16x16x64_bf16 v[88:91], v[20:23], v[176:183], v112
  v_mov_b64 v[80:81], 0
  v_smfmac_f32_16x16x64_bf16 v[88:91], v[24:27], v[184:191], v112
  v_mov_b64 v[82:83], 0
  ds_read_b64 v[64:65], v118 offset:1024
  ds_read_b64 v[66:67], v118 offset:1152
  v_smfmac_f32_16x16x64_bf16 v[88:91], v[28:31], v[192:199], v112
  s_waitcnt lgkmcnt(3)
  v_mfma_f32_16x16x32_bf16 v[100:103], v[68:71], v[96:99], v[100:103]
  v_smfmac_f32_16x16x64_bf16 v[80:83], v[4:7], v[200:207], v112
  s_waitcnt vmcnt(4)
  v_mfma_f32_16x16x32_bf16 v[104:107], v[40:43], v[96:99], v[104:107]
  v_smfmac_f32_16x16x64_bf16 v[80:83], v[8:11], v[208:215], v112
  v_cvt_pk_bf16_f32 v74, v88, v89
  v_mfma_f32_16x16x32_bf16 v[108:111], v[44:47], v[96:99], v[108:111]
  v_smfmac_f32_16x16x64_bf16 v[80:83], v[12:15], v[216:223], v112
  v_cvt_pk_bf16_f32 v75, v90, v91
  v_smfmac_f32_16x16x64_bf16 v[80:83], v[16:19], v[224:231], v112
  ds_write_b64 v116, v[74:75] offset:3200
  v_smfmac_f32_16x16x64_bf16 v[80:83], v[20:23], v[232:239], v112
  ds_read_b64_tr_b16 v[92:93], v117 offset:2560
  ds_read_b64_tr_b16 v[94:95], v117 offset:2640
  v_smfmac_f32_16x16x64_bf16 v[80:83], v[24:27], v[240:247], v112
  ds_read_b64 v[68:69], v118 offset:1536
  ds_read_b64 v[70:71], v118 offset:1664
  v_smfmac_f32_16x16x64_bf16 v[80:83], v[28:31], v[248:255], v112
  global_load_dwordx4 v[4:7], v113, s[66:67] offset:-4096
  global_load_dwordx4 v[8:11], v113, s[66:67] offset:-3072
  global_load_dwordx4 v[12:15], v113, s[66:67] offset:-2048
  global_load_dwordx4 v[16:19], v113, s[66:67] offset:-1024
  global_load_dwordx4 v[20:23], v113, s[66:67] offset:0
  global_load_dwordx4 v[24:27], v113, s[66:67] offset:1024
  global_load_dwordx4 v[28:31], v113, s[66:67] offset:2048
  s_add_u32 s66, s66, 28672
  s_addc_u32 s67, s67, 0
  s_waitcnt lgkmcnt(2)
  v_mfma_f32_16x16x32_bf16 v[100:103], v[64:67], v[92:95], v[100:103]
  s_waitcnt vmcnt(9)
  v_mfma_f32_16x16x32_bf16 v[104:107], v[48:51], v[92:95], v[104:107]
  v_cvt_pk_bf16_f32 v72, v80, v81
  v_cvt_pk_bf16_f32 v73, v82, v83
  ds_write_b64 v116, v[72:73] offset:3840
  ds_read_b64_tr_b16 v[96:97], v117 offset:3840
  ds_read_b64_tr_b16 v[98:99], v117 offset:3920
  v_mfma_f32_16x16x32_bf16 v[108:111], v[52:55], v[92:95], v[108:111]
  s_waitcnt lgkmcnt(0)
  v_mfma_f32_16x16x32_bf16 v[100:103], v[68:71], v[96:99], v[100:103]
  s_waitcnt vmcnt(7)
  v_mfma_f32_16x16x32_bf16 v[104:107], v[56:59], v[96:99], v[104:107]
  v_mfma_f32_16x16x32_bf16 v[108:111], v[60:63], v[96:99], v[108:111]
  s_nop 3
  v_add_f32_dpp v88, v100, v100 row_ror:8 row_mask:0xf bank_mask:0x3
  v_add_f32_dpp v88, v102, v102 row_ror:8 row_mask:0xf bank_mask:0xc
  v_add_f32_dpp v89, v101, v101 row_ror:8 row_mask:0xf bank_mask:0x3
  v_add_f32_dpp v89, v103, v103 row_ror:8 row_mask:0xf bank_mask:0xc
  ds_write_b64 v1, v[88:89]
  v_add_f32_dpp v84, v104, v104 row_ror:8 row_mask:0xf bank_mask:0x3
  v_add_f32_dpp v84, v106, v106 row_ror:8 row_mask:0xf bank_mask:0xc
  v_add_f32_dpp v85, v105, v105 row_ror:8 row_mask:0xf bank_mask:0x3
  v_add_f32_dpp v85, v107, v107 row_ror:8 row_mask:0xf bank_mask:0xc
  v_add_f32_dpp v86, v108, v108 row_ror:8 row_mask:0xf bank_mask:0x3
  v_add_f32_dpp v86, v110, v110 row_ror:8 row_mask:0xf bank_mask:0xc
  v_add_f32_dpp v87, v109, v109 row_ror:8 row_mask:0xf bank_mask:0x3
  v_add_f32_dpp v87, v111, v111 row_ror:8 row_mask:0xf bank_mask:0xc
  ds_write_b128 v119, v[84:87]
  v_mov_b32 v80, 0
  v_mov_b32 v81, 0
  v_mov_b32 v82, 0
  v_mov_b32 v83, 0
  s_waitcnt lgkmcnt(0)
  s_barrier
  s_add_u32 s26, s26, 32768
  s_addc_u32 s27, s27, 0
  s_cmp_ge_u32 s8, 2
  s_cbranch_scc1 L_A_nosm_188
  ds_read_b64 v[84:85], v2 offset:0
  ds_read_b64 v[86:87], v3 offset:0
  ds_read_b64 v[88:89], v2 offset:1664
  ds_read_b64 v[90:91], v3 offset:1664
  ds_read_b64 v[92:93], v2 offset:3328
  ds_read_b64 v[94:95], v3 offset:3328
  ds_read_b64 v[96:97], v2 offset:4992
  ds_read_b64 v[98:99], v3 offset:4992
  s_waitcnt lgkmcnt(4)
  v_pk_add_f32 v[84:85], v[84:85], v[88:89]
  v_pk_add_f32 v[86:87], v[86:87], v[90:91]
  s_waitcnt lgkmcnt(0)
  v_pk_add_f32 v[92:93], v[92:93], v[96:97]
  v_pk_add_f32 v[94:95], v[94:95], v[98:99]
  v_pk_add_f32 v[84:85], v[84:85], v[92:93]
  v_pk_add_f32 v[86:87], v[86:87], v[94:95]
  v_pk_add_f32 v[84:85], v[84:85], v[78:79]
  v_max3_f32 v88, v84, v85, v86
  v_max_f32 v88, v88, v87
  s_nop 1
  v_max_f32_dpp v88, v88, v88 row_ror:8 row_mask:0xf bank_mask:0xf
  s_nop 1
  v_max_f32_dpp v88, v88, v88 row_ror:4 row_mask:0xf bank_mask:0xf
  s_nop 1
  v_max_f32_dpp v88, v88, v88 row_ror:2 row_mask:0xf bank_mask:0xf
  s_nop 1
  v_max_f32_dpp v88, v88, v88 row_ror:1 row_mask:0xf bank_mask:0xf
  v_pk_add_f32 v[84:85], v[84:85], v[88:89] op_sel_hi:[1,0] neg_lo:[0,1] neg_hi:[0,1]
  v_pk_add_f32 v[86:87], v[86:87], v[88:89] op_sel_hi:[1,0] neg_lo:[0,1] neg_hi:[0,1]
  v_exp_f32 v84, v84
  v_exp_f32 v85, v85
  v_exp_f32 v86, v86
  v_exp_f32 v87, v87
  s_nop 0
  v_pk_add_f32 v[90:91], v[84:85], v[86:87]
  v_add_f32 v90, v90, v91
  s_nop 1
  v_add_f32_dpp v90, v90, v90 row_ror:8 row_mask:0xf bank_mask:0xf
  s_nop 1
  v_add_f32_dpp v90, v90, v90 row_ror:4 row_mask:0xf bank_mask:0xf
  s_nop 1
  v_add_f32_dpp v90, v90, v90 row_ror:2 row_mask:0xf bank_mask:0xf
  s_nop 1
  v_add_f32_dpp v90, v90, v90 row_ror:1 row_mask:0xf bank_mask:0xf
  v_rcp_f32 v90, v90
  s_nop 0
  v_pk_mul_f32 v[84:85], v[84:85], v[90:91] op_sel_hi:[1,0]
  v_pk_mul_f32 v[86:87], v[86:87], v[90:91] op_sel_hi:[1,0]
  v_cvt_pk_bf16_f32 v84, v84, v85
  v_cvt_pk_bf16_f32 v86, v86, v87
  global_store_dword v77, v84, s[22:23] sc1
  s_mov_b64 exec, s[62:63]
  global_store_dword v76, v86, s[24:25] sc1
  s_mov_b64 exec, -1
L_A_nosm_188:
  s_add_u32 s12, s12, 7168
  s_addc_u32 s13, s13, 0
  s_add_u32 s22, s22, 8192
  s_addc_u32 s23, s23, 0
  s_add_u32 s24, s24, 2048
  s_addc_u32 s25, s25, 0
  s_add_u32 s10, s10, 1
  s_cmp_lt_u32 s10, 64
  s_cbranch_scc1 L_A_loop_184
  s_branch L_done
L_qB_s:
  s_mov_b32 s11, 0
  v_mov_b32 v1, 1024
L_vxw_189:
  global_load_dword v2, v1, s[86:87] sc1
  s_waitcnt vmcnt(0)
  v_cmp_gt_u32 vcc, 84, v2
  s_cbranch_vccz L_vxg_190
  s_add_u32 s11, s11, 1
  s_cmp_gt_u32 s11, 262144
  s_cbranch_scc1 L_abort
  s_sleep 8
  s_branch L_vxw_189
L_vxg_190:
  s_cmp_lt_u32 s65, 2
  s_cbranch_scc1 L_stg_191
  s_add_u32 s16, s4, 48721920
  s_addc_u32 s17, s5, 0
  s_mov_b32 s11, 0
  v_mov_b32 v1, 0
L_stgp_192:
  global_load_dword v2, v1, s[16:17] sc1
  s_waitcnt vmcnt(0)
  v_cmp_eq_u32 vcc, -1, v2
  s_cbranch_vccz L_stg_191
  s_add_u32 s11, s11, 1
  s_cmp_gt_u32 s11, 262144
  s_cbranch_scc1 L_abort
  s_sleep 8
  s_branch L_stgp_192
L_stg_191:
  s_sub_u32 s43, s9, 16
  v_and_b32 v140, 63, v0
  v_lshlrev_b32 v133, 4, v140
  s_lshl_b32 s14, s8, 10
  v_add_u32 v134, s14, v133
  s_add_u32 s14, s8, 4
  s_min_u32 s14, s14, 6
  s_lshl_b32 s14, s14, 10
  v_add_u32 v135, s14, v133
  v_and_b32 v140, 8, v0
  v_cmp_eq_u32 vcc, 0, v140
  v_mov_b32 v132, 0xeeeeeeee
  v_mov_b32 v140, 0x44444444
  s_nop 1
  v_cndmask_b32 v132, v132, v140, vcc
  s_mul_i32 s14, s8, 1605632
  s_mul_i32 s15, s43, 28672
  s_add_u32 s14, s14, s15
  s_add_u32 s18, s4, 6422528
  s_addc_u32 s19, s5, 0
  s_add_u32 s18, s18, s14
  s_addc_u32 s19, s19, 0
  s_add_u32 s16, s18, 1204224
  s_addc_u32 s17, s19, 0
  s_mul_i32 s14, s8, 28672
  s_add_u32 s14, s14, 16384
  v_add_u32 v143, s14, v133
  s_add_u32 s15, s14, 0
  s_mov_b32 m0, s15
  s_nop 0
  global_load_lds_dwordx4 v133, s[16:17] offset:0
  global_load_lds_dwordx4 v133, s[16:17] offset:1024
  global_load_lds_dwordx4 v133, s[16:17] offset:2048
  global_load_lds_dwordx4 v133, s[16:17] offset:3072
  s_add_u32 s16, s16, 4096
  s_addc_u32 s17, s17, 0
  s_add_u32 s15, s14, 4096
  s_mov_b32 m0, s15
  s_nop 0
  global_load_lds_dwordx4 v133, s[16:17] offset:0
  global_load_lds_dwordx4 v133, s[16:17] offset:1024
  global_load_lds_dwordx4 v133, s[16:17] offset:2048
  global_load_lds_dwordx4 v133, s[16:17] offset:3072
  s_add_u32 s16, s16, 4096
  s_addc_u32 s17, s17, 0
  s_add_u32 s15, s14, 8192
  s_mov_b32 m0, s15
  s_nop 0
  global_load_lds_dwordx4 v133, s[16:17] offset:0
  global_load_lds_dwordx4 v133, s[16:17] offset:1024
  global_load_lds_dwordx4 v133, s[16:17] offset:2048
  global_load_lds_dwordx4 v133, s[16:17] offset:3072
  s_add_u32 s16, s16, 4096
  s_addc_u32 s17, s17, 0
  s_add_u32 s15, s14, 12288
  s_mov_b32 m0, s15
  s_nop 0
  global_load_lds_dwordx4 v133, s[16:17] offset:0
  global_load_lds_dwordx4 v133, s[16:17] offset:1024
  global_load_lds_dwordx4 v133, s[16:17] offset:2048
  global_load_lds_dwordx4 v133, s[16:17] offset:3072
  s_add_u32 s16, s16, 4096
  s_addc_u32 s17, s17, 0
  s_add_u32 s15, s14, 16384
  s_mov_b32 m0, s15
  s_nop 0
  global_load_lds_dwordx4 v133, s[16:17] offset:0
  global_load_lds_dwordx4 v133, s[16:17] offset:1024
  global_load_lds_dwordx4 v133, s[16:17] offset:2048
  global_load_lds_dwordx4 v133, s[16:17] offset:3072
  s_add_u32 s16, s16, 4096
  s_addc_u32 s17, s17, 0
  s_add_u32 s15, s14, 20480
  s_mov_b32 m0, s15
  s_nop 0
  global_load_lds_dwordx4 v133, s[16:17] offset:0
  global_load_lds_dwordx4 v133, s[16:17] offset:1024
  global_load_lds_dwordx4 v133, s[16:17] offset:2048
  global_load_lds_dwordx4 v133, s[16:17] offset:3072
  s_add_u32 s16, s16, 4096
  s_addc_u32 s17, s17, 0
  s_add_u32 s15, s14, 24576
  s_mov_b32 m0, s15
  s_nop 0
  global_load_lds_dwordx4 v133, s[16:17] offset:0
  global_load_lds_dwordx4 v133, s[16:17] offset:1024
  global_load_lds_dwordx4 v133, s[16:17] offset:2048
  global_load_lds_dwordx4 v133, s[16:17] offset:3072
  s_add_u32 s16, s16, 4096
  s_addc_u32 s17, s17, 0
  s_add_u32 s16, s18, 0
  s_addc_u32 s17, s19, 0
  global_load_dwordx4 a[0:3], v133, s[16:17] offset:0
  global_load_dwordx4 a[4:7], v133, s[16:17] offset:1024
  global_load_dwordx4 a[8:11], v133, s[16:17] offset:2048
  global_load_dwordx4 a[12:15], v133, s[16:17] offset:3072
  s_add_u32 s16, s16, 4096
  s_addc_u32 s17, s17, 0
  global_load_dwordx4 a[16:19], v133, s[16:17] offset:0
  global_load_dwordx4 a[20:23], v133, s[16:17] offset:1024
  global_load_dwordx4 a[24:27], v133, s[16:17] offset:2048
  global_load_dwordx4 a[28:31], v133, s[16:17] offset:3072
  s_add_u32 s16, s16, 4096
  s_addc_u32 s17, s17, 0
  global_load_dwordx4 a[32:35], v133, s[16:17] offset:0
  global_load_dwordx4 a[36:39], v133, s[16:17] offset:1024
  global_load_dwordx4 a[40:43], v133, s[16:17] offset:2048
  global_load_dwordx4 a[44:47], v133, s[16:17] offset:3072
  s_add_u32 s16, s16, 4096
  s_addc_u32 s17, s17, 0
  global_load_dwordx4 a[48:51], v133, s[16:17] offset:0
  global_load_dwordx4 a[52:55], v133, s[16:17] offset:1024
  global_load_dwordx4 a[56:59], v133, s[16:17] offset:2048
  global_load_dwordx4 a[60:63], v133, s[16:17] offset:3072
  s_add_u32 s16, s16, 4096
  s_addc_u32 s17, s17, 0
  global_load_dwordx4 a[64:67], v133, s[16:17] offset:0
  global_load_dwordx4 a[68:71], v133, s[16:17] offset:1024
  global_load_dwordx4 a[72:75], v133, s[16:17] offset:2048
  global_load_dwordx4 a[76:79], v133, s[16:17] offset:3072
  s_add_u32 s16, s16, 4096
  s_addc_u32 s17, s17, 0
  global_load_dwordx4 a[80:83], v133, s[16:17] offset:0
  global_load_dwordx4 a[84:87], v133, s[16:17] offset:1024
  global_load_dwordx4 a[88:91], v133, s[16:17] offset:2048
  global_load_dwordx4 a[92:95], v133, s[16:17] offset:3072
  s_add_u32 s16, s16, 4096
  s_addc_u32 s17, s17, 0
  global_load_dwordx4 a[96:99], v133, s[16:17] offset:0
  global_load_dwordx4 a[100:103], v133, s[16:17] offset:1024
  global_load_dwordx4 a[104:107], v133, s[16:17] offset:2048
  global_load_dwordx4 a[108:111], v133, s[16:17] offset:3072
  s_add_u32 s16, s16, 4096
  s_addc_u32 s17, s17, 0
  s_add_u32 s16, s18, 401408
  s_addc_u32 s17, s19, 0
  global_load_dwordx4 a[112:115], v133, s[16:17] offset:0
  global_load_dwordx4 a[116:119], v133, s[16:17] offset:1024
  global_load_dwordx4 a[120:123], v133, s[16:17] offset:2048
  global_load_dwordx4 a[124:127], v133, s[16:17] offset:3072
  s_add_u32 s16, s16, 4096
  s_addc_u32 s17, s17, 0
  global_load_dwordx4 a[128:131], v133, s[16:17] offset:0
  global_load_dwordx4 a[132:135], v133, s[16:17] offset:1024
  global_load_dwordx4 a[136:139], v133, s[16:17] offset:2048
  global_load_dwordx4 a[140:143], v133, s[16:17] offset:3072
  s_add_u32 s16, s16, 4096
  s_addc_u32 s17, s17, 0
  global_load_dwordx4 a[144:147], v133, s[16:17] offset:0
  global_load_dwordx4 a[148:151], v133, s[16:17] offset:1024
  global_load_dwordx4 a[152:155], v133, s[16:17] offset:2048
  global_load_dwordx4 a[156:159], v133, s[16:17] offset:3072
  s_add_u32 s16, s16, 4096
  s_addc_u32 s17, s17, 0
  global_load_dwordx4 a[160:163], v133, s[16:17] offset:0
  global_load_dwordx4 a[164:167], v133, s[16:17] offset:1024
  global_load_dwordx4 a[168:171], v133, s[16:17] offset:2048
  global_load_dwordx4 a[172:175], v133, s[16:17] offset:3072
  s_add_u32 s16, s16, 4096
  s_addc_u32 s17, s17, 0
  global_load_dwordx4 a[176:179], v133, s[16:17] offset:0
  global_load_dwordx4 a[180:183], v133, s[16:17] offset:1024
  global_load_dwordx4 a[184:187], v133, s[16:17] offset:2048
  global_load_dwordx4 a[188:191], v133, s[16:17] offset:3072
  s_add_u32 s16, s16, 4096
  s_addc_u32 s17, s17, 0
  global_load_dwordx4 a[192:195], v133, s[16:17] offset:0
  global_load_dwordx4 a[196:199], v133, s[16:17] offset:1024
  global_load_dwordx4 a[200:203], v133, s[16:17] offset:2048
  global_load_dwordx4 a[204:207], v133, s[16:17] offset:3072
  s_add_u32 s16, s16, 4096
  s_addc_u32 s17, s17, 0
  global_load_dwordx4 a[208:211], v133, s[16:17] offset:0
  global_load_dwordx4 a[212:215], v133, s[16:17] offset:1024
  global_load_dwordx4 a[216:219], v133, s[16:17] offset:2048
  global_load_dwordx4 a[220:223], v133, s[16:17] offset:3072
  s_add_u32 s16, s16, 4096
  s_addc_u32 s17, s17, 0
  s_add_u32 s16, s18, 802816
  s_addc_u32 s17, s19, 0
  global_load_dwordx4 a[224:227], v133, s[16:17] offset:0
  global_load_dwordx4 a[228:231], v133, s[16:17] offset:1024
  global_load_dwordx4 a[232:235], v133, s[16:17] offset:2048
  global_load_dwordx4 a[236:239], v133, s[16:17] offset:3072
  s_add_u32 s16, s16, 4096
  s_addc_u32 s17, s17, 0
  global_load_dwordx4 a[240:243], v133, s[16:17] offset:0
  global_load_dwordx4 a[244:247], v133, s[16:17] offset:1024
  global_load_dwordx4 a[248:251], v133, s[16:17] offset:2048
  global_load_dwordx4 a[252:255], v133, s[16:17] offset:3072
  s_add_u32 s16, s16, 4096
  s_addc_u32 s17, s17, 0
  global_load_dwordx4 v[176:179], v133, s[16:17] offset:0
  global_load_dwordx4 v[180:183], v133, s[16:17] offset:1024
  global_load_dwordx4 v[184:187], v133, s[16:17] offset:2048
  global_load_dwordx4 v[188:191], v133, s[16:17] offset:3072
  s_add_u32 s16, s16, 4096
  s_addc_u32 s17, s17, 0
  global_load_dwordx4 v[192:195], v133, s[16:17] offset:0
  global_load_dwordx4 v[196:199], v133, s[16:17] offset:1024
  global_load_dwordx4 v[200:203], v133, s[16:17] offset:2048
  global_load_dwordx4 v[204:207], v133, s[16:17] offset:3072
  s_add_u32 s16, s16, 4096
  s_addc_u32 s17, s17, 0
  global_load_dwordx4 v[208:211], v133, s[16:17] offset:0
  global_load_dwordx4 v[212:215], v133, s[16:17] offset:1024
  global_load_dwordx4 v[216:219], v133, s[16:17] offset:2048
  global_load_dwordx4 v[220:223], v133, s[16:17] offset:3072
  s_add_u32 s16, s16, 4096
  s_addc_u32 s17, s17, 0
  global_load_dwordx4 v[224:227], v133, s[16:17] offset:0
  global_load_dwordx4 v[228:231], v133, s[16:17] offset:1024
  global_load_dwordx4 v[232:235], v133, s[16:17] offset:2048
  global_load_dwordx4 v[236:239], v133, s[16:17] offset:3072
  s_add_u32 s16, s16, 4096
  s_addc_u32 s17, s17, 0
  global_load_dwordx4 v[240:243], v133, s[16:17] offset:0
  global_load_dwordx4 v[244:247], v133, s[16:17] offset:1024
  global_load_dwordx4 v[248:251], v133, s[16:17] offset:2048
  global_load_dwordx4 v[252:255], v133, s[16:17] offset:3072
  s_add_u32 s16, s16, 4096
  s_addc_u32 s17, s17, 0
  v_and_b32 v140, 15, v0
  v_bfe_u32 v141, v0, 4, 2
  v_bfe_u32 v142, v0, 5, 1
  v_lshlrev_b32 v136, 8, v142
  v_bfe_u32 v142, v0, 3, 1
  v_lshl_add_u32 v136, v142, 7, v136
  v_and_b32 v142, 7, v0
  v_lshl_add_u32 v136, v142, 4, v136
  s_lshl_b32 s14, s8, 9
  v_add_u32 v136, s14, v136
  v_and_b32 v142, 1, v141
  v_mul_u32_u24 v137, 576, v142
  v_lshrrev_b32 v142, 1, v141
  v_mul_u32_u24 v142, 144, v142
  v_add_u32 v137, v137, v142
  s_mul_i32 s14, s8, 1152
  v_add_u32 v137, s14, v137
  v_bfe_u32 v142, v0, 1, 1
  v_lshl_add_u32 v137, v142, 5, v137
  v_bfe_u32 v142, v0, 3, 1
  v_lshl_add_u32 v137, v142, 4, v137
  v_bfe_u32 v142, v0, 2, 1
  v_lshl_add_u32 v137, v142, 3, v137
  v_and_b32 v142, 1, v0
  v_lshl_add_u32 v137, v142, 2, v137
  v_add_u32 v137, 8192, v137
  v_and_b32 v140, 31, v0
  s_lshl_b32 s14, s8, 5
  v_add_u32 v140, s14, v140
  v_bfe_u32 v142, v140, 2, 3
  v_mul_u32_u24 v139, 896, v142
  v_bfe_u32 v142, v140, 6, 1
  v_lshl_add_u32 v139, v142, 5, v139
  v_and_b32 v142, 3, v140
  v_lshl_add_u32 v139, v142, 3, v139
  v_bfe_u32 v142, v140, 5, 1
  v_lshl_add_u32 v139, v142, 2, v139
  v_bfe_u32 v142, v140, 2, 3
  v_mul_u32_u24 v138, 144, v142
  v_bfe_u32 v142, v140, 5, 2
  v_lshl_add_u32 v138, v142, 5, v138
  v_and_b32 v142, 3, v140
  v_lshl_add_u32 v138, v142, 3, v138
  v_add_u32 v138, 8192, v138
  s_mov_b32 s10, 0
  s_add_u32 s12, s4, 49807360
  s_addc_u32 s13, s5, 0
  s_mul_i32 s14, s65, 458752
  s_add_u32 s12, s12, s14
  s_addc_u32 s13, s13, 0
  s_lshr_b32 s14, s43, 1
  s_lshl_b32 s14, s14, 10
  s_and_b32 s15, s43, 1
  s_lshl_b32 s15, s15, 9
  s_add_u32 s14, s14, s15
  s_lshl_b32 s14, s43, 6
  s_mul_i32 s15, s65, 458752
  s_add_u32 s14, s14, s15
  s_add_u32 s28, s4, 54263808
  s_addc_u32 s29, s5, 0
  s_add_u32 s28, s28, s14
  s_addc_u32 s29, s29, 0
  s_lshl_b32 s14, s8, 11
  s_add_u32 s22, s4, 51642368
  s_addc_u32 s23, s5, 0
  s_add_u32 s22, s22, s14
  s_addc_u32 s23, s23, 0
  s_add_u32 s24, s4, 53739520
  s_addc_u32 s25, s5, 0
  s_lshl_b32 s14, s65, 19
  s_add_u32 s22, s22, s14
  s_addc_u32 s23, s23, 0
  s_lshl_b32 s14, s65, 17
  s_add_u32 s24, s24, s14
  s_addc_u32 s25, s25, 0
  s_mul_i32 s14, s8, 114688
  s_lshl_b32 s15, s43, 11
  s_add_u32 s14, s14, s15
  s_add_u32 s30, s4, 12845056
  s_addc_u32 s31, s5, 0
  s_add_u32 s30, s30, s14
  s_addc_u32 s31, s31, 0
  s_add_u32 s32, s30, 28672
  s_addc_u32 s33, s31, 0
  s_add_u32 s34, s30, 57344
  s_addc_u32 s35, s31, 0
  s_add_u32 s36, s30, 86016
  s_addc_u32 s37, s31, 0
  s_waitcnt vmcnt(0) lgkmcnt(0)
  s_mov_b32 s11, 0
  v_mov_b32 v1, 1024
L_vxw_193:
  global_load_dword v2, v1, s[86:87] sc1
  s_waitcnt vmcnt(0)
  v_cmp_gt_u32 vcc, 84, v2
  s_cbranch_vccz L_vxg_194
  s_add_u32 s11, s11, 1
  s_cmp_gt_u32 s11, 262144
  s_cbranch_scc1 L_abort
  s_sleep 8
  s_branch L_vxw_193
L_vxg_194:
  s_cmp_lt_u32 s65, 2
  s_cbranch_scc1 L_stg_195
  s_add_u32 s16, s4, 48721920
  s_addc_u32 s17, s5, 0
  s_mov_b32 s11, 0
  v_mov_b32 v1, 0
L_stgp_196:
  global_load_dword v2, v1, s[16:17] sc1
  s_waitcnt vmcnt(0)
  v_cmp_eq_u32 vcc, -1, v2
  s_cbranch_vccz L_stg_195
  s_add_u32 s11, s11, 1
  s_cmp_gt_u32 s11, 262144
  s_cbranch_scc1 L_abort
  s_sleep 8
  s_branch L_stgp_196
L_stg_195:
  s_barrier
  global_load_dwordx4 v[144:147], v134, s[12:13] sc1
  global_load_dwordx4 v[148:151], v135, s[12:13] sc1
  s_waitcnt vmcnt(0)
L_B_loop_197:
  v_max3_u32 v44, v144, v145, v146
  v_max3_u32 v44, v44, v147, v148
  v_max3_u32 v44, v44, v149, v150
  v_max_u32 v44, v44, v151
  v_cmp_eq_u32 vcc, -1, v44
  s_cbranch_vccnz L_B_reg_198
  ds_write_b128 v134, v[144:147]
  ds_write_b128 v135, v[148:151]
  s_waitcnt lgkmcnt(0)
  s_barrier
  s_branch L_B_st_199
L_B_reg_198:
  s_mov_b32 s11, 0
L_B_pa_200:
  global_load_dwordx4 v[36:39], v134, s[12:13] sc1
  global_load_dwordx4 v[40:43], v135, s[12:13] sc1
  s_waitcnt vmcnt(0)
  v_max3_u32 v44, v36, v37, v38
  v_max3_u32 v44, v44, v39, v40
  v_max3_u32 v44, v44, v41, v42
  v_max_u32 v44, v44, v43
  v_cmp_eq_u32 vcc, -1, v44
  s_cbranch_vccz L_B_ga_201
  s_add_u32 s11, s11, 1
  s_cmp_gt_u32 s11, 262144
  s_cbranch_scc1 L_abort
  s_branch L_B_pa_200
L_B_ga_201:
  ds_write_b128 v134, v[36:39]
  ds_write_b128 v135, v[40:43]
  s_waitcnt lgkmcnt(0)
  s_barrier
L_B_st_199:
  ds_read_b128 v[4:7], v133 offset:0
  ds_read_b128 v[8:11], v133 offset:1024
  ds_read_b128 v[12:15], v133 offset:2048
  ds_read_b128 v[16:19], v133 offset:3072
  ds_read_b128 v[20:23], v133 offset:4096
  ds_read_b128 v[24:27], v133 offset:5120
  ds_read_b128 v[28:31], v133 offset:6144
  s_waitcnt vmcnt(0)
  s_cmp_lg_u32 s10, 3
  s_cbranch_scc1 L_n8_204
  v_cmp_gt_u32 vcc, 84, v164
  s_cbranch_vccz L_n8_204
  s_mov_b32 s11, 0
  v_mov_b32 v1, 1152
L_vxw_205:
  global_load_dword v2, v1, s[86:87] sc1
  s_waitcnt vmcnt(0)
  v_cmp_gt_u32 vcc, 84, v2
  s_cbranch_vccz L_vxg_206
  s_add_u32 s11, s11, 1
  s_cmp_gt_u32 s11, 262144
  s_cbranch_scc1 L_abort
  s_sleep 8
  s_branch L_vxw_205
L_vxg_206:
L_n8_204:
  s_cmp_lg_u32 s10, 15
  s_cbranch_scc1 L_n8_207
  v_cmp_gt_u32 vcc, 84, v164
  s_cbranch_vccz L_n8_207
  s_mov_b32 s11, 0
  v_mov_b32 v1, 1280
L_vxw_208:
  global_load_dword v2, v1, s[86:87] sc1
  s_waitcnt vmcnt(0)
  v_cmp_gt_u32 vcc, 84, v2
  s_cbranch_vccz L_vxg_209
  s_add_u32 s11, s11, 1
  s_cmp_gt_u32 s11, 262144
  s_cbranch_scc1 L_abort
  s_sleep 8
  s_branch L_vxw_208
L_vxg_209:
L_n8_207:
  s_cmp_lg_u32 s10, 2
  s_cbranch_scc1 L_n9_210
  v_mov_b32 v164, 1152
  global_load_dword v164, v164, s[86:87] sc1
L_n9_210:
  s_cmp_lg_u32 s10, 14
  s_cbranch_scc1 L_n9_211
  v_mov_b32 v164, 1280
  global_load_dword v164, v164, s[86:87] sc1
L_n9_211:
  v_mov_b64 v[32:33], 0
  v_mov_b64 v[34:35], 0
  v_mov_b64 v[156:157], 0
  v_mov_b64 v[158:159], 0
  v_mov_b64 v[160:161], 0
  v_mov_b64 v[162:163], 0
  ds_read_b128 v[116:119], v143 offset:0
  ds_read_b128 v[120:123], v143 offset:1024
  ds_read_b128 v[124:127], v143 offset:2048
  ds_read_b128 v[128:131], v143 offset:3072
  s_waitcnt lgkmcnt(10)
  v_smfmac_f32_16x16x64_bf16 v[32:35], v[4:7], a[0:7], v132
  s_waitcnt lgkmcnt(9)
  v_smfmac_f32_16x16x64_bf16 v[32:35], v[8:11], a[8:15], v132
  global_load_dwordx4 v[64:67], v133, s[30:31] offset:0
  s_waitcnt lgkmcnt(8)
  v_smfmac_f32_16x16x64_bf16 v[32:35], v[12:15], a[16:23], v132
  s_waitcnt lgkmcnt(2)
  v_smfmac_f32_16x16x64_bf16 v[156:159], v[4:7], v[116:123], v132
  ds_read_b128 v[116:119], v143 offset:4096
  ds_read_b128 v[120:123], v143 offset:5120
  v_mov_b64 v[36:37], 0
  v_smfmac_f32_16x16x64_bf16 v[32:35], v[16:19], a[24:31], v132
  v_mov_b64 v[38:39], 0
  v_smfmac_f32_16x16x64_bf16 v[32:35], v[20:23], a[32:39], v132
  global_load_dwordx4 v[68:71], v133, s[32:33] offset:0
  v_smfmac_f32_16x16x64_bf16 v[32:35], v[24:27], a[40:47], v132
  s_waitcnt lgkmcnt(2)
  v_smfmac_f32_16x16x64_bf16 v[156:159], v[8:11], v[124:131], v132
  ds_read_b128 v[124:127], v143 offset:6144
  ds_read_b128 v[128:131], v143 offset:7168
  v_smfmac_f32_16x16x64_bf16 v[32:35], v[28:31], a[48:55], v132
  v_smfmac_f32_16x16x64_bf16 v[36:39], v[4:7], a[56:63], v132
  global_load_dwordx4 v[72:75], v133, s[34:35] offset:0
  v_smfmac_f32_16x16x64_bf16 v[36:39], v[8:11], a[64:71], v132
  s_waitcnt lgkmcnt(2)
  v_smfmac_f32_16x16x64_bf16 v[156:159], v[12:15], v[116:123], v132
  ds_read_b128 v[116:119], v143 offset:8192
  ds_read_b128 v[120:123], v143 offset:9216
  v_cvt_pk_bf16_f32 v48, v32, v33
  v_smfmac_f32_16x16x64_bf16 v[36:39], v[12:15], a[72:79], v132
  v_cvt_pk_bf16_f32 v50, v34, v35
  v_smfmac_f32_16x16x64_bf16 v[36:39], v[16:19], a[80:87], v132
  global_load_dwordx4 v[76:79], v133, s[36:37] offset:0
  v_mov_b64 v[40:41], 0
  v_smfmac_f32_16x16x64_bf16 v[36:39], v[20:23], a[88:95], v132
  v_mov_b64 v[42:43], 0
  s_waitcnt lgkmcnt(2)
  v_smfmac_f32_16x16x64_bf16 v[156:159], v[16:19], v[124:131], v132
  ds_read_b128 v[124:127], v143 offset:10240
  ds_read_b128 v[128:131], v143 offset:11264
  v_smfmac_f32_16x16x64_bf16 v[36:39], v[24:27], a[96:103], v132
  v_smfmac_f32_16x16x64_bf16 v[36:39], v[28:31], a[104:111], v132
  global_load_dwordx4 v[80:83], v133, s[30:31] offset:1024
  v_smfmac_f32_16x16x64_bf16 v[40:43], v[4:7], a[112:119], v132
  s_waitcnt lgkmcnt(2)
  v_smfmac_f32_16x16x64_bf16 v[156:159], v[20:23], v[116:123], v132
  ds_read_b128 v[116:119], v143 offset:12288
  ds_read_b128 v[120:123], v143 offset:13312
  v_smfmac_f32_16x16x64_bf16 v[40:43], v[8:11], a[120:127], v132
  v_cvt_pk_bf16_f32 v56, v36, v37
  v_smfmac_f32_16x16x64_bf16 v[40:43], v[12:15], a[128:135], v132
  global_load_dwordx4 v[84:87], v133, s[32:33] offset:1024
  v_cvt_pk_bf16_f32 v58, v38, v39
  v_smfmac_f32_16x16x64_bf16 v[40:43], v[16:19], a[136:143], v132
  v_mov_b64 v[32:33], 0
  s_waitcnt lgkmcnt(2)
  v_smfmac_f32_16x16x64_bf16 v[156:159], v[24:27], v[124:131], v132
  ds_read_b128 v[124:127], v143 offset:14336
  ds_read_b128 v[128:131], v143 offset:15360
  v_mov_b64 v[34:35], 0
  v_smfmac_f32_16x16x64_bf16 v[40:43], v[20:23], a[144:151], v132
  v_smfmac_f32_16x16x64_bf16 v[40:43], v[24:27], a[152:159], v132
  global_load_dwordx4 v[88:91], v133, s[34:35] offset:1024
  v_smfmac_f32_16x16x64_bf16 v[40:43], v[28:31], a[160:167], v132
  s_waitcnt lgkmcnt(2)
  v_smfmac_f32_16x16x64_bf16 v[156:159], v[28:31], v[116:123], v132
  ds_read_b128 v[116:119], v143 offset:16384
  ds_read_b128 v[120:123], v143 offset:17408
  v_smfmac_f32_16x16x64_bf16 v[32:35], v[4:7], a[168:175], v132
  v_smfmac_f32_16x16x64_bf16 v[32:35], v[8:11], a[176:183], v132
  global_load_dwordx4 v[92:95], v133, s[36:37] offset:1024
  v_cvt_pk_bf16_f32 v49, v40, v41
  v_smfmac_f32_16x16x64_bf16 v[32:35], v[12:15], a[184:191], v132
  v_cvt_pk_bf16_f32 v51, v42, v43
  s_waitcnt lgkmcnt(2)
  v_smfmac_f32_16x16x64_bf16 v[160:163], v[4:7], v[124:131], v132
  ds_read_b128 v[124:127], v143 offset:18432
  ds_read_b128 v[128:131], v143 offset:19456
  v_cvt_pk_bf16_f32 v53, v156, v157
  v_smfmac_f32_16x16x64_bf16 v[32:35], v[16:19], a[192:199], v132
  v_cvt_pk_bf16_f32 v55, v158, v159
  v_smfmac_f32_16x16x64_bf16 v[32:35], v[20:23], a[200:207], v132
  v_mov_b64 v[36:37], 0
  v_smfmac_f32_16x16x64_bf16 v[32:35], v[24:27], a[208:215], v132
  v_mov_b64 v[38:39], 0
  s_waitcnt lgkmcnt(2)
  v_smfmac_f32_16x16x64_bf16 v[160:163], v[8:11], v[116:123], v132
  ds_read_b128 v[116:119], v143 offset:20480
  ds_read_b128 v[120:123], v143 offset:21504
  v_smfmac_f32_16x16x64_bf16 v[32:35], v[28:31], a[216:223], v132
  v_smfmac_f32_16x16x64_bf16 v[36:39], v[4:7], a[224:231], v132
  v_smfmac_f32_16x16x64_bf16 v[36:39], v[8:11], a[232:239], v132
  s_waitcnt lgkmcnt(2)
  v_smfmac_f32_16x16x64_bf16 v[160:163], v[12:15], v[124:131], v132
  ds_read_b128 v[124:127], v143 offset:22528
  ds_read_b128 v[128:131], v143 offset:23552
  v_cvt_pk_bf16_f32 v57, v32, v33
  v_smfmac_f32_16x16x64_bf16 v[36:39], v[12:15], a[240:247], v132
  v_cvt_pk_bf16_f32 v59, v34, v35
  v_smfmac_f32_16x16x64_bf16 v[36:39], v[16:19], a[248:255], v132
  v_mov_b64 v[40:41], 0
  v_smfmac_f32_16x16x64_bf16 v[36:39], v[20:23], v[176:183], v132
  v_mov_b64 v[42:43], 0
  s_waitcnt lgkmcnt(2)
  v_smfmac_f32_16x16x64_bf16 v[160:163], v[16:19], v[116:123], v132
  ds_read_b128 v[116:119], v143 offset:24576
  ds_read_b128 v[120:123], v143 offset:25600
  v_smfmac_f32_16x16x64_bf16 v[36:39], v[24:27], v[184:191], v132
  v_smfmac_f32_16x16x64_bf16 v[36:39], v[28:31], v[192:199], v132
  v_smfmac_f32_16x16x64_bf16 v[40:43], v[4:7], v[200:207], v132
  s_waitcnt lgkmcnt(2)
  v_smfmac_f32_16x16x64_bf16 v[160:163], v[20:23], v[124:131], v132
  ds_read_b128 v[124:127], v143 offset:26624
  ds_read_b128 v[128:131], v143 offset:27648
  v_smfmac_f32_16x16x64_bf16 v[40:43], v[8:11], v[208:215], v132
  v_cvt_pk_bf16_f32 v52, v36, v37
  v_smfmac_f32_16x16x64_bf16 v[40:43], v[12:15], v[216:223], v132
  v_cvt_pk_bf16_f32 v54, v38, v39
  v_smfmac_f32_16x16x64_bf16 v[40:43], v[16:19], v[224:231], v132
  s_waitcnt lgkmcnt(2)
  v_smfmac_f32_16x16x64_bf16 v[160:163], v[24:27], v[116:123], v132
  v_smfmac_f32_16x16x64_bf16 v[40:43], v[20:23], v[232:239], v132
  v_smfmac_f32_16x16x64_bf16 v[40:43], v[24:27], v[240:247], v132
  v_smfmac_f32_16x16x64_bf16 v[40:43], v[28:31], v[248:255], v132
  s_waitcnt lgkmcnt(0)
  v_smfmac_f32_16x16x64_bf16 v[160:163], v[28:31], v[124:131], v132
  s_nop 7
  v_cvt_pk_bf16_f32 v60, v40, v41
  v_cvt_pk_bf16_f32 v62, v42, v43
  v_cvt_pk_bf16_f32 v61, v160, v161
  v_cvt_pk_bf16_f32 v63, v162, v163
  s_add_u32 s30, s30, 458752
  s_addc_u32 s31, s31, 0
  s_add_u32 s32, s32, 458752
  s_addc_u32 s33, s33, 0
  s_add_u32 s34, s34, 458752
  s_addc_u32 s35, s35, 0
  s_add_u32 s36, s36, 458752
  s_addc_u32 s37, s37, 0
  v_mov_b32 v108, 0
  v_mov_b32 v109, 0
  v_mov_b32 v110, 0
  v_mov_b32 v111, 0
  v_mov_b32 v112, 0
  v_mov_b32 v113, 0
  v_mov_b32 v114, 0
  v_mov_b32 v115, 0
  s_add_u32 s14, s12, 7168
  s_addc_u32 s15, s13, 0
  global_load_dwordx4 v[144:147], v134, s[14:15] sc1
  global_load_dwordx4 v[148:151], v135, s[14:15] sc1
  s_mov_b32 s11, 0
L_Bp_pa_212:
  global_load_dwordx4 v[96:99], v133, s[22:23] sc1
  global_load_dwordx4 v[100:103], v133, s[22:23] offset:1024 sc1
  global_load_dwordx4 v[104:107], v136, s[24:25] sc1
  s_waitcnt vmcnt(0)
  v_max3_u32 v140, v96, v97, v98
  v_max3_u32 v140, v140, v99, v100
  v_max3_u32 v140, v140, v101, v102
  v_max3_u32 v140, v140, v103, v104
  v_max3_u32 v140, v140, v105, v106
  v_max_u32 v140, v140, v107
  v_cmp_eq_u32 vcc, -1, v140
  s_cbranch_vccz L_Bp_ga_213
  s_add_u32 s11, s11, 1
  s_cmp_gt_u32 s11, 262144
  s_cbranch_scc1 L_abort
  s_branch L_Bp_pa_212
L_Bp_ga_213:
  v_smfmac_f32_16x16x64_bf16 v[108:111], v[104:107], v[48:55], v132
  v_smfmac_f32_16x16x64_bf16 v[108:111], v[96:99], v[64:71], v132
  v_smfmac_f32_16x16x64_bf16 v[108:111], v[100:103], v[72:79], v132
  v_smfmac_f32_16x16x64_bf16 v[112:115], v[104:107], v[56:63], v132
  v_smfmac_f32_16x16x64_bf16 v[112:115], v[96:99], v[80:87], v132
  v_smfmac_f32_16x16x64_bf16 v[112:115], v[100:103], v[88:95], v132
  v_permlane32_swap_b32 v108, v109
  v_permlane32_swap_b32 v110, v111
  v_add_f32 v108, v108, v109
  v_add_f32 v110, v110, v111
  ds_write_b32 v137, v108 offset:0
  ds_write_b32 v137, v110 offset:288
  s_nop 0
  v_permlane32_swap_b32 v112, v113
  v_permlane32_swap_b32 v114, v115
  v_add_f32 v112, v112, v113
  v_add_f32 v114, v114, v115
  ds_write_b32 v137, v112 offset:64
  ds_write_b32 v137, v114 offset:352
  s_waitcnt lgkmcnt(0)
  s_barrier
  ds_read_b64 v[32:33], v138 offset:0
  ds_read_b64 v[34:35], v138 offset:1152
  ds_read_b64 v[36:37], v138 offset:2304
  ds_read_b64 v[38:39], v138 offset:3456
  s_waitcnt lgkmcnt(2)
  v_pk_add_f32 v[32:33], v[32:33], v[34:35]
  s_waitcnt lgkmcnt(0)
  v_pk_add_f32 v[36:37], v[36:37], v[38:39]
  v_pk_add_f32 v[32:33], v[32:33], v[36:37]
  v_cvt_pk_bf16_f32 v32, v32, v33
  v_min_u32 v32, -2, v32
  global_store_dword v139, v32, s[28:29] sc1
  s_add_u32 s12, s12, 7168
  s_addc_u32 s13, s13, 0
  s_add_u32 s28, s28, 7168
  s_addc_u32 s29, s29, 0
  s_add_u32 s22, s22, 8192
  s_addc_u32 s23, s23, 0
  s_add_u32 s24, s24, 2048
  s_addc_u32 s25, s25, 0
  s_add_u32 s10, s10, 1
  s_cmp_lt_u32 s10, 64
  s_cbranch_scc1 L_B_loop_197
  s_branch L_done
L_qL_s:
  v_and_b32 v9, 31, v0
  v_min_u32 v9, 27, v9
  v_bfe_u32 v10, v0, 5, 1
  s_lshl_b32 s14, s8, 1
  v_add_u32 v10, s14, v10
  v_mul_u32_u24 v2, 896, v10
  v_lshl_add_u32 v2, v9, 4, v2
  v_mul_u32_u24 v3, 912, v10
  v_lshl_add_u32 v3, v9, 4, v3
  v_and_b32 v9, 31, v0
  v_cmp_gt_u32 s[62:63], 28, v9
  v_bfe_u32 v9, v0, 2, 2
  v_mul_u32_u24 v4, 912, v9
  v_and_b32 v9, 3, v0
  v_lshl_add_u32 v4, v9, 3, v4
  v_bfe_u32 v9, v0, 4, 2
  s_mul_i32 s14, s8, 7
  v_add_u32 v10, s14, v9
  v_lshl_add_u32 v4, v10, 5, v4
  v_lshlrev_b32 v5, 10, v10
  v_and_b32 v10, 15, v0
  v_lshl_add_u32 v5, v10, 4, v5
  s_lshl_b32 s14, s65, 8
  v_add_u32 v5, s14, v5
  v_cmp_eq_u32 vcc, 3, v9
  v_mov_b32 v8, 4
  v_mov_b32 v10, 3
  s_nop 0
  v_cndmask_b32 v8, v8, v10, vcc
  v_lshl_add_u32 v11, v8, 5, v4
  v_lshl_add_u32 v1, v8, 10, v5
  s_mul_i32 s14, s65, 458752
  s_add_u32 s12, s4, 54263808
  s_addc_u32 s13, s5, 0
  s_add_u32 s12, s12, s14
  s_addc_u32 s13, s13, 0
  s_mul_i32 s14, s65, 7168
  s_add_u32 s26, s70, s14
  s_addc_u32 s27, s71, 0
  s_add_u32 s22, s4, 57933824
  s_addc_u32 s23, s5, 0
  s_add_u32 s22, s22, s14
  s_addc_u32 s23, s23, 0
  s_add_u32 s24, s4, 56098816
  s_addc_u32 s25, s5, 0
  global_load_dwordx4 v[48:51], v2, s[26:27]
  global_load_dwordx4 v[52:55], v2, s[26:27] offset:448
  s_mov_b32 s10, 0
L_L_loop_216:
  s_mov_b32 s11, 0
L_L_poll_217:
  global_load_dwordx4 v[12:15], v2, s[12:13] sc1
  global_load_dwordx4 v[16:19], v2, s[12:13] offset:448 sc1
  s_waitcnt vmcnt(0)
  v_max3_u32 v9, v12, v13, v14
  v_max3_u32 v9, v9, v15, v16
  v_max3_u32 v9, v9, v17, v18
  v_max_u32 v9, v9, v19
  v_cmp_eq_u32 vcc, -1, v9
  s_cbranch_vccz L_L_got_218
  s_add_u32 s11, s11, 1
  s_cmp_gt_u32 s11, 262144
  s_cbranch_scc1 L_abort
  s_sleep 2
  s_branch L_L_poll_217
L_L_got_218:
  v_mov_b64 v[20:21], v[48:49]
  v_mov_b64 v[22:23], v[50:51]
  v_mov_b64 v[24:25], v[52:53]
  v_mov_b64 v[26:27], v[54:55]
  v_lshlrev_b32 v32, 16, v12
  v_and_b32 v33, 0xffff0000, v12
  v_lshlrev_b32 v9, 16, v20
  v_and_b32 v10, 0xffff0000, v20
  v_add_f32 v32, v32, v9
  v_add_f32 v33, v33, v10
  v_cvt_pk_bf16_f32 v12, v32, v33
  v_lshlrev_b32 v34, 16, v13
  v_and_b32 v35, 0xffff0000, v13
  v_lshlrev_b32 v9, 16, v21
  v_and_b32 v10, 0xffff0000, v21
  v_add_f32 v34, v34, v9
  v_add_f32 v35, v35, v10
  v_cvt_pk_bf16_f32 v13, v34, v35
  v_lshlrev_b32 v36, 16, v14
  v_and_b32 v37, 0xffff0000, v14
  v_lshlrev_b32 v9, 16, v22
  v_and_b32 v10, 0xffff0000, v22
  v_add_f32 v36, v36, v9
  v_add_f32 v37, v37, v10
  v_cvt_pk_bf16_f32 v14, v36, v37
  v_lshlrev_b32 v38, 16, v15
  v_and_b32 v39, 0xffff0000, v15
  v_lshlrev_b32 v9, 16, v23
  v_and_b32 v10, 0xffff0000, v23
  v_add_f32 v38, v38, v9
  v_add_f32 v39, v39, v10
  v_cvt_pk_bf16_f32 v15, v38, v39
  v_lshlrev_b32 v40, 16, v16
  v_and_b32 v41, 0xffff0000, v16
  v_lshlrev_b32 v9, 16, v24
  v_and_b32 v10, 0xffff0000, v24
  v_add_f32 v40, v40, v9
  v_add_f32 v41, v41, v10
  v_cvt_pk_bf16_f32 v16, v40, v41
  v_lshlrev_b32 v42, 16, v17
  v_and_b32 v43, 0xffff0000, v17
  v_lshlrev_b32 v9, 16, v25
  v_and_b32 v10, 0xffff0000, v25
  v_add_f32 v42, v42, v9
  v_add_f32 v43, v43, v10
  v_cvt_pk_bf16_f32 v17, v42, v43
  v_lshlrev_b32 v44, 16, v18
  v_and_b32 v45, 0xffff0000, v18
  v_lshlrev_b32 v9, 16, v26
  v_and_b32 v10, 0xffff0000, v26
  v_add_f32 v44, v44, v9
  v_add_f32 v45, v45, v10
  v_cvt_pk_bf16_f32 v18, v44, v45
  v_lshlrev_b32 v46, 16, v19
  v_and_b32 v47, 0xffff0000, v19
  v_lshlrev_b32 v9, 16, v27
  v_and_b32 v10, 0xffff0000, v27
  v_add_f32 v46, v46, v9
  v_add_f32 v47, v47, v10
  v_cvt_pk_bf16_f32 v19, v46, v47
  global_store_dwordx4 v2, v[12:15], s[22:23] sc1
  global_store_dwordx4 v2, v[16:19], s[22:23] offset:448 sc1
  v_lshlrev_b32 v32, 16, v12
  v_and_b32 v33, 0xffff0000, v12
  v_lshlrev_b32 v34, 16, v13
  v_and_b32 v35, 0xffff0000, v13
  v_lshlrev_b32 v36, 16, v14
  v_and_b32 v37, 0xffff0000, v14
  v_lshlrev_b32 v38, 16, v15
  v_and_b32 v39, 0xffff0000, v15
  v_lshlrev_b32 v40, 16, v16
  v_and_b32 v41, 0xffff0000, v16
  v_lshlrev_b32 v42, 16, v17
  v_and_b32 v43, 0xffff0000, v17
  v_lshlrev_b32 v44, 16, v18
  v_and_b32 v45, 0xffff0000, v18
  v_lshlrev_b32 v46, 16, v19
  v_and_b32 v47, 0xffff0000, v19
  v_add_f32 v9, v32, v33
  v_add_f32 v9, v9, v34
  v_add_f32 v9, v9, v35
  v_add_f32 v9, v9, v36
  v_add_f32 v9, v9, v37
  v_add_f32 v9, v9, v38
  v_add_f32 v9, v9, v39
  v_add_f32 v9, v9, v40
  v_add_f32 v9, v9, v41
  v_add_f32 v9, v9, v42
  v_add_f32 v9, v9, v43
  v_add_f32 v9, v9, v44
  v_add_f32 v9, v9, v45
  v_add_f32 v9, v9, v46
  v_add_f32 v9, v9, v47
  v_cndmask_b32 v9, 0, v9, s[62:63]
  s_nop 1
  v_add_f32_dpp v9, v9, v9 row_ror:8 row_mask:0xf bank_mask:0xf
  s_nop 1
  v_add_f32_dpp v9, v9, v9 row_ror:4 row_mask:0xf bank_mask:0xf
  s_nop 1
  v_add_f32_dpp v9, v9, v9 row_ror:2 row_mask:0xf bank_mask:0xf
  s_nop 1
  v_add_f32_dpp v9, v9, v9 row_ror:1 row_mask:0xf bank_mask:0xf
  v_mov_b32 v10, v9
  s_nop 1
  v_permlane16_swap_b32 v9, v10
  v_add_f32 v9, v9, v10
  v_mul_f32 v9, 0x3b124925, v9
  v_sub_f32 v32, v32, v9
  v_sub_f32 v33, v33, v9
  v_sub_f32 v34, v34, v9
  v_sub_f32 v35, v35, v9
  v_sub_f32 v36, v36, v9
  v_sub_f32 v37, v37, v9
  v_sub_f32 v38, v38, v9
  v_sub_f32 v39, v39, v9
  v_sub_f32 v40, v40, v9
  v_sub_f32 v41, v41, v9
  v_sub_f32 v42, v42, v9
  v_sub_f32 v43, v43, v9
  v_sub_f32 v44, v44, v9
  v_sub_f32 v45, v45, v9
  v_sub_f32 v46, v46, v9
  v_sub_f32 v47, v47, v9
  v_mul_f32 v9, v32, v32
  v_fmac_f32 v9, v33, v33
  v_fmac_f32 v9, v34, v34
  v_fmac_f32 v9, v35, v35
  v_fmac_f32 v9, v36, v36
  v_fmac_f32 v9, v37, v37
  v_fmac_f32 v9, v38, v38
  v_fmac_f32 v9, v39, v39
  v_fmac_f32 v9, v40, v40
  v_fmac_f32 v9, v41, v41
  v_fmac_f32 v9, v42, v42
  v_fmac_f32 v9, v43, v43
  v_fmac_f32 v9, v44, v44
  v_fmac_f32 v9, v45, v45
  v_fmac_f32 v9, v46, v46
  v_fmac_f32 v9, v47, v47
  v_cndmask_b32 v9, 0, v9, s[62:63]
  s_nop 1
  v_add_f32_dpp v9, v9, v9 row_ror:8 row_mask:0xf bank_mask:0xf
  s_nop 1
  v_add_f32_dpp v9, v9, v9 row_ror:4 row_mask:0xf bank_mask:0xf
  s_nop 1
  v_add_f32_dpp v9, v9, v9 row_ror:2 row_mask:0xf bank_mask:0xf
  s_nop 1
  v_add_f32_dpp v9, v9, v9 row_ror:1 row_mask:0xf bank_mask:0xf
  v_mov_b32 v10, v9
  s_nop 1
  v_permlane16_swap_b32 v9, v10
  v_add_f32 v9, v9, v10
  v_mov_b32 v10, 0x3727c5ac
  v_fmac_f32 v10, 0x3b124925, v9
  v_rsq_f32 v10, v10
  s_nop 0
  v_mul_f32 v32, v32, v10
  v_mul_f32 v33, v33, v10
  v_mul_f32 v34, v34, v10
  v_mul_f32 v35, v35, v10
  v_mul_f32 v36, v36, v10
  v_mul_f32 v37, v37, v10
  v_mul_f32 v38, v38, v10
  v_mul_f32 v39, v39, v10
  v_mul_f32 v40, v40, v10
  v_mul_f32 v41, v41, v10
  v_mul_f32 v42, v42, v10
  v_mul_f32 v43, v43, v10
  v_mul_f32 v44, v44, v10
  v_mul_f32 v45, v45, v10
  v_mul_f32 v46, v46, v10
  v_mul_f32 v47, v47, v10
  v_cvt_pk_bf16_f32 v20, v32, v33
  v_cvt_pk_bf16_f32 v21, v34, v35
  v_cvt_pk_bf16_f32 v22, v36, v37
  v_cvt_pk_bf16_f32 v23, v38, v39
  v_cvt_pk_bf16_f32 v24, v40, v41
  v_cvt_pk_bf16_f32 v25, v42, v43
  v_cvt_pk_bf16_f32 v26, v44, v45
  v_cvt_pk_bf16_f32 v27, v46, v47
  ds_write_b128 v3, v[20:23]
  ds_write_b128 v3, v[24:27] offset:448
  s_waitcnt lgkmcnt(0)
  s_barrier
  ds_read_b64_tr_b16 v[32:33], v4
  ds_read_b64_tr_b16 v[34:35], v4 offset:3648
  ds_read_b64_tr_b16 v[36:37], v11
  ds_read_b64_tr_b16 v[38:39], v11 offset:3648
  s_waitcnt lgkmcnt(0)
  v_min_u32 v32, -2, v32
  v_min_u32 v33, -2, v33
  v_min_u32 v34, -2, v34
  v_min_u32 v35, -2, v35
  v_min_u32 v36, -2, v36
  v_min_u32 v37, -2, v37
  v_min_u32 v38, -2, v38
  v_min_u32 v39, -2, v39
  global_store_dwordx4 v5, v[32:35], s[24:25] sc1
  global_store_dwordx4 v1, v[36:39], s[24:25] sc1
  s_cmp_ge_u32 s10, 63
  s_cbranch_scc1 L_L_nt_219
  s_add_u32 s26, s26, 28672
  s_addc_u32 s27, s27, 0
  global_load_dwordx4 v[48:51], v2, s[26:27]
  global_load_dwordx4 v[52:55], v2, s[26:27] offset:448
L_L_nt_219:
  v_xor_b32 v3, 8192, v3
  v_xor_b32 v4, 8192, v4
  v_xor_b32 v11, 8192, v11
  s_add_u32 s12, s12, 7168
  s_addc_u32 s13, s13, 0
  s_add_u32 s22, s22, 28672
  s_addc_u32 s23, s23, 0
  s_add_u32 s24, s24, 28672
  s_addc_u32 s25, s25, 0
  s_add_u32 s10, s10, 1
  s_cmp_lt_u32 s10, 64
  s_cbranch_scc1 L_L_loop_216
  s_waitcnt vmcnt(0)
  s_barrier
  v_cmp_gt_u32 vcc, 8, v0
  s_and_saveexec_b64 s[20:21], vcc
  s_cbranch_execz L_gfsig_220
  s_add_u32 s14, s65, 56
  s_and_b32 s15, s14, 7
  s_lshl_b32 s15, s15, 7
  s_lshr_b32 s14, s14, 3
  s_lshl_b32 s14, s14, 2
  s_add_u32 s14, s14, s15
  s_add_u32 s14, s14, 4096
  v_lshlrev_b32 v112, 10, v0
  v_add_u32 v112, s14, v112
  v_mov_b32 v113, 1
  global_store_dword v112, v113, s[86:87] sc1
L_gfsig_220:
  s_mov_b64 exec, s[20:21]
  s_branch L_done
L_qF_s:
  v_and_b32 v14, 63, v0
  v_lshlrev_b32 v10, 4, v14
  s_mul_i32 s14, s65, 458752
  s_add_u32 s60, s4, 49807360
  s_addc_u32 s61, s5, 0
  s_add_u32 s60, s60, s14
  s_addc_u32 s61, s61, 0
  s_mov_b32 s10, 0
  s_cmp_ge_u32 s8, 2
  s_cbranch_scc1 L_QF_warm_221
  s_mul_i32 s14, s8, 3072
  v_add_u32 v11, s14, v10
  s_add_u32 s12, s4, 48693248
  s_addc_u32 s13, s5, 0
L_QF_loop_222:
  s_mov_b32 s11, 0
L_QF_poll_223:
  global_load_dwordx4 v[16:19], v11, s[12:13] offset:0 sc1
  global_load_dwordx4 v[20:23], v11, s[12:13] offset:1024 sc1
  global_load_dwordx4 v[24:27], v11, s[12:13] offset:2048 sc1
  global_load_dwordx4 v[28:31], v11, s[12:13] offset:3072 sc1
  s_waitcnt vmcnt(0)
  v_max3_u32 v14, v16, v17, v18
  v_max3_u32 v14, v14, v19, v20
  v_max3_u32 v14, v14, v21, v22
  v_max3_u32 v14, v14, v23, v24
  v_max3_u32 v14, v14, v25, v26
  v_max3_u32 v14, v14, v27, v28
  v_max3_u32 v14, v14, v29, v30
  v_max_u32 v14, v14, v31
  v_cmp_eq_u32 vcc, -1, v14
  s_cbranch_vccz L_QF_got_224
  s_add_u32 s11, s11, 1
  s_cmp_gt_u32 s11, 262144
  s_cbranch_scc1 L_abort
  s_branch L_QF_poll_223
L_QF_got_224:
  global_store_dwordx4 v11, v[16:19], s[60:61] offset:0 sc1
  global_store_dwordx4 v11, v[20:23], s[60:61] offset:1024 sc1
  global_store_dwordx4 v11, v[24:27], s[60:61] offset:2048 sc1
  global_store_dwordx4 v11, v[28:31], s[60:61] offset:3072 sc1
  s_nop 1
  s_add_u32 s12, s12, 7168
  s_addc_u32 s13, s13, 0
  s_add_u32 s60, s60, 7168
  s_addc_u32 s61, s61, 0
  s_add_u32 s10, s10, 1
  s_cmp_lt_u32 s10, 64
  s_cbranch_scc1 L_QF_loop_222
  s_waitcnt vmcnt(0)
  s_branch L_done
L_QF_warm_221:
  v_and_b32 v14, 63, v0
  v_lshlrev_b32 v20, 7, v14
  v_min_u32 v21, 7040, v20
  v_min_u32 v22, 1920, v20
  s_sub_u32 s14, s8, 2
  s_lshl_b32 s14, s14, 14
  s_add_u32 s22, s4, 42205184
  s_addc_u32 s23, s5, 0
  s_add_u32 s22, s22, s14
  s_addc_u32 s23, s23, 0
  s_mul_i32 s14, s65, 7168
  s_add_u32 s24, s4, 46399488
  s_addc_u32 s25, s5, 0
  s_add_u32 s24, s24, s14
  s_addc_u32 s25, s25, 0
  s_mul_i32 s14, s65, 7168
  s_add_u32 s32, s70, s14
  s_addc_u32 s33, s71, 0
  s_lshl_b32 s14, s65, 19
  s_add_u32 s26, s4, 51642368
  s_addc_u32 s27, s5, 0
  s_add_u32 s26, s26, s14
  s_addc_u32 s27, s27, 0
  s_lshl_b32 s14, s65, 17
  s_add_u32 s28, s4, 53739520
  s_addc_u32 s29, s5, 0
  s_add_u32 s28, s28, s14
  s_addc_u32 s29, s29, 0
  s_mul_i32 s14, s65, 458752
  s_add_u32 s30, s4, 54263808
  s_addc_u32 s31, s5, 0
  s_add_u32 s30, s30, s14
  s_addc_u32 s31, s31, 0
  global_load_dword v23, v20, s[22:23]
  s_add_u32 s14, s22, 8192
  s_addc_u32 s15, s23, 0
  global_load_dword v23, v20, s[14:15]
  s_cmp_eq_u32 s8, 3
  s_cbranch_scc1 L_w3_225
  global_load_dword v23, v21, s[24:25]
  global_load_dword v23, v21, s[32:33]
  s_branch L_wj_226
L_w3_225:
L_wj_226:
  s_add_u32 s22, s22, 32768
  s_addc_u32 s23, s23, 0
  s_add_u32 s24, s24, 28672
  s_addc_u32 s25, s25, 0
  s_add_u32 s32, s32, 28672
  s_addc_u32 s33, s33, 0
  s_add_u32 s26, s26, 8192
  s_addc_u32 s27, s27, 0
  s_add_u32 s28, s28, 2048
  s_addc_u32 s29, s29, 0
  s_add_u32 s30, s30, 7168
  s_addc_u32 s31, s31, 0
  global_load_dword v23, v20, s[22:23]
  s_add_u32 s14, s22, 8192
  s_addc_u32 s15, s23, 0
  global_load_dword v23, v20, s[14:15]
  s_cmp_eq_u32 s8, 3
  s_cbranch_scc1 L_w3_227
  global_load_dword v23, v21, s[24:25]
  global_load_dword v23, v21, s[32:33]
  s_branch L_wj_228
L_w3_227:
L_wj_228:
  s_add_u32 s22, s22, 32768
  s_addc_u32 s23, s23, 0
  s_add_u32 s24, s24, 28672
  s_addc_u32 s25, s25, 0
  s_add_u32 s32, s32, 28672
  s_addc_u32 s33, s33, 0
  s_add_u32 s26, s26, 8192
  s_addc_u32 s27, s27, 0
  s_add_u32 s28, s28, 2048
  s_addc_u32 s29, s29, 0
  s_add_u32 s30, s30, 7168
  s_addc_u32 s31, s31, 0
  v_mov_b32 v24, 0
L_QW_loop_229:
  s_mov_b32 s11, 0
L_QW_poll_230:
  global_load_dword v25, v24, s[60:61] sc1
  s_waitcnt vmcnt(0)
  v_cmp_eq_u32 vcc, -1, v25
  s_cbranch_vccz L_QW_got_231
  s_add_u32 s11, s11, 1
  s_cmp_gt_u32 s11, 262144
  s_cbranch_scc1 L_abort
  s_sleep 4
  s_branch L_QW_poll_230
L_QW_got_231:
  global_load_dword v23, v20, s[22:23]
  s_add_u32 s14, s22, 8192
  s_addc_u32 s15, s23, 0
  global_load_dword v23, v20, s[14:15]
  s_cmp_eq_u32 s8, 3
  s_cbranch_scc1 L_w3_232
  global_load_dword v23, v21, s[24:25]
  global_load_dword v23, v21, s[32:33]
  s_branch L_wj_233
L_w3_232:
L_wj_233:
  s_add_u32 s22, s22, 32768
  s_addc_u32 s23, s23, 0
  s_add_u32 s24, s24, 28672
  s_addc_u32 s25, s25, 0
  s_add_u32 s32, s32, 28672
  s_addc_u32 s33, s33, 0
  s_add_u32 s26, s26, 8192
  s_addc_u32 s27, s27, 0
  s_add_u32 s28, s28, 2048
  s_addc_u32 s29, s29, 0
  s_add_u32 s30, s30, 7168
  s_addc_u32 s31, s31, 0
  s_add_u32 s60, s60, 7168
  s_addc_u32 s61, s61, 0
  s_add_u32 s10, s10, 1
  s_cmp_lt_u32 s10, 62
  s_cbranch_scc1 L_QW_loop_229
  s_waitcnt vmcnt(0)
  s_branch L_done
L_free_s:
  s_sub_u32 s69, s68, 5
  s_lshl_b32 s69, s69, 5
  s_add_u32 s69, s69, s9
  s_cmp_ge_u32 s69, 84
  s_cbranch_scc1 L_pref_s
  s_mul_i32 s82, s69, 2341
  s_lshr_b32 s82, s82, 16
  s_mul_i32 s72, s82, 28
  s_sub_u32 s83, s69, s72
  v_and_b32 v1, 63, v0
  v_lshlrev_b32 v2, 4, v1
  v_add_u32 v3, 0, v2
  s_mul_i32 s72, s82, 28672
  s_mul_i32 s73, s8, 7168
  s_add_u32 s72, s72, s73
  s_add_u32 s72, s72, 4096
  s_add_u32 s76, s4, 44564480
  s_addc_u32 s77, s5, 0
  s_add_u32 s76, s76, s72
  s_addc_u32 s77, s77, 0
  s_add_u32 s80, s73, 4096
  s_mov_b32 s81, 0
  s_add_u32 s72, s80, 0
  s_mov_b32 m0, s72
  s_nop 0
  global_load_lds_dwordx4 v2, s[76:77] offset:-4096
  global_load_lds_dwordx4 v2, s[76:77] offset:-3072
  global_load_lds_dwordx4 v2, s[76:77] offset:-2048
  global_load_lds_dwordx4 v2, s[76:77] offset:-1024
  global_load_lds_dwordx4 v2, s[76:77] offset:0
  global_load_lds_dwordx4 v2, s[76:77] offset:1024
  global_load_lds_dwordx4 v2, s[76:77] offset:2048
  s_sub_u32 s84, 3, s82
  s_cmp_eq_u32 s81, 20
  s_cselect_b32 s84, s84, 3
  s_mul_i32 s84, s84, 28672
  s_add_u32 s76, s76, s84
  s_addc_u32 s77, s77, 0
  s_lshl_b32 s72, s83, 4
  s_lshl_b32 s73, s8, 2
  s_add_u32 s72, s72, s73
  s_lshl_b32 s78, s72, 10
  s_mul_i32 s72, s72, 14336
  s_add_u32 s74, s4, 6422528
  s_addc_u32 s75, s5, 0
  s_add_u32 s74, s74, s72
  s_addc_u32 s75, s75, 0
  global_load_dwordx4 a[0:3], v2, s[74:75] offset:0
  global_load_dwordx4 a[4:7], v2, s[74:75] offset:1024
  global_load_dwordx4 a[8:11], v2, s[74:75] offset:2048
  global_load_dwordx4 a[12:15], v2, s[74:75] offset:3072
  s_add_u32 s74, s74, 4096
  s_addc_u32 s75, s75, 0
  global_load_dwordx4 a[16:19], v2, s[74:75] offset:0
  global_load_dwordx4 a[20:23], v2, s[74:75] offset:1024
  global_load_dwordx4 a[24:27], v2, s[74:75] offset:2048
  global_load_dwordx4 a[28:31], v2, s[74:75] offset:3072
  s_add_u32 s74, s74, 4096
  s_addc_u32 s75, s75, 0
  global_load_dwordx4 a[32:35], v2, s[74:75] offset:0
  global_load_dwordx4 a[36:39], v2, s[74:75] offset:1024
  global_load_dwordx4 a[40:43], v2, s[74:75] offset:2048
  global_load_dwordx4 a[44:47], v2, s[74:75] offset:3072
  s_add_u32 s74, s74, 4096
  s_addc_u32 s75, s75, 0
  global_load_dwordx4 a[48:51], v2, s[74:75] offset:0
  global_load_dwordx4 a[52:55], v2, s[74:75] offset:1024
  s_add_u32 s74, s74, 2048
  s_addc_u32 s75, s75, 0
  global_load_dwordx4 a[56:59], v2, s[74:75] offset:0
  global_load_dwordx4 a[60:63], v2, s[74:75] offset:1024
  global_load_dwordx4 a[64:67], v2, s[74:75] offset:2048
  global_load_dwordx4 a[68:71], v2, s[74:75] offset:3072
  s_add_u32 s74, s74, 4096
  s_addc_u32 s75, s75, 0
  global_load_dwordx4 a[72:75], v2, s[74:75] offset:0
  global_load_dwordx4 a[76:79], v2, s[74:75] offset:1024
  global_load_dwordx4 a[80:83], v2, s[74:75] offset:2048
  global_load_dwordx4 a[84:87], v2, s[74:75] offset:3072
  s_add_u32 s74, s74, 4096
  s_addc_u32 s75, s75, 0
  global_load_dwordx4 a[88:91], v2, s[74:75] offset:0
  global_load_dwordx4 a[92:95], v2, s[74:75] offset:1024
  global_load_dwordx4 a[96:99], v2, s[74:75] offset:2048
  global_load_dwordx4 a[100:103], v2, s[74:75] offset:3072
  s_add_u32 s74, s74, 4096
  s_addc_u32 s75, s75, 0
  global_load_dwordx4 a[104:107], v2, s[74:75] offset:0
  global_load_dwordx4 a[108:111], v2, s[74:75] offset:1024
  s_add_u32 s74, s74, 2048
  s_addc_u32 s75, s75, 0
  global_load_dwordx4 a[112:115], v2, s[74:75] offset:0
  global_load_dwordx4 a[116:119], v2, s[74:75] offset:1024
  global_load_dwordx4 a[120:123], v2, s[74:75] offset:2048
  global_load_dwordx4 a[124:127], v2, s[74:75] offset:3072
  s_add_u32 s74, s74, 4096
  s_addc_u32 s75, s75, 0
  global_load_dwordx4 a[128:131], v2, s[74:75] offset:0
  global_load_dwordx4 a[132:135], v2, s[74:75] offset:1024
  global_load_dwordx4 a[136:139], v2, s[74:75] offset:2048
  global_load_dwordx4 a[140:143], v2, s[74:75] offset:3072
  s_add_u32 s74, s74, 4096
  s_addc_u32 s75, s75, 0
  global_load_dwordx4 a[144:147], v2, s[74:75] offset:0
  global_load_dwordx4 a[148:151], v2, s[74:75] offset:1024
  global_load_dwordx4 a[152:155], v2, s[74:75] offset:2048
  global_load_dwordx4 a[156:159], v2, s[74:75] offset:3072
  s_add_u32 s74, s74, 4096
  s_addc_u32 s75, s75, 0
  global_load_dwordx4 a[160:163], v2, s[74:75] offset:0
  global_load_dwordx4 a[164:167], v2, s[74:75] offset:1024
  s_add_u32 s74, s74, 2048
  s_addc_u32 s75, s75, 0
  global_load_dwordx4 a[168:171], v2, s[74:75] offset:0
  global_load_dwordx4 a[172:175], v2, s[74:75] offset:1024
  global_load_dwordx4 a[176:179], v2, s[74:75] offset:2048
  global_load_dwordx4 a[180:183], v2, s[74:75] offset:3072
  s_add_u32 s74, s74, 4096
  s_addc_u32 s75, s75, 0
  global_load_dwordx4 a[184:187], v2, s[74:75] offset:0
  global_load_dwordx4 a[188:191], v2, s[74:75] offset:1024
  global_load_dwordx4 a[192:195], v2, s[74:75] offset:2048
  global_load_dwordx4 a[196:199], v2, s[74:75] offset:3072
  s_add_u32 s74, s74, 4096
  s_addc_u32 s75, s75, 0
  global_load_dwordx4 a[200:203], v2, s[74:75] offset:0
  global_load_dwordx4 a[204:207], v2, s[74:75] offset:1024
  global_load_dwordx4 a[208:211], v2, s[74:75] offset:2048
  global_load_dwordx4 a[212:215], v2, s[74:75] offset:3072
  s_add_u32 s74, s74, 4096
  s_addc_u32 s75, s75, 0
  global_load_dwordx4 a[216:219], v2, s[74:75] offset:0
  global_load_dwordx4 a[220:223], v2, s[74:75] offset:1024
  s_add_u32 s74, s74, 2048
  s_addc_u32 s75, s75, 0
  s_mul_i32 s72, s82, 458752
  s_add_u32 s72, s72, s78
  s_add_u32 s78, s4, 12845056
  s_addc_u32 s79, s5, 0
  s_add_u32 s78, s78, s72
  s_addc_u32 s79, s79, 0
  s_waitcnt vmcnt(0)
  s_barrier
  ds_read_b128 v[8:11], v3 offset:0
  ds_read_b128 v[12:15], v3 offset:14336
  ds_read_b128 v[16:19], v3 offset:1024
  ds_read_b128 v[20:23], v3 offset:15360
  ds_read_b128 v[24:27], v3 offset:2048
  ds_read_b128 v[28:31], v3 offset:16384
  s_add_u32 s72, s80, 28672
  s_mov_b32 m0, s72
  s_nop 0
  global_load_lds_dwordx4 v2, s[76:77] offset:-4096
  global_load_lds_dwordx4 v2, s[76:77] offset:-3072
  global_load_lds_dwordx4 v2, s[76:77] offset:-2048
  global_load_lds_dwordx4 v2, s[76:77] offset:-1024
  global_load_lds_dwordx4 v2, s[76:77] offset:0
  global_load_lds_dwordx4 v2, s[76:77] offset:1024
  global_load_lds_dwordx4 v2, s[76:77] offset:2048
  s_sub_u32 s84, 3, s82
  s_cmp_eq_u32 s81, 19
  s_cselect_b32 s84, s84, 3
  s_mul_i32 s84, s84, 28672
  s_add_u32 s76, s76, s84
  s_addc_u32 s77, s77, 0
  ds_read_b128 v[32:35], v3 offset:3072
  ds_read_b128 v[36:39], v3 offset:17408
  s_waitcnt lgkmcnt(6)
  v_mfma_f32_16x16x32_bf16 v[40:43], v[8:11], a[0:3], 0
  v_mfma_f32_16x16x32_bf16 v[44:47], v[8:11], a[56:59], 0
  v_mfma_f32_16x16x32_bf16 v[48:51], v[8:11], a[112:115], 0
  v_mfma_f32_16x16x32_bf16 v[52:55], v[8:11], a[168:171], 0
  v_mfma_f32_16x16x32_bf16 v[56:59], v[12:15], a[0:3], 0
  v_mfma_f32_16x16x32_bf16 v[60:63], v[12:15], a[56:59], 0
  v_mfma_f32_16x16x32_bf16 v[64:67], v[12:15], a[112:115], 0
  v_mfma_f32_16x16x32_bf16 v[68:71], v[12:15], a[168:171], 0
  ds_read_b128 v[8:11], v3 offset:4096
  ds_read_b128 v[12:15], v3 offset:18432
  s_waitcnt lgkmcnt(6)
  v_mfma_f32_16x16x32_bf16 v[40:43], v[16:19], a[4:7], v[40:43]
  v_mfma_f32_16x16x32_bf16 v[44:47], v[16:19], a[60:63], v[44:47]
  v_mfma_f32_16x16x32_bf16 v[48:51], v[16:19], a[116:119], v[48:51]
  v_mfma_f32_16x16x32_bf16 v[52:55], v[16:19], a[172:175], v[52:55]
  v_mfma_f32_16x16x32_bf16 v[56:59], v[20:23], a[4:7], v[56:59]
  v_mfma_f32_16x16x32_bf16 v[60:63], v[20:23], a[60:63], v[60:63]
  v_mfma_f32_16x16x32_bf16 v[64:67], v[20:23], a[116:119], v[64:67]
  v_mfma_f32_16x16x32_bf16 v[68:71], v[20:23], a[172:175], v[68:71]
  ds_read_b128 v[16:19], v3 offset:5120
  ds_read_b128 v[20:23], v3 offset:19456
  s_waitcnt lgkmcnt(6)
  v_mfma_f32_16x16x32_bf16 v[40:43], v[24:27], a[8:11], v[40:43]
  v_mfma_f32_16x16x32_bf16 v[44:47], v[24:27], a[64:67], v[44:47]
  v_mfma_f32_16x16x32_bf16 v[48:51], v[24:27], a[120:123], v[48:51]
  v_mfma_f32_16x16x32_bf16 v[52:55], v[24:27], a[176:179], v[52:55]
  v_mfma_f32_16x16x32_bf16 v[56:59], v[28:31], a[8:11], v[56:59]
  v_mfma_f32_16x16x32_bf16 v[60:63], v[28:31], a[64:67], v[60:63]
  v_mfma_f32_16x16x32_bf16 v[64:67], v[28:31], a[120:123], v[64:67]
  v_mfma_f32_16x16x32_bf16 v[68:71], v[28:31], a[176:179], v[68:71]
  ds_read_b128 v[24:27], v3 offset:6144
  ds_read_b128 v[28:31], v3 offset:20480
  s_waitcnt lgkmcnt(6)
  v_mfma_f32_16x16x32_bf16 v[40:43], v[32:35], a[12:15], v[40:43]
  v_mfma_f32_16x16x32_bf16 v[44:47], v[32:35], a[68:71], v[44:47]
  v_mfma_f32_16x16x32_bf16 v[48:51], v[32:35], a[124:127], v[48:51]
  v_mfma_f32_16x16x32_bf16 v[52:55], v[32:35], a[180:183], v[52:55]
  v_mfma_f32_16x16x32_bf16 v[56:59], v[36:39], a[12:15], v[56:59]
  v_mfma_f32_16x16x32_bf16 v[60:63], v[36:39], a[68:71], v[60:63]
  v_mfma_f32_16x16x32_bf16 v[64:67], v[36:39], a[124:127], v[64:67]
  v_mfma_f32_16x16x32_bf16 v[68:71], v[36:39], a[180:183], v[68:71]
  ds_read_b128 v[32:35], v3 offset:7168
  ds_read_b128 v[36:39], v3 offset:21504
  s_waitcnt lgkmcnt(6)
  v_mfma_f32_16x16x32_bf16 v[40:43], v[8:11], a[16:19], v[40:43]
  v_mfma_f32_16x16x32_bf16 v[44:47], v[8:11], a[72:75], v[44:47]
  v_mfma_f32_16x16x32_bf16 v[48:51], v[8:11], a[128:131], v[48:51]
  v_mfma_f32_16x16x32_bf16 v[52:55], v[8:11], a[184:187], v[52:55]
  v_mfma_f32_16x16x32_bf16 v[56:59], v[12:15], a[16:19], v[56:59]
  v_mfma_f32_16x16x32_bf16 v[60:63], v[12:15], a[72:75], v[60:63]
  v_mfma_f32_16x16x32_bf16 v[64:67], v[12:15], a[128:131], v[64:67]
  v_mfma_f32_16x16x32_bf16 v[68:71], v[12:15], a[184:187], v[68:71]
  ds_read_b128 v[8:11], v3 offset:8192
  ds_read_b128 v[12:15], v3 offset:22528
  s_waitcnt lgkmcnt(6)
  v_mfma_f32_16x16x32_bf16 v[40:43], v[16:19], a[20:23], v[40:43]
  v_mfma_f32_16x16x32_bf16 v[44:47], v[16:19], a[76:79], v[44:47]
  v_mfma_f32_16x16x32_bf16 v[48:51], v[16:19], a[132:135], v[48:51]
  v_mfma_f32_16x16x32_bf16 v[52:55], v[16:19], a[188:191], v[52:55]
  v_mfma_f32_16x16x32_bf16 v[56:59], v[20:23], a[20:23], v[56:59]
  v_mfma_f32_16x16x32_bf16 v[60:63], v[20:23], a[76:79], v[60:63]
  v_mfma_f32_16x16x32_bf16 v[64:67], v[20:23], a[132:135], v[64:67]
  v_mfma_f32_16x16x32_bf16 v[68:71], v[20:23], a[188:191], v[68:71]
  ds_read_b128 v[16:19], v3 offset:9216
  ds_read_b128 v[20:23], v3 offset:23552
  s_waitcnt lgkmcnt(6)
  v_mfma_f32_16x16x32_bf16 v[40:43], v[24:27], a[24:27], v[40:43]
  v_mfma_f32_16x16x32_bf16 v[44:47], v[24:27], a[80:83], v[44:47]
  v_mfma_f32_16x16x32_bf16 v[48:51], v[24:27], a[136:139], v[48:51]
  v_mfma_f32_16x16x32_bf16 v[52:55], v[24:27], a[192:195], v[52:55]
  v_mfma_f32_16x16x32_bf16 v[56:59], v[28:31], a[24:27], v[56:59]
  v_mfma_f32_16x16x32_bf16 v[60:63], v[28:31], a[80:83], v[60:63]
  v_mfma_f32_16x16x32_bf16 v[64:67], v[28:31], a[136:139], v[64:67]
  v_mfma_f32_16x16x32_bf16 v[68:71], v[28:31], a[192:195], v[68:71]
  ds_read_b128 v[24:27], v3 offset:10240
  ds_read_b128 v[28:31], v3 offset:24576
  s_waitcnt lgkmcnt(6)
  v_mfma_f32_16x16x32_bf16 v[40:43], v[32:35], a[28:31], v[40:43]
  v_mfma_f32_16x16x32_bf16 v[44:47], v[32:35], a[84:87], v[44:47]
  v_mfma_f32_16x16x32_bf16 v[48:51], v[32:35], a[140:143], v[48:51]
  v_mfma_f32_16x16x32_bf16 v[52:55], v[32:35], a[196:199], v[52:55]
  v_mfma_f32_16x16x32_bf16 v[56:59], v[36:39], a[28:31], v[56:59]
  v_mfma_f32_16x16x32_bf16 v[60:63], v[36:39], a[84:87], v[60:63]
  v_mfma_f32_16x16x32_bf16 v[64:67], v[36:39], a[140:143], v[64:67]
  v_mfma_f32_16x16x32_bf16 v[68:71], v[36:39], a[196:199], v[68:71]
  ds_read_b128 v[32:35], v3 offset:11264
  ds_read_b128 v[36:39], v3 offset:25600
  s_waitcnt lgkmcnt(6)
  v_mfma_f32_16x16x32_bf16 v[40:43], v[8:11], a[32:35], v[40:43]
  v_mfma_f32_16x16x32_bf16 v[44:47], v[8:11], a[88:91], v[44:47]
  v_mfma_f32_16x16x32_bf16 v[48:51], v[8:11], a[144:147], v[48:51]
  v_mfma_f32_16x16x32_bf16 v[52:55], v[8:11], a[200:203], v[52:55]
  v_mfma_f32_16x16x32_bf16 v[56:59], v[12:15], a[32:35], v[56:59]
  v_mfma_f32_16x16x32_bf16 v[60:63], v[12:15], a[88:91], v[60:63]
  v_mfma_f32_16x16x32_bf16 v[64:67], v[12:15], a[144:147], v[64:67]
  v_mfma_f32_16x16x32_bf16 v[68:71], v[12:15], a[200:203], v[68:71]
  ds_read_b128 v[8:11], v3 offset:12288
  ds_read_b128 v[12:15], v3 offset:26624
  s_waitcnt lgkmcnt(6)
  v_mfma_f32_16x16x32_bf16 v[40:43], v[16:19], a[36:39], v[40:43]
  v_mfma_f32_16x16x32_bf16 v[44:47], v[16:19], a[92:95], v[44:47]
  v_mfma_f32_16x16x32_bf16 v[48:51], v[16:19], a[148:151], v[48:51]
  v_mfma_f32_16x16x32_bf16 v[52:55], v[16:19], a[204:207], v[52:55]
  v_mfma_f32_16x16x32_bf16 v[56:59], v[20:23], a[36:39], v[56:59]
  v_mfma_f32_16x16x32_bf16 v[60:63], v[20:23], a[92:95], v[60:63]
  v_mfma_f32_16x16x32_bf16 v[64:67], v[20:23], a[148:151], v[64:67]
  v_mfma_f32_16x16x32_bf16 v[68:71], v[20:23], a[204:207], v[68:71]
  ds_read_b128 v[16:19], v3 offset:13312
  ds_read_b128 v[20:23], v3 offset:27648
  s_waitcnt lgkmcnt(6)
  v_mfma_f32_16x16x32_bf16 v[40:43], v[24:27], a[40:43], v[40:43]
  v_mfma_f32_16x16x32_bf16 v[44:47], v[24:27], a[96:99], v[44:47]
  v_mfma_f32_16x16x32_bf16 v[48:51], v[24:27], a[152:155], v[48:51]
  v_mfma_f32_16x16x32_bf16 v[52:55], v[24:27], a[208:211], v[52:55]
  v_mfma_f32_16x16x32_bf16 v[56:59], v[28:31], a[40:43], v[56:59]
  v_mfma_f32_16x16x32_bf16 v[60:63], v[28:31], a[96:99], v[60:63]
  v_mfma_f32_16x16x32_bf16 v[64:67], v[28:31], a[152:155], v[64:67]
  v_mfma_f32_16x16x32_bf16 v[68:71], v[28:31], a[208:211], v[68:71]
  s_waitcnt lgkmcnt(4)
  v_mfma_f32_16x16x32_bf16 v[40:43], v[32:35], a[44:47], v[40:43]
  v_mfma_f32_16x16x32_bf16 v[44:47], v[32:35], a[100:103], v[44:47]
  v_mfma_f32_16x16x32_bf16 v[48:51], v[32:35], a[156:159], v[48:51]
  v_mfma_f32_16x16x32_bf16 v[52:55], v[32:35], a[212:215], v[52:55]
  v_mfma_f32_16x16x32_bf16 v[56:59], v[36:39], a[44:47], v[56:59]
  v_mfma_f32_16x16x32_bf16 v[60:63], v[36:39], a[100:103], v[60:63]
  v_mfma_f32_16x16x32_bf16 v[64:67], v[36:39], a[156:159], v[64:67]
  v_mfma_f32_16x16x32_bf16 v[68:71], v[36:39], a[212:215], v[68:71]
  s_waitcnt lgkmcnt(2)
  v_mfma_f32_16x16x32_bf16 v[40:43], v[8:11], a[48:51], v[40:43]
  v_mfma_f32_16x16x32_bf16 v[44:47], v[8:11], a[104:107], v[44:47]
  v_mfma_f32_16x16x32_bf16 v[48:51], v[8:11], a[160:163], v[48:51]
  v_mfma_f32_16x16x32_bf16 v[52:55], v[8:11], a[216:219], v[52:55]
  v_mfma_f32_16x16x32_bf16 v[56:59], v[12:15], a[48:51], v[56:59]
  v_mfma_f32_16x16x32_bf16 v[60:63], v[12:15], a[104:107], v[60:63]
  v_mfma_f32_16x16x32_bf16 v[64:67], v[12:15], a[160:163], v[64:67]
  v_mfma_f32_16x16x32_bf16 v[68:71], v[12:15], a[216:219], v[68:71]
  s_waitcnt lgkmcnt(0)
  v_mfma_f32_16x16x32_bf16 v[40:43], v[16:19], a[52:55], v[40:43]
  v_mfma_f32_16x16x32_bf16 v[44:47], v[16:19], a[108:111], v[44:47]
  v_mfma_f32_16x16x32_bf16 v[48:51], v[16:19], a[164:167], v[48:51]
  v_mfma_f32_16x16x32_bf16 v[52:55], v[16:19], a[220:223], v[52:55]
  v_mfma_f32_16x16x32_bf16 v[56:59], v[20:23], a[52:55], v[56:59]
  v_mfma_f32_16x16x32_bf16 v[60:63], v[20:23], a[108:111], v[60:63]
  v_mfma_f32_16x16x32_bf16 v[64:67], v[20:23], a[164:167], v[64:67]
  v_mfma_f32_16x16x32_bf16 v[68:71], v[20:23], a[220:223], v[68:71]
  s_waitcnt vmcnt(0)
  s_barrier
  s_cmp_lg_u32 s81, 1
  s_cbranch_scc1 L_ns_234
  v_cmp_eq_u32 vcc, 0, v0
  s_and_saveexec_b64 s[20:21], vcc
  s_cbranch_execz L_sig_235
  v_mov_b32 v112, 1024
  v_mov_b32 v113, 1
  global_atomic_add v112, v113, s[86:87] sc1
L_sig_235:
  s_mov_b64 exec, s[20:21]
L_ns_234:
  s_cmp_lg_u32 s81, 6
  s_cbranch_scc1 L_ns_236
  v_cmp_eq_u32 vcc, 0, v0
  s_and_saveexec_b64 s[20:21], vcc
  s_cbranch_execz L_sig_237
  v_mov_b32 v112, 1152
  v_mov_b32 v113, 1
  global_atomic_add v112, v113, s[86:87] sc1
L_sig_237:
  s_mov_b64 exec, s[20:21]
L_ns_236:
  s_add_u32 s81, s81, 1
L_vxl_238:
  ds_read_b128 v[8:11], v3 offset:28672
  ds_read_b128 v[12:15], v3 offset:43008
  ds_read_b128 v[16:19], v3 offset:29696
  ds_read_b128 v[20:23], v3 offset:44032
  ds_read_b128 v[24:27], v3 offset:30720
  ds_read_b128 v[28:31], v3 offset:45056
  s_add_u32 s72, s80, 0
  s_mov_b32 m0, s72
  s_nop 0
  global_load_lds_dwordx4 v2, s[76:77] offset:-4096
  global_load_lds_dwordx4 v2, s[76:77] offset:-3072
  global_load_lds_dwordx4 v2, s[76:77] offset:-2048
  global_load_lds_dwordx4 v2, s[76:77] offset:-1024
  global_load_lds_dwordx4 v2, s[76:77] offset:0
  global_load_lds_dwordx4 v2, s[76:77] offset:1024
  global_load_lds_dwordx4 v2, s[76:77] offset:2048
  s_sub_u32 s84, 3, s82
  s_cmp_eq_u32 s81, 19
  s_cselect_b32 s84, s84, 3
  s_mul_i32 s84, s84, 28672
  s_add_u32 s76, s76, s84
  s_addc_u32 s77, s77, 0
  ds_read_b128 v[32:35], v3 offset:31744
  ds_read_b128 v[36:39], v3 offset:46080
  s_waitcnt lgkmcnt(6)
  v_mfma_f32_16x16x32_bf16 v[72:75], v[8:11], a[0:3], 0
  v_mfma_f32_16x16x32_bf16 v[76:79], v[8:11], a[56:59], 0
  v_mfma_f32_16x16x32_bf16 v[80:83], v[8:11], a[112:115], 0
  v_mfma_f32_16x16x32_bf16 v[84:87], v[8:11], a[168:171], 0
  v_mfma_f32_16x16x32_bf16 v[88:91], v[12:15], a[0:3], 0
  v_mfma_f32_16x16x32_bf16 v[92:95], v[12:15], a[56:59], 0
  v_mfma_f32_16x16x32_bf16 v[96:99], v[12:15], a[112:115], 0
  v_mfma_f32_16x16x32_bf16 v[100:103], v[12:15], a[168:171], 0
  ds_read_b128 v[8:11], v3 offset:32768
  ds_read_b128 v[12:15], v3 offset:47104
  s_waitcnt lgkmcnt(6)
  v_mfma_f32_16x16x32_bf16 v[72:75], v[16:19], a[4:7], v[72:75]
  v_mfma_f32_16x16x32_bf16 v[76:79], v[16:19], a[60:63], v[76:79]
  v_mfma_f32_16x16x32_bf16 v[80:83], v[16:19], a[116:119], v[80:83]
  v_mfma_f32_16x16x32_bf16 v[84:87], v[16:19], a[172:175], v[84:87]
  v_mfma_f32_16x16x32_bf16 v[88:91], v[20:23], a[4:7], v[88:91]
  v_mfma_f32_16x16x32_bf16 v[92:95], v[20:23], a[60:63], v[92:95]
  v_mfma_f32_16x16x32_bf16 v[96:99], v[20:23], a[116:119], v[96:99]
  v_mfma_f32_16x16x32_bf16 v[100:103], v[20:23], a[172:175], v[100:103]
  ds_read_b128 v[16:19], v3 offset:33792
  ds_read_b128 v[20:23], v3 offset:48128
  s_waitcnt lgkmcnt(6)
  v_mfma_f32_16x16x32_bf16 v[72:75], v[24:27], a[8:11], v[72:75]
  v_mfma_f32_16x16x32_bf16 v[76:79], v[24:27], a[64:67], v[76:79]
  v_cvt_pk_bf16_f32 v104, v40, v41
  v_mfma_f32_16x16x32_bf16 v[80:83], v[24:27], a[120:123], v[80:83]
  v_mfma_f32_16x16x32_bf16 v[84:87], v[24:27], a[176:179], v[84:87]
  v_cvt_pk_bf16_f32 v105, v42, v43
  v_mfma_f32_16x16x32_bf16 v[88:91], v[28:31], a[8:11], v[88:91]
  v_mfma_f32_16x16x32_bf16 v[92:95], v[28:31], a[64:67], v[92:95]
  v_cvt_pk_bf16_f32 v106, v56, v57
  v_mfma_f32_16x16x32_bf16 v[96:99], v[28:31], a[120:123], v[96:99]
  v_mfma_f32_16x16x32_bf16 v[100:103], v[28:31], a[176:179], v[100:103]
  v_cvt_pk_bf16_f32 v107, v58, v59
  ds_read_b128 v[24:27], v3 offset:34816
  ds_read_b128 v[28:31], v3 offset:49152
  s_waitcnt lgkmcnt(6)
  v_mfma_f32_16x16x32_bf16 v[72:75], v[32:35], a[12:15], v[72:75]
  v_mfma_f32_16x16x32_bf16 v[76:79], v[32:35], a[68:71], v[76:79]
  global_store_dwordx4 v2, v[104:107], s[78:79] offset:0 sc1
  v_mfma_f32_16x16x32_bf16 v[80:83], v[32:35], a[124:127], v[80:83]
  v_mfma_f32_16x16x32_bf16 v[84:87], v[32:35], a[180:183], v[84:87]
  v_cvt_pk_bf16_f32 v108, v44, v45
  v_mfma_f32_16x16x32_bf16 v[88:91], v[36:39], a[12:15], v[88:91]
  v_mfma_f32_16x16x32_bf16 v[92:95], v[36:39], a[68:71], v[92:95]
  v_cvt_pk_bf16_f32 v109, v46, v47
  v_mfma_f32_16x16x32_bf16 v[96:99], v[36:39], a[124:127], v[96:99]
  v_mfma_f32_16x16x32_bf16 v[100:103], v[36:39], a[180:183], v[100:103]
  v_cvt_pk_bf16_f32 v110, v60, v61
  ds_read_b128 v[32:35], v3 offset:35840
  ds_read_b128 v[36:39], v3 offset:50176
  s_waitcnt lgkmcnt(6)
  v_mfma_f32_16x16x32_bf16 v[72:75], v[8:11], a[16:19], v[72:75]
  v_mfma_f32_16x16x32_bf16 v[76:79], v[8:11], a[72:75], v[76:79]
  v_cvt_pk_bf16_f32 v111, v62, v63
  v_mfma_f32_16x16x32_bf16 v[80:83], v[8:11], a[128:131], v[80:83]
  v_mfma_f32_16x16x32_bf16 v[84:87], v[8:11], a[184:187], v[84:87]
  global_store_dwordx4 v2, v[108:111], s[78:79] offset:1024 sc1
  v_mfma_f32_16x16x32_bf16 v[88:91], v[12:15], a[16:19], v[88:91]
  v_mfma_f32_16x16x32_bf16 v[92:95], v[12:15], a[72:75], v[92:95]
  v_cvt_pk_bf16_f32 v104, v48, v49
  v_mfma_f32_16x16x32_bf16 v[96:99], v[12:15], a[128:131], v[96:99]
  v_mfma_f32_16x16x32_bf16 v[100:103], v[12:15], a[184:187], v[100:103]
  v_cvt_pk_bf16_f32 v105, v50, v51
  ds_read_b128 v[8:11], v3 offset:36864
  ds_read_b128 v[12:15], v3 offset:51200
  s_waitcnt lgkmcnt(6)
  v_mfma_f32_16x16x32_bf16 v[72:75], v[16:19], a[20:23], v[72:75]
  v_mfma_f32_16x16x32_bf16 v[76:79], v[16:19], a[76:79], v[76:79]
  v_cvt_pk_bf16_f32 v106, v64, v65
  v_mfma_f32_16x16x32_bf16 v[80:83], v[16:19], a[132:135], v[80:83]
  v_mfma_f32_16x16x32_bf16 v[84:87], v[16:19], a[188:191], v[84:87]
  v_cvt_pk_bf16_f32 v107, v66, v67
  v_mfma_f32_16x16x32_bf16 v[88:91], v[20:23], a[20:23], v[88:91]
  v_mfma_f32_16x16x32_bf16 v[92:95], v[20:23], a[76:79], v[92:95]
  global_store_dwordx4 v2, v[104:107], s[78:79] offset:2048 sc1
  v_mfma_f32_16x16x32_bf16 v[96:99], v[20:23], a[132:135], v[96:99]
  v_mfma_f32_16x16x32_bf16 v[100:103], v[20:23], a[188:191], v[100:103]
  v_cvt_pk_bf16_f32 v108, v52, v53
  ds_read_b128 v[16:19], v3 offset:37888
  ds_read_b128 v[20:23], v3 offset:52224
  s_waitcnt lgkmcnt(6)
  v_mfma_f32_16x16x32_bf16 v[72:75], v[24:27], a[24:27], v[72:75]
  v_mfma_f32_16x16x32_bf16 v[76:79], v[24:27], a[80:83], v[76:79]
  v_cvt_pk_bf16_f32 v109, v54, v55
  v_mfma_f32_16x16x32_bf16 v[80:83], v[24:27], a[136:139], v[80:83]
  v_mfma_f32_16x16x32_bf16 v[84:87], v[24:27], a[192:195], v[84:87]
  v_cvt_pk_bf16_f32 v110, v68, v69
  v_mfma_f32_16x16x32_bf16 v[88:91], v[28:31], a[24:27], v[88:91]
  v_mfma_f32_16x16x32_bf16 v[92:95], v[28:31], a[80:83], v[92:95]
  v_cvt_pk_bf16_f32 v111, v70, v71
  v_mfma_f32_16x16x32_bf16 v[96:99], v[28:31], a[136:139], v[96:99]
  v_mfma_f32_16x16x32_bf16 v[100:103], v[28:31], a[192:195], v[100:103]
  global_store_dwordx4 v2, v[108:111], s[78:79] offset:3072 sc1
  ds_read_b128 v[24:27], v3 offset:38912
  ds_read_b128 v[28:31], v3 offset:53248
  s_waitcnt lgkmcnt(6)
  v_mfma_f32_16x16x32_bf16 v[72:75], v[32:35], a[28:31], v[72:75]
  v_mfma_f32_16x16x32_bf16 v[76:79], v[32:35], a[84:87], v[76:79]
  s_sub_u32 s85, 3, s82
  s_cmp_eq_u32 s81, 21
  s_cselect_b32 s85, s85, 3
  s_mul_i32 s85, s85, 458752
  s_add_u32 s78, s78, s85
  s_addc_u32 s79, s79, 0
  v_mfma_f32_16x16x32_bf16 v[80:83], v[32:35], a[140:143], v[80:83]
  v_mfma_f32_16x16x32_bf16 v[84:87], v[32:35], a[196:199], v[84:87]
  v_mfma_f32_16x16x32_bf16 v[88:91], v[36:39], a[28:31], v[88:91]
  v_mfma_f32_16x16x32_bf16 v[92:95], v[36:39], a[84:87], v[92:95]
  v_mfma_f32_16x16x32_bf16 v[96:99], v[36:39], a[140:143], v[96:99]
  v_mfma_f32_16x16x32_bf16 v[100:103], v[36:39], a[196:199], v[100:103]
  ds_read_b128 v[32:35], v3 offset:39936
  ds_read_b128 v[36:39], v3 offset:54272
  s_waitcnt lgkmcnt(6)
  v_mfma_f32_16x16x32_bf16 v[72:75], v[8:11], a[32:35], v[72:75]
  v_mfma_f32_16x16x32_bf16 v[76:79], v[8:11], a[88:91], v[76:79]
  v_mfma_f32_16x16x32_bf16 v[80:83], v[8:11], a[144:147], v[80:83]
  v_mfma_f32_16x16x32_bf16 v[84:87], v[8:11], a[200:203], v[84:87]
  v_mfma_f32_16x16x32_bf16 v[88:91], v[12:15], a[32:35], v[88:91]
  v_mfma_f32_16x16x32_bf16 v[92:95], v[12:15], a[88:91], v[92:95]
  v_mfma_f32_16x16x32_bf16 v[96:99], v[12:15], a[144:147], v[96:99]
  v_mfma_f32_16x16x32_bf16 v[100:103], v[12:15], a[200:203], v[100:103]
  ds_read_b128 v[8:11], v3 offset:40960
  ds_read_b128 v[12:15], v3 offset:55296
  s_waitcnt lgkmcnt(6)
  v_mfma_f32_16x16x32_bf16 v[72:75], v[16:19], a[36:39], v[72:75]
  v_mfma_f32_16x16x32_bf16 v[76:79], v[16:19], a[92:95], v[76:79]
  v_mfma_f32_16x16x32_bf16 v[80:83], v[16:19], a[148:151], v[80:83]
  v_mfma_f32_16x16x32_bf16 v[84:87], v[16:19], a[204:207], v[84:87]
  v_mfma_f32_16x16x32_bf16 v[88:91], v[20:23], a[36:39], v[88:91]
  v_mfma_f32_16x16x32_bf16 v[92:95], v[20:23], a[92:95], v[92:95]
  v_mfma_f32_16x16x32_bf16 v[96:99], v[20:23], a[148:151], v[96:99]
  v_mfma_f32_16x16x32_bf16 v[100:103], v[20:23], a[204:207], v[100:103]
  ds_read_b128 v[16:19], v3 offset:41984
  ds_read_b128 v[20:23], v3 offset:56320
  s_waitcnt lgkmcnt(6)
  v_mfma_f32_16x16x32_bf16 v[72:75], v[24:27], a[40:43], v[72:75]
  v_mfma_f32_16x16x32_bf16 v[76:79], v[24:27], a[96:99], v[76:79]
  v_mfma_f32_16x16x32_bf16 v[80:83], v[24:27], a[152:155], v[80:83]
  v_mfma_f32_16x16x32_bf16 v[84:87], v[24:27], a[208:211], v[84:87]
  v_mfma_f32_16x16x32_bf16 v[88:91], v[28:31], a[40:43], v[88:91]
  v_mfma_f32_16x16x32_bf16 v[92:95], v[28:31], a[96:99], v[92:95]
  v_mfma_f32_16x16x32_bf16 v[96:99], v[28:31], a[152:155], v[96:99]
  v_mfma_f32_16x16x32_bf16 v[100:103], v[28:31], a[208:211], v[100:103]
  s_waitcnt lgkmcnt(4)
  v_mfma_f32_16x16x32_bf16 v[72:75], v[32:35], a[44:47], v[72:75]
  v_mfma_f32_16x16x32_bf16 v[76:79], v[32:35], a[100:103], v[76:79]
  v_mfma_f32_16x16x32_bf16 v[80:83], v[32:35], a[156:159], v[80:83]
  v_mfma_f32_16x16x32_bf16 v[84:87], v[32:35], a[212:215], v[84:87]
  v_mfma_f32_16x16x32_bf16 v[88:91], v[36:39], a[44:47], v[88:91]
  v_mfma_f32_16x16x32_bf16 v[92:95], v[36:39], a[100:103], v[92:95]
  v_mfma_f32_16x16x32_bf16 v[96:99], v[36:39], a[156:159], v[96:99]
  v_mfma_f32_16x16x32_bf16 v[100:103], v[36:39], a[212:215], v[100:103]
  s_waitcnt lgkmcnt(2)
  v_mfma_f32_16x16x32_bf16 v[72:75], v[8:11], a[48:51], v[72:75]
  v_mfma_f32_16x16x32_bf16 v[76:79], v[8:11], a[104:107], v[76:79]
  v_mfma_f32_16x16x32_bf16 v[80:83], v[8:11], a[160:163], v[80:83]
  v_mfma_f32_16x16x32_bf16 v[84:87], v[8:11], a[216:219], v[84:87]
  v_mfma_f32_16x16x32_bf16 v[88:91], v[12:15], a[48:51], v[88:91]
  v_mfma_f32_16x16x32_bf16 v[92:95], v[12:15], a[104:107], v[92:95]
  v_mfma_f32_16x16x32_bf16 v[96:99], v[12:15], a[160:163], v[96:99]
  v_mfma_f32_16x16x32_bf16 v[100:103], v[12:15], a[216:219], v[100:103]
  s_waitcnt lgkmcnt(0)
  v_mfma_f32_16x16x32_bf16 v[72:75], v[16:19], a[52:55], v[72:75]
  v_mfma_f32_16x16x32_bf16 v[76:79], v[16:19], a[108:111], v[76:79]
  v_mfma_f32_16x16x32_bf16 v[80:83], v[16:19], a[164:167], v[80:83]
  v_mfma_f32_16x16x32_bf16 v[84:87], v[16:19], a[220:223], v[84:87]
  v_mfma_f32_16x16x32_bf16 v[88:91], v[20:23], a[52:55], v[88:91]
  v_mfma_f32_16x16x32_bf16 v[92:95], v[20:23], a[108:111], v[92:95]
  v_mfma_f32_16x16x32_bf16 v[96:99], v[20:23], a[164:167], v[96:99]
  v_mfma_f32_16x16x32_bf16 v[100:103], v[20:23], a[220:223], v[100:103]
  s_waitcnt vmcnt(4)
  s_cmp_lg_u32 s81, 1
  s_cbranch_scc1 L_vx1_239
  s_waitcnt vmcnt(0)
L_vx1_239:
  s_barrier
  s_cmp_lg_u32 s81, 1
  s_cbranch_scc1 L_ns_240
  v_cmp_eq_u32 vcc, 0, v0
  s_and_saveexec_b64 s[20:21], vcc
  s_cbranch_execz L_sig_241
  v_mov_b32 v112, 1024
  v_mov_b32 v113, 1
  global_atomic_add v112, v113, s[86:87] sc1
L_sig_241:
  s_mov_b64 exec, s[20:21]
L_ns_240:
  s_cmp_lg_u32 s81, 6
  s_cbranch_scc1 L_ns_242
  v_cmp_eq_u32 vcc, 0, v0
  s_and_saveexec_b64 s[20:21], vcc
  s_cbranch_execz L_sig_243
  v_mov_b32 v112, 1152
  v_mov_b32 v113, 1
  global_atomic_add v112, v113, s[86:87] sc1
L_sig_243:
  s_mov_b64 exec, s[20:21]
L_ns_242:
  s_add_u32 s81, s81, 1
  ds_read_b128 v[8:11], v3 offset:0
  ds_read_b128 v[12:15], v3 offset:14336
  ds_read_b128 v[16:19], v3 offset:1024
  ds_read_b128 v[20:23], v3 offset:15360
  ds_read_b128 v[24:27], v3 offset:2048
  ds_read_b128 v[28:31], v3 offset:16384
  s_add_u32 s72, s80, 28672
  s_mov_b32 m0, s72
  s_nop 0
  global_load_lds_dwordx4 v2, s[76:77] offset:-4096
  global_load_lds_dwordx4 v2, s[76:77] offset:-3072
  global_load_lds_dwordx4 v2, s[76:77] offset:-2048
  global_load_lds_dwordx4 v2, s[76:77] offset:-1024
  global_load_lds_dwordx4 v2, s[76:77] offset:0
  global_load_lds_dwordx4 v2, s[76:77] offset:1024
  global_load_lds_dwordx4 v2, s[76:77] offset:2048
  s_sub_u32 s84, 3, s82
  s_cmp_eq_u32 s81, 19
  s_cselect_b32 s84, s84, 3
  s_mul_i32 s84, s84, 28672
  s_add_u32 s76, s76, s84
  s_addc_u32 s77, s77, 0
  ds_read_b128 v[32:35], v3 offset:3072
  ds_read_b128 v[36:39], v3 offset:17408
  s_waitcnt lgkmcnt(6)
  v_mfma_f32_16x16x32_bf16 v[40:43], v[8:11], a[0:3], 0
  v_mfma_f32_16x16x32_bf16 v[44:47], v[8:11], a[56:59], 0
  v_mfma_f32_16x16x32_bf16 v[48:51], v[8:11], a[112:115], 0
  v_mfma_f32_16x16x32_bf16 v[52:55], v[8:11], a[168:171], 0
  v_mfma_f32_16x16x32_bf16 v[56:59], v[12:15], a[0:3], 0
  v_mfma_f32_16x16x32_bf16 v[60:63], v[12:15], a[56:59], 0
  v_mfma_f32_16x16x32_bf16 v[64:67], v[12:15], a[112:115], 0
  v_mfma_f32_16x16x32_bf16 v[68:71], v[12:15], a[168:171], 0
  ds_read_b128 v[8:11], v3 offset:4096
  ds_read_b128 v[12:15], v3 offset:18432
  s_waitcnt lgkmcnt(6)
  v_mfma_f32_16x16x32_bf16 v[40:43], v[16:19], a[4:7], v[40:43]
  v_mfma_f32_16x16x32_bf16 v[44:47], v[16:19], a[60:63], v[44:47]
  v_mfma_f32_16x16x32_bf16 v[48:51], v[16:19], a[116:119], v[48:51]
  v_mfma_f32_16x16x32_bf16 v[52:55], v[16:19], a[172:175], v[52:55]
  v_mfma_f32_16x16x32_bf16 v[56:59], v[20:23], a[4:7], v[56:59]
  v_mfma_f32_16x16x32_bf16 v[60:63], v[20:23], a[60:63], v[60:63]
  v_mfma_f32_16x16x32_bf16 v[64:67], v[20:23], a[116:119], v[64:67]
  v_mfma_f32_16x16x32_bf16 v[68:71], v[20:23], a[172:175], v[68:71]
  ds_read_b128 v[16:19], v3 offset:5120
  ds_read_b128 v[20:23], v3 offset:19456
  s_waitcnt lgkmcnt(6)
  v_mfma_f32_16x16x32_bf16 v[40:43], v[24:27], a[8:11], v[40:43]
  v_mfma_f32_16x16x32_bf16 v[44:47], v[24:27], a[64:67], v[44:47]
  v_cvt_pk_bf16_f32 v104, v72, v73
  v_mfma_f32_16x16x32_bf16 v[48:51], v[24:27], a[120:123], v[48:51]
  v_mfma_f32_16x16x32_bf16 v[52:55], v[24:27], a[176:179], v[52:55]
  v_cvt_pk_bf16_f32 v105, v74, v75
  v_mfma_f32_16x16x32_bf16 v[56:59], v[28:31], a[8:11], v[56:59]
  v_mfma_f32_16x16x32_bf16 v[60:63], v[28:31], a[64:67], v[60:63]
  v_cvt_pk_bf16_f32 v106, v88, v89
  v_mfma_f32_16x16x32_bf16 v[64:67], v[28:31], a[120:123], v[64:67]
  v_mfma_f32_16x16x32_bf16 v[68:71], v[28:31], a[176:179], v[68:71]
  v_cvt_pk_bf16_f32 v107, v90, v91
  ds_read_b128 v[24:27], v3 offset:6144
  ds_read_b128 v[28:31], v3 offset:20480
  s_waitcnt lgkmcnt(6)
  v_mfma_f32_16x16x32_bf16 v[40:43], v[32:35], a[12:15], v[40:43]
  v_mfma_f32_16x16x32_bf16 v[44:47], v[32:35], a[68:71], v[44:47]
  global_store_dwordx4 v2, v[104:107], s[78:79] offset:0 sc1
  v_mfma_f32_16x16x32_bf16 v[48:51], v[32:35], a[124:127], v[48:51]
  v_mfma_f32_16x16x32_bf16 v[52:55], v[32:35], a[180:183], v[52:55]
  v_cvt_pk_bf16_f32 v108, v76, v77
  v_mfma_f32_16x16x32_bf16 v[56:59], v[36:39], a[12:15], v[56:59]
  v_mfma_f32_16x16x32_bf16 v[60:63], v[36:39], a[68:71], v[60:63]
  v_cvt_pk_bf16_f32 v109, v78, v79
  v_mfma_f32_16x16x32_bf16 v[64:67], v[36:39], a[124:127], v[64:67]
  v_mfma_f32_16x16x32_bf16 v[68:71], v[36:39], a[180:183], v[68:71]
  v_cvt_pk_bf16_f32 v110, v92, v93
  ds_read_b128 v[32:35], v3 offset:7168
  ds_read_b128 v[36:39], v3 offset:21504
  s_waitcnt lgkmcnt(6)
  v_mfma_f32_16x16x32_bf16 v[40:43], v[8:11], a[16:19], v[40:43]
  v_mfma_f32_16x16x32_bf16 v[44:47], v[8:11], a[72:75], v[44:47]
  v_cvt_pk_bf16_f32 v111, v94, v95
  v_mfma_f32_16x16x32_bf16 v[48:51], v[8:11], a[128:131], v[48:51]
  v_mfma_f32_16x16x32_bf16 v[52:55], v[8:11], a[184:187], v[52:55]
  global_store_dwordx4 v2, v[108:111], s[78:79] offset:1024 sc1
  v_mfma_f32_16x16x32_bf16 v[56:59], v[12:15], a[16:19], v[56:59]
  v_mfma_f32_16x16x32_bf16 v[60:63], v[12:15], a[72:75], v[60:63]
  v_cvt_pk_bf16_f32 v104, v80, v81
  v_mfma_f32_16x16x32_bf16 v[64:67], v[12:15], a[128:131], v[64:67]
  v_mfma_f32_16x16x32_bf16 v[68:71], v[12:15], a[184:187], v[68:71]
  v_cvt_pk_bf16_f32 v105, v82, v83
  ds_read_b128 v[8:11], v3 offset:8192
  ds_read_b128 v[12:15], v3 offset:22528
  s_waitcnt lgkmcnt(6)
  v_mfma_f32_16x16x32_bf16 v[40:43], v[16:19], a[20:23], v[40:43]
  v_mfma_f32_16x16x32_bf16 v[44:47], v[16:19], a[76:79], v[44:47]
  v_cvt_pk_bf16_f32 v106, v96, v97
  v_mfma_f32_16x16x32_bf16 v[48:51], v[16:19], a[132:135], v[48:51]
  v_mfma_f32_16x16x32_bf16 v[52:55], v[16:19], a[188:191], v[52:55]
  v_cvt_pk_bf16_f32 v107, v98, v99
  v_mfma_f32_16x16x32_bf16 v[56:59], v[20:23], a[20:23], v[56:59]
  v_mfma_f32_16x16x32_bf16 v[60:63], v[20:23], a[76:79], v[60:63]
  global_store_dwordx4 v2, v[104:107], s[78:79] offset:2048 sc1
  v_mfma_f32_16x16x32_bf16 v[64:67], v[20:23], a[132:135], v[64:67]
  v_mfma_f32_16x16x32_bf16 v[68:71], v[20:23], a[188:191], v[68:71]
  v_cvt_pk_bf16_f32 v108, v84, v85
  ds_read_b128 v[16:19], v3 offset:9216
  ds_read_b128 v[20:23], v3 offset:23552
  s_waitcnt lgkmcnt(6)
  v_mfma_f32_16x16x32_bf16 v[40:43], v[24:27], a[24:27], v[40:43]
  v_mfma_f32_16x16x32_bf16 v[44:47], v[24:27], a[80:83], v[44:47]
  v_cvt_pk_bf16_f32 v109, v86, v87
  v_mfma_f32_16x16x32_bf16 v[48:51], v[24:27], a[136:139], v[48:51]
  v_mfma_f32_16x16x32_bf16 v[52:55], v[24:27], a[192:195], v[52:55]
  v_cvt_pk_bf16_f32 v110, v100, v101
  v_mfma_f32_16x16x32_bf16 v[56:59], v[28:31], a[24:27], v[56:59]
  v_mfma_f32_16x16x32_bf16 v[60:63], v[28:31], a[80:83], v[60:63]
  v_cvt_pk_bf16_f32 v111, v102, v103
  v_mfma_f32_16x16x32_bf16 v[64:67], v[28:31], a[136:139], v[64:67]
  v_mfma_f32_16x16x32_bf16 v[68:71], v[28:31], a[192:195], v[68:71]
  global_store_dwordx4 v2, v[108:111], s[78:79] offset:3072 sc1
  ds_read_b128 v[24:27], v3 offset:10240
  ds_read_b128 v[28:31], v3 offset:24576
  s_waitcnt lgkmcnt(6)
  v_mfma_f32_16x16x32_bf16 v[40:43], v[32:35], a[28:31], v[40:43]
  v_mfma_f32_16x16x32_bf16 v[44:47], v[32:35], a[84:87], v[44:47]
  s_sub_u32 s85, 3, s82
  s_cmp_eq_u32 s81, 21
  s_cselect_b32 s85, s85, 3
  s_mul_i32 s85, s85, 458752
  s_add_u32 s78, s78, s85
  s_addc_u32 s79, s79, 0
  v_mfma_f32_16x16x32_bf16 v[48:51], v[32:35], a[140:143], v[48:51]
  v_mfma_f32_16x16x32_bf16 v[52:55], v[32:35], a[196:199], v[52:55]
  v_mfma_f32_16x16x32_bf16 v[56:59], v[36:39], a[28:31], v[56:59]
  v_mfma_f32_16x16x32_bf16 v[60:63], v[36:39], a[84:87], v[60:63]
  v_mfma_f32_16x16x32_bf16 v[64:67], v[36:39], a[140:143], v[64:67]
  v_mfma_f32_16x16x32_bf16 v[68:71], v[36:39], a[196:199], v[68:71]
  ds_read_b128 v[32:35], v3 offset:11264
  ds_read_b128 v[36:39], v3 offset:25600
  s_waitcnt lgkmcnt(6)
  v_mfma_f32_16x16x32_bf16 v[40:43], v[8:11], a[32:35], v[40:43]
  v_mfma_f32_16x16x32_bf16 v[44:47], v[8:11], a[88:91], v[44:47]
  v_mfma_f32_16x16x32_bf16 v[48:51], v[8:11], a[144:147], v[48:51]
  v_mfma_f32_16x16x32_bf16 v[52:55], v[8:11], a[200:203], v[52:55]
  v_mfma_f32_16x16x32_bf16 v[56:59], v[12:15], a[32:35], v[56:59]
  v_mfma_f32_16x16x32_bf16 v[60:63], v[12:15], a[88:91], v[60:63]
  v_mfma_f32_16x16x32_bf16 v[64:67], v[12:15], a[144:147], v[64:67]
  v_mfma_f32_16x16x32_bf16 v[68:71], v[12:15], a[200:203], v[68:71]
  ds_read_b128 v[8:11], v3 offset:12288
  ds_read_b128 v[12:15], v3 offset:26624
  s_waitcnt lgkmcnt(6)
  v_mfma_f32_16x16x32_bf16 v[40:43], v[16:19], a[36:39], v[40:43]
  v_mfma_f32_16x16x32_bf16 v[44:47], v[16:19], a[92:95], v[44:47]
  v_mfma_f32_16x16x32_bf16 v[48:51], v[16:19], a[148:151], v[48:51]
  v_mfma_f32_16x16x32_bf16 v[52:55], v[16:19], a[204:207], v[52:55]
  v_mfma_f32_16x16x32_bf16 v[56:59], v[20:23], a[36:39], v[56:59]
  v_mfma_f32_16x16x32_bf16 v[60:63], v[20:23], a[92:95], v[60:63]
  v_mfma_f32_16x16x32_bf16 v[64:67], v[20:23], a[148:151], v[64:67]
  v_mfma_f32_16x16x32_bf16 v[68:71], v[20:23], a[204:207], v[68:71]
  ds_read_b128 v[16:19], v3 offset:13312
  ds_read_b128 v[20:23], v3 offset:27648
  s_waitcnt lgkmcnt(6)
  v_mfma_f32_16x16x32_bf16 v[40:43], v[24:27], a[40:43], v[40:43]
  v_mfma_f32_16x16x32_bf16 v[44:47], v[24:27], a[96:99], v[44:47]
  v_mfma_f32_16x16x32_bf16 v[48:51], v[24:27], a[152:155], v[48:51]
  v_mfma_f32_16x16x32_bf16 v[52:55], v[24:27], a[208:211], v[52:55]
  v_mfma_f32_16x16x32_bf16 v[56:59], v[28:31], a[40:43], v[56:59]
  v_mfma_f32_16x16x32_bf16 v[60:63], v[28:31], a[96:99], v[60:63]
  v_mfma_f32_16x16x32_bf16 v[64:67], v[28:31], a[152:155], v[64:67]
  v_mfma_f32_16x16x32_bf16 v[68:71], v[28:31], a[208:211], v[68:71]
  s_waitcnt lgkmcnt(4)
  v_mfma_f32_16x16x32_bf16 v[40:43], v[32:35], a[44:47], v[40:43]
  v_mfma_f32_16x16x32_bf16 v[44:47], v[32:35], a[100:103], v[44:47]
  v_mfma_f32_16x16x32_bf16 v[48:51], v[32:35], a[156:159], v[48:51]
  v_mfma_f32_16x16x32_bf16 v[52:55], v[32:35], a[212:215], v[52:55]
  v_mfma_f32_16x16x32_bf16 v[56:59], v[36:39], a[44:47], v[56:59]
  v_mfma_f32_16x16x32_bf16 v[60:63], v[36:39], a[100:103], v[60:63]
  v_mfma_f32_16x16x32_bf16 v[64:67], v[36:39], a[156:159], v[64:67]
  v_mfma_f32_16x16x32_bf16 v[68:71], v[36:39], a[212:215], v[68:71]
  s_waitcnt lgkmcnt(2)
  v_mfma_f32_16x16x32_bf16 v[40:43], v[8:11], a[48:51], v[40:43]
  v_mfma_f32_16x16x32_bf16 v[44:47], v[8:11], a[104:107], v[44:47]
  v_mfma_f32_16x16x32_bf16 v[48:51], v[8:11], a[160:163], v[48:51]
  v_mfma_f32_16x16x32_bf16 v[52:55], v[8:11], a[216:219], v[52:55]
  v_mfma_f32_16x16x32_bf16 v[56:59], v[12:15], a[48:51], v[56:59]
  v_mfma_f32_16x16x32_bf16 v[60:63], v[12:15], a[104:107], v[60:63]
  v_mfma_f32_16x16x32_bf16 v[64:67], v[12:15], a[160:163], v[64:67]
  v_mfma_f32_16x16x32_bf16 v[68:71], v[12:15], a[216:219], v[68:71]
  s_waitcnt lgkmcnt(0)
  v_mfma_f32_16x16x32_bf16 v[40:43], v[16:19], a[52:55], v[40:43]
  v_mfma_f32_16x16x32_bf16 v[44:47], v[16:19], a[108:111], v[44:47]
  v_mfma_f32_16x16x32_bf16 v[48:51], v[16:19], a[164:167], v[48:51]
  v_mfma_f32_16x16x32_bf16 v[52:55], v[16:19], a[220:223], v[52:55]
  v_mfma_f32_16x16x32_bf16 v[56:59], v[20:23], a[52:55], v[56:59]
  v_mfma_f32_16x16x32_bf16 v[60:63], v[20:23], a[108:111], v[60:63]
  v_mfma_f32_16x16x32_bf16 v[64:67], v[20:23], a[164:167], v[64:67]
  v_mfma_f32_16x16x32_bf16 v[68:71], v[20:23], a[220:223], v[68:71]
  s_waitcnt vmcnt(4)
  s_cmp_lg_u32 s81, 1
  s_cbranch_scc1 L_vx1_244
  s_waitcnt vmcnt(0)
L_vx1_244:
  s_barrier
  s_cmp_lg_u32 s81, 1
  s_cbranch_scc1 L_ns_245
  v_cmp_eq_u32 vcc, 0, v0
  s_and_saveexec_b64 s[20:21], vcc
  s_cbranch_execz L_sig_246
  v_mov_b32 v112, 1024
  v_mov_b32 v113, 1
  global_atomic_add v112, v113, s[86:87] sc1
L_sig_246:
  s_mov_b64 exec, s[20:21]
L_ns_245:
  s_cmp_lg_u32 s81, 6
  s_cbranch_scc1 L_ns_247
  v_cmp_eq_u32 vcc, 0, v0
  s_and_saveexec_b64 s[20:21], vcc
  s_cbranch_execz L_sig_248
  v_mov_b32 v112, 1152
  v_mov_b32 v113, 1
  global_atomic_add v112, v113, s[86:87] sc1
L_sig_248:
  s_mov_b64 exec, s[20:21]
L_ns_247:
  s_add_u32 s81, s81, 1
  s_cmp_lt_u32 s81, 21
  s_cbranch_scc1 L_vxl_238
  ds_read_b128 v[8:11], v3 offset:28672
  ds_read_b128 v[12:15], v3 offset:43008
  ds_read_b128 v[16:19], v3 offset:29696
  ds_read_b128 v[20:23], v3 offset:44032
  ds_read_b128 v[24:27], v3 offset:30720
  ds_read_b128 v[28:31], v3 offset:45056
  ds_read_b128 v[32:35], v3 offset:31744
  ds_read_b128 v[36:39], v3 offset:46080
  s_waitcnt lgkmcnt(6)
  v_mfma_f32_16x16x32_bf16 v[72:75], v[8:11], a[0:3], 0
  v_mfma_f32_16x16x32_bf16 v[76:79], v[8:11], a[56:59], 0
  v_mfma_f32_16x16x32_bf16 v[80:83], v[8:11], a[112:115], 0
  v_mfma_f32_16x16x32_bf16 v[84:87], v[8:11], a[168:171], 0
  v_mfma_f32_16x16x32_bf16 v[88:91], v[12:15], a[0:3], 0
  v_mfma_f32_16x16x32_bf16 v[92:95], v[12:15], a[56:59], 0
  v_mfma_f32_16x16x32_bf16 v[96:99], v[12:15], a[112:115], 0
  v_mfma_f32_16x16x32_bf16 v[100:103], v[12:15], a[168:171], 0
  ds_read_b128 v[8:11], v3 offset:32768
  ds_read_b128 v[12:15], v3 offset:47104
  s_waitcnt lgkmcnt(6)
  v_mfma_f32_16x16x32_bf16 v[72:75], v[16:19], a[4:7], v[72:75]
  v_mfma_f32_16x16x32_bf16 v[76:79], v[16:19], a[60:63], v[76:79]
  v_mfma_f32_16x16x32_bf16 v[80:83], v[16:19], a[116:119], v[80:83]
  v_mfma_f32_16x16x32_bf16 v[84:87], v[16:19], a[172:175], v[84:87]
  v_mfma_f32_16x16x32_bf16 v[88:91], v[20:23], a[4:7], v[88:91]
  v_mfma_f32_16x16x32_bf16 v[92:95], v[20:23], a[60:63], v[92:95]
  v_mfma_f32_16x16x32_bf16 v[96:99], v[20:23], a[116:119], v[96:99]
  v_mfma_f32_16x16x32_bf16 v[100:103], v[20:23], a[172:175], v[100:103]
  ds_read_b128 v[16:19], v3 offset:33792
  ds_read_b128 v[20:23], v3 offset:48128
  s_waitcnt lgkmcnt(6)
  v_mfma_f32_16x16x32_bf16 v[72:75], v[24:27], a[8:11], v[72:75]
  v_mfma_f32_16x16x32_bf16 v[76:79], v[24:27], a[64:67], v[76:79]
  v_cvt_pk_bf16_f32 v104, v40, v41
  v_mfma_f32_16x16x32_bf16 v[80:83], v[24:27], a[120:123], v[80:83]
  v_mfma_f32_16x16x32_bf16 v[84:87], v[24:27], a[176:179], v[84:87]
  v_cvt_pk_bf16_f32 v105, v42, v43
  v_mfma_f32_16x16x32_bf16 v[88:91], v[28:31], a[8:11], v[88:91]
  v_mfma_f32_16x16x32_bf16 v[92:95], v[28:31], a[64:67], v[92:95]
  v_cvt_pk_bf16_f32 v106, v56, v57
  v_mfma_f32_16x16x32_bf16 v[96:99], v[28:31], a[120:123], v[96:99]
  v_mfma_f32_16x16x32_bf16 v[100:103], v[28:31], a[176:179], v[100:103]
  v_cvt_pk_bf16_f32 v107, v58, v59
  ds_read_b128 v[24:27], v3 offset:34816
  ds_read_b128 v[28:31], v3 offset:49152
  s_waitcnt lgkmcnt(6)
  v_mfma_f32_16x16x32_bf16 v[72:75], v[32:35], a[12:15], v[72:75]
  v_mfma_f32_16x16x32_bf16 v[76:79], v[32:35], a[68:71], v[76:79]
  global_store_dwordx4 v2, v[104:107], s[78:79] offset:0 sc1
  v_mfma_f32_16x16x32_bf16 v[80:83], v[32:35], a[124:127], v[80:83]
  v_mfma_f32_16x16x32_bf16 v[84:87], v[32:35], a[180:183], v[84:87]
  v_cvt_pk_bf16_f32 v108, v44, v45
  v_mfma_f32_16x16x32_bf16 v[88:91], v[36:39], a[12:15], v[88:91]
  v_mfma_f32_16x16x32_bf16 v[92:95], v[36:39], a[68:71], v[92:95]
  v_cvt_pk_bf16_f32 v109, v46, v47
  v_mfma_f32_16x16x32_bf16 v[96:99], v[36:39], a[124:127], v[96:99]
  v_mfma_f32_16x16x32_bf16 v[100:103], v[36:39], a[180:183], v[100:103]
  v_cvt_pk_bf16_f32 v110, v60, v61
  ds_read_b128 v[32:35], v3 offset:35840
  ds_read_b128 v[36:39], v3 offset:50176
  s_waitcnt lgkmcnt(6)
  v_mfma_f32_16x16x32_bf16 v[72:75], v[8:11], a[16:19], v[72:75]
  v_mfma_f32_16x16x32_bf16 v[76:79], v[8:11], a[72:75], v[76:79]
  v_cvt_pk_bf16_f32 v111, v62, v63
  v_mfma_f32_16x16x32_bf16 v[80:83], v[8:11], a[128:131], v[80:83]
  v_mfma_f32_16x16x32_bf16 v[84:87], v[8:11], a[184:187], v[84:87]
  global_store_dwordx4 v2, v[108:111], s[78:79] offset:1024 sc1
  v_mfma_f32_16x16x32_bf16 v[88:91], v[12:15], a[16:19], v[88:91]
  v_mfma_f32_16x16x32_bf16 v[92:95], v[12:15], a[72:75], v[92:95]
  v_cvt_pk_bf16_f32 v104, v48, v49
  v_mfma_f32_16x16x32_bf16 v[96:99], v[12:15], a[128:131], v[96:99]
  v_mfma_f32_16x16x32_bf16 v[100:103], v[12:15], a[184:187], v[100:103]
  v_cvt_pk_bf16_f32 v105, v50, v51
  ds_read_b128 v[8:11], v3 offset:36864
  ds_read_b128 v[12:15], v3 offset:51200
  s_waitcnt lgkmcnt(6)
  v_mfma_f32_16x16x32_bf16 v[72:75], v[16:19], a[20:23], v[72:75]
  v_mfma_f32_16x16x32_bf16 v[76:79], v[16:19], a[76:79], v[76:79]
  v_cvt_pk_bf16_f32 v106, v64, v65
  v_mfma_f32_16x16x32_bf16 v[80:83], v[16:19], a[132:135], v[80:83]
  v_mfma_f32_16x16x32_bf16 v[84:87], v[16:19], a[188:191], v[84:87]
  v_cvt_pk_bf16_f32 v107, v66, v67
  v_mfma_f32_16x16x32_bf16 v[88:91], v[20:23], a[20:23], v[88:91]
  v_mfma_f32_16x16x32_bf16 v[92:95], v[20:23], a[76:79], v[92:95]
  global_store_dwordx4 v2, v[104:107], s[78:79] offset:2048 sc1
  v_mfma_f32_16x16x32_bf16 v[96:99], v[20:23], a[132:135], v[96:99]
  v_mfma_f32_16x16x32_bf16 v[100:103], v[20:23], a[188:191], v[100:103]
  v_cvt_pk_bf16_f32 v108, v52, v53
  ds_read_b128 v[16:19], v3 offset:37888
  ds_read_b128 v[20:23], v3 offset:52224
  s_waitcnt lgkmcnt(6)
  v_mfma_f32_16x16x32_bf16 v[72:75], v[24:27], a[24:27], v[72:75]
  v_mfma_f32_16x16x32_bf16 v[76:79], v[24:27], a[80:83], v[76:79]
  v_cvt_pk_bf16_f32 v109, v54, v55
  v_mfma_f32_16x16x32_bf16 v[80:83], v[24:27], a[136:139], v[80:83]
  v_mfma_f32_16x16x32_bf16 v[84:87], v[24:27], a[192:195], v[84:87]
  v_cvt_pk_bf16_f32 v110, v68, v69
  v_mfma_f32_16x16x32_bf16 v[88:91], v[28:31], a[24:27], v[88:91]
  v_mfma_f32_16x16x32_bf16 v[92:95], v[28:31], a[80:83], v[92:95]
  v_cvt_pk_bf16_f32 v111, v70, v71
  v_mfma_f32_16x16x32_bf16 v[96:99], v[28:31], a[136:139], v[96:99]
  v_mfma_f32_16x16x32_bf16 v[100:103], v[28:31], a[192:195], v[100:103]
  global_store_dwordx4 v2, v[108:111], s[78:79] offset:3072 sc1
  ds_read_b128 v[24:27], v3 offset:38912
  ds_read_b128 v[28:31], v3 offset:53248
  s_waitcnt lgkmcnt(6)
  v_mfma_f32_16x16x32_bf16 v[72:75], v[32:35], a[28:31], v[72:75]
  v_mfma_f32_16x16x32_bf16 v[76:79], v[32:35], a[84:87], v[76:79]
  s_sub_u32 s85, 3, s82
  s_cmp_eq_u32 s81, 21
  s_cselect_b32 s85, s85, 3
  s_mul_i32 s85, s85, 458752
  s_add_u32 s78, s78, s85
  s_addc_u32 s79, s79, 0
  v_mfma_f32_16x16x32_bf16 v[80:83], v[32:35], a[140:143], v[80:83]
  v_mfma_f32_16x16x32_bf16 v[84:87], v[32:35], a[196:199], v[84:87]
  v_mfma_f32_16x16x32_bf16 v[88:91], v[36:39], a[28:31], v[88:91]
  v_mfma_f32_16x16x32_bf16 v[92:95], v[36:39], a[84:87], v[92:95]
  v_mfma_f32_16x16x32_bf16 v[96:99], v[36:39], a[140:143], v[96:99]
  v_mfma_f32_16x16x32_bf16 v[100:103], v[36:39], a[196:199], v[100:103]
  ds_read_b128 v[32:35], v3 offset:39936
  ds_read_b128 v[36:39], v3 offset:54272
  s_waitcnt lgkmcnt(6)
  v_mfma_f32_16x16x32_bf16 v[72:75], v[8:11], a[32:35], v[72:75]
  v_mfma_f32_16x16x32_bf16 v[76:79], v[8:11], a[88:91], v[76:79]
  v_mfma_f32_16x16x32_bf16 v[80:83], v[8:11], a[144:147], v[80:83]
  v_mfma_f32_16x16x32_bf16 v[84:87], v[8:11], a[200:203], v[84:87]
  v_mfma_f32_16x16x32_bf16 v[88:91], v[12:15], a[32:35], v[88:91]
  v_mfma_f32_16x16x32_bf16 v[92:95], v[12:15], a[88:91], v[92:95]
  v_mfma_f32_16x16x32_bf16 v[96:99], v[12:15], a[144:147], v[96:99]
  v_mfma_f32_16x16x32_bf16 v[100:103], v[12:15], a[200:203], v[100:103]
  ds_read_b128 v[8:11], v3 offset:40960
  ds_read_b128 v[12:15], v3 offset:55296
  s_waitcnt lgkmcnt(6)
  v_mfma_f32_16x16x32_bf16 v[72:75], v[16:19], a[36:39], v[72:75]
  v_mfma_f32_16x16x32_bf16 v[76:79], v[16:19], a[92:95], v[76:79]
  v_mfma_f32_16x16x32_bf16 v[80:83], v[16:19], a[148:151], v[80:83]
  v_mfma_f32_16x16x32_bf16 v[84:87], v[16:19], a[204:207], v[84:87]
  v_mfma_f32_16x16x32_bf16 v[88:91], v[20:23], a[36:39], v[88:91]
  v_mfma_f32_16x16x32_bf16 v[92:95], v[20:23], a[92:95], v[92:95]
  v_mfma_f32_16x16x32_bf16 v[96:99], v[20:23], a[148:151], v[96:99]
  v_mfma_f32_16x16x32_bf16 v[100:103], v[20:23], a[204:207], v[100:103]
  ds_read_b128 v[16:19], v3 offset:41984
  ds_read_b128 v[20:23], v3 offset:56320
  s_waitcnt lgkmcnt(6)
  v_mfma_f32_16x16x32_bf16 v[72:75], v[24:27], a[40:43], v[72:75]
  v_mfma_f32_16x16x32_bf16 v[76:79], v[24:27], a[96:99], v[76:79]
  v_mfma_f32_16x16x32_bf16 v[80:83], v[24:27], a[152:155], v[80:83]
  v_mfma_f32_16x16x32_bf16 v[84:87], v[24:27], a[208:211], v[84:87]
  v_mfma_f32_16x16x32_bf16 v[88:91], v[28:31], a[40:43], v[88:91]
  v_mfma_f32_16x16x32_bf16 v[92:95], v[28:31], a[96:99], v[92:95]
  v_mfma_f32_16x16x32_bf16 v[96:99], v[28:31], a[152:155], v[96:99]
  v_mfma_f32_16x16x32_bf16 v[100:103], v[28:31], a[208:211], v[100:103]
  s_waitcnt lgkmcnt(4)
  v_mfma_f32_16x16x32_bf16 v[72:75], v[32:35], a[44:47], v[72:75]
  v_mfma_f32_16x16x32_bf16 v[76:79], v[32:35], a[100:103], v[76:79]
  v_mfma_f32_16x16x32_bf16 v[80:83], v[32:35], a[156:159], v[80:83]
  v_mfma_f32_16x16x32_bf16 v[84:87], v[32:35], a[212:215], v[84:87]
  v_mfma_f32_16x16x32_bf16 v[88:91], v[36:39], a[44:47], v[88:91]
  v_mfma_f32_16x16x32_bf16 v[92:95], v[36:39], a[100:103], v[92:95]
  v_mfma_f32_16x16x32_bf16 v[96:99], v[36:39], a[156:159], v[96:99]
  v_mfma_f32_16x16x32_bf16 v[100:103], v[36:39], a[212:215], v[100:103]
  s_waitcnt lgkmcnt(2)
  v_mfma_f32_16x16x32_bf16 v[72:75], v[8:11], a[48:51], v[72:75]
  v_mfma_f32_16x16x32_bf16 v[76:79], v[8:11], a[104:107], v[76:79]
  v_mfma_f32_16x16x32_bf16 v[80:83], v[8:11], a[160:163], v[80:83]
  v_mfma_f32_16x16x32_bf16 v[84:87], v[8:11], a[216:219], v[84:87]
  v_mfma_f32_16x16x32_bf16 v[88:91], v[12:15], a[48:51], v[88:91]
  v_mfma_f32_16x16x32_bf16 v[92:95], v[12:15], a[104:107], v[92:95]
  v_mfma_f32_16x16x32_bf16 v[96:99], v[12:15], a[160:163], v[96:99]
  v_mfma_f32_16x16x32_bf16 v[100:103], v[12:15], a[216:219], v[100:103]
  s_waitcnt lgkmcnt(0)
  v_mfma_f32_16x16x32_bf16 v[72:75], v[16:19], a[52:55], v[72:75]
  v_mfma_f32_16x16x32_bf16 v[76:79], v[16:19], a[108:111], v[76:79]
  v_mfma_f32_16x16x32_bf16 v[80:83], v[16:19], a[164:167], v[80:83]
  v_mfma_f32_16x16x32_bf16 v[84:87], v[16:19], a[220:223], v[84:87]
  v_mfma_f32_16x16x32_bf16 v[88:91], v[20:23], a[52:55], v[88:91]
  v_mfma_f32_16x16x32_bf16 v[92:95], v[20:23], a[108:111], v[92:95]
  v_mfma_f32_16x16x32_bf16 v[96:99], v[20:23], a[164:167], v[96:99]
  v_mfma_f32_16x16x32_bf16 v[100:103], v[20:23], a[220:223], v[100:103]
  s_add_u32 s81, s81, 1
  s_nop 7
  v_cvt_pk_bf16_f32 v104, v72, v73
  v_cvt_pk_bf16_f32 v105, v74, v75
  v_cvt_pk_bf16_f32 v106, v88, v89
  v_cvt_pk_bf16_f32 v107, v90, v91
  global_store_dwordx4 v2, v[104:107], s[78:79] offset:0 sc1
  v_cvt_pk_bf16_f32 v108, v76, v77
  v_cvt_pk_bf16_f32 v109, v78, v79
  v_cvt_pk_bf16_f32 v110, v92, v93
  v_cvt_pk_bf16_f32 v111, v94, v95
  global_store_dwordx4 v2, v[108:111], s[78:79] offset:1024 sc1
  v_cvt_pk_bf16_f32 v104, v80, v81
  v_cvt_pk_bf16_f32 v105, v82, v83
  v_cvt_pk_bf16_f32 v106, v96, v97
  v_cvt_pk_bf16_f32 v107, v98, v99
  global_store_dwordx4 v2, v[104:107], s[78:79] offset:2048 sc1
  v_cvt_pk_bf16_f32 v108, v84, v85
  v_cvt_pk_bf16_f32 v109, v86, v87
  v_cvt_pk_bf16_f32 v110, v100, v101
  v_cvt_pk_bf16_f32 v111, v102, v103
  global_store_dwordx4 v2, v[108:111], s[78:79] offset:3072 sc1
  s_sub_u32 s85, 3, s82
  s_cmp_eq_u32 s81, 21
  s_cselect_b32 s85, s85, 3
  s_mul_i32 s85, s85, 458752
  s_add_u32 s78, s78, s85
  s_addc_u32 s79, s79, 0
  s_waitcnt vmcnt(0)
  s_barrier
  v_cmp_eq_u32 vcc, 0, v0
  s_and_saveexec_b64 s[20:21], vcc
  s_cbranch_execz L_sig_249
  v_mov_b32 v112, 1280
  v_mov_b32 v113, 1
  global_atomic_add v112, v113, s[86:87] sc1
L_sig_249:
  s_mov_b64 exec, s[20:21]
  s_cmp_ge_u32 s69, 56
  s_cbranch_scc1 L_done
  s_cmp_ge_u32 s9, 28
  s_cbranch_scc1 L_g1np_250
  s_mul_i32 s36, s9, 9363
  s_lshr_b32 s36, s36, 16
  s_mul_i32 s37, s36, 7
  s_sub_u32 s37, s9, s37
  s_lshl_b32 s14, s68, 2
  s_add_u32 s36, s36, s14
  s_load_dwordx2 s[22:23], s[0:1], 80
  s_load_dwordx2 s[24:25], s[0:1], 88
  s_load_dwordx2 s[26:27], s[0:1], 96
  s_waitcnt lgkmcnt(0)
  v_and_b32 v10, 63, v0
  v_lshrrev_b32 v11, 3, v10
  s_lshl_b32 s30, s8, 3
  v_add_u32 v11, s30, v11
  v_lshlrev_b32 v8, 12, v11
  v_and_b32 v10, 7, v0
  v_lshl_add_u32 v8, v10, 4, v8
  s_lshl_b32 s30, s36, 7
  s_add_u32 s32, s22, s30
  s_addc_u32 s33, s23, 0
  v_bfe_u32 v10, v0, 4, 2
  v_lshlrev_b32 v10, 3, v10
  v_bfe_u32 v11, v0, 2, 2
  v_add_u32 v10, v10, v11
  v_lshlrev_b32 v9, 7, v10
  v_and_b32 v10, 3, v0
  v_lshl_add_u32 v9, v10, 3, v9
  s_lshl_b32 s30, s8, 5
  v_add_u32 v9, s30, v9
  s_lshl_b32 s34, s8, 10
  s_barrier
  s_add_u32 s30, s34, 0
  s_mov_b32 m0, s30
  s_nop 0
  global_load_lds_dwordx4 v8, s[32:33]
  s_add_u32 s32, s32, 131072
  s_addc_u32 s33, s33, 0
  s_add_u32 s30, s34, 4096
  s_mov_b32 m0, s30
  s_nop 0
  global_load_lds_dwordx4 v8, s[32:33]
  s_add_u32 s32, s32, 131072
  s_addc_u32 s33, s33, 0
  s_add_u32 s30, s34, 8192
  s_mov_b32 m0, s30
  s_nop 0
  global_load_lds_dwordx4 v8, s[32:33]
  s_add_u32 s32, s32, 131072
  s_addc_u32 s33, s33, 0
  s_add_u32 s30, s34, 12288
  s_mov_b32 m0, s30
  s_nop 0
  global_load_lds_dwordx4 v8, s[32:33]
  s_add_u32 s32, s32, 131072
  s_addc_u32 s33, s33, 0
  s_add_u32 s30, s34, 16384
  s_mov_b32 m0, s30
  s_nop 0
  global_load_lds_dwordx4 v8, s[32:33]
  s_add_u32 s32, s32, 131072
  s_addc_u32 s33, s33, 0
  s_add_u32 s30, s34, 20480
  s_mov_b32 m0, s30
  s_nop 0
  global_load_lds_dwordx4 v8, s[32:33]
  s_add_u32 s32, s32, 131072
  s_addc_u32 s33, s33, 0
  s_add_u32 s30, s34, 24576
  s_mov_b32 m0, s30
  s_nop 0
  global_load_lds_dwordx4 v8, s[32:33]
  s_add_u32 s32, s32, 131072
  s_addc_u32 s33, s33, 0
  s_add_u32 s30, s34, 28672
  s_mov_b32 m0, s30
  s_nop 0
  global_load_lds_dwordx4 v8, s[32:33]
  s_add_u32 s32, s32, 131072
  s_addc_u32 s33, s33, 0
  s_add_u32 s30, s34, 32768
  s_mov_b32 m0, s30
  s_nop 0
  global_load_lds_dwordx4 v8, s[32:33]
  s_add_u32 s32, s32, 131072
  s_addc_u32 s33, s33, 0
  s_add_u32 s30, s34, 36864
  s_mov_b32 m0, s30
  s_nop 0
  global_load_lds_dwordx4 v8, s[32:33]
  s_add_u32 s32, s32, 131072
  s_addc_u32 s33, s33, 0
  s_add_u32 s30, s34, 40960
  s_mov_b32 m0, s30
  s_nop 0
  global_load_lds_dwordx4 v8, s[32:33]
  s_add_u32 s32, s32, 131072
  s_addc_u32 s33, s33, 0
  s_add_u32 s30, s34, 45056
  s_mov_b32 m0, s30
  s_nop 0
  global_load_lds_dwordx4 v8, s[32:33]
  s_add_u32 s32, s32, 131072
  s_addc_u32 s33, s33, 0
  s_add_u32 s30, s34, 49152
  s_mov_b32 m0, s30
  s_nop 0
  global_load_lds_dwordx4 v8, s[32:33]
  s_add_u32 s32, s32, 131072
  s_addc_u32 s33, s33, 0
  s_add_u32 s30, s34, 53248
  s_mov_b32 m0, s30
  s_nop 0
  global_load_lds_dwordx4 v8, s[32:33]
  s_add_u32 s32, s32, 131072
  s_addc_u32 s33, s33, 0
  s_add_u32 s30, s34, 57344
  s_mov_b32 m0, s30
  s_nop 0
  global_load_lds_dwordx4 v8, s[32:33]
  s_add_u32 s32, s32, 131072
  s_addc_u32 s33, s33, 0
  s_add_u32 s30, s34, 61440
  s_mov_b32 m0, s30
  s_nop 0
  global_load_lds_dwordx4 v8, s[32:33]
  s_add_u32 s32, s32, 131072
  s_addc_u32 s33, s33, 0
  s_add_u32 s30, s34, 65536
  s_mov_b32 m0, s30
  s_nop 0
  global_load_lds_dwordx4 v8, s[32:33]
  s_add_u32 s32, s32, 131072
  s_addc_u32 s33, s33, 0
  s_add_u32 s30, s34, 69632
  s_mov_b32 m0, s30
  s_nop 0
  global_load_lds_dwordx4 v8, s[32:33]
  s_add_u32 s32, s32, 131072
  s_addc_u32 s33, s33, 0
  s_add_u32 s30, s34, 73728
  s_mov_b32 m0, s30
  s_nop 0
  global_load_lds_dwordx4 v8, s[32:33]
  s_add_u32 s32, s32, 131072
  s_addc_u32 s33, s33, 0
  s_add_u32 s30, s34, 77824
  s_mov_b32 m0, s30
  s_nop 0
  global_load_lds_dwordx4 v8, s[32:33]
  s_add_u32 s32, s32, 131072
  s_addc_u32 s33, s33, 0
  s_add_u32 s30, s34, 81920
  s_mov_b32 m0, s30
  s_nop 0
  global_load_lds_dwordx4 v8, s[32:33]
  s_add_u32 s32, s32, 131072
  s_addc_u32 s33, s33, 0
  s_add_u32 s30, s34, 86016
  s_mov_b32 m0, s30
  s_nop 0
  global_load_lds_dwordx4 v8, s[32:33]
  s_add_u32 s32, s32, 131072
  s_addc_u32 s33, s33, 0
  s_add_u32 s30, s34, 90112
  s_mov_b32 m0, s30
  s_nop 0
  global_load_lds_dwordx4 v8, s[32:33]
  s_add_u32 s32, s32, 131072
  s_addc_u32 s33, s33, 0
  s_add_u32 s30, s34, 94208
  s_mov_b32 m0, s30
  s_nop 0
  global_load_lds_dwordx4 v8, s[32:33]
  s_add_u32 s32, s32, 131072
  s_addc_u32 s33, s33, 0
  s_add_u32 s30, s34, 98304
  s_mov_b32 m0, s30
  s_nop 0
  global_load_lds_dwordx4 v8, s[32:33]
  s_add_u32 s32, s32, 131072
  s_addc_u32 s33, s33, 0
  s_add_u32 s30, s34, 102400
  s_mov_b32 m0, s30
  s_nop 0
  global_load_lds_dwordx4 v8, s[32:33]
  s_add_u32 s32, s32, 131072
  s_addc_u32 s33, s33, 0
  s_add_u32 s30, s34, 106496
  s_mov_b32 m0, s30
  s_nop 0
  global_load_lds_dwordx4 v8, s[32:33]
  s_add_u32 s32, s32, 131072
  s_addc_u32 s33, s33, 0
  s_add_u32 s30, s34, 110592
  s_mov_b32 m0, s30
  s_nop 0
  global_load_lds_dwordx4 v8, s[32:33]
  s_add_u32 s32, s32, 131072
  s_addc_u32 s33, s33, 0
  v_add_u32 v10, 57344, v9
  s_waitcnt vmcnt(14)
  s_barrier
  ds_read_b64_tr_b16 a[0:1], v9 offset:0
  ds_read_b64_tr_b16 a[2:3], v9 offset:512
  ds_read_b64_tr_b16 a[4:5], v9 offset:4096
  ds_read_b64_tr_b16 a[6:7], v9 offset:4608
  ds_read_b64_tr_b16 a[8:9], v9 offset:8192
  ds_read_b64_tr_b16 a[10:11], v9 offset:8704
  ds_read_b64_tr_b16 a[12:13], v9 offset:12288
  ds_read_b64_tr_b16 a[14:15], v9 offset:12800
  ds_read_b64_tr_b16 a[16:17], v9 offset:16384
  ds_read_b64_tr_b16 a[18:19], v9 offset:16896
  ds_read_b64_tr_b16 a[20:21], v9 offset:20480
  ds_read_b64_tr_b16 a[22:23], v9 offset:20992
  ds_read_b64_tr_b16 a[24:25], v9 offset:24576
  ds_read_b64_tr_b16 a[26:27], v9 offset:25088
  s_waitcnt lgkmcnt(0)
  ds_read_b64_tr_b16 a[28:29], v9 offset:28672
  ds_read_b64_tr_b16 a[30:31], v9 offset:29184
  ds_read_b64_tr_b16 a[32:33], v9 offset:32768
  ds_read_b64_tr_b16 a[34:35], v9 offset:33280
  ds_read_b64_tr_b16 a[36:37], v9 offset:36864
  ds_read_b64_tr_b16 a[38:39], v9 offset:37376
  ds_read_b64_tr_b16 a[40:41], v9 offset:40960
  ds_read_b64_tr_b16 a[42:43], v9 offset:41472
  ds_read_b64_tr_b16 a[44:45], v9 offset:45056
  ds_read_b64_tr_b16 a[46:47], v9 offset:45568
  ds_read_b64_tr_b16 a[48:49], v9 offset:49152
  ds_read_b64_tr_b16 a[50:51], v9 offset:49664
  ds_read_b64_tr_b16 a[52:53], v9 offset:53248
  ds_read_b64_tr_b16 a[54:55], v9 offset:53760
  s_waitcnt lgkmcnt(0)
  s_barrier
  s_add_u32 s30, s34, 0
  s_mov_b32 m0, s30
  s_nop 0
  global_load_lds_dwordx4 v8, s[32:33]
  s_add_u32 s32, s32, 131072
  s_addc_u32 s33, s33, 0
  s_add_u32 s30, s34, 4096
  s_mov_b32 m0, s30
  s_nop 0
  global_load_lds_dwordx4 v8, s[32:33]
  s_add_u32 s32, s32, 131072
  s_addc_u32 s33, s33, 0
  s_add_u32 s30, s34, 8192
  s_mov_b32 m0, s30
  s_nop 0
  global_load_lds_dwordx4 v8, s[32:33]
  s_add_u32 s32, s32, 131072
  s_addc_u32 s33, s33, 0
  s_add_u32 s30, s34, 12288
  s_mov_b32 m0, s30
  s_nop 0
  global_load_lds_dwordx4 v8, s[32:33]
  s_add_u32 s32, s32, 131072
  s_addc_u32 s33, s33, 0
  s_add_u32 s30, s34, 16384
  s_mov_b32 m0, s30
  s_nop 0
  global_load_lds_dwordx4 v8, s[32:33]
  s_add_u32 s32, s32, 131072
  s_addc_u32 s33, s33, 0
  s_add_u32 s30, s34, 20480
  s_mov_b32 m0, s30
  s_nop 0
  global_load_lds_dwordx4 v8, s[32:33]
  s_add_u32 s32, s32, 131072
  s_addc_u32 s33, s33, 0
  s_add_u32 s30, s34, 24576
  s_mov_b32 m0, s30
  s_nop 0
  global_load_lds_dwordx4 v8, s[32:33]
  s_add_u32 s32, s32, 131072
  s_addc_u32 s33, s33, 0
  s_add_u32 s30, s34, 28672
  s_mov_b32 m0, s30
  s_nop 0
  global_load_lds_dwordx4 v8, s[32:33]
  s_add_u32 s32, s32, 131072
  s_addc_u32 s33, s33, 0
  s_add_u32 s30, s34, 32768
  s_mov_b32 m0, s30
  s_nop 0
  global_load_lds_dwordx4 v8, s[32:33]
  s_add_u32 s32, s32, 131072
  s_addc_u32 s33, s33, 0
  s_add_u32 s30, s34, 36864
  s_mov_b32 m0, s30
  s_nop 0
  global_load_lds_dwordx4 v8, s[32:33]
  s_add_u32 s32, s32, 131072
  s_addc_u32 s33, s33, 0
  s_add_u32 s30, s34, 40960
  s_mov_b32 m0, s30
  s_nop 0
  global_load_lds_dwordx4 v8, s[32:33]
  s_add_u32 s32, s32, 131072
  s_addc_u32 s33, s33, 0
  s_add_u32 s30, s34, 45056
  s_mov_b32 m0, s30
  s_nop 0
  global_load_lds_dwordx4 v8, s[32:33]
  s_add_u32 s32, s32, 131072
  s_addc_u32 s33, s33, 0
  s_add_u32 s30, s34, 49152
  s_mov_b32 m0, s30
  s_nop 0
  global_load_lds_dwordx4 v8, s[32:33]
  s_add_u32 s32, s32, 131072
  s_addc_u32 s33, s33, 0
  s_add_u32 s30, s34, 53248
  s_mov_b32 m0, s30
  s_nop 0
  global_load_lds_dwordx4 v8, s[32:33]
  s_add_u32 s32, s32, 131072
  s_addc_u32 s33, s33, 0
  s_waitcnt vmcnt(14)
  s_barrier
  ds_read_b64_tr_b16 a[56:57], v10 offset:0
  ds_read_b64_tr_b16 a[58:59], v10 offset:512
  ds_read_b64_tr_b16 a[60:61], v10 offset:4096
  ds_read_b64_tr_b16 a[62:63], v10 offset:4608
  ds_read_b64_tr_b16 a[64:65], v10 offset:8192
  ds_read_b64_tr_b16 a[66:67], v10 offset:8704
  ds_read_b64_tr_b16 a[68:69], v10 offset:12288
  ds_read_b64_tr_b16 a[70:71], v10 offset:12800
  ds_read_b64_tr_b16 a[72:73], v10 offset:16384
  ds_read_b64_tr_b16 a[74:75], v10 offset:16896
  ds_read_b64_tr_b16 a[76:77], v10 offset:20480
  ds_read_b64_tr_b16 a[78:79], v10 offset:20992
  ds_read_b64_tr_b16 a[80:81], v10 offset:24576
  ds_read_b64_tr_b16 a[82:83], v10 offset:25088
  s_waitcnt lgkmcnt(0)
  ds_read_b64_tr_b16 a[84:85], v10 offset:28672
  ds_read_b64_tr_b16 a[86:87], v10 offset:29184
  ds_read_b64_tr_b16 a[88:89], v10 offset:32768
  ds_read_b64_tr_b16 a[90:91], v10 offset:33280
  ds_read_b64_tr_b16 a[92:93], v10 offset:36864
  ds_read_b64_tr_b16 a[94:95], v10 offset:37376
  ds_read_b64_tr_b16 a[96:97], v10 offset:40960
  ds_read_b64_tr_b16 a[98:99], v10 offset:41472
  ds_read_b64_tr_b16 a[100:101], v10 offset:45056
  ds_read_b64_tr_b16 a[102:103], v10 offset:45568
  ds_read_b64_tr_b16 a[104:105], v10 offset:49152
  ds_read_b64_tr_b16 a[106:107], v10 offset:49664
  ds_read_b64_tr_b16 a[108:109], v10 offset:53248
  ds_read_b64_tr_b16 a[110:111], v10 offset:53760
  s_waitcnt lgkmcnt(0)
  s_barrier
  s_add_u32 s30, s34, 57344
  s_mov_b32 m0, s30
  s_nop 0
  global_load_lds_dwordx4 v8, s[32:33]
  s_add_u32 s32, s32, 131072
  s_addc_u32 s33, s33, 0
  s_add_u32 s30, s34, 61440
  s_mov_b32 m0, s30
  s_nop 0
  global_load_lds_dwordx4 v8, s[32:33]
  s_add_u32 s32, s32, 131072
  s_addc_u32 s33, s33, 0
  s_add_u32 s30, s34, 65536
  s_mov_b32 m0, s30
  s_nop 0
  global_load_lds_dwordx4 v8, s[32:33]
  s_add_u32 s32, s32, 131072
  s_addc_u32 s33, s33, 0
  s_add_u32 s30, s34, 69632
  s_mov_b32 m0, s30
  s_nop 0
  global_load_lds_dwordx4 v8, s[32:33]
  s_add_u32 s32, s32, 131072
  s_addc_u32 s33, s33, 0
  s_add_u32 s30, s34, 73728
  s_mov_b32 m0, s30
  s_nop 0
  global_load_lds_dwordx4 v8, s[32:33]
  s_add_u32 s32, s32, 131072
  s_addc_u32 s33, s33, 0
  s_add_u32 s30, s34, 77824
  s_mov_b32 m0, s30
  s_nop 0
  global_load_lds_dwordx4 v8, s[32:33]
  s_add_u32 s32, s32, 131072
  s_addc_u32 s33, s33, 0
  s_add_u32 s30, s34, 81920
  s_mov_b32 m0, s30
  s_nop 0
  global_load_lds_dwordx4 v8, s[32:33]
  s_add_u32 s32, s32, 131072
  s_addc_u32 s33, s33, 0
  s_add_u32 s30, s34, 86016
  s_mov_b32 m0, s30
  s_nop 0
  global_load_lds_dwordx4 v8, s[32:33]
  s_add_u32 s32, s32, 131072
  s_addc_u32 s33, s33, 0
  s_add_u32 s30, s34, 90112
  s_mov_b32 m0, s30
  s_nop 0
  global_load_lds_dwordx4 v8, s[32:33]
  s_add_u32 s32, s32, 131072
  s_addc_u32 s33, s33, 0
  s_add_u32 s30, s34, 94208
  s_mov_b32 m0, s30
  s_nop 0
  global_load_lds_dwordx4 v8, s[32:33]
  s_add_u32 s32, s32, 131072
  s_addc_u32 s33, s33, 0
  s_add_u32 s30, s34, 98304
  s_mov_b32 m0, s30
  s_nop 0
  global_load_lds_dwordx4 v8, s[32:33]
  s_add_u32 s32, s32, 131072
  s_addc_u32 s33, s33, 0
  s_add_u32 s30, s34, 102400
  s_mov_b32 m0, s30
  s_nop 0
  global_load_lds_dwordx4 v8, s[32:33]
  s_add_u32 s32, s32, 131072
  s_addc_u32 s33, s33, 0
  s_add_u32 s30, s34, 106496
  s_mov_b32 m0, s30
  s_nop 0
  global_load_lds_dwordx4 v8, s[32:33]
  s_add_u32 s32, s32, 131072
  s_addc_u32 s33, s33, 0
  s_add_u32 s30, s34, 110592
  s_mov_b32 m0, s30
  s_nop 0
  global_load_lds_dwordx4 v8, s[32:33]
  s_add_u32 s32, s32, 131072
  s_addc_u32 s33, s33, 0
  s_waitcnt vmcnt(14)
  s_barrier
  ds_read_b64_tr_b16 a[112:113], v9 offset:0
  ds_read_b64_tr_b16 a[114:115], v9 offset:512
  ds_read_b64_tr_b16 a[116:117], v9 offset:4096
  ds_read_b64_tr_b16 a[118:119], v9 offset:4608
  ds_read_b64_tr_b16 a[120:121], v9 offset:8192
  ds_read_b64_tr_b16 a[122:123], v9 offset:8704
  ds_read_b64_tr_b16 a[124:125], v9 offset:12288
  ds_read_b64_tr_b16 a[126:127], v9 offset:12800
  ds_read_b64_tr_b16 a[128:129], v9 offset:16384
  ds_read_b64_tr_b16 a[130:131], v9 offset:16896
  ds_read_b64_tr_b16 a[132:133], v9 offset:20480
  ds_read_b64_tr_b16 a[134:135], v9 offset:20992
  ds_read_b64_tr_b16 a[136:137], v9 offset:24576
  ds_read_b64_tr_b16 a[138:139], v9 offset:25088
  s_waitcnt lgkmcnt(0)
  ds_read_b64_tr_b16 a[140:141], v9 offset:28672
  ds_read_b64_tr_b16 a[142:143], v9 offset:29184
  ds_read_b64_tr_b16 a[144:145], v9 offset:32768
  ds_read_b64_tr_b16 a[146:147], v9 offset:33280
  ds_read_b64_tr_b16 a[148:149], v9 offset:36864
  ds_read_b64_tr_b16 a[150:151], v9 offset:37376
  ds_read_b64_tr_b16 a[152:153], v9 offset:40960
  ds_read_b64_tr_b16 a[154:155], v9 offset:41472
  ds_read_b64_tr_b16 a[156:157], v9 offset:45056
  ds_read_b64_tr_b16 a[158:159], v9 offset:45568
  ds_read_b64_tr_b16 a[160:161], v9 offset:49152
  ds_read_b64_tr_b16 a[162:163], v9 offset:49664
  ds_read_b64_tr_b16 a[164:165], v9 offset:53248
  ds_read_b64_tr_b16 a[166:167], v9 offset:53760
  s_waitcnt lgkmcnt(0)
  s_waitcnt vmcnt(0)
  s_barrier
  ds_read_b64_tr_b16 a[168:169], v10 offset:0
  ds_read_b64_tr_b16 a[170:171], v10 offset:512
  ds_read_b64_tr_b16 a[172:173], v10 offset:4096
  ds_read_b64_tr_b16 a[174:175], v10 offset:4608
  ds_read_b64_tr_b16 a[176:177], v10 offset:8192
  ds_read_b64_tr_b16 a[178:179], v10 offset:8704
  ds_read_b64_tr_b16 a[180:181], v10 offset:12288
  ds_read_b64_tr_b16 a[182:183], v10 offset:12800
  ds_read_b64_tr_b16 a[184:185], v10 offset:16384
  ds_read_b64_tr_b16 a[186:187], v10 offset:16896
  ds_read_b64_tr_b16 a[188:189], v10 offset:20480
  ds_read_b64_tr_b16 a[190:191], v10 offset:20992
  ds_read_b64_tr_b16 a[192:193], v10 offset:24576
  ds_read_b64_tr_b16 a[194:195], v10 offset:25088
  s_waitcnt lgkmcnt(0)
  ds_read_b64_tr_b16 a[196:197], v10 offset:28672
  ds_read_b64_tr_b16 a[198:199], v10 offset:29184
  ds_read_b64_tr_b16 a[200:201], v10 offset:32768
  ds_read_b64_tr_b16 a[202:203], v10 offset:33280
  ds_read_b64_tr_b16 a[204:205], v10 offset:36864
  ds_read_b64_tr_b16 a[206:207], v10 offset:37376
  ds_read_b64_tr_b16 a[208:209], v10 offset:40960
  ds_read_b64_tr_b16 a[210:211], v10 offset:41472
  ds_read_b64_tr_b16 a[212:213], v10 offset:45056
  ds_read_b64_tr_b16 a[214:215], v10 offset:45568
  ds_read_b64_tr_b16 a[216:217], v10 offset:49152
  ds_read_b64_tr_b16 a[218:219], v10 offset:49664
  ds_read_b64_tr_b16 a[220:221], v10 offset:53248
  ds_read_b64_tr_b16 a[222:223], v10 offset:53760
  s_waitcnt lgkmcnt(0)
  s_mov_b32 s38, 1
  s_barrier
L_g1np_250:
  s_load_dwordx2 s[78:79], s[0:1], 64
  s_load_dwordx2 s[80:81], s[0:1], 72
  v_and_b32 v7, 63, v0
  v_lshlrev_b32 v2, 4, v7
  v_lshrrev_b32 v8, 2, v7
  v_mul_u32_u24 v3, 3584, v8
  v_and_b32 v7, 3, v0
  v_lshl_add_u32 v3, v7, 4, v3
  v_mul_u32_u24 v4, 80, v8
  v_lshl_add_u32 v4, v7, 4, v4
  s_mul_i32 s72, s8, 2560
  v_add_u32 v4, s72, v4
  v_bfe_u32 v7, v0, 4, 2
  v_lshlrev_b32 v7, 3, v7
  v_bfe_u32 v8, v0, 2, 2
  v_add_u32 v7, v7, v8
  v_mul_u32_u24 v5, 80, v7
  v_and_b32 v7, 3, v0
  v_lshl_add_u32 v5, v7, 4, v5
  v_add_u32 v5, s72, v5
  v_and_b32 v7, 63, v0
  v_min_u32 v7, 27, v7
  v_lshrrev_b32 v9, 2, v7
  v_lshlrev_b32 v9, 10, v9
  v_and_b32 v7, 3, v7
  v_lshl_add_u32 v9, v7, 8, v9
  v_add_u32 v9, 252, v9
  s_waitcnt lgkmcnt(0)
  s_lshl_b32 s72, s69, 6
  s_add_u32 s78, s78, s72
  s_addc_u32 s79, s79, 0
  s_add_u32 s80, s80, s72
  s_addc_u32 s81, s81, 0
  s_mul_i32 s72, s8, 7168
  s_add_u32 s76, s4, 56102912
  s_addc_u32 s77, s5, 0
  s_add_u32 s76, s76, s72
  s_addc_u32 s77, s77, 0
  v_bfe_u32 v7, v0, 4, 2
  v_lshlrev_b32 v7, 4, v7
  global_load_dwordx4 v[28:31], v7, s[80:81]
  s_waitcnt vmcnt(0)
  v_lshlrev_b32 v120, 16, v28
  v_and_b32 v121, 0xffff0000, v28
  v_lshlrev_b32 v122, 16, v29
  v_and_b32 v123, 0xffff0000, v29
  v_lshlrev_b32 v124, 16, v30
  v_and_b32 v125, 0xffff0000, v30
  v_lshlrev_b32 v126, 16, v31
  v_and_b32 v127, 0xffff0000, v31
  v_mov_b32 v64, 0
  v_mov_b32 v65, 0
  v_mov_b32 v66, 0
  v_mov_b32 v67, 0
  v_mov_b32 v68, 0
  v_mov_b32 v69, 0
  v_mov_b32 v70, 0
  v_mov_b32 v71, 0
  v_mov_b32 v72, 0
  v_mov_b32 v73, 0
  v_mov_b32 v74, 0
  v_mov_b32 v75, 0
  v_mov_b32 v76, 0
  v_mov_b32 v77, 0
  v_mov_b32 v78, 0
  v_mov_b32 v79, 0
  v_mov_b32 v80, 0
  v_mov_b32 v81, 0
  v_mov_b32 v82, 0
  v_mov_b32 v83, 0
  v_mov_b32 v84, 0
  v_mov_b32 v85, 0
  v_mov_b32 v86, 0
  v_mov_b32 v87, 0
  v_mov_b32 v88, 0
  v_mov_b32 v89, 0
  v_mov_b32 v90, 0
  v_mov_b32 v91, 0
  v_mov_b32 v92, 0
  v_mov_b32 v93, 0
  v_mov_b32 v94, 0
  v_mov_b32 v95, 0
  v_mov_b32 v96, 0
  v_mov_b32 v97, 0
  v_mov_b32 v98, 0
  v_mov_b32 v99, 0
  v_mov_b32 v100, 0
  v_mov_b32 v101, 0
  v_mov_b32 v102, 0
  v_mov_b32 v103, 0
  v_mov_b32 v104, 0
  v_mov_b32 v105, 0
  v_mov_b32 v106, 0
  v_mov_b32 v107, 0
  v_mov_b32 v108, 0
  v_mov_b32 v109, 0
  v_mov_b32 v110, 0
  v_mov_b32 v111, 0
  v_mov_b32 v112, 0
  v_mov_b32 v113, 0
  v_mov_b32 v114, 0
  v_mov_b32 v115, 0
  v_mov_b32 v116, 0
  v_mov_b32 v117, 0
  v_mov_b32 v118, 0
  v_mov_b32 v119, 0
  global_load_dwordx4 v[12:15], v3, s[78:79]
  s_add_u32 s74, s78, 57344
  s_addc_u32 s75, s79, 0
  global_load_dwordx4 v[16:19], v3, s[74:75]
  s_add_u32 s78, s78, 114688
  s_addc_u32 s79, s79, 0
  s_mov_b32 s85, 0
L_G1_loop_251:
  s_waitcnt vmcnt(0)
  ds_write_b128 v4, v[12:15]
  ds_write_b128 v4, v[16:19] offset:1280
  ds_read_b64_tr_b16 v[20:21], v5 offset:0
  ds_read_b64_tr_b16 v[22:23], v5 offset:320
  ds_read_b64_tr_b16 v[24:25], v5 offset:8
  ds_read_b64_tr_b16 v[26:27], v5 offset:328
  s_cmp_ge_u32 s85, 63
  s_cbranch_scc1 L_G1_nw_252
  global_load_dwordx4 v[12:15], v3, s[78:79]
  s_add_u32 s74, s78, 57344
  s_addc_u32 s75, s79, 0
  global_load_dwordx4 v[16:19], v3, s[74:75]
  s_add_u32 s78, s78, 114688
  s_addc_u32 s79, s79, 0
L_G1_nw_252:
  s_mov_b32 s84, 0
L_G1_poll_253:
  global_load_dwordx4 v[28:31], v2, s[76:77] offset:-4096 sc1
  global_load_dwordx4 v[32:35], v2, s[76:77] offset:-3072 sc1
  global_load_dwordx4 v[36:39], v2, s[76:77] offset:-2048 sc1
  global_load_dwordx4 v[40:43], v2, s[76:77] offset:-1024 sc1
  global_load_dwordx4 v[44:47], v2, s[76:77] offset:0 sc1
  global_load_dwordx4 v[48:51], v2, s[76:77] offset:1024 sc1
  global_load_dwordx4 v[52:55], v2, s[76:77] offset:2048 sc1
  s_waitcnt vmcnt(0)
  v_max3_u32 v7, v28, v29, v30
  v_max3_u32 v7, v7, v31, v32
  v_max3_u32 v7, v7, v33, v34
  v_max3_u32 v7, v7, v35, v36
  v_max3_u32 v7, v7, v37, v38
  v_max3_u32 v7, v7, v39, v40
  v_max3_u32 v7, v7, v41, v42
  v_max3_u32 v7, v7, v43, v44
  v_max3_u32 v7, v7, v45, v46
  v_max3_u32 v7, v7, v47, v48
  v_max3_u32 v7, v7, v49, v50
  v_max3_u32 v7, v7, v51, v52
  v_max3_u32 v7, v7, v53, v54
  v_max_u32 v7, v7, v55
  v_cmp_eq_u32 vcc, -1, v7
  s_cbranch_vccz L_G1_got_254
L_G1_ipoll_255:
  s_add_u32 s84, s84, 1
  s_cmp_gt_u32 s84, 262144
  s_cbranch_scc1 L_abort
  global_load_dword v7, v9, s[76:77] offset:-4096 sc1
  s_waitcnt vmcnt(0)
  v_cmp_eq_u32 vcc, -1, v7
  s_cbranch_vccz L_G1_poll_253
  s_sleep 1
  s_branch L_G1_ipoll_255
L_G1_got_254:
  s_waitcnt lgkmcnt(0)
  v_mfma_f32_16x16x32_bf16 v[64:67], v[20:23], v[28:31], v[64:67]
  v_mfma_f32_16x16x32_bf16 v[92:95], v[24:27], v[28:31], v[92:95]
  v_mfma_f32_16x16x32_bf16 v[68:71], v[20:23], v[32:35], v[68:71]
  v_mfma_f32_16x16x32_bf16 v[96:99], v[24:27], v[32:35], v[96:99]
  v_mfma_f32_16x16x32_bf16 v[72:75], v[20:23], v[36:39], v[72:75]
  v_mfma_f32_16x16x32_bf16 v[100:103], v[24:27], v[36:39], v[100:103]
  v_mfma_f32_16x16x32_bf16 v[76:79], v[20:23], v[40:43], v[76:79]
  v_mfma_f32_16x16x32_bf16 v[104:107], v[24:27], v[40:43], v[104:107]
  v_mfma_f32_16x16x32_bf16 v[80:83], v[20:23], v[44:47], v[80:83]
  v_mfma_f32_16x16x32_bf16 v[108:111], v[24:27], v[44:47], v[108:111]
  v_mfma_f32_16x16x32_bf16 v[84:87], v[20:23], v[48:51], v[84:87]
  v_mfma_f32_16x16x32_bf16 v[112:115], v[24:27], v[48:51], v[112:115]
  v_mfma_f32_16x16x32_bf16 v[88:91], v[20:23], v[52:55], v[88:91]
  v_mfma_f32_16x16x32_bf16 v[116:119], v[24:27], v[52:55], v[116:119]
  s_add_u32 s76, s76, 28672
  s_addc_u32 s77, s77, 0
  s_add_u32 s85, s85, 1
  s_cmp_lt_u32 s85, 64
  s_cbranch_scc1 L_G1_loop_251
  v_bfe_u32 v7, v0, 2, 1
  v_mul_u32_u24 v6, 57344, v7
  v_bfe_u32 v7, v0, 3, 1
  v_lshlrev_b32 v7, 2, v7
  v_and_b32 v8, 3, v0
  v_add_u32 v7, v7, v8
  v_bfe_u32 v8, v0, 4, 2
  v_lshl_add_u32 v7, v8, 4, v7
  v_lshl_add_u32 v6, v7, 4, v6
  s_lshl_b32 s72, s69, 10
  s_add_u32 s82, s4, 59768832
  s_addc_u32 s83, s5, 0
  s_add_u32 s82, s82, s72
  s_addc_u32 s83, s83, 0
  v_mov_b32 v40, 0xbdd2d3e8
  v_mov_b32 v41, 0xbdd2d3e8
  v_mov_b32 v42, 0xc0135761
  v_mov_b32 v43, 0xc0135761
  v_mov_b32 v44, 1.0
  v_mov_b32 v45, 1.0
  v_pk_add_f32 v[64:65], v[64:65], v[120:121]
  v_pk_add_f32 v[66:67], v[66:67], v[122:123]
  v_pk_mul_f32 v[36:37], v[64:65], v[64:65]
  v_pk_mul_f32 v[38:39], v[66:67], v[66:67]
  v_pk_fma_f32 v[36:37], v[36:37], v[40:41], v[42:43]
  v_pk_fma_f32 v[38:39], v[38:39], v[40:41], v[42:43]
  v_pk_mul_f32 v[36:37], v[36:37], v[64:65]
  v_pk_mul_f32 v[38:39], v[38:39], v[66:67]
  v_exp_f32 v36, v36
  v_exp_f32 v37, v37
  v_exp_f32 v38, v38
  v_exp_f32 v39, v39
  v_pk_add_f32 v[36:37], v[36:37], v[44:45]
  v_pk_add_f32 v[38:39], v[38:39], v[44:45]
  v_rcp_f32 v36, v36
  v_rcp_f32 v37, v37
  v_rcp_f32 v38, v38
  v_rcp_f32 v39, v39
  s_nop 0
  v_pk_mul_f32 v[64:65], v[64:65], v[36:37]
  v_pk_mul_f32 v[66:67], v[66:67], v[38:39]
  v_cvt_pk_bf16_f32 v32, v64, v65
  v_cvt_pk_bf16_f32 v33, v66, v67
  v_pk_add_f32 v[92:93], v[92:93], v[124:125]
  v_pk_add_f32 v[94:95], v[94:95], v[126:127]
  v_pk_mul_f32 v[36:37], v[92:93], v[92:93]
  v_pk_mul_f32 v[38:39], v[94:95], v[94:95]
  v_pk_fma_f32 v[36:37], v[36:37], v[40:41], v[42:43]
  v_pk_fma_f32 v[38:39], v[38:39], v[40:41], v[42:43]
  v_pk_mul_f32 v[36:37], v[36:37], v[92:93]
  v_pk_mul_f32 v[38:39], v[38:39], v[94:95]
  v_exp_f32 v36, v36
  v_exp_f32 v37, v37
  v_exp_f32 v38, v38
  v_exp_f32 v39, v39
  v_pk_add_f32 v[36:37], v[36:37], v[44:45]
  v_pk_add_f32 v[38:39], v[38:39], v[44:45]
  v_rcp_f32 v36, v36
  v_rcp_f32 v37, v37
  v_rcp_f32 v38, v38
  v_rcp_f32 v39, v39
  s_nop 0
  v_pk_mul_f32 v[92:93], v[92:93], v[36:37]
  v_pk_mul_f32 v[94:95], v[94:95], v[38:39]
  v_cvt_pk_bf16_f32 v34, v92, v93
  v_cvt_pk_bf16_f32 v35, v94, v95
  s_mul_i32 s72, s8, 7
  s_add_u32 s72, s72, 0
  s_lshr_b32 s73, s72, 1
  s_mul_i32 s73, s73, 114688
  s_and_b32 s72, s72, 1
  s_lshl_b32 s72, s72, 7
  s_add_u32 s72, s72, s73
  s_add_u32 s74, s82, s72
  s_addc_u32 s75, s83, 0
  global_store_dwordx4 v6, v[32:35], s[74:75] sc1
  s_nop 1
  v_pk_add_f32 v[68:69], v[68:69], v[120:121]
  v_pk_add_f32 v[70:71], v[70:71], v[122:123]
  v_pk_mul_f32 v[36:37], v[68:69], v[68:69]
  v_pk_mul_f32 v[38:39], v[70:71], v[70:71]
  v_pk_fma_f32 v[36:37], v[36:37], v[40:41], v[42:43]
  v_pk_fma_f32 v[38:39], v[38:39], v[40:41], v[42:43]
  v_pk_mul_f32 v[36:37], v[36:37], v[68:69]
  v_pk_mul_f32 v[38:39], v[38:39], v[70:71]
  v_exp_f32 v36, v36
  v_exp_f32 v37, v37
  v_exp_f32 v38, v38
  v_exp_f32 v39, v39
  v_pk_add_f32 v[36:37], v[36:37], v[44:45]
  v_pk_add_f32 v[38:39], v[38:39], v[44:45]
  v_rcp_f32 v36, v36
  v_rcp_f32 v37, v37
  v_rcp_f32 v38, v38
  v_rcp_f32 v39, v39
  s_nop 0
  v_pk_mul_f32 v[68:69], v[68:69], v[36:37]
  v_pk_mul_f32 v[70:71], v[70:71], v[38:39]
  v_cvt_pk_bf16_f32 v32, v68, v69
  v_cvt_pk_bf16_f32 v33, v70, v71
  v_pk_add_f32 v[96:97], v[96:97], v[124:125]
  v_pk_add_f32 v[98:99], v[98:99], v[126:127]
  v_pk_mul_f32 v[36:37], v[96:97], v[96:97]
  v_pk_mul_f32 v[38:39], v[98:99], v[98:99]
  v_pk_fma_f32 v[36:37], v[36:37], v[40:41], v[42:43]
  v_pk_fma_f32 v[38:39], v[38:39], v[40:41], v[42:43]
  v_pk_mul_f32 v[36:37], v[36:37], v[96:97]
  v_pk_mul_f32 v[38:39], v[38:39], v[98:99]
  v_exp_f32 v36, v36
  v_exp_f32 v37, v37
  v_exp_f32 v38, v38
  v_exp_f32 v39, v39
  v_pk_add_f32 v[36:37], v[36:37], v[44:45]
  v_pk_add_f32 v[38:39], v[38:39], v[44:45]
  v_rcp_f32 v36, v36
  v_rcp_f32 v37, v37
  v_rcp_f32 v38, v38
  v_rcp_f32 v39, v39
  s_nop 0
  v_pk_mul_f32 v[96:97], v[96:97], v[36:37]
  v_pk_mul_f32 v[98:99], v[98:99], v[38:39]
  v_cvt_pk_bf16_f32 v34, v96, v97
  v_cvt_pk_bf16_f32 v35, v98, v99
  s_mul_i32 s72, s8, 7
  s_add_u32 s72, s72, 1
  s_lshr_b32 s73, s72, 1
  s_mul_i32 s73, s73, 114688
  s_and_b32 s72, s72, 1
  s_lshl_b32 s72, s72, 7
  s_add_u32 s72, s72, s73
  s_add_u32 s74, s82, s72
  s_addc_u32 s75, s83, 0
  global_store_dwordx4 v6, v[32:35], s[74:75] sc1
  s_nop 1
  v_pk_add_f32 v[72:73], v[72:73], v[120:121]
  v_pk_add_f32 v[74:75], v[74:75], v[122:123]
  v_pk_mul_f32 v[36:37], v[72:73], v[72:73]
  v_pk_mul_f32 v[38:39], v[74:75], v[74:75]
  v_pk_fma_f32 v[36:37], v[36:37], v[40:41], v[42:43]
  v_pk_fma_f32 v[38:39], v[38:39], v[40:41], v[42:43]
  v_pk_mul_f32 v[36:37], v[36:37], v[72:73]
  v_pk_mul_f32 v[38:39], v[38:39], v[74:75]
  v_exp_f32 v36, v36
  v_exp_f32 v37, v37
  v_exp_f32 v38, v38
  v_exp_f32 v39, v39
  v_pk_add_f32 v[36:37], v[36:37], v[44:45]
  v_pk_add_f32 v[38:39], v[38:39], v[44:45]
  v_rcp_f32 v36, v36
  v_rcp_f32 v37, v37
  v_rcp_f32 v38, v38
  v_rcp_f32 v39, v39
  s_nop 0
  v_pk_mul_f32 v[72:73], v[72:73], v[36:37]
  v_pk_mul_f32 v[74:75], v[74:75], v[38:39]
  v_cvt_pk_bf16_f32 v32, v72, v73
  v_cvt_pk_bf16_f32 v33, v74, v75
  v_pk_add_f32 v[100:101], v[100:101], v[124:125]
  v_pk_add_f32 v[102:103], v[102:103], v[126:127]
  v_pk_mul_f32 v[36:37], v[100:101], v[100:101]
  v_pk_mul_f32 v[38:39], v[102:103], v[102:103]
  v_pk_fma_f32 v[36:37], v[36:37], v[40:41], v[42:43]
  v_pk_fma_f32 v[38:39], v[38:39], v[40:41], v[42:43]
  v_pk_mul_f32 v[36:37], v[36:37], v[100:101]
  v_pk_mul_f32 v[38:39], v[38:39], v[102:103]
  v_exp_f32 v36, v36
  v_exp_f32 v37, v37
  v_exp_f32 v38, v38
  v_exp_f32 v39, v39
  v_pk_add_f32 v[36:37], v[36:37], v[44:45]
  v_pk_add_f32 v[38:39], v[38:39], v[44:45]
  v_rcp_f32 v36, v36
  v_rcp_f32 v37, v37
  v_rcp_f32 v38, v38
  v_rcp_f32 v39, v39
  s_nop 0
  v_pk_mul_f32 v[100:101], v[100:101], v[36:37]
  v_pk_mul_f32 v[102:103], v[102:103], v[38:39]
  v_cvt_pk_bf16_f32 v34, v100, v101
  v_cvt_pk_bf16_f32 v35, v102, v103
  s_mul_i32 s72, s8, 7
  s_add_u32 s72, s72, 2
  s_lshr_b32 s73, s72, 1
  s_mul_i32 s73, s73, 114688
  s_and_b32 s72, s72, 1
  s_lshl_b32 s72, s72, 7
  s_add_u32 s72, s72, s73
  s_add_u32 s74, s82, s72
  s_addc_u32 s75, s83, 0
  global_store_dwordx4 v6, v[32:35], s[74:75] sc1
  s_nop 1
  v_pk_add_f32 v[76:77], v[76:77], v[120:121]
  v_pk_add_f32 v[78:79], v[78:79], v[122:123]
  v_pk_mul_f32 v[36:37], v[76:77], v[76:77]
  v_pk_mul_f32 v[38:39], v[78:79], v[78:79]
  v_pk_fma_f32 v[36:37], v[36:37], v[40:41], v[42:43]
  v_pk_fma_f32 v[38:39], v[38:39], v[40:41], v[42:43]
  v_pk_mul_f32 v[36:37], v[36:37], v[76:77]
  v_pk_mul_f32 v[38:39], v[38:39], v[78:79]
  v_exp_f32 v36, v36
  v_exp_f32 v37, v37
  v_exp_f32 v38, v38
  v_exp_f32 v39, v39
  v_pk_add_f32 v[36:37], v[36:37], v[44:45]
  v_pk_add_f32 v[38:39], v[38:39], v[44:45]
  v_rcp_f32 v36, v36
  v_rcp_f32 v37, v37
  v_rcp_f32 v38, v38
  v_rcp_f32 v39, v39
  s_nop 0
  v_pk_mul_f32 v[76:77], v[76:77], v[36:37]
  v_pk_mul_f32 v[78:79], v[78:79], v[38:39]
  v_cvt_pk_bf16_f32 v32, v76, v77
  v_cvt_pk_bf16_f32 v33, v78, v79
  v_pk_add_f32 v[104:105], v[104:105], v[124:125]
  v_pk_add_f32 v[106:107], v[106:107], v[126:127]
  v_pk_mul_f32 v[36:37], v[104:105], v[104:105]
  v_pk_mul_f32 v[38:39], v[106:107], v[106:107]
  v_pk_fma_f32 v[36:37], v[36:37], v[40:41], v[42:43]
  v_pk_fma_f32 v[38:39], v[38:39], v[40:41], v[42:43]
  v_pk_mul_f32 v[36:37], v[36:37], v[104:105]
  v_pk_mul_f32 v[38:39], v[38:39], v[106:107]
  v_exp_f32 v36, v36
  v_exp_f32 v37, v37
  v_exp_f32 v38, v38
  v_exp_f32 v39, v39
  v_pk_add_f32 v[36:37], v[36:37], v[44:45]
  v_pk_add_f32 v[38:39], v[38:39], v[44:45]
  v_rcp_f32 v36, v36
  v_rcp_f32 v37, v37
  v_rcp_f32 v38, v38
  v_rcp_f32 v39, v39
  s_nop 0
  v_pk_mul_f32 v[104:105], v[104:105], v[36:37]
  v_pk_mul_f32 v[106:107], v[106:107], v[38:39]
  v_cvt_pk_bf16_f32 v34, v104, v105
  v_cvt_pk_bf16_f32 v35, v106, v107
  s_mul_i32 s72, s8, 7
  s_add_u32 s72, s72, 3
  s_lshr_b32 s73, s72, 1
  s_mul_i32 s73, s73, 114688
  s_and_b32 s72, s72, 1
  s_lshl_b32 s72, s72, 7
  s_add_u32 s72, s72, s73
  s_add_u32 s74, s82, s72
  s_addc_u32 s75, s83, 0
  global_store_dwordx4 v6, v[32:35], s[74:75] sc1
  s_nop 1
  v_pk_add_f32 v[80:81], v[80:81], v[120:121]
  v_pk_add_f32 v[82:83], v[82:83], v[122:123]
  v_pk_mul_f32 v[36:37], v[80:81], v[80:81]
  v_pk_mul_f32 v[38:39], v[82:83], v[82:83]
  v_pk_fma_f32 v[36:37], v[36:37], v[40:41], v[42:43]
  v_pk_fma_f32 v[38:39], v[38:39], v[40:41], v[42:43]
  v_pk_mul_f32 v[36:37], v[36:37], v[80:81]
  v_pk_mul_f32 v[38:39], v[38:39], v[82:83]
  v_exp_f32 v36, v36
  v_exp_f32 v37, v37
  v_exp_f32 v38, v38
  v_exp_f32 v39, v39
  v_pk_add_f32 v[36:37], v[36:37], v[44:45]
  v_pk_add_f32 v[38:39], v[38:39], v[44:45]
  v_rcp_f32 v36, v36
  v_rcp_f32 v37, v37
  v_rcp_f32 v38, v38
  v_rcp_f32 v39, v39
  s_nop 0
  v_pk_mul_f32 v[80:81], v[80:81], v[36:37]
  v_pk_mul_f32 v[82:83], v[82:83], v[38:39]
  v_cvt_pk_bf16_f32 v32, v80, v81
  v_cvt_pk_bf16_f32 v33, v82, v83
  v_pk_add_f32 v[108:109], v[108:109], v[124:125]
  v_pk_add_f32 v[110:111], v[110:111], v[126:127]
  v_pk_mul_f32 v[36:37], v[108:109], v[108:109]
  v_pk_mul_f32 v[38:39], v[110:111], v[110:111]
  v_pk_fma_f32 v[36:37], v[36:37], v[40:41], v[42:43]
  v_pk_fma_f32 v[38:39], v[38:39], v[40:41], v[42:43]
  v_pk_mul_f32 v[36:37], v[36:37], v[108:109]
  v_pk_mul_f32 v[38:39], v[38:39], v[110:111]
  v_exp_f32 v36, v36
  v_exp_f32 v37, v37
  v_exp_f32 v38, v38
  v_exp_f32 v39, v39
  v_pk_add_f32 v[36:37], v[36:37], v[44:45]
  v_pk_add_f32 v[38:39], v[38:39], v[44:45]
  v_rcp_f32 v36, v36
  v_rcp_f32 v37, v37
  v_rcp_f32 v38, v38
  v_rcp_f32 v39, v39
  s_nop 0
  v_pk_mul_f32 v[108:109], v[108:109], v[36:37]
  v_pk_mul_f32 v[110:111], v[110:111], v[38:39]
  v_cvt_pk_bf16_f32 v34, v108, v109
  v_cvt_pk_bf16_f32 v35, v110, v111
  s_mul_i32 s72, s8, 7
  s_add_u32 s72, s72, 4
  s_lshr_b32 s73, s72, 1
  s_mul_i32 s73, s73, 114688
  s_and_b32 s72, s72, 1
  s_lshl_b32 s72, s72, 7
  s_add_u32 s72, s72, s73
  s_add_u32 s74, s82, s72
  s_addc_u32 s75, s83, 0
  global_store_dwordx4 v6, v[32:35], s[74:75] sc1
  s_nop 1
  v_pk_add_f32 v[84:85], v[84:85], v[120:121]
  v_pk_add_f32 v[86:87], v[86:87], v[122:123]
  v_pk_mul_f32 v[36:37], v[84:85], v[84:85]
  v_pk_mul_f32 v[38:39], v[86:87], v[86:87]
  v_pk_fma_f32 v[36:37], v[36:37], v[40:41], v[42:43]
  v_pk_fma_f32 v[38:39], v[38:39], v[40:41], v[42:43]
  v_pk_mul_f32 v[36:37], v[36:37], v[84:85]
  v_pk_mul_f32 v[38:39], v[38:39], v[86:87]
  v_exp_f32 v36, v36
  v_exp_f32 v37, v37
  v_exp_f32 v38, v38
  v_exp_f32 v39, v39
  v_pk_add_f32 v[36:37], v[36:37], v[44:45]
  v_pk_add_f32 v[38:39], v[38:39], v[44:45]
  v_rcp_f32 v36, v36
  v_rcp_f32 v37, v37
  v_rcp_f32 v38, v38
  v_rcp_f32 v39, v39
  s_nop 0
  v_pk_mul_f32 v[84:85], v[84:85], v[36:37]
  v_pk_mul_f32 v[86:87], v[86:87], v[38:39]
  v_cvt_pk_bf16_f32 v32, v84, v85
  v_cvt_pk_bf16_f32 v33, v86, v87
  v_pk_add_f32 v[112:113], v[112:113], v[124:125]
  v_pk_add_f32 v[114:115], v[114:115], v[126:127]
  v_pk_mul_f32 v[36:37], v[112:113], v[112:113]
  v_pk_mul_f32 v[38:39], v[114:115], v[114:115]
  v_pk_fma_f32 v[36:37], v[36:37], v[40:41], v[42:43]
  v_pk_fma_f32 v[38:39], v[38:39], v[40:41], v[42:43]
  v_pk_mul_f32 v[36:37], v[36:37], v[112:113]
  v_pk_mul_f32 v[38:39], v[38:39], v[114:115]
  v_exp_f32 v36, v36
  v_exp_f32 v37, v37
  v_exp_f32 v38, v38
  v_exp_f32 v39, v39
  v_pk_add_f32 v[36:37], v[36:37], v[44:45]
  v_pk_add_f32 v[38:39], v[38:39], v[44:45]
  v_rcp_f32 v36, v36
  v_rcp_f32 v37, v37
  v_rcp_f32 v38, v38
  v_rcp_f32 v39, v39
  s_nop 0
  v_pk_mul_f32 v[112:113], v[112:113], v[36:37]
  v_pk_mul_f32 v[114:115], v[114:115], v[38:39]
  v_cvt_pk_bf16_f32 v34, v112, v113
  v_cvt_pk_bf16_f32 v35, v114, v115
  s_mul_i32 s72, s8, 7
  s_add_u32 s72, s72, 5
  s_lshr_b32 s73, s72, 1
  s_mul_i32 s73, s73, 114688
  s_and_b32 s72, s72, 1
  s_lshl_b32 s72, s72, 7
  s_add_u32 s72, s72, s73
  s_add_u32 s74, s82, s72
  s_addc_u32 s75, s83, 0
  global_store_dwordx4 v6, v[32:35], s[74:75] sc1
  s_nop 1
  v_pk_add_f32 v[88:89], v[88:89], v[120:121]
  v_pk_add_f32 v[90:91], v[90:91], v[122:123]
  v_pk_mul_f32 v[36:37], v[88:89], v[88:89]
  v_pk_mul_f32 v[38:39], v[90:91], v[90:91]
  v_pk_fma_f32 v[36:37], v[36:37], v[40:41], v[42:43]
  v_pk_fma_f32 v[38:39], v[38:39], v[40:41], v[42:43]
  v_pk_mul_f32 v[36:37], v[36:37], v[88:89]
  v_pk_mul_f32 v[38:39], v[38:39], v[90:91]
  v_exp_f32 v36, v36
  v_exp_f32 v37, v37
  v_exp_f32 v38, v38
  v_exp_f32 v39, v39
  v_pk_add_f32 v[36:37], v[36:37], v[44:45]
  v_pk_add_f32 v[38:39], v[38:39], v[44:45]
  v_rcp_f32 v36, v36
  v_rcp_f32 v37, v37
  v_rcp_f32 v38, v38
  v_rcp_f32 v39, v39
  s_nop 0
  v_pk_mul_f32 v[88:89], v[88:89], v[36:37]
  v_pk_mul_f32 v[90:91], v[90:91], v[38:39]
  v_cvt_pk_bf16_f32 v32, v88, v89
  v_cvt_pk_bf16_f32 v33, v90, v91
  v_pk_add_f32 v[116:117], v[116:117], v[124:125]
  v_pk_add_f32 v[118:119], v[118:119], v[126:127]
  v_pk_mul_f32 v[36:37], v[116:117], v[116:117]
  v_pk_mul_f32 v[38:39], v[118:119], v[118:119]
  v_pk_fma_f32 v[36:37], v[36:37], v[40:41], v[42:43]
  v_pk_fma_f32 v[38:39], v[38:39], v[40:41], v[42:43]
  v_pk_mul_f32 v[36:37], v[36:37], v[116:117]
  v_pk_mul_f32 v[38:39], v[38:39], v[118:119]
  v_exp_f32 v36, v36
  v_exp_f32 v37, v37
  v_exp_f32 v38, v38
  v_exp_f32 v39, v39
  v_pk_add_f32 v[36:37], v[36:37], v[44:45]
  v_pk_add_f32 v[38:39], v[38:39], v[44:45]
  v_rcp_f32 v36, v36
  v_rcp_f32 v37, v37
  v_rcp_f32 v38, v38
  v_rcp_f32 v39, v39
  s_nop 0
  v_pk_mul_f32 v[116:117], v[116:117], v[36:37]
  v_pk_mul_f32 v[118:119], v[118:119], v[38:39]
  v_cvt_pk_bf16_f32 v34, v116, v117
  v_cvt_pk_bf16_f32 v35, v118, v119
  s_mul_i32 s72, s8, 7
  s_add_u32 s72, s72, 6
  s_lshr_b32 s73, s72, 1
  s_mul_i32 s73, s73, 114688
  s_and_b32 s72, s72, 1
  s_lshl_b32 s72, s72, 7
  s_add_u32 s72, s72, s73
  s_add_u32 s74, s82, s72
  s_addc_u32 s75, s83, 0
  global_store_dwordx4 v6, v[32:35], s[74:75] sc1
  s_nop 1
  s_waitcnt vmcnt(0)
  s_barrier
  v_cmp_gt_u32 vcc, 8, v0
  s_and_saveexec_b64 s[20:21], vcc
  s_cbranch_execz L_gfsig_256
  s_add_u32 s14, s69, 0
  s_and_b32 s15, s14, 7
  s_lshl_b32 s15, s15, 7
  s_lshr_b32 s14, s14, 3
  s_lshl_b32 s14, s14, 2
  s_add_u32 s14, s14, s15
  s_add_u32 s14, s14, 4096
  v_lshlrev_b32 v112, 10, v0
  v_add_u32 v112, s14, v112
  v_mov_b32 v113, 1
  global_store_dword v112, v113, s[86:87] sc1
L_gfsig_256:
  s_mov_b64 exec, s[20:21]
  s_branch L_done
L_pref_s:
  s_load_dwordx2 s[72:73], s[0:1], 80
  s_sub_u32 s74, s69, 84
  s_mul_i32 s74, s74, 614400
  v_lshlrev_b32 v2, 4, v0
  s_waitcnt lgkmcnt(0)
  s_mov_b32 s75, 0
L_pref_257:
  s_add_u32 s76, s74, s75
  s_min_u32 s76, s76, 7335936
  s_add_u32 s78, s72, s76
  s_addc_u32 s79, s73, 0
  global_load_dwordx4 v[4:7], v2, s[78:79]
  s_add_u32 s75, s75, 4096
  s_cmp_lt_u32 s75, 614400
  s_cbranch_scc1 L_pref_257
  s_waitcnt vmcnt(0)
  s_branch L_done
L_chain_s:
  s_cmp_eq_u32 s9, 31
  s_cbranch_scc1 L_cidle_s
  s_cmp_eq_u32 s9, 30
  s_cbranch_scc1 L_roleF_s
  s_cmp_ge_u32 s9, 16
  s_cbranch_scc1 L_roleB_s
  v_and_b32 v78, 63, v0
  v_lshlrev_b32 v113, 4, v78
  s_lshl_b32 s14, s8, 10
  v_add_u32 v114, s14, v113
  s_add_u32 s14, s8, 4
  s_min_u32 s14, s14, 6
  s_lshl_b32 s14, s14, 10
  v_add_u32 v115, s14, v113
  v_and_b32 v78, 8, v0
  v_cmp_eq_u32 vcc, 0, v78
  v_mov_b32 v112, 0xeeeeeeee
  v_mov_b32 v78, 0x44444444
  s_nop 1
  v_cndmask_b32 v112, v112, v78, vcc
  s_lshl_b32 s14, s8, 11
  s_add_u32 s15, s14, 1024
  s_cmp_eq_u32 s8, 3
  s_cselect_b32 s15, 5120, s15
  v_add_u32 v114, s14, v113
  v_add_u32 v115, s15, v113
  s_mul_i32 s14, s9, 401408
  s_mul_i32 s15, s8, 100352
  s_add_u32 s14, s14, s15
  s_add_u32 s16, s4, 0
  s_addc_u32 s17, s5, 0
  s_add_u32 s16, s16, s14
  s_addc_u32 s17, s17, 0
  s_cmp_lg_u32 s8, 0
  s_cbranch_scc1 L_wl_n_259
  s_add_u32 s18, s16, 0
  s_addc_u32 s19, s17, 0
  global_load_dwordx4 a[0:3], v113, s[18:19]
  global_load_dwordx4 a[4:7], v113, s[18:19] offset:1024
  s_add_u32 s18, s16, 2048
  s_addc_u32 s19, s17, 0
  global_load_dwordx4 a[8:11], v113, s[18:19]
  global_load_dwordx4 a[12:15], v113, s[18:19] offset:1024
  s_add_u32 s18, s16, 4096
  s_addc_u32 s19, s17, 0
  global_load_dwordx4 a[16:19], v113, s[18:19]
  global_load_dwordx4 a[20:23], v113, s[18:19] offset:1024
  s_add_u32 s18, s16, 6144
  s_addc_u32 s19, s17, 0
  global_load_dwordx4 a[24:27], v113, s[18:19]
  global_load_dwordx4 a[28:31], v113, s[18:19] offset:1024
  s_add_u32 s18, s16, 8192
  s_addc_u32 s19, s17, 0
  global_load_dwordx4 a[32:35], v113, s[18:19]
  global_load_dwordx4 a[36:39], v113, s[18:19] offset:1024
  s_add_u32 s18, s16, 10240
  s_addc_u32 s19, s17, 0
  global_load_dwordx4 a[40:43], v113, s[18:19]
  global_load_dwordx4 a[44:47], v113, s[18:19] offset:1024
  s_add_u32 s18, s16, 12288
  s_addc_u32 s19, s17, 0
  global_load_dwordx4 a[48:51], v113, s[18:19]
  global_load_dwordx4 a[52:55], v113, s[18:19] offset:1024
  s_add_u32 s18, s16, 14336
  s_addc_u32 s19, s17, 0
  global_load_dwordx4 a[56:59], v113, s[18:19]
  global_load_dwordx4 a[60:63], v113, s[18:19] offset:1024
  s_add_u32 s18, s16, 16384
  s_addc_u32 s19, s17, 0
  global_load_dwordx4 a[64:67], v113, s[18:19]
  global_load_dwordx4 a[68:71], v113, s[18:19] offset:1024
  s_add_u32 s18, s16, 18432
  s_addc_u32 s19, s17, 0
  global_load_dwordx4 a[72:75], v113, s[18:19]
  global_load_dwordx4 a[76:79], v113, s[18:19] offset:1024
  s_add_u32 s18, s16, 20480
  s_addc_u32 s19, s17, 0
  global_load_dwordx4 a[80:83], v113, s[18:19]
  global_load_dwordx4 a[84:87], v113, s[18:19] offset:1024
  s_add_u32 s18, s16, 22528
  s_addc_u32 s19, s17, 0
  global_load_dwordx4 a[88:91], v113, s[18:19]
  global_load_dwordx4 a[92:95], v113, s[18:19] offset:1024
  s_add_u32 s18, s16, 24576
  s_addc_u32 s19, s17, 0
  global_load_dwordx4 a[96:99], v113, s[18:19]
  global_load_dwordx4 a[100:103], v113, s[18:19] offset:1024
  s_add_u32 s18, s16, 26624
  s_addc_u32 s19, s17, 0
  global_load_dwordx4 a[104:107], v113, s[18:19]
  global_load_dwordx4 a[108:111], v113, s[18:19] offset:1024
  s_add_u32 s18, s16, 28672
  s_addc_u32 s19, s17, 0
  global_load_dwordx4 a[112:115], v113, s[18:19]
  global_load_dwordx4 a[116:119], v113, s[18:19] offset:1024
  s_add_u32 s18, s16, 30720
  s_addc_u32 s19, s17, 0
  global_load_dwordx4 a[120:123], v113, s[18:19]
  global_load_dwordx4 a[124:127], v113, s[18:19] offset:1024
  s_add_u32 s18, s16, 32768
  s_addc_u32 s19, s17, 0
  global_load_dwordx4 a[128:131], v113, s[18:19]
  global_load_dwordx4 a[132:135], v113, s[18:19] offset:1024
  s_add_u32 s18, s16, 34816
  s_addc_u32 s19, s17, 0
  global_load_dwordx4 a[136:139], v113, s[18:19]
  global_load_dwordx4 a[140:143], v113, s[18:19] offset:1024
  s_add_u32 s18, s16, 36864
  s_addc_u32 s19, s17, 0
  global_load_dwordx4 a[144:147], v113, s[18:19]
  global_load_dwordx4 a[148:151], v113, s[18:19] offset:1024
  s_add_u32 s18, s16, 38912
  s_addc_u32 s19, s17, 0
  global_load_dwordx4 a[152:155], v113, s[18:19]
  global_load_dwordx4 a[156:159], v113, s[18:19] offset:1024
  s_add_u32 s18, s16, 40960
  s_addc_u32 s19, s17, 0
  global_load_dwordx4 a[160:163], v113, s[18:19]
  global_load_dwordx4 a[164:167], v113, s[18:19] offset:1024
  s_add_u32 s18, s16, 43008
  s_addc_u32 s19, s17, 0
  global_load_dwordx4 a[168:171], v113, s[18:19]
  global_load_dwordx4 a[172:175], v113, s[18:19] offset:1024
  s_add_u32 s18, s16, 45056
  s_addc_u32 s19, s17, 0
  global_load_dwordx4 a[176:179], v113, s[18:19]
  global_load_dwordx4 a[180:183], v113, s[18:19] offset:1024
  s_add_u32 s18, s16, 47104
  s_addc_u32 s19, s17, 0
  global_load_dwordx4 a[184:187], v113, s[18:19]
  global_load_dwordx4 a[188:191], v113, s[18:19] offset:1024
  s_add_u32 s18, s16, 49152
  s_addc_u32 s19, s17, 0
  global_load_dwordx4 a[192:195], v113, s[18:19]
  global_load_dwordx4 a[196:199], v113, s[18:19] offset:1024
  s_add_u32 s18, s16, 51200
  s_addc_u32 s19, s17, 0
  global_load_dwordx4 a[200:203], v113, s[18:19]
  global_load_dwordx4 a[204:207], v113, s[18:19] offset:1024
  s_add_u32 s18, s16, 53248
  s_addc_u32 s19, s17, 0
  global_load_dwordx4 a[208:211], v113, s[18:19]
  global_load_dwordx4 a[212:215], v113, s[18:19] offset:1024
  s_add_u32 s18, s16, 55296
  s_addc_u32 s19, s17, 0
  global_load_dwordx4 a[216:219], v113, s[18:19]
  global_load_dwordx4 a[220:223], v113, s[18:19] offset:1024
  s_add_u32 s18, s16, 57344
  s_addc_u32 s19, s17, 0
  global_load_dwordx4 a[224:227], v113, s[18:19]
  global_load_dwordx4 a[228:231], v113, s[18:19] offset:1024
  s_add_u32 s18, s16, 59392
  s_addc_u32 s19, s17, 0
  global_load_dwordx4 a[232:235], v113, s[18:19]
  global_load_dwordx4 a[236:239], v113, s[18:19] offset:1024
  s_add_u32 s18, s16, 61440
  s_addc_u32 s19, s17, 0
  global_load_dwordx4 a[240:243], v113, s[18:19]
  global_load_dwordx4 a[244:247], v113, s[18:19] offset:1024
  s_add_u32 s18, s16, 63488
  s_addc_u32 s19, s17, 0
  global_load_dwordx4 a[248:251], v113, s[18:19]
  global_load_dwordx4 a[252:255], v113, s[18:19] offset:1024
  s_add_u32 s18, s16, 65536
  s_addc_u32 s19, s17, 0
  global_load_dwordx4 v[120:123], v113, s[18:19]
  global_load_dwordx4 v[124:127], v113, s[18:19] offset:1024
  s_add_u32 s18, s16, 67584
  s_addc_u32 s19, s17, 0
  global_load_dwordx4 v[128:131], v113, s[18:19]
  global_load_dwordx4 v[132:135], v113, s[18:19] offset:1024
  s_add_u32 s18, s16, 69632
  s_addc_u32 s19, s17, 0
  global_load_dwordx4 v[136:139], v113, s[18:19]
  global_load_dwordx4 v[140:143], v113, s[18:19] offset:1024
  s_add_u32 s18, s16, 71680
  s_addc_u32 s19, s17, 0
  global_load_dwordx4 v[144:147], v113, s[18:19]
  global_load_dwordx4 v[148:151], v113, s[18:19] offset:1024
  s_add_u32 s18, s16, 73728
  s_addc_u32 s19, s17, 0
  global_load_dwordx4 v[152:155], v113, s[18:19]
  global_load_dwordx4 v[156:159], v113, s[18:19] offset:1024
  s_add_u32 s18, s16, 75776
  s_addc_u32 s19, s17, 0
  global_load_dwordx4 v[160:163], v113, s[18:19]
  global_load_dwordx4 v[164:167], v113, s[18:19] offset:1024
  s_add_u32 s18, s16, 77824
  s_addc_u32 s19, s17, 0
  global_load_dwordx4 v[168:171], v113, s[18:19]
  global_load_dwordx4 v[172:175], v113, s[18:19] offset:1024
  s_add_u32 s18, s16, 79872
  s_addc_u32 s19, s17, 0
  global_load_dwordx4 v[176:179], v113, s[18:19]
  global_load_dwordx4 v[180:183], v113, s[18:19] offset:1024
  s_add_u32 s18, s16, 81920
  s_addc_u32 s19, s17, 0
  global_load_dwordx4 v[184:187], v113, s[18:19]
  global_load_dwordx4 v[188:191], v113, s[18:19] offset:1024
  s_add_u32 s18, s16, 83968
  s_addc_u32 s19, s17, 0
  global_load_dwordx4 v[192:195], v113, s[18:19]
  global_load_dwordx4 v[196:199], v113, s[18:19] offset:1024
  s_add_u32 s18, s16, 86016
  s_addc_u32 s19, s17, 0
  global_load_dwordx4 v[200:203], v113, s[18:19]
  global_load_dwordx4 v[204:207], v113, s[18:19] offset:1024
  s_add_u32 s18, s16, 88064
  s_addc_u32 s19, s17, 0
  global_load_dwordx4 v[208:211], v113, s[18:19]
  global_load_dwordx4 v[212:215], v113, s[18:19] offset:1024
  s_add_u32 s18, s16, 90112
  s_addc_u32 s19, s17, 0
  global_load_dwordx4 v[216:219], v113, s[18:19]
  global_load_dwordx4 v[220:223], v113, s[18:19] offset:1024
  s_add_u32 s18, s16, 92160
  s_addc_u32 s19, s17, 0
  global_load_dwordx4 v[224:227], v113, s[18:19]
  global_load_dwordx4 v[228:231], v113, s[18:19] offset:1024
  s_add_u32 s18, s16, 94208
  s_addc_u32 s19, s17, 0
  global_load_dwordx4 v[232:235], v113, s[18:19]
  global_load_dwordx4 v[236:239], v113, s[18:19] offset:1024
  s_add_u32 s18, s16, 96256
  s_addc_u32 s19, s17, 0
  global_load_dwordx4 v[240:243], v113, s[18:19]
  global_load_dwordx4 v[244:247], v113, s[18:19] offset:1024
  s_add_u32 s18, s16, 98304
  s_addc_u32 s19, s17, 0
  global_load_dwordx4 v[248:251], v113, s[18:19]
  global_load_dwordx4 v[252:255], v113, s[18:19] offset:1024
  s_branch L_wl_j_258
L_wl_n_259:
  s_cmp_lg_u32 s8, 1
  s_cbranch_scc1 L_wl_n_260
  s_add_u32 s18, s16, 4096
  s_addc_u32 s19, s17, 0
  global_load_dwordx4 a[0:3], v113, s[18:19]
  global_load_dwordx4 a[4:7], v113, s[18:19] offset:1024
  s_add_u32 s18, s16, 6144
  s_addc_u32 s19, s17, 0
  global_load_dwordx4 a[8:11], v113, s[18:19]
  global_load_dwordx4 a[12:15], v113, s[18:19] offset:1024
  s_add_u32 s18, s16, 0
  s_addc_u32 s19, s17, 0
  global_load_dwordx4 a[16:19], v113, s[18:19]
  global_load_dwordx4 a[20:23], v113, s[18:19] offset:1024
  s_add_u32 s18, s16, 2048
  s_addc_u32 s19, s17, 0
  global_load_dwordx4 a[24:27], v113, s[18:19]
  global_load_dwordx4 a[28:31], v113, s[18:19] offset:1024
  s_add_u32 s18, s16, 8192
  s_addc_u32 s19, s17, 0
  global_load_dwordx4 a[32:35], v113, s[18:19]
  global_load_dwordx4 a[36:39], v113, s[18:19] offset:1024
  s_add_u32 s18, s16, 10240
  s_addc_u32 s19, s17, 0
  global_load_dwordx4 a[40:43], v113, s[18:19]
  global_load_dwordx4 a[44:47], v113, s[18:19] offset:1024
  s_add_u32 s18, s16, 12288
  s_addc_u32 s19, s17, 0
  global_load_dwordx4 a[48:51], v113, s[18:19]
  global_load_dwordx4 a[52:55], v113, s[18:19] offset:1024
  s_add_u32 s18, s16, 18432
  s_addc_u32 s19, s17, 0
  global_load_dwordx4 a[56:59], v113, s[18:19]
  global_load_dwordx4 a[60:63], v113, s[18:19] offset:1024
  s_add_u32 s18, s16, 20480
  s_addc_u32 s19, s17, 0
  global_load_dwordx4 a[64:67], v113, s[18:19]
  global_load_dwordx4 a[68:71], v113, s[18:19] offset:1024
  s_add_u32 s18, s16, 14336
  s_addc_u32 s19, s17, 0
  global_load_dwordx4 a[72:75], v113, s[18:19]
  global_load_dwordx4 a[76:79], v113, s[18:19] offset:1024
  s_add_u32 s18, s16, 16384
  s_addc_u32 s19, s17, 0
  global_load_dwordx4 a[80:83], v113, s[18:19]
  global_load_dwordx4 a[84:87], v113, s[18:19] offset:1024
  s_add_u32 s18, s16, 22528
  s_addc_u32 s19, s17, 0
  global_load_dwordx4 a[88:91], v113, s[18:19]
  global_load_dwordx4 a[92:95], v113, s[18:19] offset:1024
  s_add_u32 s18, s16, 24576
  s_addc_u32 s19, s17, 0
  global_load_dwordx4 a[96:99], v113, s[18:19]
  global_load_dwordx4 a[100:103], v113, s[18:19] offset:1024
  s_add_u32 s18, s16, 26624
  s_addc_u32 s19, s17, 0
  global_load_dwordx4 a[104:107], v113, s[18:19]
  global_load_dwordx4 a[108:111], v113, s[18:19] offset:1024
  s_add_u32 s18, s16, 32768
  s_addc_u32 s19, s17, 0
  global_load_dwordx4 a[112:115], v113, s[18:19]
  global_load_dwordx4 a[116:119], v113, s[18:19] offset:1024
  s_add_u32 s18, s16, 34816
  s_addc_u32 s19, s17, 0
  global_load_dwordx4 a[120:123], v113, s[18:19]
  global_load_dwordx4 a[124:127], v113, s[18:19] offset:1024
  s_add_u32 s18, s16, 28672
  s_addc_u32 s19, s17, 0
  global_load_dwordx4 a[128:131], v113, s[18:19]
  global_load_dwordx4 a[132:135], v113, s[18:19] offset:1024
  s_add_u32 s18, s16, 30720
  s_addc_u32 s19, s17, 0
  global_load_dwordx4 a[136:139], v113, s[18:19]
  global_load_dwordx4 a[140:143], v113, s[18:19] offset:1024
  s_add_u32 s18, s16, 36864
  s_addc_u32 s19, s17, 0
  global_load_dwordx4 a[144:147], v113, s[18:19]
  global_load_dwordx4 a[148:151], v113, s[18:19] offset:1024
  s_add_u32 s18, s16, 38912
  s_addc_u32 s19, s17, 0
  global_load_dwordx4 a[152:155], v113, s[18:19]
  global_load_dwordx4 a[156:159], v113, s[18:19] offset:1024
  s_add_u32 s18, s16, 40960
  s_addc_u32 s19, s17, 0
  global_load_dwordx4 a[160:163], v113, s[18:19]
  global_load_dwordx4 a[164:167], v113, s[18:19] offset:1024
  s_add_u32 s18, s16, 47104
  s_addc_u32 s19, s17, 0
  global_load_dwordx4 a[168:171], v113, s[18:19]
  global_load_dwordx4 a[172:175], v113, s[18:19] offset:1024
  s_add_u32 s18, s16, 49152
  s_addc_u32 s19, s17, 0
  global_load_dwordx4 a[176:179], v113, s[18:19]
  global_load_dwordx4 a[180:183], v113, s[18:19] offset:1024
  s_add_u32 s18, s16, 43008
  s_addc_u32 s19, s17, 0
  global_load_dwordx4 a[184:187], v113, s[18:19]
  global_load_dwordx4 a[188:191], v113, s[18:19] offset:1024
  s_add_u32 s18, s16, 45056
  s_addc_u32 s19, s17, 0
  global_load_dwordx4 a[192:195], v113, s[18:19]
  global_load_dwordx4 a[196:199], v113, s[18:19] offset:1024
  s_add_u32 s18, s16, 51200
  s_addc_u32 s19, s17, 0
  global_load_dwordx4 a[200:203], v113, s[18:19]
  global_load_dwordx4 a[204:207], v113, s[18:19] offset:1024
  s_add_u32 s18, s16, 53248
  s_addc_u32 s19, s17, 0
  global_load_dwordx4 a[208:211], v113, s[18:19]
  global_load_dwordx4 a[212:215], v113, s[18:19] offset:1024
  s_add_u32 s18, s16, 55296
  s_addc_u32 s19, s17, 0
  global_load_dwordx4 a[216:219], v113, s[18:19]
  global_load_dwordx4 a[220:223], v113, s[18:19] offset:1024
  s_add_u32 s18, s16, 61440
  s_addc_u32 s19, s17, 0
  global_load_dwordx4 a[224:227], v113, s[18:19]
  global_load_dwordx4 a[228:231], v113, s[18:19] offset:1024
  s_add_u32 s18, s16, 63488
  s_addc_u32 s19, s17, 0
  global_load_dwordx4 a[232:235], v113, s[18:19]
  global_load_dwordx4 a[236:239], v113, s[18:19] offset:1024
  s_add_u32 s18, s16, 57344
  s_addc_u32 s19, s17, 0
  global_load_dwordx4 a[240:243], v113, s[18:19]
  global_load_dwordx4 a[244:247], v113, s[18:19] offset:1024
  s_add_u32 s18, s16, 59392
  s_addc_u32 s19, s17, 0
  global_load_dwordx4 a[248:251], v113, s[18:19]
  global_load_dwordx4 a[252:255], v113, s[18:19] offset:1024
  s_add_u32 s18, s16, 65536
  s_addc_u32 s19, s17, 0
  global_load_dwordx4 v[120:123], v113, s[18:19]
  global_load_dwordx4 v[124:127], v113, s[18:19] offset:1024
  s_add_u32 s18, s16, 67584
  s_addc_u32 s19, s17, 0
  global_load_dwordx4 v[128:131], v113, s[18:19]
  global_load_dwordx4 v[132:135], v113, s[18:19] offset:1024
  s_add_u32 s18, s16, 69632
  s_addc_u32 s19, s17, 0
  global_load_dwordx4 v[136:139], v113, s[18:19]
  global_load_dwordx4 v[140:143], v113, s[18:19] offset:1024
  s_add_u32 s18, s16, 75776
  s_addc_u32 s19, s17, 0
  global_load_dwordx4 v[144:147], v113, s[18:19]
  global_load_dwordx4 v[148:151], v113, s[18:19] offset:1024
  s_add_u32 s18, s16, 77824
  s_addc_u32 s19, s17, 0
  global_load_dwordx4 v[152:155], v113, s[18:19]
  global_load_dwordx4 v[156:159], v113, s[18:19] offset:1024
  s_add_u32 s18, s16, 71680
  s_addc_u32 s19, s17, 0
  global_load_dwordx4 v[160:163], v113, s[18:19]
  global_load_dwordx4 v[164:167], v113, s[18:19] offset:1024
  s_add_u32 s18, s16, 73728
  s_addc_u32 s19, s17, 0
  global_load_dwordx4 v[168:171], v113, s[18:19]
  global_load_dwordx4 v[172:175], v113, s[18:19] offset:1024
  s_add_u32 s18, s16, 79872
  s_addc_u32 s19, s17, 0
  global_load_dwordx4 v[176:179], v113, s[18:19]
  global_load_dwordx4 v[180:183], v113, s[18:19] offset:1024
  s_add_u32 s18, s16, 81920
  s_addc_u32 s19, s17, 0
  global_load_dwordx4 v[184:187], v113, s[18:19]
  global_load_dwordx4 v[188:191], v113, s[18:19] offset:1024
  s_add_u32 s18, s16, 83968
  s_addc_u32 s19, s17, 0
  global_load_dwordx4 v[192:195], v113, s[18:19]
  global_load_dwordx4 v[196:199], v113, s[18:19] offset:1024
  s_add_u32 s18, s16, 90112
  s_addc_u32 s19, s17, 0
  global_load_dwordx4 v[200:203], v113, s[18:19]
  global_load_dwordx4 v[204:207], v113, s[18:19] offset:1024
  s_add_u32 s18, s16, 92160
  s_addc_u32 s19, s17, 0
  global_load_dwordx4 v[208:211], v113, s[18:19]
  global_load_dwordx4 v[212:215], v113, s[18:19] offset:1024
  s_add_u32 s18, s16, 86016
  s_addc_u32 s19, s17, 0
  global_load_dwordx4 v[216:219], v113, s[18:19]
  global_load_dwordx4 v[220:223], v113, s[18:19] offset:1024
  s_add_u32 s18, s16, 88064
  s_addc_u32 s19, s17, 0
  global_load_dwordx4 v[224:227], v113, s[18:19]
  global_load_dwordx4 v[228:231], v113, s[18:19] offset:1024
  s_add_u32 s18, s16, 94208
  s_addc_u32 s19, s17, 0
  global_load_dwordx4 v[232:235], v113, s[18:19]
  global_load_dwordx4 v[236:239], v113, s[18:19] offset:1024
  s_add_u32 s18, s16, 96256
  s_addc_u32 s19, s17, 0
  global_load_dwordx4 v[240:243], v113, s[18:19]
  global_load_dwordx4 v[244:247], v113, s[18:19] offset:1024
  s_add_u32 s18, s16, 98304
  s_addc_u32 s19, s17, 0
  global_load_dwordx4 v[248:251], v113, s[18:19]
  global_load_dwordx4 v[252:255], v113, s[18:19] offset:1024
  s_branch L_wl_j_258
L_wl_n_260:
  s_cmp_lg_u32 s8, 2
  s_cbranch_scc1 L_wl_n_261
  s_add_u32 s18, s16, 8192
  s_addc_u32 s19, s17, 0
  global_load_dwordx4 a[0:3], v113, s[18:19]
  global_load_dwordx4 a[4:7], v113, s[18:19] offset:1024
  s_add_u32 s18, s16, 10240
  s_addc_u32 s19, s17, 0
  global_load_dwordx4 a[8:11], v113, s[18:19]
  global_load_dwordx4 a[12:15], v113, s[18:19] offset:1024
  s_add_u32 s18, s16, 0
  s_addc_u32 s19, s17, 0
  global_load_dwordx4 a[16:19], v113, s[18:19]
  global_load_dwordx4 a[20:23], v113, s[18:19] offset:1024
  s_add_u32 s18, s16, 2048
  s_addc_u32 s19, s17, 0
  global_load_dwordx4 a[24:27], v113, s[18:19]
  global_load_dwordx4 a[28:31], v113, s[18:19] offset:1024
  s_add_u32 s18, s16, 4096
  s_addc_u32 s19, s17, 0
  global_load_dwordx4 a[32:35], v113, s[18:19]
  global_load_dwordx4 a[36:39], v113, s[18:19] offset:1024
  s_add_u32 s18, s16, 6144
  s_addc_u32 s19, s17, 0
  global_load_dwordx4 a[40:43], v113, s[18:19]
  global_load_dwordx4 a[44:47], v113, s[18:19] offset:1024
  s_add_u32 s18, s16, 12288
  s_addc_u32 s19, s17, 0
  global_load_dwordx4 a[48:51], v113, s[18:19]
  global_load_dwordx4 a[52:55], v113, s[18:19] offset:1024
  s_add_u32 s18, s16, 22528
  s_addc_u32 s19, s17, 0
  global_load_dwordx4 a[56:59], v113, s[18:19]
  global_load_dwordx4 a[60:63], v113, s[18:19] offset:1024
  s_add_u32 s18, s16, 24576
  s_addc_u32 s19, s17, 0
  global_load_dwordx4 a[64:67], v113, s[18:19]
  global_load_dwordx4 a[68:71], v113, s[18:19] offset:1024
  s_add_u32 s18, s16, 14336
  s_addc_u32 s19, s17, 0
  global_load_dwordx4 a[72:75], v113, s[18:19]
  global_load_dwordx4 a[76:79], v113, s[18:19] offset:1024
  s_add_u32 s18, s16, 16384
  s_addc_u32 s19, s17, 0
  global_load_dwordx4 a[80:83], v113, s[18:19]
  global_load_dwordx4 a[84:87], v113, s[18:19] offset:1024
  s_add_u32 s18, s16, 18432
  s_addc_u32 s19, s17, 0
  global_load_dwordx4 a[88:91], v113, s[18:19]
  global_load_dwordx4 a[92:95], v113, s[18:19] offset:1024
  s_add_u32 s18, s16, 20480
  s_addc_u32 s19, s17, 0
  global_load_dwordx4 a[96:99], v113, s[18:19]
  global_load_dwordx4 a[100:103], v113, s[18:19] offset:1024
  s_add_u32 s18, s16, 26624
  s_addc_u32 s19, s17, 0
  global_load_dwordx4 a[104:107], v113, s[18:19]
  global_load_dwordx4 a[108:111], v113, s[18:19] offset:1024
  s_add_u32 s18, s16, 36864
  s_addc_u32 s19, s17, 0
  global_load_dwordx4 a[112:115], v113, s[18:19]
  global_load_dwordx4 a[116:119], v113, s[18:19] offset:1024
  s_add_u32 s18, s16, 38912
  s_addc_u32 s19, s17, 0
  global_load_dwordx4 a[120:123], v113, s[18:19]
  global_load_dwordx4 a[124:127], v113, s[18:19] offset:1024
  s_add_u32 s18, s16, 28672
  s_addc_u32 s19, s17, 0
  global_load_dwordx4 a[128:131], v113, s[18:19]
  global_load_dwordx4 a[132:135], v113, s[18:19] offset:1024
  s_add_u32 s18, s16, 30720
  s_addc_u32 s19, s17, 0
  global_load_dwordx4 a[136:139], v113, s[18:19]
  global_load_dwordx4 a[140:143], v113, s[18:19] offset:1024
  s_add_u32 s18, s16, 32768
  s_addc_u32 s19, s17, 0
  global_load_dwordx4 a[144:147], v113, s[18:19]
  global_load_dwordx4 a[148:151], v113, s[18:19] offset:1024
  s_add_u32 s18, s16, 34816
  s_addc_u32 s19, s17, 0
  global_load_dwordx4 a[152:155], v113, s[18:19]
  global_load_dwordx4 a[156:159], v113, s[18:19] offset:1024
  s_add_u32 s18, s16, 40960
  s_addc_u32 s19, s17, 0
  global_load_dwordx4 a[160:163], v113, s[18:19]
  global_load_dwordx4 a[164:167], v113, s[18:19] offset:1024
  s_add_u32 s18, s16, 51200
  s_addc_u32 s19, s17, 0
  global_load_dwordx4 a[168:171], v113, s[18:19]
  global_load_dwordx4 a[172:175], v113, s[18:19] offset:1024
  s_add_u32 s18, s16, 53248
  s_addc_u32 s19, s17, 0
  global_load_dwordx4 a[176:179], v113, s[18:19]
  global_load_dwordx4 a[180:183], v113, s[18:19] offset:1024
  s_add_u32 s18, s16, 43008
  s_addc_u32 s19, s17, 0
  global_load_dwordx4 a[184:187], v113, s[18:19]
  global_load_dwordx4 a[188:191], v113, s[18:19] offset:1024
  s_add_u32 s18, s16, 45056
  s_addc_u32 s19, s17, 0
  global_load_dwordx4 a[192:195], v113, s[18:19]
  global_load_dwordx4 a[196:199], v113, s[18:19] offset:1024
  s_add_u32 s18, s16, 47104
  s_addc_u32 s19, s17, 0
  global_load_dwordx4 a[200:203], v113, s[18:19]
  global_load_dwordx4 a[204:207], v113, s[18:19] offset:1024
  s_add_u32 s18, s16, 49152
  s_addc_u32 s19, s17, 0
  global_load_dwordx4 a[208:211], v113, s[18:19]
  global_load_dwordx4 a[212:215], v113, s[18:19] offset:1024
  s_add_u32 s18, s16, 55296
  s_addc_u32 s19, s17, 0
  global_load_dwordx4 a[216:219], v113, s[18:19]
  global_load_dwordx4 a[220:223], v113, s[18:19] offset:1024
  s_add_u32 s18, s16, 65536
  s_addc_u32 s19, s17, 0
  global_load_dwordx4 a[224:227], v113, s[18:19]
  global_load_dwordx4 a[228:231], v113, s[18:19] offset:1024
  s_add_u32 s18, s16, 67584
  s_addc_u32 s19, s17, 0
  global_load_dwordx4 a[232:235], v113, s[18:19]
  global_load_dwordx4 a[236:239], v113, s[18:19] offset:1024
  s_add_u32 s18, s16, 57344
  s_addc_u32 s19, s17, 0
  global_load_dwordx4 a[240:243], v113, s[18:19]
  global_load_dwordx4 a[244:247], v113, s[18:19] offset:1024
  s_add_u32 s18, s16, 59392
  s_addc_u32 s19, s17, 0
  global_load_dwordx4 a[248:251], v113, s[18:19]
  global_load_dwordx4 a[252:255], v113, s[18:19] offset:1024
  s_add_u32 s18, s16, 61440
  s_addc_u32 s19, s17, 0
  global_load_dwordx4 v[120:123], v113, s[18:19]
  global_load_dwordx4 v[124:127], v113, s[18:19] offset:1024
  s_add_u32 s18, s16, 63488
  s_addc_u32 s19, s17, 0
  global_load_dwordx4 v[128:131], v113, s[18:19]
  global_load_dwordx4 v[132:135], v113, s[18:19] offset:1024
  s_add_u32 s18, s16, 69632
  s_addc_u32 s19, s17, 0
  global_load_dwordx4 v[136:139], v113, s[18:19]
  global_load_dwordx4 v[140:143], v113, s[18:19] offset:1024
  s_add_u32 s18, s16, 79872
  s_addc_u32 s19, s17, 0
  global_load_dwordx4 v[144:147], v113, s[18:19]
  global_load_dwordx4 v[148:151], v113, s[18:19] offset:1024
  s_add_u32 s18, s16, 81920
  s_addc_u32 s19, s17, 0
  global_load_dwordx4 v[152:155], v113, s[18:19]
  global_load_dwordx4 v[156:159], v113, s[18:19] offset:1024
  s_add_u32 s18, s16, 71680
  s_addc_u32 s19, s17, 0
  global_load_dwordx4 v[160:163], v113, s[18:19]
  global_load_dwordx4 v[164:167], v113, s[18:19] offset:1024
  s_add_u32 s18, s16, 73728
  s_addc_u32 s19, s17, 0
  global_load_dwordx4 v[168:171], v113, s[18:19]
  global_load_dwordx4 v[172:175], v113, s[18:19] offset:1024
  s_add_u32 s18, s16, 75776
  s_addc_u32 s19, s17, 0
  global_load_dwordx4 v[176:179], v113, s[18:19]
  global_load_dwordx4 v[180:183], v113, s[18:19] offset:1024
  s_add_u32 s18, s16, 77824
  s_addc_u32 s19, s17, 0
  global_load_dwordx4 v[184:187], v113, s[18:19]
  global_load_dwordx4 v[188:191], v113, s[18:19] offset:1024
  s_add_u32 s18, s16, 83968
  s_addc_u32 s19, s17, 0
  global_load_dwordx4 v[192:195], v113, s[18:19]
  global_load_dwordx4 v[196:199], v113, s[18:19] offset:1024
  s_add_u32 s18, s16, 94208
  s_addc_u32 s19, s17, 0
  global_load_dwordx4 v[200:203], v113, s[18:19]
  global_load_dwordx4 v[204:207], v113, s[18:19] offset:1024
  s_add_u32 s18, s16, 96256
  s_addc_u32 s19, s17, 0
  global_load_dwordx4 v[208:211], v113, s[18:19]
  global_load_dwordx4 v[212:215], v113, s[18:19] offset:1024
  s_add_u32 s18, s16, 86016
  s_addc_u32 s19, s17, 0
  global_load_dwordx4 v[216:219], v113, s[18:19]
  global_load_dwordx4 v[220:223], v113, s[18:19] offset:1024
  s_add_u32 s18, s16, 88064
  s_addc_u32 s19, s17, 0
  global_load_dwordx4 v[224:227], v113, s[18:19]
  global_load_dwordx4 v[228:231], v113, s[18:19] offset:1024
  s_add_u32 s18, s16, 90112
  s_addc_u32 s19, s17, 0
  global_load_dwordx4 v[232:235], v113, s[18:19]
  global_load_dwordx4 v[236:239], v113, s[18:19] offset:1024
  s_add_u32 s18, s16, 92160
  s_addc_u32 s19, s17, 0
  global_load_dwordx4 v[240:243], v113, s[18:19]
  global_load_dwordx4 v[244:247], v113, s[18:19] offset:1024
  s_add_u32 s18, s16, 98304
  s_addc_u32 s19, s17, 0
  global_load_dwordx4 v[248:251], v113, s[18:19]
  global_load_dwordx4 v[252:255], v113, s[18:19] offset:1024
  s_branch L_wl_j_258
L_wl_n_261:
  s_add_u32 s18, s16, 12288
  s_addc_u32 s19, s17, 0
  global_load_dwordx4 a[0:3], v113, s[18:19]
  global_load_dwordx4 a[4:7], v113, s[18:19] offset:1024
  s_add_u32 s18, s16, 10240
  s_addc_u32 s19, s17, 0
  global_load_dwordx4 a[8:11], v113, s[18:19]
  global_load_dwordx4 a[12:15], v113, s[18:19] offset:1024
  s_add_u32 s18, s16, 0
  s_addc_u32 s19, s17, 0
  global_load_dwordx4 a[16:19], v113, s[18:19]
  global_load_dwordx4 a[20:23], v113, s[18:19] offset:1024
  s_add_u32 s18, s16, 2048
  s_addc_u32 s19, s17, 0
  global_load_dwordx4 a[24:27], v113, s[18:19]
  global_load_dwordx4 a[28:31], v113, s[18:19] offset:1024
  s_add_u32 s18, s16, 4096
  s_addc_u32 s19, s17, 0
  global_load_dwordx4 a[32:35], v113, s[18:19]
  global_load_dwordx4 a[36:39], v113, s[18:19] offset:1024
  s_add_u32 s18, s16, 6144
  s_addc_u32 s19, s17, 0
  global_load_dwordx4 a[40:43], v113, s[18:19]
  global_load_dwordx4 a[44:47], v113, s[18:19] offset:1024
  s_add_u32 s18, s16, 8192
  s_addc_u32 s19, s17, 0
  global_load_dwordx4 a[48:51], v113, s[18:19]
  global_load_dwordx4 a[52:55], v113, s[18:19] offset:1024
  s_add_u32 s18, s16, 26624
  s_addc_u32 s19, s17, 0
  global_load_dwordx4 a[56:59], v113, s[18:19]
  global_load_dwordx4 a[60:63], v113, s[18:19] offset:1024
  s_add_u32 s18, s16, 24576
  s_addc_u32 s19, s17, 0
  global_load_dwordx4 a[64:67], v113, s[18:19]
  global_load_dwordx4 a[68:71], v113, s[18:19] offset:1024
  s_add_u32 s18, s16, 14336
  s_addc_u32 s19, s17, 0
  global_load_dwordx4 a[72:75], v113, s[18:19]
  global_load_dwordx4 a[76:79], v113, s[18:19] offset:1024
  s_add_u32 s18, s16, 16384
  s_addc_u32 s19, s17, 0
  global_load_dwordx4 a[80:83], v113, s[18:19]
  global_load_dwordx4 a[84:87], v113, s[18:19] offset:1024
  s_add_u32 s18, s16, 18432
  s_addc_u32 s19, s17, 0
  global_load_dwordx4 a[88:91], v113, s[18:19]
  global_load_dwordx4 a[92:95], v113, s[18:19] offset:1024
  s_add_u32 s18, s16, 20480
  s_addc_u32 s19, s17, 0
  global_load_dwordx4 a[96:99], v113, s[18:19]
  global_load_dwordx4 a[100:103], v113, s[18:19] offset:1024
  s_add_u32 s18, s16, 22528
  s_addc_u32 s19, s17, 0
  global_load_dwordx4 a[104:107], v113, s[18:19]
  global_load_dwordx4 a[108:111], v113, s[18:19] offset:1024
  s_add_u32 s18, s16, 40960
  s_addc_u32 s19, s17, 0
  global_load_dwordx4 a[112:115], v113, s[18:19]
  global_load_dwordx4 a[116:119], v113, s[18:19] offset:1024
  s_add_u32 s18, s16, 38912
  s_addc_u32 s19, s17, 0
  global_load_dwordx4 a[120:123], v113, s[18:19]
  global_load_dwordx4 a[124:127], v113, s[18:19] offset:1024
  s_add_u32 s18, s16, 28672
  s_addc_u32 s19, s17, 0
  global_load_dwordx4 a[128:131], v113, s[18:19]
  global_load_dwordx4 a[132:135], v113, s[18:19] offset:1024
  s_add_u32 s18, s16, 30720
  s_addc_u32 s19, s17, 0
  global_load_dwordx4 a[136:139], v113, s[18:19]
  global_load_dwordx4 a[140:143], v113, s[18:19] offset:1024
  s_add_u32 s18, s16, 32768
  s_addc_u32 s19, s17, 0
  global_load_dwordx4 a[144:147], v113, s[18:19]
  global_load_dwordx4 a[148:151], v113, s[18:19] offset:1024
  s_add_u32 s18, s16, 34816
  s_addc_u32 s19, s17, 0
  global_load_dwordx4 a[152:155], v113, s[18:19]
  global_load_dwordx4 a[156:159], v113, s[18:19] offset:1024
  s_add_u32 s18, s16, 36864
  s_addc_u32 s19, s17, 0
  global_load_dwordx4 a[160:163], v113, s[18:19]
  global_load_dwordx4 a[164:167], v113, s[18:19] offset:1024
  s_add_u32 s18, s16, 55296
  s_addc_u32 s19, s17, 0
  global_load_dwordx4 a[168:171], v113, s[18:19]
  global_load_dwordx4 a[172:175], v113, s[18:19] offset:1024
  s_add_u32 s18, s16, 53248
  s_addc_u32 s19, s17, 0
  global_load_dwordx4 a[176:179], v113, s[18:19]
  global_load_dwordx4 a[180:183], v113, s[18:19] offset:1024
  s_add_u32 s18, s16, 43008
  s_addc_u32 s19, s17, 0
  global_load_dwordx4 a[184:187], v113, s[18:19]
  global_load_dwordx4 a[188:191], v113, s[18:19] offset:1024
  s_add_u32 s18, s16, 45056
  s_addc_u32 s19, s17, 0
  global_load_dwordx4 a[192:195], v113, s[18:19]
  global_load_dwordx4 a[196:199], v113, s[18:19] offset:1024
  s_add_u32 s18, s16, 47104
  s_addc_u32 s19, s17, 0
  global_load_dwordx4 a[200:203], v113, s[18:19]
  global_load_dwordx4 a[204:207], v113, s[18:19] offset:1024
  s_add_u32 s18, s16, 49152
  s_addc_u32 s19, s17, 0
  global_load_dwordx4 a[208:211], v113, s[18:19]
  global_load_dwordx4 a[212:215], v113, s[18:19] offset:1024
  s_add_u32 s18, s16, 51200
  s_addc_u32 s19, s17, 0
  global_load_dwordx4 a[216:219], v113, s[18:19]
  global_load_dwordx4 a[220:223], v113, s[18:19] offset:1024
  s_add_u32 s18, s16, 69632
  s_addc_u32 s19, s17, 0
  global_load_dwordx4 a[224:227], v113, s[18:19]
  global_load_dwordx4 a[228:231], v113, s[18:19] offset:1024
  s_add_u32 s18, s16, 67584
  s_addc_u32 s19, s17, 0
  global_load_dwordx4 a[232:235], v113, s[18:19]
  global_load_dwordx4 a[236:239], v113, s[18:19] offset:1024
  s_add_u32 s18, s16, 57344
  s_addc_u32 s19, s17, 0
  global_load_dwordx4 a[240:243], v113, s[18:19]
  global_load_dwordx4 a[244:247], v113, s[18:19] offset:1024
  s_add_u32 s18, s16, 59392
  s_addc_u32 s19, s17, 0
  global_load_dwordx4 a[248:251], v113, s[18:19]
  global_load_dwordx4 a[252:255], v113, s[18:19] offset:1024
  s_add_u32 s18, s16, 61440
  s_addc_u32 s19, s17, 0
  global_load_dwordx4 v[120:123], v113, s[18:19]
  global_load_dwordx4 v[124:127], v113, s[18:19] offset:1024
  s_add_u32 s18, s16, 63488
  s_addc_u32 s19, s17, 0
  global_load_dwordx4 v[128:131], v113, s[18:19]
  global_load_dwordx4 v[132:135], v113, s[18:19] offset:1024
  s_add_u32 s18, s16, 65536
  s_addc_u32 s19, s17, 0
  global_load_dwordx4 v[136:139], v113, s[18:19]
  global_load_dwordx4 v[140:143], v113, s[18:19] offset:1024
  s_add_u32 s18, s16, 83968
  s_addc_u32 s19, s17, 0
  global_load_dwordx4 v[144:147], v113, s[18:19]
  global_load_dwordx4 v[148:151], v113, s[18:19] offset:1024
  s_add_u32 s18, s16, 81920
  s_addc_u32 s19, s17, 0
  global_load_dwordx4 v[152:155], v113, s[18:19]
  global_load_dwordx4 v[156:159], v113, s[18:19] offset:1024
  s_add_u32 s18, s16, 71680
  s_addc_u32 s19, s17, 0
  global_load_dwordx4 v[160:163], v113, s[18:19]
  global_load_dwordx4 v[164:167], v113, s[18:19] offset:1024
  s_add_u32 s18, s16, 73728
  s_addc_u32 s19, s17, 0
  global_load_dwordx4 v[168:171], v113, s[18:19]
  global_load_dwordx4 v[172:175], v113, s[18:19] offset:1024
  s_add_u32 s18, s16, 75776
  s_addc_u32 s19, s17, 0
  global_load_dwordx4 v[176:179], v113, s[18:19]
  global_load_dwordx4 v[180:183], v113, s[18:19] offset:1024
  s_add_u32 s18, s16, 77824
  s_addc_u32 s19, s17, 0
  global_load_dwordx4 v[184:187], v113, s[18:19]
  global_load_dwordx4 v[188:191], v113, s[18:19] offset:1024
  s_add_u32 s18, s16, 79872
  s_addc_u32 s19, s17, 0
  global_load_dwordx4 v[192:195], v113, s[18:19]
  global_load_dwordx4 v[196:199], v113, s[18:19] offset:1024
  s_add_u32 s18, s16, 98304
  s_addc_u32 s19, s17, 0
  global_load_dwordx4 v[200:203], v113, s[18:19]
  global_load_dwordx4 v[204:207], v113, s[18:19] offset:1024
  s_add_u32 s18, s16, 96256
  s_addc_u32 s19, s17, 0
  global_load_dwordx4 v[208:211], v113, s[18:19]
  global_load_dwordx4 v[212:215], v113, s[18:19] offset:1024
  s_add_u32 s18, s16, 86016
  s_addc_u32 s19, s17, 0
  global_load_dwordx4 v[216:219], v113, s[18:19]
  global_load_dwordx4 v[220:223], v113, s[18:19] offset:1024
  s_add_u32 s18, s16, 88064
  s_addc_u32 s19, s17, 0
  global_load_dwordx4 v[224:227], v113, s[18:19]
  global_load_dwordx4 v[228:231], v113, s[18:19] offset:1024
  s_add_u32 s18, s16, 90112
  s_addc_u32 s19, s17, 0
  global_load_dwordx4 v[232:235], v113, s[18:19]
  global_load_dwordx4 v[236:239], v113, s[18:19] offset:1024
  s_add_u32 s18, s16, 92160
  s_addc_u32 s19, s17, 0
  global_load_dwordx4 v[240:243], v113, s[18:19]
  global_load_dwordx4 v[244:247], v113, s[18:19] offset:1024
  s_add_u32 s18, s16, 94208
  s_addc_u32 s19, s17, 0
  global_load_dwordx4 v[248:251], v113, s[18:19]
  global_load_dwordx4 v[252:255], v113, s[18:19] offset:1024
L_wl_j_258:
  v_and_b32 v78, 15, v0
  v_bfe_u32 v79, v0, 4, 2
  s_mul_i32 s14, s8, 5120
  s_add_u32 s14, s14, 8192
  v_mul_u32_u24 v116, 40, v78
  v_lshl_add_u32 v116, v79, 3, v116
  v_add_u32 v116, s14, v116
  v_bfe_u32 v88, v0, 2, 1
  v_bfe_u32 v117, v0, 3, 1
  v_lshl_add_u32 v88, v117, 2, v88
  v_lshl_add_u32 v88, v79, 3, v88
  v_mul_u32_u24 v88, 40, v88
  v_and_b32 v117, 3, v0
  v_lshl_add_u32 v117, v117, 3, v88
  v_add_u32 v117, s14, v117
  s_mul_i32 s14, s8, 112
  v_lshl_add_u32 v88, v79, 3, s14
  v_lshrrev_b32 v118, 6, v88
  v_lshlrev_b32 v118, 10, v118
  v_bfe_u32 v119, v88, 4, 2
  v_lshl_add_u32 v118, v119, 8, v118
  v_bfe_u32 v119, v88, 3, 1
  v_lshl_add_u32 v118, v119, 3, v118
  v_and_b32 v119, 7, v0
  v_lshl_add_u32 v118, v119, 4, v118
  s_mul_i32 s14, s8, 1664
  s_add_u32 s14, s14, 28672
  v_mul_u32_u24 v119, 288, v79
  v_lshl_add_u32 v119, v78, 4, v119
  v_add_u32 v119, s14, v119
  v_lshlrev_b32 v1, 7, v79
  v_lshl_add_u32 v1, v78, 3, v1
  v_add_u32 v1, s14, v1
  v_add_u32 v1, 1152, v1
  v_and_b32 v88, 1, v79
  v_lshlrev_b32 v88, 2, v88
  v_sub_u32 v88, v78, v88
  v_and_b32 v60, 1, v88
  v_lshlrev_b32 v60, 4, v60
  v_mov_b32 v61, 0x3f80
  v_lshlrev_b32 v62, v60, v61
  v_cmp_gt_u32 vcc, 4, v88
  v_cmp_gt_u32 s[16:17], 8, v78
  s_nop 1
  s_and_b64 vcc, vcc, s[16:17]
  v_cndmask_b32 v62, 0, v62, vcc
  v_bfe_u32 v88, v88, 1, 1
  v_cmp_eq_u32 vcc, 0, v88
  s_nop 1
  v_cndmask_b32 v60, 0, v62, vcc
  v_cndmask_b32 v61, v62, 0, vcc
  v_lshrrev_b32 v62, 1, v113
  s_mul_i32 s14, s8, 112
  s_add_u32 s14, s14, 96
  v_lshl_add_u32 v88, v79, 2, s14
  v_lshrrev_b32 v63, 6, v88
  v_lshlrev_b32 v63, 10, v63
  v_bfe_u32 v89, v88, 4, 2
  v_lshl_add_u32 v63, v89, 8, v63
  v_bfe_u32 v89, v88, 2, 2
  v_lshl_add_u32 v63, v89, 2, v63
  v_and_b32 v89, 7, v0
  v_lshl_add_u32 v63, v89, 4, v63
  s_lshl_b32 s14, s8, 10
  s_add_u32 s66, s4, 44302336
  s_addc_u32 s67, s5, 0
  s_add_u32 s66, s66, s14
  s_addc_u32 s67, s67, 0
  s_and_b32 s14, s8, 1
  s_lshl_b32 s14, s14, 2
  v_add_u32 v78, s14, v79
  v_and_b32 v79, 15, v0
  v_lshrrev_b32 v88, 2, v79
  v_mul_u32_u24 v2, 288, v88
  v_lshl_add_u32 v2, v78, 4, v2
  v_and_b32 v88, 1, v79
  v_lshl_add_u32 v2, v88, 7, v2
  v_bfe_u32 v88, v79, 1, 1
  v_lshl_add_u32 v2, v88, 3, v2
  v_add_u32 v2, 28672, v2
  v_lshrrev_b32 v88, 1, v79
  v_lshlrev_b32 v3, 7, v88
  v_lshl_add_u32 v3, v78, 3, v3
  v_and_b32 v88, 1, v79
  v_lshl_add_u32 v3, v88, 6, v3
  v_add_u32 v3, 29824, v3
  v_mov_b32 v88, 36864
  v_cmp_gt_u32 vcc, 4, v79
  s_nop 1
  v_cndmask_b32 v3, v88, v3, vcc
  v_lshrrev_b32 v88, 3, v79
  v_lshlrev_b32 v77, 8, v88
  v_and_b32 v88, 1, v79
  v_lshl_add_u32 v77, v88, 7, v77
  v_lshl_add_u32 v77, v78, 4, v77
  v_bfe_u32 v88, v79, 1, 2
  v_lshl_add_u32 v77, v88, 2, v77
  v_lshlrev_b32 v76, 2, v79
  v_lshl_add_u32 v76, v78, 4, v76
  v_cmp_gt_u32 s[62:63], 4, v79
  v_lshlrev_b32 v78, 4, v0
  v_add_u32 v78, 7168, v78
  v_mov_b32 v80, 0
  v_mov_b32 v81, 0
  v_mov_b32 v82, 0
  v_mov_b32 v83, 0
  ds_write_b128 v78, v[80:83] offset:0
  ds_write_b128 v78, v[80:83] offset:4096
  ds_write_b128 v78, v[80:83] offset:8192
  ds_write_b128 v78, v[80:83] offset:12288
  ds_write_b128 v78, v[80:83] offset:16384
  ds_write_b128 v78, v[80:83] offset:20480
  v_mov_b32 v84, 0xf149f2ca
  v_mov_b32 v85, v84
  v_mov_b32 v78, 36864
  ds_write_b64 v78, v[84:85] offset:0
  ds_write_b64 v78, v[84:85] offset:1664
  ds_write_b64 v78, v[84:85] offset:3328
  ds_write_b64 v78, v[84:85] offset:4992
  s_mov_b32 s10, 0
  s_add_u32 s12, s4, 48234496
  s_addc_u32 s13, s5, 0
  s_lshl_b32 s14, s8, 13
  s_add_u32 s14, s14, 4096
  s_add_u32 s26, s4, 42205184
  s_addc_u32 s27, s5, 0
  s_add_u32 s26, s26, s14
  s_addc_u32 s27, s27, 0
  s_lshr_b32 s14, s9, 1
  s_lshl_b32 s14, s14, 10
  s_and_b32 s15, s9, 1
  s_lshl_b32 s15, s15, 9
  s_add_u32 s14, s14, s15
  s_add_u32 s22, s4, 49152000
  s_addc_u32 s23, s5, 0
  s_add_u32 s22, s22, s14
  s_addc_u32 s23, s23, 0
  s_lshl_b32 s14, s9, 7
  s_add_u32 s24, s4, 49676288
  s_addc_u32 s25, s5, 0
  s_add_u32 s24, s24, s14
  s_addc_u32 s25, s25, 0
  v_mov_b64 v[80:81], 0
  v_mov_b64 v[82:83], 0
  v_mov_b64 v[84:85], 0
  v_mov_b64 v[86:87], 0
  v_mov_b64 v[88:89], 0
  v_mov_b64 v[90:91], 0
  s_waitcnt vmcnt(0) lgkmcnt(0)
  s_barrier
L_A_loop_263:
  s_mov_b32 s11, 0
L_A_poll_264:
  global_load_dwordx4 v[4:7], v114, s[12:13] sc1
  global_load_dwordx4 v[8:11], v115, s[12:13] sc1
  s_waitcnt vmcnt(0)
  v_max3_u32 v100, v4, v5, v6
  v_max3_u32 v100, v100, v7, v8
  v_max3_u32 v100, v100, v9, v10
  v_max_u32 v100, v100, v11
  v_cmp_eq_u32 vcc, -1, v100
  s_cbranch_vccz L_A_got_265
  s_add_u32 s11, s11, 1
  s_cmp_gt_u32 s11, 262144
  s_cbranch_scc1 L_abort
  s_branch L_A_poll_264
L_A_got_265:
  ds_write_b128 v114, v[4:7]
  ds_write_b128 v115, v[8:11]
  v_smfmac_f32_16x16x64_bf16 v[80:83], v[4:7], a[0:7], v112
  v_smfmac_f32_16x16x64_bf16 v[80:83], v[8:11], a[8:15], v112
  v_smfmac_f32_16x16x64_bf16 v[84:87], v[4:7], a[56:63], v112
  v_smfmac_f32_16x16x64_bf16 v[84:87], v[8:11], a[64:71], v112
  v_smfmac_f32_16x16x64_bf16 v[88:91], v[4:7], a[112:119], v112
  v_smfmac_f32_16x16x64_bf16 v[88:91], v[8:11], a[120:127], v112
  s_waitcnt lgkmcnt(0)
  s_barrier
  s_cmp_lg_u32 s8, 0
  s_cbranch_scc1 L_mar_n_267
  ds_read_b128 v[12:15], v113 offset:2048
  ds_read_b128 v[16:19], v113 offset:3072
  ds_read_b128 v[20:23], v113 offset:4096
  ds_read_b128 v[24:27], v113 offset:5120
  ds_read_b128 v[28:31], v113 offset:6144
  s_branch L_mar_j_266
L_mar_n_267:
  s_cmp_lg_u32 s8, 1
  s_cbranch_scc1 L_mar_n_268
  ds_read_b128 v[12:15], v113 offset:0
  ds_read_b128 v[16:19], v113 offset:1024
  ds_read_b128 v[20:23], v113 offset:4096
  ds_read_b128 v[24:27], v113 offset:5120
  ds_read_b128 v[28:31], v113 offset:6144
  s_branch L_mar_j_266
L_mar_n_268:
  s_cmp_lg_u32 s8, 2
  s_cbranch_scc1 L_mar_n_269
  ds_read_b128 v[12:15], v113 offset:0
  ds_read_b128 v[16:19], v113 offset:1024
  ds_read_b128 v[20:23], v113 offset:2048
  ds_read_b128 v[24:27], v113 offset:3072
  ds_read_b128 v[28:31], v113 offset:6144
  s_branch L_mar_j_266
L_mar_n_269:
  ds_read_b128 v[12:15], v113 offset:0
  ds_read_b128 v[16:19], v113 offset:1024
  ds_read_b128 v[20:23], v113 offset:2048
  ds_read_b128 v[24:27], v113 offset:3072
  ds_read_b128 v[28:31], v113 offset:4096
L_mar_j_266:
  s_waitcnt lgkmcnt(4)
  v_smfmac_f32_16x16x64_bf16 v[80:83], v[12:15], a[16:23], v112
  s_waitcnt lgkmcnt(3)
  v_smfmac_f32_16x16x64_bf16 v[80:83], v[16:19], a[24:31], v112
  global_load_dwordx4 v[32:35], v113, s[26:27] offset:-4096
  s_waitcnt lgkmcnt(2)
  v_smfmac_f32_16x16x64_bf16 v[80:83], v[20:23], a[32:39], v112
  s_waitcnt lgkmcnt(1)
  v_smfmac_f32_16x16x64_bf16 v[80:83], v[24:27], a[40:47], v112
  s_waitcnt lgkmcnt(0)
  v_smfmac_f32_16x16x64_bf16 v[80:83], v[28:31], a[48:55], v112
  v_smfmac_f32_16x16x64_bf16 v[84:87], v[12:15], a[72:79], v112
  global_load_dwordx4 v[36:39], v113, s[26:27] offset:-3072
  v_smfmac_f32_16x16x64_bf16 v[84:87], v[16:19], a[80:87], v112
  v_cvt_pk_bf16_f32 v72, v80, v81
  v_smfmac_f32_16x16x64_bf16 v[84:87], v[20:23], a[88:95], v112
  v_cvt_pk_bf16_f32 v73, v82, v83
  v_smfmac_f32_16x16x64_bf16 v[84:87], v[24:27], a[96:103], v112
  ds_write_b64 v116, v[72:73] offset:0
  v_smfmac_f32_16x16x64_bf16 v[84:87], v[28:31], a[104:111], v112
  v_mov_b64 v[80:81], 0
  global_load_dwordx4 v[40:43], v113, s[26:27] offset:-2048
  v_smfmac_f32_16x16x64_bf16 v[88:91], v[12:15], a[128:135], v112
  v_mov_b64 v[82:83], 0
  v_smfmac_f32_16x16x64_bf16 v[88:91], v[16:19], a[136:143], v112
  v_cvt_pk_bf16_f32 v74, v84, v85
  v_smfmac_f32_16x16x64_bf16 v[88:91], v[20:23], a[144:151], v112
  v_cvt_pk_bf16_f32 v75, v86, v87
  v_smfmac_f32_16x16x64_bf16 v[88:91], v[24:27], a[152:159], v112
  ds_write_b64 v116, v[74:75] offset:640
  global_load_dwordx4 v[44:47], v113, s[26:27] offset:-1024
  v_smfmac_f32_16x16x64_bf16 v[88:91], v[28:31], a[160:167], v112
  v_mov_b64 v[84:85], 0
  v_smfmac_f32_16x16x64_bf16 v[80:83], v[4:7], a[168:175], v112
  v_mov_b64 v[86:87], 0
  v_smfmac_f32_16x16x64_bf16 v[80:83], v[8:11], a[176:183], v112
  v_cvt_pk_bf16_f32 v72, v88, v89
  ds_read_b64_tr_b16 v[92:93], v117 offset:0
  ds_read_b64_tr_b16 v[94:95], v117 offset:80
  v_smfmac_f32_16x16x64_bf16 v[80:83], v[12:15], a[184:191], v112
  v_cvt_pk_bf16_f32 v73, v90, v91
  ds_read_b64 v[64:65], v118 offset:0
  ds_read_b64 v[66:67], v118 offset:128
  global_load_dwordx4 v[48:51], v113, s[26:27] offset:0
  v_smfmac_f32_16x16x64_bf16 v[80:83], v[16:19], a[192:199], v112
  ds_write_b64 v116, v[72:73] offset:1280
  v_smfmac_f32_16x16x64_bf16 v[80:83], v[20:23], a[200:207], v112
  v_mov_b64 v[88:89], 0
  v_smfmac_f32_16x16x64_bf16 v[80:83], v[24:27], a[208:215], v112
  v_mov_b64 v[90:91], 0
  v_smfmac_f32_16x16x64_bf16 v[80:83], v[28:31], a[216:223], v112
  global_load_dwordx4 v[52:55], v113, s[26:27] offset:1024
  v_smfmac_f32_16x16x64_bf16 v[84:87], v[4:7], a[224:231], v112
  v_smfmac_f32_16x16x64_bf16 v[84:87], v[8:11], a[232:239], v112
  v_cvt_pk_bf16_f32 v74, v80, v81
  v_smfmac_f32_16x16x64_bf16 v[84:87], v[12:15], a[240:247], v112
  v_cvt_pk_bf16_f32 v75, v82, v83
  v_smfmac_f32_16x16x64_bf16 v[84:87], v[16:19], a[248:255], v112
  ds_write_b64 v116, v[74:75] offset:1920
  s_waitcnt lgkmcnt(2)
  v_mfma_f32_16x16x32_bf16 v[100:103], v[64:67], v[92:95], 0
  global_load_dwordx2 v[56:57], v62, s[66:67] offset:0
  v_smfmac_f32_16x16x64_bf16 v[84:87], v[20:23], v[120:127], v112
  v_mov_b64 v[80:81], 0
  s_waitcnt vmcnt(5)
  v_mfma_f32_16x16x32_bf16 v[104:107], v[32:35], v[92:95], 0
  v_smfmac_f32_16x16x64_bf16 v[84:87], v[24:27], v[128:135], v112
  v_mov_b64 v[82:83], 0
  v_mfma_f32_16x16x32_bf16 v[108:111], v[36:39], v[92:95], 0
  v_smfmac_f32_16x16x64_bf16 v[84:87], v[28:31], v[136:143], v112
  ds_read_b64_tr_b16 v[96:97], v117 offset:1280
  ds_read_b64_tr_b16 v[98:99], v117 offset:1360
  v_smfmac_f32_16x16x64_bf16 v[88:91], v[4:7], v[144:151], v112
  ds_read_b64 v[68:69], v118 offset:512
  ds_read_b64 v[70:71], v118 offset:640
  global_load_dwordx2 v[58:59], v62, s[66:67] offset:512
  v_smfmac_f32_16x16x64_bf16 v[88:91], v[8:11], v[152:159], v112
  v_cvt_pk_bf16_f32 v72, v84, v85
  v_smfmac_f32_16x16x64_bf16 v[88:91], v[12:15], v[160:167], v112
  v_cvt_pk_bf16_f32 v73, v86, v87
  v_smfmac_f32_16x16x64_bf16 v[88:91], v[16:19], v[168:175], v112
  ds_write_b64 v116, v[72:73] offset:2560
  v_smfmac_f32_16x16x64_bf16 v[88:91], v[20:23], v[176:183], v112
  v_smfmac_f32_16x16x64_bf16 v[88:91], v[24:27], v[184:191], v112
  v_smfmac_f32_16x16x64_bf16 v[88:91], v[28:31], v[192:199], v112
  v_smfmac_f32_16x16x64_bf16 v[80:83], v[4:7], v[200:207], v112
  ds_read_b64 v[64:65], v118 offset:1024
  ds_read_b64 v[66:67], v118 offset:1152
  v_smfmac_f32_16x16x64_bf16 v[80:83], v[8:11], v[208:215], v112
  v_cvt_pk_bf16_f32 v74, v88, v89
  s_waitcnt lgkmcnt(3)
  v_mfma_f32_16x16x32_bf16 v[100:103], v[68:71], v[96:99], v[100:103]
  v_smfmac_f32_16x16x64_bf16 v[80:83], v[12:15], v[216:223], v112
  v_cvt_pk_bf16_f32 v75, v90, v91
  s_waitcnt vmcnt(4)
  v_mfma_f32_16x16x32_bf16 v[104:107], v[40:43], v[96:99], v[104:107]
  v_smfmac_f32_16x16x64_bf16 v[80:83], v[16:19], v[224:231], v112
  ds_write_b64 v116, v[74:75] offset:3200
  v_mfma_f32_16x16x32_bf16 v[108:111], v[44:47], v[96:99], v[108:111]
  v_smfmac_f32_16x16x64_bf16 v[80:83], v[20:23], v[232:239], v112
  ds_read_b64_tr_b16 v[92:93], v117 offset:2560
  ds_read_b64_tr_b16 v[94:95], v117 offset:2640
  v_smfmac_f32_16x16x64_bf16 v[80:83], v[24:27], v[240:247], v112
  ds_read2_b32 v[68:69], v63 offset0:0 offset1:32
  v_smfmac_f32_16x16x64_bf16 v[80:83], v[28:31], v[248:255], v112
  s_waitcnt lgkmcnt(1)
  v_mfma_f32_16x16x32_bf16 v[100:103], v[64:67], v[92:95], v[100:103]
  s_waitcnt vmcnt(2)
  v_mfma_f32_16x16x32_bf16 v[104:107], v[48:51], v[92:95], v[104:107]
  v_cvt_pk_bf16_f32 v72, v80, v81
  v_cvt_pk_bf16_f32 v73, v82, v83
  s_nop 1
  v_mfma_f32_16x16x16_bf16 v[96:99], v[72:73], v[60:61], 0
  v_mfma_f32_16x16x32_bf16 v[108:111], v[52:55], v[92:95], v[108:111]
  s_waitcnt lgkmcnt(0)
  s_waitcnt vmcnt(0)
  s_nop 3
  v_cvt_pk_bf16_f32 v74, v96, v97
  v_cvt_pk_bf16_f32 v75, v98, v99
  s_nop 1
  v_mfma_f32_16x16x16_bf16 v[104:107], v[56:57], v[74:75], v[104:107]
  v_mfma_f32_16x16x16_bf16 v[108:111], v[58:59], v[74:75], v[108:111]
  v_mfma_f32_16x16x16_bf16 v[100:103], v[68:69], v[74:75], v[100:103]
  s_nop 1
  v_add_f32_dpp v84, v104, v104 row_ror:8 row_mask:0xf bank_mask:0x3
  v_add_f32_dpp v84, v106, v106 row_ror:8 row_mask:0xf bank_mask:0xc
  v_add_f32_dpp v85, v105, v105 row_ror:8 row_mask:0xf bank_mask:0x3
  v_add_f32_dpp v85, v107, v107 row_ror:8 row_mask:0xf bank_mask:0xc
  v_add_f32_dpp v86, v108, v108 row_ror:8 row_mask:0xf bank_mask:0x3
  v_add_f32_dpp v86, v110, v110 row_ror:8 row_mask:0xf bank_mask:0xc
  v_add_f32_dpp v87, v109, v109 row_ror:8 row_mask:0xf bank_mask:0x3
  v_add_f32_dpp v87, v111, v111 row_ror:8 row_mask:0xf bank_mask:0xc
  ds_write_b128 v119, v[84:87]
  v_add_f32_dpp v88, v100, v100 row_ror:8 row_mask:0xf bank_mask:0x3
  v_add_f32_dpp v88, v102, v102 row_ror:8 row_mask:0xf bank_mask:0xc
  v_add_f32_dpp v89, v101, v101 row_ror:8 row_mask:0xf bank_mask:0x3
  v_add_f32_dpp v89, v103, v103 row_ror:8 row_mask:0xf bank_mask:0xc
  ds_write_b64 v1, v[88:89]
  v_mov_b64 v[80:81], 0
  v_mov_b64 v[82:83], 0
  s_waitcnt lgkmcnt(0)
  s_barrier
  s_add_u32 s26, s26, 32768
  s_addc_u32 s27, s27, 0
  s_add_u32 s66, s66, 4096
  s_addc_u32 s67, s67, 0
  s_cmp_ge_u32 s8, 2
  s_cbranch_scc1 L_A_nosm_271
  ds_read_b64 v[84:85], v2 offset:0
  ds_read_b64 v[86:87], v3 offset:0
  ds_read_b64 v[88:89], v2 offset:1664
  ds_read_b64 v[90:91], v3 offset:1664
  ds_read_b64 v[92:93], v2 offset:3328
  ds_read_b64 v[94:95], v3 offset:3328
  ds_read_b64 v[96:97], v2 offset:4992
  ds_read_b64 v[98:99], v3 offset:4992
  s_waitcnt lgkmcnt(4)
  v_pk_add_f32 v[84:85], v[84:85], v[88:89]
  v_pk_add_f32 v[86:87], v[86:87], v[90:91]
  s_waitcnt lgkmcnt(0)
  v_pk_add_f32 v[92:93], v[92:93], v[96:97]
  v_pk_add_f32 v[94:95], v[94:95], v[98:99]
  v_pk_add_f32 v[84:85], v[84:85], v[92:93]
  v_pk_add_f32 v[86:87], v[86:87], v[94:95]
  v_max3_f32 v88, v84, v85, v86
  v_max_f32 v88, v88, v87
  s_nop 1
  v_max_f32_dpp v88, v88, v88 row_ror:8 row_mask:0xf bank_mask:0xf
  s_nop 1
  v_max_f32_dpp v88, v88, v88 row_ror:4 row_mask:0xf bank_mask:0xf
  s_nop 1
  v_max_f32_dpp v88, v88, v88 row_ror:2 row_mask:0xf bank_mask:0xf
  s_nop 1
  v_max_f32_dpp v88, v88, v88 row_ror:1 row_mask:0xf bank_mask:0xf
  v_pk_add_f32 v[84:85], v[84:85], v[88:89] op_sel_hi:[1,0] neg_lo:[0,1] neg_hi:[0,1]
  v_pk_add_f32 v[86:87], v[86:87], v[88:89] op_sel_hi:[1,0] neg_lo:[0,1] neg_hi:[0,1]
  v_exp_f32 v84, v84
  v_exp_f32 v85, v85
  v_exp_f32 v86, v86
  v_exp_f32 v87, v87
  v_add_f32 v91, v84, v85
  v_add_f32 v90, v86, v87
  v_add_f32 v90, v90, v91
  s_nop 1
  v_add_f32_dpp v90, v90, v90 row_ror:8 row_mask:0xf bank_mask:0xf
  s_nop 1
  v_add_f32_dpp v90, v90, v90 row_ror:4 row_mask:0xf bank_mask:0xf
  s_nop 1
  v_add_f32_dpp v90, v90, v90 row_ror:2 row_mask:0xf bank_mask:0xf
  s_nop 1
  v_add_f32_dpp v90, v90, v90 row_ror:1 row_mask:0xf bank_mask:0xf
  v_rcp_f32 v90, v90
  s_nop 0
  v_pk_mul_f32 v[84:85], v[84:85], v[90:91] op_sel_hi:[1,0]
  v_pk_mul_f32 v[86:87], v[86:87], v[90:91] op_sel_hi:[1,0]
  v_cvt_pk_bf16_f32 v84, v84, v85
  v_cvt_pk_bf16_f32 v86, v86, v87
  global_store_dword v77, v84, s[22:23] sc1
  s_mov_b64 exec, s[62:63]
  global_store_dword v76, v86, s[24:25] sc1
  s_mov_b64 exec, -1
L_A_nosm_271:
  s_cmp_ge_u32 s8, 2
  s_cbranch_scc1 L_ps_272
  s_sleep 15
  s_branch L_ps_273
L_ps_272:
  s_sleep 21
L_ps_273:
  v_mov_b64 v[84:85], 0
  v_mov_b64 v[86:87], 0
  v_mov_b64 v[88:89], 0
  v_mov_b64 v[90:91], 0
  s_add_u32 s12, s12, 7168
  s_addc_u32 s13, s13, 0
  s_add_u32 s22, s22, 8192
  s_addc_u32 s23, s23, 0
  s_add_u32 s24, s24, 2048
  s_addc_u32 s25, s25, 0
  s_add_u32 s10, s10, 1
  s_cmp_lt_u32 s10, 63
  s_cbranch_scc1 L_A_loop_263
  s_branch L_done
L_roleB_s:
  s_sub_u32 s43, s9, 16
  v_and_b32 v140, 63, v0
  v_lshlrev_b32 v133, 4, v140
  s_lshl_b32 s14, s8, 10
  v_add_u32 v134, s14, v133
  s_add_u32 s14, s8, 4
  s_min_u32 s14, s14, 6
  s_lshl_b32 s14, s14, 10
  v_add_u32 v135, s14, v133
  v_and_b32 v140, 8, v0
  v_cmp_eq_u32 vcc, 0, v140
  v_mov_b32 v132, 0xeeeeeeee
  v_mov_b32 v140, 0x44444444
  s_nop 1
  v_cndmask_b32 v132, v132, v140, vcc
  s_mul_i32 s14, s8, 1605632
  s_mul_i32 s15, s43, 28672
  s_add_u32 s14, s14, s15
  s_add_u32 s18, s4, 6422528
  s_addc_u32 s19, s5, 0
  s_add_u32 s18, s18, s14
  s_addc_u32 s19, s19, 0
  s_add_u32 s16, s18, 1204224
  s_addc_u32 s17, s19, 0
  s_mul_i32 s14, s8, 28672
  s_add_u32 s14, s14, 16384
  v_add_u32 v143, s14, v133
  s_add_u32 s15, s14, 0
  s_mov_b32 m0, s15
  s_nop 0
  global_load_lds_dwordx4 v133, s[16:17] offset:0
  global_load_lds_dwordx4 v133, s[16:17] offset:1024
  global_load_lds_dwordx4 v133, s[16:17] offset:2048
  global_load_lds_dwordx4 v133, s[16:17] offset:3072
  s_add_u32 s16, s16, 4096
  s_addc_u32 s17, s17, 0
  s_add_u32 s15, s14, 4096
  s_mov_b32 m0, s15
  s_nop 0
  global_load_lds_dwordx4 v133, s[16:17] offset:0
  global_load_lds_dwordx4 v133, s[16:17] offset:1024
  global_load_lds_dwordx4 v133, s[16:17] offset:2048
  global_load_lds_dwordx4 v133, s[16:17] offset:3072
  s_add_u32 s16, s16, 4096
  s_addc_u32 s17, s17, 0
  s_add_u32 s15, s14, 8192
  s_mov_b32 m0, s15
  s_nop 0
  global_load_lds_dwordx4 v133, s[16:17] offset:0
  global_load_lds_dwordx4 v133, s[16:17] offset:1024
  global_load_lds_dwordx4 v133, s[16:17] offset:2048
  global_load_lds_dwordx4 v133, s[16:17] offset:3072
  s_add_u32 s16, s16, 4096
  s_addc_u32 s17, s17, 0
  s_add_u32 s15, s14, 12288
  s_mov_b32 m0, s15
  s_nop 0
  global_load_lds_dwordx4 v133, s[16:17] offset:0
  global_load_lds_dwordx4 v133, s[16:17] offset:1024
  global_load_lds_dwordx4 v133, s[16:17] offset:2048
  global_load_lds_dwordx4 v133, s[16:17] offset:3072
  s_add_u32 s16, s16, 4096
  s_addc_u32 s17, s17, 0
  s_add_u32 s15, s14, 16384
  s_mov_b32 m0, s15
  s_nop 0
  global_load_lds_dwordx4 v133, s[16:17] offset:0
  global_load_lds_dwordx4 v133, s[16:17] offset:1024
  global_load_lds_dwordx4 v133, s[16:17] offset:2048
  global_load_lds_dwordx4 v133, s[16:17] offset:3072
  s_add_u32 s16, s16, 4096
  s_addc_u32 s17, s17, 0
  s_add_u32 s15, s14, 20480
  s_mov_b32 m0, s15
  s_nop 0
  global_load_lds_dwordx4 v133, s[16:17] offset:0
  global_load_lds_dwordx4 v133, s[16:17] offset:1024
  global_load_lds_dwordx4 v133, s[16:17] offset:2048
  global_load_lds_dwordx4 v133, s[16:17] offset:3072
  s_add_u32 s16, s16, 4096
  s_addc_u32 s17, s17, 0
  s_add_u32 s15, s14, 24576
  s_mov_b32 m0, s15
  s_nop 0
  global_load_lds_dwordx4 v133, s[16:17] offset:0
  global_load_lds_dwordx4 v133, s[16:17] offset:1024
  global_load_lds_dwordx4 v133, s[16:17] offset:2048
  global_load_lds_dwordx4 v133, s[16:17] offset:3072
  s_add_u32 s16, s16, 4096
  s_addc_u32 s17, s17, 0
  s_add_u32 s16, s18, 0
  s_addc_u32 s17, s19, 0
  global_load_dwordx4 a[0:3], v133, s[16:17] offset:0
  global_load_dwordx4 a[4:7], v133, s[16:17] offset:1024
  global_load_dwordx4 a[8:11], v133, s[16:17] offset:2048
  global_load_dwordx4 a[12:15], v133, s[16:17] offset:3072
  s_add_u32 s16, s16, 4096
  s_addc_u32 s17, s17, 0
  global_load_dwordx4 a[16:19], v133, s[16:17] offset:0
  global_load_dwordx4 a[20:23], v133, s[16:17] offset:1024
  global_load_dwordx4 a[24:27], v133, s[16:17] offset:2048
  global_load_dwordx4 a[28:31], v133, s[16:17] offset:3072
  s_add_u32 s16, s16, 4096
  s_addc_u32 s17, s17, 0
  global_load_dwordx4 a[32:35], v133, s[16:17] offset:0
  global_load_dwordx4 a[36:39], v133, s[16:17] offset:1024
  global_load_dwordx4 a[40:43], v133, s[16:17] offset:2048
  global_load_dwordx4 a[44:47], v133, s[16:17] offset:3072
  s_add_u32 s16, s16, 4096
  s_addc_u32 s17, s17, 0
  global_load_dwordx4 a[48:51], v133, s[16:17] offset:0
  global_load_dwordx4 a[52:55], v133, s[16:17] offset:1024
  global_load_dwordx4 a[56:59], v133, s[16:17] offset:2048
  global_load_dwordx4 a[60:63], v133, s[16:17] offset:3072
  s_add_u32 s16, s16, 4096
  s_addc_u32 s17, s17, 0
  global_load_dwordx4 a[64:67], v133, s[16:17] offset:0
  global_load_dwordx4 a[68:71], v133, s[16:17] offset:1024
  global_load_dwordx4 a[72:75], v133, s[16:17] offset:2048
  global_load_dwordx4 a[76:79], v133, s[16:17] offset:3072
  s_add_u32 s16, s16, 4096
  s_addc_u32 s17, s17, 0
  global_load_dwordx4 a[80:83], v133, s[16:17] offset:0
  global_load_dwordx4 a[84:87], v133, s[16:17] offset:1024
  global_load_dwordx4 a[88:91], v133, s[16:17] offset:2048
  global_load_dwordx4 a[92:95], v133, s[16:17] offset:3072
  s_add_u32 s16, s16, 4096
  s_addc_u32 s17, s17, 0
  global_load_dwordx4 a[96:99], v133, s[16:17] offset:0
  global_load_dwordx4 a[100:103], v133, s[16:17] offset:1024
  global_load_dwordx4 a[104:107], v133, s[16:17] offset:2048
  global_load_dwordx4 a[108:111], v133, s[16:17] offset:3072
  s_add_u32 s16, s16, 4096
  s_addc_u32 s17, s17, 0
  s_add_u32 s16, s18, 401408
  s_addc_u32 s17, s19, 0
  global_load_dwordx4 a[112:115], v133, s[16:17] offset:0
  global_load_dwordx4 a[116:119], v133, s[16:17] offset:1024
  global_load_dwordx4 a[120:123], v133, s[16:17] offset:2048
  global_load_dwordx4 a[124:127], v133, s[16:17] offset:3072
  s_add_u32 s16, s16, 4096
  s_addc_u32 s17, s17, 0
  global_load_dwordx4 a[128:131], v133, s[16:17] offset:0
  global_load_dwordx4 a[132:135], v133, s[16:17] offset:1024
  global_load_dwordx4 a[136:139], v133, s[16:17] offset:2048
  global_load_dwordx4 a[140:143], v133, s[16:17] offset:3072
  s_add_u32 s16, s16, 4096
  s_addc_u32 s17, s17, 0
  global_load_dwordx4 a[144:147], v133, s[16:17] offset:0
  global_load_dwordx4 a[148:151], v133, s[16:17] offset:1024
  global_load_dwordx4 a[152:155], v133, s[16:17] offset:2048
  global_load_dwordx4 a[156:159], v133, s[16:17] offset:3072
  s_add_u32 s16, s16, 4096
  s_addc_u32 s17, s17, 0
  global_load_dwordx4 a[160:163], v133, s[16:17] offset:0
  global_load_dwordx4 a[164:167], v133, s[16:17] offset:1024
  global_load_dwordx4 a[168:171], v133, s[16:17] offset:2048
  global_load_dwordx4 a[172:175], v133, s[16:17] offset:3072
  s_add_u32 s16, s16, 4096
  s_addc_u32 s17, s17, 0
  global_load_dwordx4 a[176:179], v133, s[16:17] offset:0
  global_load_dwordx4 a[180:183], v133, s[16:17] offset:1024
  global_load_dwordx4 a[184:187], v133, s[16:17] offset:2048
  global_load_dwordx4 a[188:191], v133, s[16:17] offset:3072
  s_add_u32 s16, s16, 4096
  s_addc_u32 s17, s17, 0
  global_load_dwordx4 a[192:195], v133, s[16:17] offset:0
  global_load_dwordx4 a[196:199], v133, s[16:17] offset:1024
  global_load_dwordx4 a[200:203], v133, s[16:17] offset:2048
  global_load_dwordx4 a[204:207], v133, s[16:17] offset:3072
  s_add_u32 s16, s16, 4096
  s_addc_u32 s17, s17, 0
  global_load_dwordx4 a[208:211], v133, s[16:17] offset:0
  global_load_dwordx4 a[212:215], v133, s[16:17] offset:1024
  global_load_dwordx4 a[216:219], v133, s[16:17] offset:2048
  global_load_dwordx4 a[220:223], v133, s[16:17] offset:3072
  s_add_u32 s16, s16, 4096
  s_addc_u32 s17, s17, 0
  s_add_u32 s16, s18, 802816
  s_addc_u32 s17, s19, 0
  global_load_dwordx4 a[224:227], v133, s[16:17] offset:0
  global_load_dwordx4 a[228:231], v133, s[16:17] offset:1024
  global_load_dwordx4 a[232:235], v133, s[16:17] offset:2048
  global_load_dwordx4 a[236:239], v133, s[16:17] offset:3072
  s_add_u32 s16, s16, 4096
  s_addc_u32 s17, s17, 0
  global_load_dwordx4 a[240:243], v133, s[16:17] offset:0
  global_load_dwordx4 a[244:247], v133, s[16:17] offset:1024
  global_load_dwordx4 a[248:251], v133, s[16:17] offset:2048
  global_load_dwordx4 a[252:255], v133, s[16:17] offset:3072
  s_add_u32 s16, s16, 4096
  s_addc_u32 s17, s17, 0
  global_load_dwordx4 v[176:179], v133, s[16:17] offset:0
  global_load_dwordx4 v[180:183], v133, s[16:17] offset:1024
  global_load_dwordx4 v[184:187], v133, s[16:17] offset:2048
  global_load_dwordx4 v[188:191], v133, s[16:17] offset:3072
  s_add_u32 s16, s16, 4096
  s_addc_u32 s17, s17, 0
  global_load_dwordx4 v[192:195], v133, s[16:17] offset:0
  global_load_dwordx4 v[196:199], v133, s[16:17] offset:1024
  global_load_dwordx4 v[200:203], v133, s[16:17] offset:2048
  global_load_dwordx4 v[204:207], v133, s[16:17] offset:3072
  s_add_u32 s16, s16, 4096
  s_addc_u32 s17, s17, 0
  global_load_dwordx4 v[208:211], v133, s[16:17] offset:0
  global_load_dwordx4 v[212:215], v133, s[16:17] offset:1024
  global_load_dwordx4 v[216:219], v133, s[16:17] offset:2048
  global_load_dwordx4 v[220:223], v133, s[16:17] offset:3072
  s_add_u32 s16, s16, 4096
  s_addc_u32 s17, s17, 0
  global_load_dwordx4 v[224:227], v133, s[16:17] offset:0
  global_load_dwordx4 v[228:231], v133, s[16:17] offset:1024
  global_load_dwordx4 v[232:235], v133, s[16:17] offset:2048
  global_load_dwordx4 v[236:239], v133, s[16:17] offset:3072
  s_add_u32 s16, s16, 4096
  s_addc_u32 s17, s17, 0
  global_load_dwordx4 v[240:243], v133, s[16:17] offset:0
  global_load_dwordx4 v[244:247], v133, s[16:17] offset:1024
  global_load_dwordx4 v[248:251], v133, s[16:17] offset:2048
  global_load_dwordx4 v[252:255], v133, s[16:17] offset:3072
  s_add_u32 s16, s16, 4096
  s_addc_u32 s17, s17, 0
  v_and_b32 v140, 15, v0
  v_bfe_u32 v141, v0, 4, 2
  v_bfe_u32 v142, v0, 5, 1
  v_lshlrev_b32 v136, 8, v142
  v_bfe_u32 v142, v0, 3, 1
  v_lshl_add_u32 v136, v142, 7, v136
  v_and_b32 v142, 7, v0
  v_lshl_add_u32 v136, v142, 4, v136
  s_lshl_b32 s14, s8, 9
  v_add_u32 v136, s14, v136
  v_and_b32 v142, 1, v141
  v_mul_u32_u24 v137, 576, v142
  v_lshrrev_b32 v142, 1, v141
  v_mul_u32_u24 v142, 144, v142
  v_add_u32 v137, v137, v142
  s_mul_i32 s14, s8, 1152
  v_add_u32 v137, s14, v137
  v_bfe_u32 v142, v0, 1, 1
  v_lshl_add_u32 v137, v142, 5, v137
  v_bfe_u32 v142, v0, 3, 1
  v_lshl_add_u32 v137, v142, 4, v137
  v_bfe_u32 v142, v0, 2, 1
  v_lshl_add_u32 v137, v142, 3, v137
  v_and_b32 v142, 1, v0
  v_lshl_add_u32 v137, v142, 2, v137
  v_add_u32 v137, 8192, v137
  v_and_b32 v140, 31, v0
  s_lshl_b32 s14, s8, 5
  v_add_u32 v140, s14, v140
  v_lshlrev_b32 v139, 2, v140
  v_bfe_u32 v142, v140, 2, 3
  v_mul_u32_u24 v138, 144, v142
  v_bfe_u32 v142, v140, 5, 2
  v_lshl_add_u32 v138, v142, 5, v138
  v_and_b32 v142, 3, v140
  v_lshl_add_u32 v138, v142, 3, v138
  v_add_u32 v138, 8192, v138
  s_mov_b32 s10, 0
  s_add_u32 s12, s4, 48234496
  s_addc_u32 s13, s5, 0
  s_lshr_b32 s14, s43, 1
  s_lshl_b32 s14, s14, 10
  s_and_b32 s15, s43, 1
  s_lshl_b32 s15, s15, 9
  s_add_u32 s14, s14, s15
  s_add_u32 s28, s4, 48241664
  s_addc_u32 s29, s5, 0
  s_add_u32 s28, s28, s14
  s_addc_u32 s29, s29, 0
  s_lshl_b32 s14, s8, 11
  s_add_u32 s22, s4, 49152000
  s_addc_u32 s23, s5, 0
  s_add_u32 s22, s22, s14
  s_addc_u32 s23, s23, 0
  s_add_u32 s24, s4, 49676288
  s_addc_u32 s25, s5, 0
  s_mul_i32 s14, s8, 114688
  s_lshl_b32 s15, s43, 11
  s_add_u32 s14, s14, s15
  s_add_u32 s30, s4, 12845056
  s_addc_u32 s31, s5, 0
  s_add_u32 s30, s30, s14
  s_addc_u32 s31, s31, 0
  s_add_u32 s32, s30, 28672
  s_addc_u32 s33, s31, 0
  s_add_u32 s34, s30, 57344
  s_addc_u32 s35, s31, 0
  s_add_u32 s36, s30, 86016
  s_addc_u32 s37, s31, 0
  s_waitcnt vmcnt(0) lgkmcnt(0)
  s_mov_b32 s11, 0
  v_mov_b32 v1, 1024
L_vxw_274:
  global_load_dword v2, v1, s[86:87] sc1
  s_waitcnt vmcnt(0)
  v_cmp_gt_u32 vcc, 84, v2
  s_cbranch_vccz L_vxg_275
  s_add_u32 s11, s11, 1
  s_cmp_gt_u32 s11, 262144
  s_cbranch_scc1 L_abort
  s_sleep 8
  s_branch L_vxw_274
L_vxg_275:
  s_barrier
L_B_loop_276:
  s_mov_b32 s11, 0
L_B_pa_277:
  global_load_dwordx4 v[36:39], v134, s[12:13] sc1
  global_load_dwordx4 v[40:43], v135, s[12:13] sc1
  s_waitcnt vmcnt(0)
  v_max3_u32 v44, v36, v37, v38
  v_max3_u32 v44, v44, v39, v40
  v_max3_u32 v44, v44, v41, v42
  v_max_u32 v44, v44, v43
  v_cmp_eq_u32 vcc, -1, v44
  s_cbranch_vccz L_B_ga_278
  s_add_u32 s11, s11, 1
  s_cmp_gt_u32 s11, 262144
  s_cbranch_scc1 L_abort
  s_branch L_B_pa_277
L_B_ga_278:
  ds_write_b128 v134, v[36:39]
  ds_write_b128 v135, v[40:43]
  s_waitcnt lgkmcnt(0)
  s_barrier
  ds_read_b128 v[4:7], v133 offset:0
  ds_read_b128 v[8:11], v133 offset:1024
  ds_read_b128 v[12:15], v133 offset:2048
  ds_read_b128 v[16:19], v133 offset:3072
  ds_read_b128 v[20:23], v133 offset:4096
  ds_read_b128 v[24:27], v133 offset:5120
  ds_read_b128 v[28:31], v133 offset:6144
  s_waitcnt vmcnt(0)
  s_cmp_lg_u32 s10, 3
  s_cbranch_scc1 L_n8_281
  v_cmp_gt_u32 vcc, 84, v164
  s_cbranch_vccz L_n8_281
  s_mov_b32 s11, 0
  v_mov_b32 v1, 1152
L_vxw_282:
  global_load_dword v2, v1, s[86:87] sc1
  s_waitcnt vmcnt(0)
  v_cmp_gt_u32 vcc, 84, v2
  s_cbranch_vccz L_vxg_283
  s_add_u32 s11, s11, 1
  s_cmp_gt_u32 s11, 262144
  s_cbranch_scc1 L_abort
  s_sleep 8
  s_branch L_vxw_282
L_vxg_283:
L_n8_281:
  s_cmp_lg_u32 s10, 15
  s_cbranch_scc1 L_n8_284
  v_cmp_gt_u32 vcc, 84, v164
  s_cbranch_vccz L_n8_284
  s_mov_b32 s11, 0
  v_mov_b32 v1, 1280
L_vxw_285:
  global_load_dword v2, v1, s[86:87] sc1
  s_waitcnt vmcnt(0)
  v_cmp_gt_u32 vcc, 84, v2
  s_cbranch_vccz L_vxg_286
  s_add_u32 s11, s11, 1
  s_cmp_gt_u32 s11, 262144
  s_cbranch_scc1 L_abort
  s_sleep 8
  s_branch L_vxw_285
L_vxg_286:
L_n8_284:
  s_cmp_lg_u32 s10, 2
  s_cbranch_scc1 L_n9_287
  v_mov_b32 v164, 1152
  global_load_dword v164, v164, s[86:87] sc1
L_n9_287:
  s_cmp_lg_u32 s10, 14
  s_cbranch_scc1 L_n9_288
  v_mov_b32 v164, 1280
  global_load_dword v164, v164, s[86:87] sc1
L_n9_288:
  v_mov_b64 v[32:33], 0
  v_mov_b64 v[34:35], 0
  v_mov_b64 v[156:157], 0
  v_mov_b64 v[158:159], 0
  v_mov_b64 v[160:161], 0
  v_mov_b64 v[162:163], 0
  ds_read_b128 v[116:119], v143 offset:0
  ds_read_b128 v[120:123], v143 offset:1024
  ds_read_b128 v[124:127], v143 offset:2048
  ds_read_b128 v[128:131], v143 offset:3072
  s_waitcnt lgkmcnt(10)
  v_smfmac_f32_16x16x64_bf16 v[32:35], v[4:7], a[0:7], v132
  s_waitcnt lgkmcnt(9)
  v_smfmac_f32_16x16x64_bf16 v[32:35], v[8:11], a[8:15], v132
  global_load_dwordx4 v[64:67], v133, s[30:31] offset:0
  s_waitcnt lgkmcnt(8)
  v_smfmac_f32_16x16x64_bf16 v[32:35], v[12:15], a[16:23], v132
  s_waitcnt lgkmcnt(2)
  v_smfmac_f32_16x16x64_bf16 v[156:159], v[4:7], v[116:123], v132
  ds_read_b128 v[116:119], v143 offset:4096
  ds_read_b128 v[120:123], v143 offset:5120
  v_mov_b64 v[36:37], 0
  v_smfmac_f32_16x16x64_bf16 v[32:35], v[16:19], a[24:31], v132
  v_mov_b64 v[38:39], 0
  v_smfmac_f32_16x16x64_bf16 v[32:35], v[20:23], a[32:39], v132
  global_load_dwordx4 v[68:71], v133, s[32:33] offset:0
  v_smfmac_f32_16x16x64_bf16 v[32:35], v[24:27], a[40:47], v132
  s_waitcnt lgkmcnt(2)
  v_smfmac_f32_16x16x64_bf16 v[156:159], v[8:11], v[124:131], v132
  ds_read_b128 v[124:127], v143 offset:6144
  ds_read_b128 v[128:131], v143 offset:7168
  v_smfmac_f32_16x16x64_bf16 v[32:35], v[28:31], a[48:55], v132
  v_smfmac_f32_16x16x64_bf16 v[36:39], v[4:7], a[56:63], v132
  global_load_dwordx4 v[72:75], v133, s[34:35] offset:0
  v_smfmac_f32_16x16x64_bf16 v[36:39], v[8:11], a[64:71], v132
  s_waitcnt lgkmcnt(2)
  v_smfmac_f32_16x16x64_bf16 v[156:159], v[12:15], v[116:123], v132
  ds_read_b128 v[116:119], v143 offset:8192
  ds_read_b128 v[120:123], v143 offset:9216
  v_cvt_pk_bf16_f32 v48, v32, v33
  v_smfmac_f32_16x16x64_bf16 v[36:39], v[12:15], a[72:79], v132
  v_cvt_pk_bf16_f32 v50, v34, v35
  v_smfmac_f32_16x16x64_bf16 v[36:39], v[16:19], a[80:87], v132
  global_load_dwordx4 v[76:79], v133, s[36:37] offset:0
  v_mov_b64 v[40:41], 0
  v_smfmac_f32_16x16x64_bf16 v[36:39], v[20:23], a[88:95], v132
  v_mov_b64 v[42:43], 0
  s_waitcnt lgkmcnt(2)
  v_smfmac_f32_16x16x64_bf16 v[156:159], v[16:19], v[124:131], v132
  ds_read_b128 v[124:127], v143 offset:10240
  ds_read_b128 v[128:131], v143 offset:11264
  v_smfmac_f32_16x16x64_bf16 v[36:39], v[24:27], a[96:103], v132
  v_smfmac_f32_16x16x64_bf16 v[36:39], v[28:31], a[104:111], v132
  global_load_dwordx4 v[80:83], v133, s[30:31] offset:1024
  v_smfmac_f32_16x16x64_bf16 v[40:43], v[4:7], a[112:119], v132
  s_waitcnt lgkmcnt(2)
  v_smfmac_f32_16x16x64_bf16 v[156:159], v[20:23], v[116:123], v132
  ds_read_b128 v[116:119], v143 offset:12288
  ds_read_b128 v[120:123], v143 offset:13312
  v_smfmac_f32_16x16x64_bf16 v[40:43], v[8:11], a[120:127], v132
  v_cvt_pk_bf16_f32 v56, v36, v37
  v_smfmac_f32_16x16x64_bf16 v[40:43], v[12:15], a[128:135], v132
  global_load_dwordx4 v[84:87], v133, s[32:33] offset:1024
  v_cvt_pk_bf16_f32 v58, v38, v39
  v_smfmac_f32_16x16x64_bf16 v[40:43], v[16:19], a[136:143], v132
  v_mov_b64 v[32:33], 0
  s_waitcnt lgkmcnt(2)
  v_smfmac_f32_16x16x64_bf16 v[156:159], v[24:27], v[124:131], v132
  ds_read_b128 v[124:127], v143 offset:14336
  ds_read_b128 v[128:131], v143 offset:15360
  v_mov_b64 v[34:35], 0
  v_smfmac_f32_16x16x64_bf16 v[40:43], v[20:23], a[144:151], v132
  v_smfmac_f32_16x16x64_bf16 v[40:43], v[24:27], a[152:159], v132
  global_load_dwordx4 v[88:91], v133, s[34:35] offset:1024
  v_smfmac_f32_16x16x64_bf16 v[40:43], v[28:31], a[160:167], v132
  s_waitcnt lgkmcnt(2)
  v_smfmac_f32_16x16x64_bf16 v[156:159], v[28:31], v[116:123], v132
  ds_read_b128 v[116:119], v143 offset:16384
  ds_read_b128 v[120:123], v143 offset:17408
  v_smfmac_f32_16x16x64_bf16 v[32:35], v[4:7], a[168:175], v132
  v_smfmac_f32_16x16x64_bf16 v[32:35], v[8:11], a[176:183], v132
  global_load_dwordx4 v[92:95], v133, s[36:37] offset:1024
  v_cvt_pk_bf16_f32 v49, v40, v41
  v_smfmac_f32_16x16x64_bf16 v[32:35], v[12:15], a[184:191], v132
  v_cvt_pk_bf16_f32 v51, v42, v43
  s_waitcnt lgkmcnt(2)
  v_smfmac_f32_16x16x64_bf16 v[160:163], v[4:7], v[124:131], v132
  ds_read_b128 v[124:127], v143 offset:18432
  ds_read_b128 v[128:131], v143 offset:19456
  v_cvt_pk_bf16_f32 v53, v156, v157
  v_smfmac_f32_16x16x64_bf16 v[32:35], v[16:19], a[192:199], v132
  v_cvt_pk_bf16_f32 v55, v158, v159
  v_smfmac_f32_16x16x64_bf16 v[32:35], v[20:23], a[200:207], v132
  v_mov_b64 v[36:37], 0
  v_smfmac_f32_16x16x64_bf16 v[32:35], v[24:27], a[208:215], v132
  v_mov_b64 v[38:39], 0
  s_waitcnt lgkmcnt(2)
  v_smfmac_f32_16x16x64_bf16 v[160:163], v[8:11], v[116:123], v132
  ds_read_b128 v[116:119], v143 offset:20480
  ds_read_b128 v[120:123], v143 offset:21504
  v_smfmac_f32_16x16x64_bf16 v[32:35], v[28:31], a[216:223], v132
  v_smfmac_f32_16x16x64_bf16 v[36:39], v[4:7], a[224:231], v132
  v_smfmac_f32_16x16x64_bf16 v[36:39], v[8:11], a[232:239], v132
  s_waitcnt lgkmcnt(2)
  v_smfmac_f32_16x16x64_bf16 v[160:163], v[12:15], v[124:131], v132
  ds_read_b128 v[124:127], v143 offset:22528
  ds_read_b128 v[128:131], v143 offset:23552
  v_cvt_pk_bf16_f32 v57, v32, v33
  v_smfmac_f32_16x16x64_bf16 v[36:39], v[12:15], a[240:247], v132
  v_cvt_pk_bf16_f32 v59, v34, v35
  v_smfmac_f32_16x16x64_bf16 v[36:39], v[16:19], a[248:255], v132
  v_mov_b64 v[40:41], 0
  v_smfmac_f32_16x16x64_bf16 v[36:39], v[20:23], v[176:183], v132
  v_mov_b64 v[42:43], 0
  s_waitcnt lgkmcnt(2)
  v_smfmac_f32_16x16x64_bf16 v[160:163], v[16:19], v[116:123], v132
  ds_read_b128 v[116:119], v143 offset:24576
  ds_read_b128 v[120:123], v143 offset:25600
  v_smfmac_f32_16x16x64_bf16 v[36:39], v[24:27], v[184:191], v132
  v_smfmac_f32_16x16x64_bf16 v[36:39], v[28:31], v[192:199], v132
  v_smfmac_f32_16x16x64_bf16 v[40:43], v[4:7], v[200:207], v132
  s_waitcnt lgkmcnt(2)
  v_smfmac_f32_16x16x64_bf16 v[160:163], v[20:23], v[124:131], v132
  ds_read_b128 v[124:127], v143 offset:26624
  ds_read_b128 v[128:131], v143 offset:27648
  v_smfmac_f32_16x16x64_bf16 v[40:43], v[8:11], v[208:215], v132
  v_cvt_pk_bf16_f32 v52, v36, v37
  v_smfmac_f32_16x16x64_bf16 v[40:43], v[12:15], v[216:223], v132
  v_cvt_pk_bf16_f32 v54, v38, v39
  v_smfmac_f32_16x16x64_bf16 v[40:43], v[16:19], v[224:231], v132
  s_waitcnt lgkmcnt(2)
  v_smfmac_f32_16x16x64_bf16 v[160:163], v[24:27], v[116:123], v132
  v_smfmac_f32_16x16x64_bf16 v[40:43], v[20:23], v[232:239], v132
  v_smfmac_f32_16x16x64_bf16 v[40:43], v[24:27], v[240:247], v132
  v_smfmac_f32_16x16x64_bf16 v[40:43], v[28:31], v[248:255], v132
  s_waitcnt lgkmcnt(0)
  v_smfmac_f32_16x16x64_bf16 v[160:163], v[28:31], v[124:131], v132
  s_nop 7
  v_cvt_pk_bf16_f32 v60, v40, v41
  v_cvt_pk_bf16_f32 v62, v42, v43
  v_cvt_pk_bf16_f32 v61, v160, v161
  v_cvt_pk_bf16_f32 v63, v162, v163
  s_add_u32 s30, s30, 458752
  s_addc_u32 s31, s31, 0
  s_add_u32 s32, s32, 458752
  s_addc_u32 s33, s33, 0
  s_add_u32 s34, s34, 458752
  s_addc_u32 s35, s35, 0
  s_add_u32 s36, s36, 458752
  s_addc_u32 s37, s37, 0
  v_mov_b32 v108, 0
  v_mov_b32 v109, 0
  v_mov_b32 v110, 0
  v_mov_b32 v111, 0
  v_mov_b32 v112, 0
  v_mov_b32 v113, 0
  v_mov_b32 v114, 0
  v_mov_b32 v115, 0
  s_mov_b32 s11, 0
  s_sleep 11
L_Bp_pa_289:
  global_load_dwordx4 v[96:99], v133, s[22:23] sc1
  global_load_dwordx4 v[100:103], v133, s[22:23] offset:1024 sc1
  global_load_dwordx4 v[104:107], v136, s[24:25] sc1
  s_waitcnt vmcnt(0)
  v_max3_u32 v140, v96, v97, v98
  v_max3_u32 v140, v140, v99, v100
  v_max3_u32 v140, v140, v101, v102
  v_max3_u32 v140, v140, v103, v104
  v_max3_u32 v140, v140, v105, v106
  v_max_u32 v140, v140, v107
  v_cmp_eq_u32 vcc, -1, v140
  s_cbranch_vccz L_Bp_ga_290
  s_add_u32 s11, s11, 1
  s_cmp_gt_u32 s11, 262144
  s_cbranch_scc1 L_abort
  s_branch L_Bp_pa_289
L_Bp_ga_290:
  v_smfmac_f32_16x16x64_bf16 v[108:111], v[104:107], v[48:55], v132
  v_smfmac_f32_16x16x64_bf16 v[108:111], v[96:99], v[64:71], v132
  v_smfmac_f32_16x16x64_bf16 v[108:111], v[100:103], v[72:79], v132
  v_smfmac_f32_16x16x64_bf16 v[112:115], v[104:107], v[56:63], v132
  v_smfmac_f32_16x16x64_bf16 v[112:115], v[96:99], v[80:87], v132
  v_smfmac_f32_16x16x64_bf16 v[112:115], v[100:103], v[88:95], v132
  v_permlane32_swap_b32 v108, v109
  v_permlane32_swap_b32 v110, v111
  v_add_f32 v108, v108, v109
  v_add_f32 v110, v110, v111
  ds_write_b32 v137, v108 offset:0
  ds_write_b32 v137, v110 offset:288
  s_nop 0
  v_permlane32_swap_b32 v112, v113
  v_permlane32_swap_b32 v114, v115
  v_add_f32 v112, v112, v113
  v_add_f32 v114, v114, v115
  ds_write_b32 v137, v112 offset:64
  ds_write_b32 v137, v114 offset:352
  s_waitcnt lgkmcnt(0)
  s_barrier
  ds_read_b64 v[32:33], v138 offset:0
  ds_read_b64 v[34:35], v138 offset:1152
  ds_read_b64 v[36:37], v138 offset:2304
  ds_read_b64 v[38:39], v138 offset:3456
  s_waitcnt lgkmcnt(2)
  v_pk_add_f32 v[32:33], v[32:33], v[34:35]
  s_waitcnt lgkmcnt(0)
  v_pk_add_f32 v[36:37], v[36:37], v[38:39]
  v_pk_add_f32 v[32:33], v[32:33], v[36:37]
  v_cvt_pk_bf16_f32 v32, v32, v33
  v_min_u32 v32, -2, v32
  global_store_dword v139, v32, s[28:29] sc1
  s_cmp_lg_u32 s10, 62
  s_cbranch_scc1 L_Blast_293
  s_add_u32 s14, s28, 458752
  s_addc_u32 s15, s29, 0
  global_store_dword v139, v32, s[14:15] sc1
L_Blast_293:
  s_add_u32 s12, s12, 7168
  s_addc_u32 s13, s13, 0
  s_add_u32 s28, s28, 7168
  s_addc_u32 s29, s29, 0
  s_add_u32 s22, s22, 8192
  s_addc_u32 s23, s23, 0
  s_add_u32 s24, s24, 2048
  s_addc_u32 s25, s25, 0
  s_add_u32 s10, s10, 1
  s_cmp_lt_u32 s10, 63
  s_cbranch_scc1 L_B_loop_276
  s_branch L_done
L_roleF_s:
  v_and_b32 v14, 63, v0
  v_lshlrev_b32 v10, 4, v14
  s_lshl_b32 s14, s8, 10
  v_add_u32 v11, s14, v10
  s_add_u32 s14, s8, 4
  s_min_u32 s14, s14, 6
  s_lshl_b32 s14, s14, 10
  v_add_u32 v12, s14, v10
  v_and_b32 v14, 8, v0
  v_cmp_eq_u32 vcc, 0, v14
  v_mov_b32 v13, 0xeeeeeeee
  v_mov_b32 v14, 0x44444444
  s_nop 1
  v_cndmask_b32 v13, v13, v14, vcc
  s_add_u32 s12, s4, 48234496
  s_addc_u32 s13, s5, 0
  s_add_u32 s60, s4, 48693248
  s_addc_u32 s61, s5, 0
  v_and_b32 v30, 63, v0
  v_lshlrev_b32 v30, 7, v30
  s_lshl_b32 s14, s8, 13
  s_add_u32 s26, s4, 42205184
  s_addc_u32 s27, s5, 0
  s_add_u32 s26, s26, s14
  s_addc_u32 s27, s27, 0
  v_mov_b32 v31, v30
  s_mov_b32 s18, 49676288
  s_mov_b32 s19, 2048
  s_mov_b32 s20, 1920
  s_cmp_eq_u32 s8, 1
  s_cselect_b32 s18, 49152000, s18
  s_cselect_b32 s19, 8192, s19
  s_cselect_b32 s20, 8064, s20
  s_cmp_eq_u32 s8, 3
  s_cselect_b32 s18, 44302336, s18
  s_cselect_b32 s19, 4096, s19
  s_cselect_b32 s20, 3968, s20
  s_cmp_eq_u32 s8, 0
  s_cselect_b32 s18, 48234496, s18
  s_cselect_b32 s19, 7168, s19
  s_cselect_b32 s20, 7040, s20
  v_min_u32 v31, s20, v30
  s_add_u32 s22, s4, s18
  s_addc_u32 s23, s5, 0
  s_mov_b32 s43, s19
  s_mov_b32 s11, 0
  v_mov_b32 v1, 1024
L_vxw_294:
  global_load_dword v2, v1, s[86:87] sc1
  s_waitcnt vmcnt(0)
  v_cmp_gt_u32 vcc, 84, v2
  s_cbranch_vccz L_vxg_295
  s_add_u32 s11, s11, 1
  s_cmp_gt_u32 s11, 262144
  s_cbranch_scc1 L_abort
  s_sleep 8
  s_branch L_vxw_294
L_vxg_295:
  global_load_dword v33, v30, s[26:27]
  s_add_u32 s26, s26, 32768
  s_addc_u32 s27, s27, 0
  s_add_u32 s22, s22, s43
  s_addc_u32 s23, s23, 0
  global_load_dword v33, v30, s[26:27]
  s_add_u32 s26, s26, 32768
  s_addc_u32 s27, s27, 0
  s_add_u32 s22, s22, s43
  s_addc_u32 s23, s23, 0
  global_load_dword v33, v30, s[26:27]
  s_add_u32 s26, s26, 32768
  s_addc_u32 s27, s27, 0
  s_add_u32 s22, s22, s43
  s_addc_u32 s23, s23, 0
  global_load_dword v33, v30, s[26:27]
  s_add_u32 s26, s26, 32768
  s_addc_u32 s27, s27, 0
  s_add_u32 s22, s22, s43
  s_addc_u32 s23, s23, 0
  s_mov_b32 s10, 0
L_F_loop_296:
  s_cmp_ge_u32 s10, 60
  s_cbranch_scc1 L_F_nt_297
  global_load_dword v33, v30, s[26:27]
  s_add_u32 s26, s26, 32768
  s_addc_u32 s27, s27, 0
  s_add_u32 s22, s22, s43
  s_addc_u32 s23, s23, 0
L_F_nt_297:
  s_mov_b32 s11, 0
L_F_poll_298:
  global_load_dwordx4 v[16:19], v11, s[12:13] sc1
  global_load_dwordx4 v[20:23], v12, s[12:13] sc1
  s_waitcnt vmcnt(0)
  v_max3_u32 v14, v16, v17, v18
  v_max3_u32 v14, v14, v19, v20
  v_max3_u32 v14, v14, v21, v22
  v_max_u32 v14, v14, v23
  v_cmp_eq_u32 vcc, -1, v14
  s_cbranch_vccz L_F_got_299
  s_add_u32 s11, s11, 1
  s_cmp_gt_u32 s11, 262144
  s_cbranch_scc1 L_abort
  s_sleep 4
  s_branch L_F_poll_298
L_F_got_299:
  global_store_dwordx4 v11, v[16:19], s[60:61] sc1
  global_store_dwordx4 v12, v[20:23], s[60:61] sc1
  s_waitcnt vmcnt(0)
  s_add_u32 s12, s12, 7168
  s_addc_u32 s13, s13, 0
  s_add_u32 s60, s60, 7168
  s_addc_u32 s61, s61, 0
  s_add_u32 s10, s10, 1
  s_cmp_lt_u32 s10, 64
  s_cbranch_scc1 L_F_loop_296
  s_branch L_done
L_cidle_s:
  s_branch L_done
L_abort:
  v_mov_b32 v1, 12
  v_mov_b32 v2, 1
  global_atomic_add v1, v2, s[6:7] sc1
  s_waitcnt vmcnt(0)
  s_branch L_fin
L_pdone:
L_done:
  s_mov_b64 exec, -1
  s_cmp_ge_u32 s9, 28
  s_cbranch_scc1 L_fin
  s_cmp_eq_u32 s38, 1
  s_cbranch_scc1 L_g2pre_300
  s_cmp_eq_u32 s68, 0
  s_cbranch_scc1 L_g2nq_301
  s_cmp_ge_u32 s68, 5
  s_cbranch_scc1 L_g2nq_301
  s_add_u32 s16, s4, 57932800
  s_addc_u32 s17, s5, 0
  s_lshl_b32 s14, s65, 8
  v_mov_b32 v1, s14
  s_mov_b32 s11, 0
L_g2q_302:
  global_load_dword v2, v1, s[16:17] offset:252 sc1
  s_waitcnt vmcnt(0)
  v_cmp_eq_u32 vcc, -1, v2
  s_cbranch_vccz L_g2qg_303
  s_add_u32 s11, s11, 1
  s_cmp_gt_u32 s11, 262144
  s_cbranch_scc1 L_fin
  s_sleep 4
  s_branch L_g2q_302
L_g2qg_303:
L_g2nq_301:
  s_mul_i32 s36, s9, 9363
  s_lshr_b32 s36, s36, 16
  s_mul_i32 s37, s36, 7
  s_sub_u32 s37, s9, s37
  s_lshl_b32 s14, s68, 2
  s_add_u32 s36, s36, s14
  s_load_dwordx2 s[22:23], s[0:1], 80
  s_load_dwordx2 s[24:25], s[0:1], 88
  s_load_dwordx2 s[26:27], s[0:1], 96
  s_waitcnt lgkmcnt(0)
  v_and_b32 v10, 63, v0
  v_lshrrev_b32 v11, 3, v10
  s_lshl_b32 s30, s8, 3
  v_add_u32 v11, s30, v11
  v_lshlrev_b32 v8, 12, v11
  v_and_b32 v10, 7, v0
  v_lshl_add_u32 v8, v10, 4, v8
  s_lshl_b32 s30, s36, 7
  s_add_u32 s32, s22, s30
  s_addc_u32 s33, s23, 0
  v_bfe_u32 v10, v0, 4, 2
  v_lshlrev_b32 v10, 3, v10
  v_bfe_u32 v11, v0, 2, 2
  v_add_u32 v10, v10, v11
  v_lshlrev_b32 v9, 7, v10
  v_and_b32 v10, 3, v0
  v_lshl_add_u32 v9, v10, 3, v9
  s_lshl_b32 s30, s8, 5
  v_add_u32 v9, s30, v9
  s_lshl_b32 s34, s8, 10
  s_barrier
  s_add_u32 s30, s34, 0
  s_mov_b32 m0, s30
  s_nop 0
  global_load_lds_dwordx4 v8, s[32:33]
  s_add_u32 s32, s32, 131072
  s_addc_u32 s33, s33, 0
  s_add_u32 s30, s34, 4096
  s_mov_b32 m0, s30
  s_nop 0
  global_load_lds_dwordx4 v8, s[32:33]
  s_add_u32 s32, s32, 131072
  s_addc_u32 s33, s33, 0
  s_add_u32 s30, s34, 8192
  s_mov_b32 m0, s30
  s_nop 0
  global_load_lds_dwordx4 v8, s[32:33]
  s_add_u32 s32, s32, 131072
  s_addc_u32 s33, s33, 0
  s_add_u32 s30, s34, 12288
  s_mov_b32 m0, s30
  s_nop 0
  global_load_lds_dwordx4 v8, s[32:33]
  s_add_u32 s32, s32, 131072
  s_addc_u32 s33, s33, 0
  s_add_u32 s30, s34, 16384
  s_mov_b32 m0, s30
  s_nop 0
  global_load_lds_dwordx4 v8, s[32:33]
  s_add_u32 s32, s32, 131072
  s_addc_u32 s33, s33, 0
  s_add_u32 s30, s34, 20480
  s_mov_b32 m0, s30
  s_nop 0
  global_load_lds_dwordx4 v8, s[32:33]
  s_add_u32 s32, s32, 131072
  s_addc_u32 s33, s33, 0
  s_add_u32 s30, s34, 24576
  s_mov_b32 m0, s30
  s_nop 0
  global_load_lds_dwordx4 v8, s[32:33]
  s_add_u32 s32, s32, 131072
  s_addc_u32 s33, s33, 0
  s_add_u32 s30, s34, 28672
  s_mov_b32 m0, s30
  s_nop 0
  global_load_lds_dwordx4 v8, s[32:33]
  s_add_u32 s32, s32, 131072
  s_addc_u32 s33, s33, 0
  s_add_u32 s30, s34, 32768
  s_mov_b32 m0, s30
  s_nop 0
  global_load_lds_dwordx4 v8, s[32:33]
  s_add_u32 s32, s32, 131072
  s_addc_u32 s33, s33, 0
  s_add_u32 s30, s34, 36864
  s_mov_b32 m0, s30
  s_nop 0
  global_load_lds_dwordx4 v8, s[32:33]
  s_add_u32 s32, s32, 131072
  s_addc_u32 s33, s33, 0
  s_add_u32 s30, s34, 40960
  s_mov_b32 m0, s30
  s_nop 0
  global_load_lds_dwordx4 v8, s[32:33]
  s_add_u32 s32, s32, 131072
  s_addc_u32 s33, s33, 0
  s_add_u32 s30, s34, 45056
  s_mov_b32 m0, s30
  s_nop 0
  global_load_lds_dwordx4 v8, s[32:33]
  s_add_u32 s32, s32, 131072
  s_addc_u32 s33, s33, 0
  s_add_u32 s30, s34, 49152
  s_mov_b32 m0, s30
  s_nop 0
  global_load_lds_dwordx4 v8, s[32:33]
  s_add_u32 s32, s32, 131072
  s_addc_u32 s33, s33, 0
  s_add_u32 s30, s34, 53248
  s_mov_b32 m0, s30
  s_nop 0
  global_load_lds_dwordx4 v8, s[32:33]
  s_add_u32 s32, s32, 131072
  s_addc_u32 s33, s33, 0
  s_add_u32 s30, s34, 57344
  s_mov_b32 m0, s30
  s_nop 0
  global_load_lds_dwordx4 v8, s[32:33]
  s_add_u32 s32, s32, 131072
  s_addc_u32 s33, s33, 0
  s_add_u32 s30, s34, 61440
  s_mov_b32 m0, s30
  s_nop 0
  global_load_lds_dwordx4 v8, s[32:33]
  s_add_u32 s32, s32, 131072
  s_addc_u32 s33, s33, 0
  s_add_u32 s30, s34, 65536
  s_mov_b32 m0, s30
  s_nop 0
  global_load_lds_dwordx4 v8, s[32:33]
  s_add_u32 s32, s32, 131072
  s_addc_u32 s33, s33, 0
  s_add_u32 s30, s34, 69632
  s_mov_b32 m0, s30
  s_nop 0
  global_load_lds_dwordx4 v8, s[32:33]
  s_add_u32 s32, s32, 131072
  s_addc_u32 s33, s33, 0
  s_add_u32 s30, s34, 73728
  s_mov_b32 m0, s30
  s_nop 0
  global_load_lds_dwordx4 v8, s[32:33]
  s_add_u32 s32, s32, 131072
  s_addc_u32 s33, s33, 0
  s_add_u32 s30, s34, 77824
  s_mov_b32 m0, s30
  s_nop 0
  global_load_lds_dwordx4 v8, s[32:33]
  s_add_u32 s32, s32, 131072
  s_addc_u32 s33, s33, 0
  s_add_u32 s30, s34, 81920
  s_mov_b32 m0, s30
  s_nop 0
  global_load_lds_dwordx4 v8, s[32:33]
  s_add_u32 s32, s32, 131072
  s_addc_u32 s33, s33, 0
  s_add_u32 s30, s34, 86016
  s_mov_b32 m0, s30
  s_nop 0
  global_load_lds_dwordx4 v8, s[32:33]
  s_add_u32 s32, s32, 131072
  s_addc_u32 s33, s33, 0
  s_add_u32 s30, s34, 90112
  s_mov_b32 m0, s30
  s_nop 0
  global_load_lds_dwordx4 v8, s[32:33]
  s_add_u32 s32, s32, 131072
  s_addc_u32 s33, s33, 0
  s_add_u32 s30, s34, 94208
  s_mov_b32 m0, s30
  s_nop 0
  global_load_lds_dwordx4 v8, s[32:33]
  s_add_u32 s32, s32, 131072
  s_addc_u32 s33, s33, 0
  s_add_u32 s30, s34, 98304
  s_mov_b32 m0, s30
  s_nop 0
  global_load_lds_dwordx4 v8, s[32:33]
  s_add_u32 s32, s32, 131072
  s_addc_u32 s33, s33, 0
  s_add_u32 s30, s34, 102400
  s_mov_b32 m0, s30
  s_nop 0
  global_load_lds_dwordx4 v8, s[32:33]
  s_add_u32 s32, s32, 131072
  s_addc_u32 s33, s33, 0
  s_add_u32 s30, s34, 106496
  s_mov_b32 m0, s30
  s_nop 0
  global_load_lds_dwordx4 v8, s[32:33]
  s_add_u32 s32, s32, 131072
  s_addc_u32 s33, s33, 0
  s_add_u32 s30, s34, 110592
  s_mov_b32 m0, s30
  s_nop 0
  global_load_lds_dwordx4 v8, s[32:33]
  s_add_u32 s32, s32, 131072
  s_addc_u32 s33, s33, 0
  v_add_u32 v10, 57344, v9
  s_waitcnt vmcnt(14)
  s_barrier
  ds_read_b64_tr_b16 a[0:1], v9 offset:0
  ds_read_b64_tr_b16 a[2:3], v9 offset:512
  ds_read_b64_tr_b16 a[4:5], v9 offset:4096
  ds_read_b64_tr_b16 a[6:7], v9 offset:4608
  ds_read_b64_tr_b16 a[8:9], v9 offset:8192
  ds_read_b64_tr_b16 a[10:11], v9 offset:8704
  ds_read_b64_tr_b16 a[12:13], v9 offset:12288
  ds_read_b64_tr_b16 a[14:15], v9 offset:12800
  ds_read_b64_tr_b16 a[16:17], v9 offset:16384
  ds_read_b64_tr_b16 a[18:19], v9 offset:16896
  ds_read_b64_tr_b16 a[20:21], v9 offset:20480
  ds_read_b64_tr_b16 a[22:23], v9 offset:20992
  ds_read_b64_tr_b16 a[24:25], v9 offset:24576
  ds_read_b64_tr_b16 a[26:27], v9 offset:25088
  s_waitcnt lgkmcnt(0)
  ds_read_b64_tr_b16 a[28:29], v9 offset:28672
  ds_read_b64_tr_b16 a[30:31], v9 offset:29184
  ds_read_b64_tr_b16 a[32:33], v9 offset:32768
  ds_read_b64_tr_b16 a[34:35], v9 offset:33280
  ds_read_b64_tr_b16 a[36:37], v9 offset:36864
  ds_read_b64_tr_b16 a[38:39], v9 offset:37376
  ds_read_b64_tr_b16 a[40:41], v9 offset:40960
  ds_read_b64_tr_b16 a[42:43], v9 offset:41472
  ds_read_b64_tr_b16 a[44:45], v9 offset:45056
  ds_read_b64_tr_b16 a[46:47], v9 offset:45568
  ds_read_b64_tr_b16 a[48:49], v9 offset:49152
  ds_read_b64_tr_b16 a[50:51], v9 offset:49664
  ds_read_b64_tr_b16 a[52:53], v9 offset:53248
  ds_read_b64_tr_b16 a[54:55], v9 offset:53760
  s_waitcnt lgkmcnt(0)
  s_barrier
  s_add_u32 s30, s34, 0
  s_mov_b32 m0, s30
  s_nop 0
  global_load_lds_dwordx4 v8, s[32:33]
  s_add_u32 s32, s32, 131072
  s_addc_u32 s33, s33, 0
  s_add_u32 s30, s34, 4096
  s_mov_b32 m0, s30
  s_nop 0
  global_load_lds_dwordx4 v8, s[32:33]
  s_add_u32 s32, s32, 131072
  s_addc_u32 s33, s33, 0
  s_add_u32 s30, s34, 8192
  s_mov_b32 m0, s30
  s_nop 0
  global_load_lds_dwordx4 v8, s[32:33]
  s_add_u32 s32, s32, 131072
  s_addc_u32 s33, s33, 0
  s_add_u32 s30, s34, 12288
  s_mov_b32 m0, s30
  s_nop 0
  global_load_lds_dwordx4 v8, s[32:33]
  s_add_u32 s32, s32, 131072
  s_addc_u32 s33, s33, 0
  s_add_u32 s30, s34, 16384
  s_mov_b32 m0, s30
  s_nop 0
  global_load_lds_dwordx4 v8, s[32:33]
  s_add_u32 s32, s32, 131072
  s_addc_u32 s33, s33, 0
  s_add_u32 s30, s34, 20480
  s_mov_b32 m0, s30
  s_nop 0
  global_load_lds_dwordx4 v8, s[32:33]
  s_add_u32 s32, s32, 131072
  s_addc_u32 s33, s33, 0
  s_add_u32 s30, s34, 24576
  s_mov_b32 m0, s30
  s_nop 0
  global_load_lds_dwordx4 v8, s[32:33]
  s_add_u32 s32, s32, 131072
  s_addc_u32 s33, s33, 0
  s_add_u32 s30, s34, 28672
  s_mov_b32 m0, s30
  s_nop 0
  global_load_lds_dwordx4 v8, s[32:33]
  s_add_u32 s32, s32, 131072
  s_addc_u32 s33, s33, 0
  s_add_u32 s30, s34, 32768
  s_mov_b32 m0, s30
  s_nop 0
  global_load_lds_dwordx4 v8, s[32:33]
  s_add_u32 s32, s32, 131072
  s_addc_u32 s33, s33, 0
  s_add_u32 s30, s34, 36864
  s_mov_b32 m0, s30
  s_nop 0
  global_load_lds_dwordx4 v8, s[32:33]
  s_add_u32 s32, s32, 131072
  s_addc_u32 s33, s33, 0
  s_add_u32 s30, s34, 40960
  s_mov_b32 m0, s30
  s_nop 0
  global_load_lds_dwordx4 v8, s[32:33]
  s_add_u32 s32, s32, 131072
  s_addc_u32 s33, s33, 0
  s_add_u32 s30, s34, 45056
  s_mov_b32 m0, s30
  s_nop 0
  global_load_lds_dwordx4 v8, s[32:33]
  s_add_u32 s32, s32, 131072
  s_addc_u32 s33, s33, 0
  s_add_u32 s30, s34, 49152
  s_mov_b32 m0, s30
  s_nop 0
  global_load_lds_dwordx4 v8, s[32:33]
  s_add_u32 s32, s32, 131072
  s_addc_u32 s33, s33, 0
  s_add_u32 s30, s34, 53248
  s_mov_b32 m0, s30
  s_nop 0
  global_load_lds_dwordx4 v8, s[32:33]
  s_add_u32 s32, s32, 131072
  s_addc_u32 s33, s33, 0
  s_waitcnt vmcnt(14)
  s_barrier
  ds_read_b64_tr_b16 a[56:57], v10 offset:0
  ds_read_b64_tr_b16 a[58:59], v10 offset:512
  ds_read_b64_tr_b16 a[60:61], v10 offset:4096
  ds_read_b64_tr_b16 a[62:63], v10 offset:4608
  ds_read_b64_tr_b16 a[64:65], v10 offset:8192
  ds_read_b64_tr_b16 a[66:67], v10 offset:8704
  ds_read_b64_tr_b16 a[68:69], v10 offset:12288
  ds_read_b64_tr_b16 a[70:71], v10 offset:12800
  ds_read_b64_tr_b16 a[72:73], v10 offset:16384
  ds_read_b64_tr_b16 a[74:75], v10 offset:16896
  ds_read_b64_tr_b16 a[76:77], v10 offset:20480
  ds_read_b64_tr_b16 a[78:79], v10 offset:20992
  ds_read_b64_tr_b16 a[80:81], v10 offset:24576
  ds_read_b64_tr_b16 a[82:83], v10 offset:25088
  s_waitcnt lgkmcnt(0)
  ds_read_b64_tr_b16 a[84:85], v10 offset:28672
  ds_read_b64_tr_b16 a[86:87], v10 offset:29184
  ds_read_b64_tr_b16 a[88:89], v10 offset:32768
  ds_read_b64_tr_b16 a[90:91], v10 offset:33280
  ds_read_b64_tr_b16 a[92:93], v10 offset:36864
  ds_read_b64_tr_b16 a[94:95], v10 offset:37376
  ds_read_b64_tr_b16 a[96:97], v10 offset:40960
  ds_read_b64_tr_b16 a[98:99], v10 offset:41472
  ds_read_b64_tr_b16 a[100:101], v10 offset:45056
  ds_read_b64_tr_b16 a[102:103], v10 offset:45568
  ds_read_b64_tr_b16 a[104:105], v10 offset:49152
  ds_read_b64_tr_b16 a[106:107], v10 offset:49664
  ds_read_b64_tr_b16 a[108:109], v10 offset:53248
  ds_read_b64_tr_b16 a[110:111], v10 offset:53760
  s_waitcnt lgkmcnt(0)
  s_barrier
  s_add_u32 s30, s34, 57344
  s_mov_b32 m0, s30
  s_nop 0
  global_load_lds_dwordx4 v8, s[32:33]
  s_add_u32 s32, s32, 131072
  s_addc_u32 s33, s33, 0
  s_add_u32 s30, s34, 61440
  s_mov_b32 m0, s30
  s_nop 0
  global_load_lds_dwordx4 v8, s[32:33]
  s_add_u32 s32, s32, 131072
  s_addc_u32 s33, s33, 0
  s_add_u32 s30, s34, 65536
  s_mov_b32 m0, s30
  s_nop 0
  global_load_lds_dwordx4 v8, s[32:33]
  s_add_u32 s32, s32, 131072
  s_addc_u32 s33, s33, 0
  s_add_u32 s30, s34, 69632
  s_mov_b32 m0, s30
  s_nop 0
  global_load_lds_dwordx4 v8, s[32:33]
  s_add_u32 s32, s32, 131072
  s_addc_u32 s33, s33, 0
  s_add_u32 s30, s34, 73728
  s_mov_b32 m0, s30
  s_nop 0
  global_load_lds_dwordx4 v8, s[32:33]
  s_add_u32 s32, s32, 131072
  s_addc_u32 s33, s33, 0
  s_add_u32 s30, s34, 77824
  s_mov_b32 m0, s30
  s_nop 0
  global_load_lds_dwordx4 v8, s[32:33]
  s_add_u32 s32, s32, 131072
  s_addc_u32 s33, s33, 0
  s_add_u32 s30, s34, 81920
  s_mov_b32 m0, s30
  s_nop 0
  global_load_lds_dwordx4 v8, s[32:33]
  s_add_u32 s32, s32, 131072
  s_addc_u32 s33, s33, 0
  s_add_u32 s30, s34, 86016
  s_mov_b32 m0, s30
  s_nop 0
  global_load_lds_dwordx4 v8, s[32:33]
  s_add_u32 s32, s32, 131072
  s_addc_u32 s33, s33, 0
  s_add_u32 s30, s34, 90112
  s_mov_b32 m0, s30
  s_nop 0
  global_load_lds_dwordx4 v8, s[32:33]
  s_add_u32 s32, s32, 131072
  s_addc_u32 s33, s33, 0
  s_add_u32 s30, s34, 94208
  s_mov_b32 m0, s30
  s_nop 0
  global_load_lds_dwordx4 v8, s[32:33]
  s_add_u32 s32, s32, 131072
  s_addc_u32 s33, s33, 0
  s_add_u32 s30, s34, 98304
  s_mov_b32 m0, s30
  s_nop 0
  global_load_lds_dwordx4 v8, s[32:33]
  s_add_u32 s32, s32, 131072
  s_addc_u32 s33, s33, 0
  s_add_u32 s30, s34, 102400
  s_mov_b32 m0, s30
  s_nop 0
  global_load_lds_dwordx4 v8, s[32:33]
  s_add_u32 s32, s32, 131072
  s_addc_u32 s33, s33, 0
  s_add_u32 s30, s34, 106496
  s_mov_b32 m0, s30
  s_nop 0
  global_load_lds_dwordx4 v8, s[32:33]
  s_add_u32 s32, s32, 131072
  s_addc_u32 s33, s33, 0
  s_add_u32 s30, s34, 110592
  s_mov_b32 m0, s30
  s_nop 0
  global_load_lds_dwordx4 v8, s[32:33]
  s_add_u32 s32, s32, 131072
  s_addc_u32 s33, s33, 0
  s_waitcnt vmcnt(14)
  s_barrier
  ds_read_b64_tr_b16 a[112:113], v9 offset:0
  ds_read_b64_tr_b16 a[114:115], v9 offset:512
  ds_read_b64_tr_b16 a[116:117], v9 offset:4096
  ds_read_b64_tr_b16 a[118:119], v9 offset:4608
  ds_read_b64_tr_b16 a[120:121], v9 offset:8192
  ds_read_b64_tr_b16 a[122:123], v9 offset:8704
  ds_read_b64_tr_b16 a[124:125], v9 offset:12288
  ds_read_b64_tr_b16 a[126:127], v9 offset:12800
  ds_read_b64_tr_b16 a[128:129], v9 offset:16384
  ds_read_b64_tr_b16 a[130:131], v9 offset:16896
  ds_read_b64_tr_b16 a[132:133], v9 offset:20480
  ds_read_b64_tr_b16 a[134:135], v9 offset:20992
  ds_read_b64_tr_b16 a[136:137], v9 offset:24576
  ds_read_b64_tr_b16 a[138:139], v9 offset:25088
  s_waitcnt lgkmcnt(0)
  ds_read_b64_tr_b16 a[140:141], v9 offset:28672
  ds_read_b64_tr_b16 a[142:143], v9 offset:29184
  ds_read_b64_tr_b16 a[144:145], v9 offset:32768
  ds_read_b64_tr_b16 a[146:147], v9 offset:33280
  ds_read_b64_tr_b16 a[148:149], v9 offset:36864
  ds_read_b64_tr_b16 a[150:151], v9 offset:37376
  ds_read_b64_tr_b16 a[152:153], v9 offset:40960
  ds_read_b64_tr_b16 a[154:155], v9 offset:41472
  ds_read_b64_tr_b16 a[156:157], v9 offset:45056
  ds_read_b64_tr_b16 a[158:159], v9 offset:45568
  ds_read_b64_tr_b16 a[160:161], v9 offset:49152
  ds_read_b64_tr_b16 a[162:163], v9 offset:49664
  ds_read_b64_tr_b16 a[164:165], v9 offset:53248
  ds_read_b64_tr_b16 a[166:167], v9 offset:53760
  s_waitcnt lgkmcnt(0)
  s_waitcnt vmcnt(0)
  s_barrier
  ds_read_b64_tr_b16 a[168:169], v10 offset:0
  ds_read_b64_tr_b16 a[170:171], v10 offset:512
  ds_read_b64_tr_b16 a[172:173], v10 offset:4096
  ds_read_b64_tr_b16 a[174:175], v10 offset:4608
  ds_read_b64_tr_b16 a[176:177], v10 offset:8192
  ds_read_b64_tr_b16 a[178:179], v10 offset:8704
  ds_read_b64_tr_b16 a[180:181], v10 offset:12288
  ds_read_b64_tr_b16 a[182:183], v10 offset:12800
  ds_read_b64_tr_b16 a[184:185], v10 offset:16384
  ds_read_b64_tr_b16 a[186:187], v10 offset:16896
  ds_read_b64_tr_b16 a[188:189], v10 offset:20480
  ds_read_b64_tr_b16 a[190:191], v10 offset:20992
  ds_read_b64_tr_b16 a[192:193], v10 offset:24576
  ds_read_b64_tr_b16 a[194:195], v10 offset:25088
  s_waitcnt lgkmcnt(0)
  ds_read_b64_tr_b16 a[196:197], v10 offset:28672
  ds_read_b64_tr_b16 a[198:199], v10 offset:29184
  ds_read_b64_tr_b16 a[200:201], v10 offset:32768
  ds_read_b64_tr_b16 a[202:203], v10 offset:33280
  ds_read_b64_tr_b16 a[204:205], v10 offset:36864
  ds_read_b64_tr_b16 a[206:207], v10 offset:37376
  ds_read_b64_tr_b16 a[208:209], v10 offset:40960
  ds_read_b64_tr_b16 a[210:211], v10 offset:41472
  ds_read_b64_tr_b16 a[212:213], v10 offset:45056
  ds_read_b64_tr_b16 a[214:215], v10 offset:45568
  ds_read_b64_tr_b16 a[216:217], v10 offset:49152
  ds_read_b64_tr_b16 a[218:219], v10 offset:49664
  ds_read_b64_tr_b16 a[220:221], v10 offset:53248
  ds_read_b64_tr_b16 a[222:223], v10 offset:53760
  s_waitcnt lgkmcnt(0)
L_g2pre_300:
  v_and_b32 v10, 63, v0
  v_lshlrev_b32 v8, 4, v10
  v_mov_b32 v9, v8
  s_lshl_b32 s30, s37, 2
  s_add_u32 s30, s30, s8
  s_mul_i32 s30, s30, 57344
  s_add_u32 s28, s4, 59768832
  s_addc_u32 s29, s5, 0
  s_add_u32 s28, s28, s30
  s_addc_u32 s29, s29, 0
  s_lshl_b32 s34, s8, 10
  s_cmp_lg_u32 s8, 0
  s_cbranch_scc1 L_gfg_306
  s_mov_b32 s11, 0
  s_lshl_b32 s14, s68, 10
  s_add_u32 s14, s14, 4096
  v_and_b32 v1, 63, v0
  v_min_u32 v1, 59, v1
  v_and_b32 v2, 7, v1
  v_lshlrev_b32 v2, 7, v2
  v_lshrrev_b32 v1, 3, v1
  v_lshl_add_u32 v1, v1, 2, v2
  v_add_u32 v1, s14, v1
L_gfp_305:
  global_load_dword v2, v1, s[86:87] sc1
  s_waitcnt vmcnt(0)
  v_cmp_eq_u32 vcc, 0, v2
  s_cbranch_vccz L_gfg_306
  s_add_u32 s11, s11, 1
  s_cmp_gt_u32 s11, 262144
  s_cbranch_scc1 L_fin
  s_sleep 1
  s_branch L_gfp_305
L_gfg_306:
  s_barrier
  v_and_b32 v10, 15, v0
  s_lshl_b32 s30, s8, 4
  s_lshl_b32 s31, s36, 6
  s_add_u32 s30, s30, s31
  v_add_u32 v13, s30, v10
  v_mul_u32_u24 v12, 896, v13
  v_bfe_u32 v10, v0, 4, 2
  v_lshl_add_u32 v12, v10, 4, v12
  s_lshl_b32 s30, s37, 7
  v_add_u32 v12, s30, v12
  v_lshlrev_b32 v13, 1, v13
  s_add_u32 s30, s34, 0
  s_mov_b32 m0, s30
  s_nop 0
  global_load_lds_dwordx4 v8, s[28:29]
  s_add_u32 s28, s28, 1024
  s_addc_u32 s29, s29, 0
  s_add_u32 s30, s34, 4096
  s_mov_b32 m0, s30
  s_nop 0
  global_load_lds_dwordx4 v8, s[28:29]
  s_add_u32 s28, s28, 1024
  s_addc_u32 s29, s29, 0
  s_add_u32 s30, s34, 8192
  s_mov_b32 m0, s30
  s_nop 0
  global_load_lds_dwordx4 v8, s[28:29]
  s_add_u32 s28, s28, 1024
  s_addc_u32 s29, s29, 0
  s_add_u32 s30, s34, 12288
  s_mov_b32 m0, s30
  s_nop 0
  global_load_lds_dwordx4 v8, s[28:29]
  s_add_u32 s28, s28, 1024
  s_addc_u32 s29, s29, 0
  s_add_u32 s30, s34, 16384
  s_mov_b32 m0, s30
  s_nop 0
  global_load_lds_dwordx4 v8, s[28:29]
  s_add_u32 s28, s28, 1024
  s_addc_u32 s29, s29, 0
  s_add_u32 s30, s34, 20480
  s_mov_b32 m0, s30
  s_nop 0
  global_load_lds_dwordx4 v8, s[28:29]
  s_add_u32 s28, s28, 1024
  s_addc_u32 s29, s29, 0
  s_add_u32 s30, s34, 24576
  s_mov_b32 m0, s30
  s_nop 0
  global_load_lds_dwordx4 v8, s[28:29]
  s_add_u32 s28, s28, 1024
  s_addc_u32 s29, s29, 0
  s_add_u32 s30, s34, 28672
  s_mov_b32 m0, s30
  s_nop 0
  global_load_lds_dwordx4 v8, s[28:29]
  s_add_u32 s28, s28, 1024
  s_addc_u32 s29, s29, 0
  s_add_u32 s30, s34, 32768
  s_mov_b32 m0, s30
  s_nop 0
  global_load_lds_dwordx4 v8, s[28:29]
  s_add_u32 s28, s28, 1024
  s_addc_u32 s29, s29, 0
  s_add_u32 s30, s34, 36864
  s_mov_b32 m0, s30
  s_nop 0
  global_load_lds_dwordx4 v8, s[28:29]
  s_add_u32 s28, s28, 1024
  s_addc_u32 s29, s29, 0
  s_add_u32 s30, s34, 40960
  s_mov_b32 m0, s30
  s_nop 0
  global_load_lds_dwordx4 v8, s[28:29]
  s_add_u32 s28, s28, 1024
  s_addc_u32 s29, s29, 0
  s_add_u32 s30, s34, 45056
  s_mov_b32 m0, s30
  s_nop 0
  global_load_lds_dwordx4 v8, s[28:29]
  s_add_u32 s28, s28, 1024
  s_addc_u32 s29, s29, 0
  s_add_u32 s30, s34, 49152
  s_mov_b32 m0, s30
  s_nop 0
  global_load_lds_dwordx4 v8, s[28:29]
  s_add_u32 s28, s28, 1024
  s_addc_u32 s29, s29, 0
  s_add_u32 s30, s34, 53248
  s_mov_b32 m0, s30
  s_nop 0
  global_load_lds_dwordx4 v8, s[28:29]
  s_add_u32 s28, s28, 1024
  s_addc_u32 s29, s29, 0
  s_add_u32 s32, s4, 57933824
  s_addc_u32 s33, s5, 0
  global_load_dwordx4 v[96:99], v12, s[32:33] offset:0
  global_load_dwordx4 v[100:103], v12, s[32:33] offset:64
  global_load_ushort v104, v13, s[24:25]
  s_waitcnt vmcnt(15)
  s_barrier
  ds_read_b128 v[16:19], v9 offset:0
  ds_read_b128 v[20:23], v9 offset:1024
  ds_read_b128 v[24:27], v9 offset:2048
  ds_read_b128 v[28:31], v9 offset:3072
  ds_read_b128 v[32:35], v9 offset:4096
  ds_read_b128 v[36:39], v9 offset:5120
  ds_read_b128 v[40:43], v9 offset:6144
  ds_read_b128 v[44:47], v9 offset:7168
  s_waitcnt vmcnt(13) lgkmcnt(0)
  s_barrier
  s_add_u32 s30, s34, 57344
  s_mov_b32 m0, s30
  s_nop 0
  global_load_lds_dwordx4 v8, s[28:29]
  s_add_u32 s28, s28, 1024
  s_addc_u32 s29, s29, 0
  s_add_u32 s30, s34, 61440
  s_mov_b32 m0, s30
  s_nop 0
  global_load_lds_dwordx4 v8, s[28:29]
  s_add_u32 s28, s28, 1024
  s_addc_u32 s29, s29, 0
  ds_read_b128 v[48:51], v9 offset:8192
  ds_read_b128 v[52:55], v9 offset:9216
  ds_read_b128 v[56:59], v9 offset:10240
  ds_read_b128 v[60:63], v9 offset:11264
  ds_read_b128 v[64:67], v9 offset:12288
  ds_read_b128 v[68:71], v9 offset:13312
  ds_read_b128 v[72:75], v9 offset:14336
  ds_read_b128 v[76:79], v9 offset:15360
  v_mfma_f32_16x16x32_bf16 v[80:83], v[16:19], a[0:3], 0
  v_mfma_f32_16x16x32_bf16 v[84:87], v[20:23], a[0:3], 0
  v_mfma_f32_16x16x32_bf16 v[88:91], v[24:27], a[0:3], 0
  v_mfma_f32_16x16x32_bf16 v[92:95], v[28:31], a[0:3], 0
  v_mfma_f32_16x16x32_bf16 v[80:83], v[32:35], a[4:7], v[80:83]
  v_mfma_f32_16x16x32_bf16 v[84:87], v[36:39], a[4:7], v[84:87]
  v_mfma_f32_16x16x32_bf16 v[88:91], v[40:43], a[4:7], v[88:91]
  v_mfma_f32_16x16x32_bf16 v[92:95], v[44:47], a[4:7], v[92:95]
  s_waitcnt vmcnt(13) lgkmcnt(0)
  s_barrier
  s_add_u32 s30, s34, 0
  s_mov_b32 m0, s30
  s_nop 0
  global_load_lds_dwordx4 v8, s[28:29]
  s_add_u32 s28, s28, 1024
  s_addc_u32 s29, s29, 0
  s_add_u32 s30, s34, 4096
  s_mov_b32 m0, s30
  s_nop 0
  global_load_lds_dwordx4 v8, s[28:29]
  s_add_u32 s28, s28, 1024
  s_addc_u32 s29, s29, 0
  ds_read_b128 v[16:19], v9 offset:16384
  ds_read_b128 v[20:23], v9 offset:17408
  ds_read_b128 v[24:27], v9 offset:18432
  ds_read_b128 v[28:31], v9 offset:19456
  ds_read_b128 v[32:35], v9 offset:20480
  ds_read_b128 v[36:39], v9 offset:21504
  ds_read_b128 v[40:43], v9 offset:22528
  ds_read_b128 v[44:47], v9 offset:23552
  v_mfma_f32_16x16x32_bf16 v[80:83], v[48:51], a[8:11], v[80:83]
  v_mfma_f32_16x16x32_bf16 v[84:87], v[52:55], a[8:11], v[84:87]
  v_mfma_f32_16x16x32_bf16 v[88:91], v[56:59], a[8:11], v[88:91]
  v_mfma_f32_16x16x32_bf16 v[92:95], v[60:63], a[8:11], v[92:95]
  v_mfma_f32_16x16x32_bf16 v[80:83], v[64:67], a[12:15], v[80:83]
  v_mfma_f32_16x16x32_bf16 v[84:87], v[68:71], a[12:15], v[84:87]
  v_mfma_f32_16x16x32_bf16 v[88:91], v[72:75], a[12:15], v[88:91]
  v_mfma_f32_16x16x32_bf16 v[92:95], v[76:79], a[12:15], v[92:95]
  s_waitcnt vmcnt(13) lgkmcnt(0)
  s_barrier
  s_add_u32 s30, s34, 8192
  s_mov_b32 m0, s30
  s_nop 0
  global_load_lds_dwordx4 v8, s[28:29]
  s_add_u32 s28, s28, 1024
  s_addc_u32 s29, s29, 0
  s_add_u32 s30, s34, 12288
  s_mov_b32 m0, s30
  s_nop 0
  global_load_lds_dwordx4 v8, s[28:29]
  s_add_u32 s28, s28, 1024
  s_addc_u32 s29, s29, 0
  ds_read_b128 v[48:51], v9 offset:24576
  ds_read_b128 v[52:55], v9 offset:25600
  ds_read_b128 v[56:59], v9 offset:26624
  ds_read_b128 v[60:63], v9 offset:27648
  ds_read_b128 v[64:67], v9 offset:28672
  ds_read_b128 v[68:71], v9 offset:29696
  ds_read_b128 v[72:75], v9 offset:30720
  ds_read_b128 v[76:79], v9 offset:31744
  v_mfma_f32_16x16x32_bf16 v[80:83], v[16:19], a[16:19], v[80:83]
  v_mfma_f32_16x16x32_bf16 v[84:87], v[20:23], a[16:19], v[84:87]
  v_mfma_f32_16x16x32_bf16 v[88:91], v[24:27], a[16:19], v[88:91]
  v_mfma_f32_16x16x32_bf16 v[92:95], v[28:31], a[16:19], v[92:95]
  v_mfma_f32_16x16x32_bf16 v[80:83], v[32:35], a[20:23], v[80:83]
  v_mfma_f32_16x16x32_bf16 v[84:87], v[36:39], a[20:23], v[84:87]
  v_mfma_f32_16x16x32_bf16 v[88:91], v[40:43], a[20:23], v[88:91]
  v_mfma_f32_16x16x32_bf16 v[92:95], v[44:47], a[20:23], v[92:95]
  s_waitcnt vmcnt(13) lgkmcnt(0)
  s_barrier
  s_add_u32 s30, s34, 16384
  s_mov_b32 m0, s30
  s_nop 0
  global_load_lds_dwordx4 v8, s[28:29]
  s_add_u32 s28, s28, 1024
  s_addc_u32 s29, s29, 0
  s_add_u32 s30, s34, 20480
  s_mov_b32 m0, s30
  s_nop 0
  global_load_lds_dwordx4 v8, s[28:29]
  s_add_u32 s28, s28, 1024
  s_addc_u32 s29, s29, 0
  ds_read_b128 v[16:19], v9 offset:32768
  ds_read_b128 v[20:23], v9 offset:33792
  ds_read_b128 v[24:27], v9 offset:34816
  ds_read_b128 v[28:31], v9 offset:35840
  ds_read_b128 v[32:35], v9 offset:36864
  ds_read_b128 v[36:39], v9 offset:37888
  ds_read_b128 v[40:43], v9 offset:38912
  ds_read_b128 v[44:47], v9 offset:39936
  v_mfma_f32_16x16x32_bf16 v[80:83], v[48:51], a[24:27], v[80:83]
  v_mfma_f32_16x16x32_bf16 v[84:87], v[52:55], a[24:27], v[84:87]
  v_mfma_f32_16x16x32_bf16 v[88:91], v[56:59], a[24:27], v[88:91]
  v_mfma_f32_16x16x32_bf16 v[92:95], v[60:63], a[24:27], v[92:95]
  v_mfma_f32_16x16x32_bf16 v[80:83], v[64:67], a[28:31], v[80:83]
  v_mfma_f32_16x16x32_bf16 v[84:87], v[68:71], a[28:31], v[84:87]
  v_mfma_f32_16x16x32_bf16 v[88:91], v[72:75], a[28:31], v[88:91]
  v_mfma_f32_16x16x32_bf16 v[92:95], v[76:79], a[28:31], v[92:95]
  s_waitcnt vmcnt(13) lgkmcnt(0)
  s_barrier
  s_add_u32 s30, s34, 24576
  s_mov_b32 m0, s30
  s_nop 0
  global_load_lds_dwordx4 v8, s[28:29]
  s_add_u32 s28, s28, 1024
  s_addc_u32 s29, s29, 0
  s_add_u32 s30, s34, 28672
  s_mov_b32 m0, s30
  s_nop 0
  global_load_lds_dwordx4 v8, s[28:29]
  s_add_u32 s28, s28, 1024
  s_addc_u32 s29, s29, 0
  ds_read_b128 v[48:51], v9 offset:40960
  ds_read_b128 v[52:55], v9 offset:41984
  ds_read_b128 v[56:59], v9 offset:43008
  ds_read_b128 v[60:63], v9 offset:44032
  ds_read_b128 v[64:67], v9 offset:45056
  ds_read_b128 v[68:71], v9 offset:46080
  ds_read_b128 v[72:75], v9 offset:47104
  ds_read_b128 v[76:79], v9 offset:48128
  v_mfma_f32_16x16x32_bf16 v[80:83], v[16:19], a[32:35], v[80:83]
  v_mfma_f32_16x16x32_bf16 v[84:87], v[20:23], a[32:35], v[84:87]
  v_mfma_f32_16x16x32_bf16 v[88:91], v[24:27], a[32:35], v[88:91]
  v_mfma_f32_16x16x32_bf16 v[92:95], v[28:31], a[32:35], v[92:95]
  v_mfma_f32_16x16x32_bf16 v[80:83], v[32:35], a[36:39], v[80:83]
  v_mfma_f32_16x16x32_bf16 v[84:87], v[36:39], a[36:39], v[84:87]
  v_mfma_f32_16x16x32_bf16 v[88:91], v[40:43], a[36:39], v[88:91]
  v_mfma_f32_16x16x32_bf16 v[92:95], v[44:47], a[36:39], v[92:95]
  s_waitcnt vmcnt(13) lgkmcnt(0)
  s_barrier
  s_add_u32 s30, s34, 32768
  s_mov_b32 m0, s30
  s_nop 0
  global_load_lds_dwordx4 v8, s[28:29]
  s_add_u32 s28, s28, 1024
  s_addc_u32 s29, s29, 0
  s_add_u32 s30, s34, 36864
  s_mov_b32 m0, s30
  s_nop 0
  global_load_lds_dwordx4 v8, s[28:29]
  s_add_u32 s28, s28, 1024
  s_addc_u32 s29, s29, 0
  ds_read_b128 v[16:19], v9 offset:49152
  ds_read_b128 v[20:23], v9 offset:50176
  ds_read_b128 v[24:27], v9 offset:51200
  ds_read_b128 v[28:31], v9 offset:52224
  ds_read_b128 v[32:35], v9 offset:53248
  ds_read_b128 v[36:39], v9 offset:54272
  ds_read_b128 v[40:43], v9 offset:55296
  ds_read_b128 v[44:47], v9 offset:56320
  v_mfma_f32_16x16x32_bf16 v[80:83], v[48:51], a[40:43], v[80:83]
  v_mfma_f32_16x16x32_bf16 v[84:87], v[52:55], a[40:43], v[84:87]
  v_mfma_f32_16x16x32_bf16 v[88:91], v[56:59], a[40:43], v[88:91]
  v_mfma_f32_16x16x32_bf16 v[92:95], v[60:63], a[40:43], v[92:95]
  v_mfma_f32_16x16x32_bf16 v[80:83], v[64:67], a[44:47], v[80:83]
  v_mfma_f32_16x16x32_bf16 v[84:87], v[68:71], a[44:47], v[84:87]
  v_mfma_f32_16x16x32_bf16 v[88:91], v[72:75], a[44:47], v[88:91]
  v_mfma_f32_16x16x32_bf16 v[92:95], v[76:79], a[44:47], v[92:95]
  s_waitcnt vmcnt(10) lgkmcnt(0)
  s_barrier
  s_add_u32 s30, s34, 40960
  s_mov_b32 m0, s30
  s_nop 0
  global_load_lds_dwordx4 v8, s[28:29]
  s_add_u32 s28, s28, 1024
  s_addc_u32 s29, s29, 0
  s_add_u32 s30, s34, 45056
  s_mov_b32 m0, s30
  s_nop 0
  global_load_lds_dwordx4 v8, s[28:29]
  s_add_u32 s28, s28, 1024
  s_addc_u32 s29, s29, 0
  ds_read_b128 v[48:51], v9 offset:57344
  ds_read_b128 v[52:55], v9 offset:58368
  ds_read_b128 v[56:59], v9 offset:59392
  ds_read_b128 v[60:63], v9 offset:60416
  ds_read_b128 v[64:67], v9 offset:61440
  ds_read_b128 v[68:71], v9 offset:62464
  ds_read_b128 v[72:75], v9 offset:63488
  ds_read_b128 v[76:79], v9 offset:64512
  v_mfma_f32_16x16x32_bf16 v[80:83], v[16:19], a[48:51], v[80:83]
  v_mfma_f32_16x16x32_bf16 v[84:87], v[20:23], a[48:51], v[84:87]
  v_mfma_f32_16x16x32_bf16 v[88:91], v[24:27], a[48:51], v[88:91]
  v_mfma_f32_16x16x32_bf16 v[92:95], v[28:31], a[48:51], v[92:95]
  v_mfma_f32_16x16x32_bf16 v[80:83], v[32:35], a[52:55], v[80:83]
  v_mfma_f32_16x16x32_bf16 v[84:87], v[36:39], a[52:55], v[84:87]
  v_mfma_f32_16x16x32_bf16 v[88:91], v[40:43], a[52:55], v[88:91]
  v_mfma_f32_16x16x32_bf16 v[92:95], v[44:47], a[52:55], v[92:95]
  s_waitcnt vmcnt(10) lgkmcnt(0)
  s_barrier
  s_add_u32 s30, s34, 49152
  s_mov_b32 m0, s30
  s_nop 0
  global_load_lds_dwordx4 v8, s[28:29]
  s_add_u32 s28, s28, 1024
  s_addc_u32 s29, s29, 0
  s_add_u32 s30, s34, 53248
  s_mov_b32 m0, s30
  s_nop 0
  global_load_lds_dwordx4 v8, s[28:29]
  s_add_u32 s28, s28, 1024
  s_addc_u32 s29, s29, 0
  ds_read_b128 v[16:19], v9 offset:0
  ds_read_b128 v[20:23], v9 offset:1024
  ds_read_b128 v[24:27], v9 offset:2048
  ds_read_b128 v[28:31], v9 offset:3072
  ds_read_b128 v[32:35], v9 offset:4096
  ds_read_b128 v[36:39], v9 offset:5120
  ds_read_b128 v[40:43], v9 offset:6144
  ds_read_b128 v[44:47], v9 offset:7168
  v_mfma_f32_16x16x32_bf16 v[80:83], v[48:51], a[56:59], v[80:83]
  v_mfma_f32_16x16x32_bf16 v[84:87], v[52:55], a[56:59], v[84:87]
  v_mfma_f32_16x16x32_bf16 v[88:91], v[56:59], a[56:59], v[88:91]
  v_mfma_f32_16x16x32_bf16 v[92:95], v[60:63], a[56:59], v[92:95]
  v_mfma_f32_16x16x32_bf16 v[80:83], v[64:67], a[60:63], v[80:83]
  v_mfma_f32_16x16x32_bf16 v[84:87], v[68:71], a[60:63], v[84:87]
  v_mfma_f32_16x16x32_bf16 v[88:91], v[72:75], a[60:63], v[88:91]
  v_mfma_f32_16x16x32_bf16 v[92:95], v[76:79], a[60:63], v[92:95]
  s_waitcnt vmcnt(10) lgkmcnt(0)
  s_barrier
  s_add_u32 s30, s34, 57344
  s_mov_b32 m0, s30
  s_nop 0
  global_load_lds_dwordx4 v8, s[28:29]
  s_add_u32 s28, s28, 1024
  s_addc_u32 s29, s29, 0
  s_add_u32 s30, s34, 61440
  s_mov_b32 m0, s30
  s_nop 0
  global_load_lds_dwordx4 v8, s[28:29]
  s_add_u32 s28, s28, 1024
  s_addc_u32 s29, s29, 0
  ds_read_b128 v[48:51], v9 offset:8192
  ds_read_b128 v[52:55], v9 offset:9216
  ds_read_b128 v[56:59], v9 offset:10240
  ds_read_b128 v[60:63], v9 offset:11264
  ds_read_b128 v[64:67], v9 offset:12288
  ds_read_b128 v[68:71], v9 offset:13312
  ds_read_b128 v[72:75], v9 offset:14336
  ds_read_b128 v[76:79], v9 offset:15360
  v_mfma_f32_16x16x32_bf16 v[80:83], v[16:19], a[64:67], v[80:83]
  v_mfma_f32_16x16x32_bf16 v[84:87], v[20:23], a[64:67], v[84:87]
  v_mfma_f32_16x16x32_bf16 v[88:91], v[24:27], a[64:67], v[88:91]
  v_mfma_f32_16x16x32_bf16 v[92:95], v[28:31], a[64:67], v[92:95]
  v_mfma_f32_16x16x32_bf16 v[80:83], v[32:35], a[68:71], v[80:83]
  v_mfma_f32_16x16x32_bf16 v[84:87], v[36:39], a[68:71], v[84:87]
  v_mfma_f32_16x16x32_bf16 v[88:91], v[40:43], a[68:71], v[88:91]
  v_mfma_f32_16x16x32_bf16 v[92:95], v[44:47], a[68:71], v[92:95]
  s_waitcnt vmcnt(10) lgkmcnt(0)
  s_barrier
  s_add_u32 s30, s34, 0
  s_mov_b32 m0, s30
  s_nop 0
  global_load_lds_dwordx4 v8, s[28:29]
  s_add_u32 s28, s28, 1024
  s_addc_u32 s29, s29, 0
  s_add_u32 s30, s34, 4096
  s_mov_b32 m0, s30
  s_nop 0
  global_load_lds_dwordx4 v8, s[28:29]
  s_add_u32 s28, s28, 1024
  s_addc_u32 s29, s29, 0
  ds_read_b128 v[16:19], v9 offset:16384
  ds_read_b128 v[20:23], v9 offset:17408
  ds_read_b128 v[24:27], v9 offset:18432
  ds_read_b128 v[28:31], v9 offset:19456
  ds_read_b128 v[32:35], v9 offset:20480
  ds_read_b128 v[36:39], v9 offset:21504
  ds_read_b128 v[40:43], v9 offset:22528
  ds_read_b128 v[44:47], v9 offset:23552
  v_mfma_f32_16x16x32_bf16 v[80:83], v[48:51], a[72:75], v[80:83]
  v_mfma_f32_16x16x32_bf16 v[84:87], v[52:55], a[72:75], v[84:87]
  v_mfma_f32_16x16x32_bf16 v[88:91], v[56:59], a[72:75], v[88:91]
  v_mfma_f32_16x16x32_bf16 v[92:95], v[60:63], a[72:75], v[92:95]
  v_mfma_f32_16x16x32_bf16 v[80:83], v[64:67], a[76:79], v[80:83]
  v_mfma_f32_16x16x32_bf16 v[84:87], v[68:71], a[76:79], v[84:87]
  v_mfma_f32_16x16x32_bf16 v[88:91], v[72:75], a[76:79], v[88:91]
  v_mfma_f32_16x16x32_bf16 v[92:95], v[76:79], a[76:79], v[92:95]
  s_waitcnt vmcnt(10) lgkmcnt(0)
  s_barrier
  s_add_u32 s30, s34, 8192
  s_mov_b32 m0, s30
  s_nop 0
  global_load_lds_dwordx4 v8, s[28:29]
  s_add_u32 s28, s28, 1024
  s_addc_u32 s29, s29, 0
  s_add_u32 s30, s34, 12288
  s_mov_b32 m0, s30
  s_nop 0
  global_load_lds_dwordx4 v8, s[28:29]
  s_add_u32 s28, s28, 1024
  s_addc_u32 s29, s29, 0
  ds_read_b128 v[48:51], v9 offset:24576
  ds_read_b128 v[52:55], v9 offset:25600
  ds_read_b128 v[56:59], v9 offset:26624
  ds_read_b128 v[60:63], v9 offset:27648
  ds_read_b128 v[64:67], v9 offset:28672
  ds_read_b128 v[68:71], v9 offset:29696
  ds_read_b128 v[72:75], v9 offset:30720
  ds_read_b128 v[76:79], v9 offset:31744
  v_mfma_f32_16x16x32_bf16 v[80:83], v[16:19], a[80:83], v[80:83]
  v_mfma_f32_16x16x32_bf16 v[84:87], v[20:23], a[80:83], v[84:87]
  v_mfma_f32_16x16x32_bf16 v[88:91], v[24:27], a[80:83], v[88:91]
  v_mfma_f32_16x16x32_bf16 v[92:95], v[28:31], a[80:83], v[92:95]
  v_mfma_f32_16x16x32_bf16 v[80:83], v[32:35], a[84:87], v[80:83]
  v_mfma_f32_16x16x32_bf16 v[84:87], v[36:39], a[84:87], v[84:87]
  v_mfma_f32_16x16x32_bf16 v[88:91], v[40:43], a[84:87], v[88:91]
  v_mfma_f32_16x16x32_bf16 v[92:95], v[44:47], a[84:87], v[92:95]
  s_waitcnt vmcnt(10) lgkmcnt(0)
  s_barrier
  s_add_u32 s30, s34, 16384
  s_mov_b32 m0, s30
  s_nop 0
  global_load_lds_dwordx4 v8, s[28:29]
  s_add_u32 s28, s28, 1024
  s_addc_u32 s29, s29, 0
  s_add_u32 s30, s34, 20480
  s_mov_b32 m0, s30
  s_nop 0
  global_load_lds_dwordx4 v8, s[28:29]
  s_add_u32 s28, s28, 1024
  s_addc_u32 s29, s29, 0
  ds_read_b128 v[16:19], v9 offset:32768
  ds_read_b128 v[20:23], v9 offset:33792
  ds_read_b128 v[24:27], v9 offset:34816
  ds_read_b128 v[28:31], v9 offset:35840
  ds_read_b128 v[32:35], v9 offset:36864
  ds_read_b128 v[36:39], v9 offset:37888
  ds_read_b128 v[40:43], v9 offset:38912
  ds_read_b128 v[44:47], v9 offset:39936
  v_mfma_f32_16x16x32_bf16 v[80:83], v[48:51], a[88:91], v[80:83]
  v_mfma_f32_16x16x32_bf16 v[84:87], v[52:55], a[88:91], v[84:87]
  v_mfma_f32_16x16x32_bf16 v[88:91], v[56:59], a[88:91], v[88:91]
  v_mfma_f32_16x16x32_bf16 v[92:95], v[60:63], a[88:91], v[92:95]
  v_mfma_f32_16x16x32_bf16 v[80:83], v[64:67], a[92:95], v[80:83]
  v_mfma_f32_16x16x32_bf16 v[84:87], v[68:71], a[92:95], v[84:87]
  v_mfma_f32_16x16x32_bf16 v[88:91], v[72:75], a[92:95], v[88:91]
  v_mfma_f32_16x16x32_bf16 v[92:95], v[76:79], a[92:95], v[92:95]
  s_waitcnt vmcnt(10) lgkmcnt(0)
  s_barrier
  s_add_u32 s30, s34, 24576
  s_mov_b32 m0, s30
  s_nop 0
  global_load_lds_dwordx4 v8, s[28:29]
  s_add_u32 s28, s28, 1024
  s_addc_u32 s29, s29, 0
  s_add_u32 s30, s34, 28672
  s_mov_b32 m0, s30
  s_nop 0
  global_load_lds_dwordx4 v8, s[28:29]
  s_add_u32 s28, s28, 1024
  s_addc_u32 s29, s29, 0
  ds_read_b128 v[48:51], v9 offset:40960
  ds_read_b128 v[52:55], v9 offset:41984
  ds_read_b128 v[56:59], v9 offset:43008
  ds_read_b128 v[60:63], v9 offset:44032
  ds_read_b128 v[64:67], v9 offset:45056
  ds_read_b128 v[68:71], v9 offset:46080
  ds_read_b128 v[72:75], v9 offset:47104
  ds_read_b128 v[76:79], v9 offset:48128
  v_mfma_f32_16x16x32_bf16 v[80:83], v[16:19], a[96:99], v[80:83]
  v_mfma_f32_16x16x32_bf16 v[84:87], v[20:23], a[96:99], v[84:87]
  v_mfma_f32_16x16x32_bf16 v[88:91], v[24:27], a[96:99], v[88:91]
  v_mfma_f32_16x16x32_bf16 v[92:95], v[28:31], a[96:99], v[92:95]
  v_mfma_f32_16x16x32_bf16 v[80:83], v[32:35], a[100:103], v[80:83]
  v_mfma_f32_16x16x32_bf16 v[84:87], v[36:39], a[100:103], v[84:87]
  v_mfma_f32_16x16x32_bf16 v[88:91], v[40:43], a[100:103], v[88:91]
  v_mfma_f32_16x16x32_bf16 v[92:95], v[44:47], a[100:103], v[92:95]
  s_waitcnt vmcnt(10) lgkmcnt(0)
  s_barrier
  s_add_u32 s30, s34, 32768
  s_mov_b32 m0, s30
  s_nop 0
  global_load_lds_dwordx4 v8, s[28:29]
  s_add_u32 s28, s28, 1024
  s_addc_u32 s29, s29, 0
  s_add_u32 s30, s34, 36864
  s_mov_b32 m0, s30
  s_nop 0
  global_load_lds_dwordx4 v8, s[28:29]
  s_add_u32 s28, s28, 1024
  s_addc_u32 s29, s29, 0
  ds_read_b128 v[16:19], v9 offset:49152
  ds_read_b128 v[20:23], v9 offset:50176
  ds_read_b128 v[24:27], v9 offset:51200
  ds_read_b128 v[28:31], v9 offset:52224
  ds_read_b128 v[32:35], v9 offset:53248
  ds_read_b128 v[36:39], v9 offset:54272
  ds_read_b128 v[40:43], v9 offset:55296
  ds_read_b128 v[44:47], v9 offset:56320
  v_mfma_f32_16x16x32_bf16 v[80:83], v[48:51], a[104:107], v[80:83]
  v_mfma_f32_16x16x32_bf16 v[84:87], v[52:55], a[104:107], v[84:87]
  v_mfma_f32_16x16x32_bf16 v[88:91], v[56:59], a[104:107], v[88:91]
  v_mfma_f32_16x16x32_bf16 v[92:95], v[60:63], a[104:107], v[92:95]
  v_mfma_f32_16x16x32_bf16 v[80:83], v[64:67], a[108:111], v[80:83]
  v_mfma_f32_16x16x32_bf16 v[84:87], v[68:71], a[108:111], v[84:87]
  v_mfma_f32_16x16x32_bf16 v[88:91], v[72:75], a[108:111], v[88:91]
  v_mfma_f32_16x16x32_bf16 v[92:95], v[76:79], a[108:111], v[92:95]
  s_waitcnt vmcnt(10) lgkmcnt(0)
  s_barrier
  s_add_u32 s30, s34, 40960
  s_mov_b32 m0, s30
  s_nop 0
  global_load_lds_dwordx4 v8, s[28:29]
  s_add_u32 s28, s28, 1024
  s_addc_u32 s29, s29, 0
  s_add_u32 s30, s34, 45056
  s_mov_b32 m0, s30
  s_nop 0
  global_load_lds_dwordx4 v8, s[28:29]
  s_add_u32 s28, s28, 1024
  s_addc_u32 s29, s29, 0
  ds_read_b128 v[48:51], v9 offset:57344
  ds_read_b128 v[52:55], v9 offset:58368
  ds_read_b128 v[56:59], v9 offset:59392
  ds_read_b128 v[60:63], v9 offset:60416
  ds_read_b128 v[64:67], v9 offset:61440
  ds_read_b128 v[68:71], v9 offset:62464
  ds_read_b128 v[72:75], v9 offset:63488
  ds_read_b128 v[76:79], v9 offset:64512
  v_mfma_f32_16x16x32_bf16 v[80:83], v[16:19], a[112:115], v[80:83]
  v_mfma_f32_16x16x32_bf16 v[84:87], v[20:23], a[112:115], v[84:87]
  v_mfma_f32_16x16x32_bf16 v[88:91], v[24:27], a[112:115], v[88:91]
  v_mfma_f32_16x16x32_bf16 v[92:95], v[28:31], a[112:115], v[92:95]
  v_mfma_f32_16x16x32_bf16 v[80:83], v[32:35], a[116:119], v[80:83]
  v_mfma_f32_16x16x32_bf16 v[84:87], v[36:39], a[116:119], v[84:87]
  v_mfma_f32_16x16x32_bf16 v[88:91], v[40:43], a[116:119], v[88:91]
  v_mfma_f32_16x16x32_bf16 v[92:95], v[44:47], a[116:119], v[92:95]
  s_waitcnt vmcnt(10) lgkmcnt(0)
  s_barrier
  s_add_u32 s30, s34, 49152
  s_mov_b32 m0, s30
  s_nop 0
  global_load_lds_dwordx4 v8, s[28:29]
  s_add_u32 s28, s28, 1024
  s_addc_u32 s29, s29, 0
  s_add_u32 s30, s34, 53248
  s_mov_b32 m0, s30
  s_nop 0
  global_load_lds_dwordx4 v8, s[28:29]
  s_add_u32 s28, s28, 1024
  s_addc_u32 s29, s29, 0
  ds_read_b128 v[16:19], v9 offset:0
  ds_read_b128 v[20:23], v9 offset:1024
  ds_read_b128 v[24:27], v9 offset:2048
  ds_read_b128 v[28:31], v9 offset:3072
  ds_read_b128 v[32:35], v9 offset:4096
  ds_read_b128 v[36:39], v9 offset:5120
  ds_read_b128 v[40:43], v9 offset:6144
  ds_read_b128 v[44:47], v9 offset:7168
  v_mfma_f32_16x16x32_bf16 v[80:83], v[48:51], a[120:123], v[80:83]
  v_mfma_f32_16x16x32_bf16 v[84:87], v[52:55], a[120:123], v[84:87]
  v_mfma_f32_16x16x32_bf16 v[88:91], v[56:59], a[120:123], v[88:91]
  v_mfma_f32_16x16x32_bf16 v[92:95], v[60:63], a[120:123], v[92:95]
  v_mfma_f32_16x16x32_bf16 v[80:83], v[64:67], a[124:127], v[80:83]
  v_mfma_f32_16x16x32_bf16 v[84:87], v[68:71], a[124:127], v[84:87]
  v_mfma_f32_16x16x32_bf16 v[88:91], v[72:75], a[124:127], v[88:91]
  v_mfma_f32_16x16x32_bf16 v[92:95], v[76:79], a[124:127], v[92:95]
  s_waitcnt vmcnt(10) lgkmcnt(0)
  s_barrier
  s_add_u32 s30, s34, 57344
  s_mov_b32 m0, s30
  s_nop 0
  global_load_lds_dwordx4 v8, s[28:29]
  s_add_u32 s28, s28, 1024
  s_addc_u32 s29, s29, 0
  s_add_u32 s30, s34, 61440
  s_mov_b32 m0, s30
  s_nop 0
  global_load_lds_dwordx4 v8, s[28:29]
  s_add_u32 s28, s28, 1024
  s_addc_u32 s29, s29, 0
  ds_read_b128 v[48:51], v9 offset:8192
  ds_read_b128 v[52:55], v9 offset:9216
  ds_read_b128 v[56:59], v9 offset:10240
  ds_read_b128 v[60:63], v9 offset:11264
  ds_read_b128 v[64:67], v9 offset:12288
  ds_read_b128 v[68:71], v9 offset:13312
  ds_read_b128 v[72:75], v9 offset:14336
  ds_read_b128 v[76:79], v9 offset:15360
  v_mfma_f32_16x16x32_bf16 v[80:83], v[16:19], a[128:131], v[80:83]
  v_mfma_f32_16x16x32_bf16 v[84:87], v[20:23], a[128:131], v[84:87]
  v_mfma_f32_16x16x32_bf16 v[88:91], v[24:27], a[128:131], v[88:91]
  v_mfma_f32_16x16x32_bf16 v[92:95], v[28:31], a[128:131], v[92:95]
  v_mfma_f32_16x16x32_bf16 v[80:83], v[32:35], a[132:135], v[80:83]
  v_mfma_f32_16x16x32_bf16 v[84:87], v[36:39], a[132:135], v[84:87]
  v_mfma_f32_16x16x32_bf16 v[88:91], v[40:43], a[132:135], v[88:91]
  v_mfma_f32_16x16x32_bf16 v[92:95], v[44:47], a[132:135], v[92:95]
  s_waitcnt vmcnt(10) lgkmcnt(0)
  s_barrier
  s_add_u32 s30, s34, 0
  s_mov_b32 m0, s30
  s_nop 0
  global_load_lds_dwordx4 v8, s[28:29]
  s_add_u32 s28, s28, 1024
  s_addc_u32 s29, s29, 0
  s_add_u32 s30, s34, 4096
  s_mov_b32 m0, s30
  s_nop 0
  global_load_lds_dwordx4 v8, s[28:29]
  s_add_u32 s28, s28, 1024
  s_addc_u32 s29, s29, 0
  ds_read_b128 v[16:19], v9 offset:16384
  ds_read_b128 v[20:23], v9 offset:17408
  ds_read_b128 v[24:27], v9 offset:18432
  ds_read_b128 v[28:31], v9 offset:19456
  ds_read_b128 v[32:35], v9 offset:20480
  ds_read_b128 v[36:39], v9 offset:21504
  ds_read_b128 v[40:43], v9 offset:22528
  ds_read_b128 v[44:47], v9 offset:23552
  v_mfma_f32_16x16x32_bf16 v[80:83], v[48:51], a[136:139], v[80:83]
  v_mfma_f32_16x16x32_bf16 v[84:87], v[52:55], a[136:139], v[84:87]
  v_mfma_f32_16x16x32_bf16 v[88:91], v[56:59], a[136:139], v[88:91]
  v_mfma_f32_16x16x32_bf16 v[92:95], v[60:63], a[136:139], v[92:95]
  v_mfma_f32_16x16x32_bf16 v[80:83], v[64:67], a[140:143], v[80:83]
  v_mfma_f32_16x16x32_bf16 v[84:87], v[68:71], a[140:143], v[84:87]
  v_mfma_f32_16x16x32_bf16 v[88:91], v[72:75], a[140:143], v[88:91]
  v_mfma_f32_16x16x32_bf16 v[92:95], v[76:79], a[140:143], v[92:95]
  s_waitcnt vmcnt(10) lgkmcnt(0)
  s_barrier
  s_add_u32 s30, s34, 8192
  s_mov_b32 m0, s30
  s_nop 0
  global_load_lds_dwordx4 v8, s[28:29]
  s_add_u32 s28, s28, 1024
  s_addc_u32 s29, s29, 0
  s_add_u32 s30, s34, 12288
  s_mov_b32 m0, s30
  s_nop 0
  global_load_lds_dwordx4 v8, s[28:29]
  s_add_u32 s28, s28, 1024
  s_addc_u32 s29, s29, 0
  ds_read_b128 v[48:51], v9 offset:24576
  ds_read_b128 v[52:55], v9 offset:25600
  ds_read_b128 v[56:59], v9 offset:26624
  ds_read_b128 v[60:63], v9 offset:27648
  ds_read_b128 v[64:67], v9 offset:28672
  ds_read_b128 v[68:71], v9 offset:29696
  ds_read_b128 v[72:75], v9 offset:30720
  ds_read_b128 v[76:79], v9 offset:31744
  v_mfma_f32_16x16x32_bf16 v[80:83], v[16:19], a[144:147], v[80:83]
  v_mfma_f32_16x16x32_bf16 v[84:87], v[20:23], a[144:147], v[84:87]
  v_mfma_f32_16x16x32_bf16 v[88:91], v[24:27], a[144:147], v[88:91]
  v_mfma_f32_16x16x32_bf16 v[92:95], v[28:31], a[144:147], v[92:95]
  v_mfma_f32_16x16x32_bf16 v[80:83], v[32:35], a[148:151], v[80:83]
  v_mfma_f32_16x16x32_bf16 v[84:87], v[36:39], a[148:151], v[84:87]
  v_mfma_f32_16x16x32_bf16 v[88:91], v[40:43], a[148:151], v[88:91]
  v_mfma_f32_16x16x32_bf16 v[92:95], v[44:47], a[148:151], v[92:95]
  s_waitcnt vmcnt(10) lgkmcnt(0)
  s_barrier
  s_add_u32 s30, s34, 16384
  s_mov_b32 m0, s30
  s_nop 0
  global_load_lds_dwordx4 v8, s[28:29]
  s_add_u32 s28, s28, 1024
  s_addc_u32 s29, s29, 0
  s_add_u32 s30, s34, 20480
  s_mov_b32 m0, s30
  s_nop 0
  global_load_lds_dwordx4 v8, s[28:29]
  s_add_u32 s28, s28, 1024
  s_addc_u32 s29, s29, 0
  ds_read_b128 v[16:19], v9 offset:32768
  ds_read_b128 v[20:23], v9 offset:33792
  ds_read_b128 v[24:27], v9 offset:34816
  ds_read_b128 v[28:31], v9 offset:35840
  ds_read_b128 v[32:35], v9 offset:36864
  ds_read_b128 v[36:39], v9 offset:37888
  ds_read_b128 v[40:43], v9 offset:38912
  ds_read_b128 v[44:47], v9 offset:39936
  v_mfma_f32_16x16x32_bf16 v[80:83], v[48:51], a[152:155], v[80:83]
  v_mfma_f32_16x16x32_bf16 v[84:87], v[52:55], a[152:155], v[84:87]
  v_mfma_f32_16x16x32_bf16 v[88:91], v[56:59], a[152:155], v[88:91]
  v_mfma_f32_16x16x32_bf16 v[92:95], v[60:63], a[152:155], v[92:95]
  v_mfma_f32_16x16x32_bf16 v[80:83], v[64:67], a[156:159], v[80:83]
  v_mfma_f32_16x16x32_bf16 v[84:87], v[68:71], a[156:159], v[84:87]
  v_mfma_f32_16x16x32_bf16 v[88:91], v[72:75], a[156:159], v[88:91]
  v_mfma_f32_16x16x32_bf16 v[92:95], v[76:79], a[156:159], v[92:95]
  s_waitcnt vmcnt(10) lgkmcnt(0)
  s_barrier
  s_add_u32 s30, s34, 24576
  s_mov_b32 m0, s30
  s_nop 0
  global_load_lds_dwordx4 v8, s[28:29]
  s_add_u32 s28, s28, 1024
  s_addc_u32 s29, s29, 0
  s_add_u32 s30, s34, 28672
  s_mov_b32 m0, s30
  s_nop 0
  global_load_lds_dwordx4 v8, s[28:29]
  s_add_u32 s28, s28, 1024
  s_addc_u32 s29, s29, 0
  ds_read_b128 v[48:51], v9 offset:40960
  ds_read_b128 v[52:55], v9 offset:41984
  ds_read_b128 v[56:59], v9 offset:43008
  ds_read_b128 v[60:63], v9 offset:44032
  ds_read_b128 v[64:67], v9 offset:45056
  ds_read_b128 v[68:71], v9 offset:46080
  ds_read_b128 v[72:75], v9 offset:47104
  ds_read_b128 v[76:79], v9 offset:48128
  v_mfma_f32_16x16x32_bf16 v[80:83], v[16:19], a[160:163], v[80:83]
  v_mfma_f32_16x16x32_bf16 v[84:87], v[20:23], a[160:163], v[84:87]
  v_mfma_f32_16x16x32_bf16 v[88:91], v[24:27], a[160:163], v[88:91]
  v_mfma_f32_16x16x32_bf16 v[92:95], v[28:31], a[160:163], v[92:95]
  v_mfma_f32_16x16x32_bf16 v[80:83], v[32:35], a[164:167], v[80:83]
  v_mfma_f32_16x16x32_bf16 v[84:87], v[36:39], a[164:167], v[84:87]
  v_mfma_f32_16x16x32_bf16 v[88:91], v[40:43], a[164:167], v[88:91]
  v_mfma_f32_16x16x32_bf16 v[92:95], v[44:47], a[164:167], v[92:95]
  s_waitcnt vmcnt(10) lgkmcnt(0)
  s_barrier
  ds_read_b128 v[16:19], v9 offset:49152
  ds_read_b128 v[20:23], v9 offset:50176
  ds_read_b128 v[24:27], v9 offset:51200
  ds_read_b128 v[28:31], v9 offset:52224
  ds_read_b128 v[32:35], v9 offset:53248
  ds_read_b128 v[36:39], v9 offset:54272
  ds_read_b128 v[40:43], v9 offset:55296
  ds_read_b128 v[44:47], v9 offset:56320
  v_mfma_f32_16x16x32_bf16 v[80:83], v[48:51], a[168:171], v[80:83]
  v_mfma_f32_16x16x32_bf16 v[84:87], v[52:55], a[168:171], v[84:87]
  v_mfma_f32_16x16x32_bf16 v[88:91], v[56:59], a[168:171], v[88:91]
  v_mfma_f32_16x16x32_bf16 v[92:95], v[60:63], a[168:171], v[92:95]
  v_mfma_f32_16x16x32_bf16 v[80:83], v[64:67], a[172:175], v[80:83]
  v_mfma_f32_16x16x32_bf16 v[84:87], v[68:71], a[172:175], v[84:87]
  v_mfma_f32_16x16x32_bf16 v[88:91], v[72:75], a[172:175], v[88:91]
  v_mfma_f32_16x16x32_bf16 v[92:95], v[76:79], a[172:175], v[92:95]
  s_waitcnt vmcnt(8) lgkmcnt(0)
  s_barrier
  ds_read_b128 v[48:51], v9 offset:57344
  ds_read_b128 v[52:55], v9 offset:58368
  ds_read_b128 v[56:59], v9 offset:59392
  ds_read_b128 v[60:63], v9 offset:60416
  ds_read_b128 v[64:67], v9 offset:61440
  ds_read_b128 v[68:71], v9 offset:62464
  ds_read_b128 v[72:75], v9 offset:63488
  ds_read_b128 v[76:79], v9 offset:64512
  v_mfma_f32_16x16x32_bf16 v[80:83], v[16:19], a[176:179], v[80:83]
  v_mfma_f32_16x16x32_bf16 v[84:87], v[20:23], a[176:179], v[84:87]
  v_mfma_f32_16x16x32_bf16 v[88:91], v[24:27], a[176:179], v[88:91]
  v_mfma_f32_16x16x32_bf16 v[92:95], v[28:31], a[176:179], v[92:95]
  v_mfma_f32_16x16x32_bf16 v[80:83], v[32:35], a[180:183], v[80:83]
  v_mfma_f32_16x16x32_bf16 v[84:87], v[36:39], a[180:183], v[84:87]
  v_mfma_f32_16x16x32_bf16 v[88:91], v[40:43], a[180:183], v[88:91]
  v_mfma_f32_16x16x32_bf16 v[92:95], v[44:47], a[180:183], v[92:95]
  s_waitcnt vmcnt(6) lgkmcnt(0)
  s_barrier
  ds_read_b128 v[16:19], v9 offset:0
  ds_read_b128 v[20:23], v9 offset:1024
  ds_read_b128 v[24:27], v9 offset:2048
  ds_read_b128 v[28:31], v9 offset:3072
  ds_read_b128 v[32:35], v9 offset:4096
  ds_read_b128 v[36:39], v9 offset:5120
  ds_read_b128 v[40:43], v9 offset:6144
  ds_read_b128 v[44:47], v9 offset:7168
  v_mfma_f32_16x16x32_bf16 v[80:83], v[48:51], a[184:187], v[80:83]
  v_mfma_f32_16x16x32_bf16 v[84:87], v[52:55], a[184:187], v[84:87]
  v_mfma_f32_16x16x32_bf16 v[88:91], v[56:59], a[184:187], v[88:91]
  v_mfma_f32_16x16x32_bf16 v[92:95], v[60:63], a[184:187], v[92:95]
  v_mfma_f32_16x16x32_bf16 v[80:83], v[64:67], a[188:191], v[80:83]
  v_mfma_f32_16x16x32_bf16 v[84:87], v[68:71], a[188:191], v[84:87]
  v_mfma_f32_16x16x32_bf16 v[88:91], v[72:75], a[188:191], v[88:91]
  v_mfma_f32_16x16x32_bf16 v[92:95], v[76:79], a[188:191], v[92:95]
  s_waitcnt vmcnt(4) lgkmcnt(0)
  s_barrier
  ds_read_b128 v[48:51], v9 offset:8192
  ds_read_b128 v[52:55], v9 offset:9216
  ds_read_b128 v[56:59], v9 offset:10240
  ds_read_b128 v[60:63], v9 offset:11264
  ds_read_b128 v[64:67], v9 offset:12288
  ds_read_b128 v[68:71], v9 offset:13312
  ds_read_b128 v[72:75], v9 offset:14336
  ds_read_b128 v[76:79], v9 offset:15360
  v_mfma_f32_16x16x32_bf16 v[80:83], v[16:19], a[192:195], v[80:83]
  v_mfma_f32_16x16x32_bf16 v[84:87], v[20:23], a[192:195], v[84:87]
  v_mfma_f32_16x16x32_bf16 v[88:91], v[24:27], a[192:195], v[88:91]
  v_mfma_f32_16x16x32_bf16 v[92:95], v[28:31], a[192:195], v[92:95]
  v_mfma_f32_16x16x32_bf16 v[80:83], v[32:35], a[196:199], v[80:83]
  v_mfma_f32_16x16x32_bf16 v[84:87], v[36:39], a[196:199], v[84:87]
  v_mfma_f32_16x16x32_bf16 v[88:91], v[40:43], a[196:199], v[88:91]
  v_mfma_f32_16x16x32_bf16 v[92:95], v[44:47], a[196:199], v[92:95]
  s_waitcnt vmcnt(2) lgkmcnt(0)
  s_barrier
  ds_read_b128 v[16:19], v9 offset:16384
  ds_read_b128 v[20:23], v9 offset:17408
  ds_read_b128 v[24:27], v9 offset:18432
  ds_read_b128 v[28:31], v9 offset:19456
  ds_read_b128 v[32:35], v9 offset:20480
  ds_read_b128 v[36:39], v9 offset:21504
  ds_read_b128 v[40:43], v9 offset:22528
  ds_read_b128 v[44:47], v9 offset:23552
  v_mfma_f32_16x16x32_bf16 v[80:83], v[48:51], a[200:203], v[80:83]
  v_mfma_f32_16x16x32_bf16 v[84:87], v[52:55], a[200:203], v[84:87]
  v_mfma_f32_16x16x32_bf16 v[88:91], v[56:59], a[200:203], v[88:91]
  v_mfma_f32_16x16x32_bf16 v[92:95], v[60:63], a[200:203], v[92:95]
  v_mfma_f32_16x16x32_bf16 v[80:83], v[64:67], a[204:207], v[80:83]
  v_mfma_f32_16x16x32_bf16 v[84:87], v[68:71], a[204:207], v[84:87]
  v_mfma_f32_16x16x32_bf16 v[88:91], v[72:75], a[204:207], v[88:91]
  v_mfma_f32_16x16x32_bf16 v[92:95], v[76:79], a[204:207], v[92:95]
  s_waitcnt vmcnt(0) lgkmcnt(0)
  s_barrier
  ds_read_b128 v[48:51], v9 offset:24576
  ds_read_b128 v[52:55], v9 offset:25600
  ds_read_b128 v[56:59], v9 offset:26624
  ds_read_b128 v[60:63], v9 offset:27648
  ds_read_b128 v[64:67], v9 offset:28672
  ds_read_b128 v[68:71], v9 offset:29696
  ds_read_b128 v[72:75], v9 offset:30720
  ds_read_b128 v[76:79], v9 offset:31744
  v_mfma_f32_16x16x32_bf16 v[80:83], v[16:19], a[208:211], v[80:83]
  v_mfma_f32_16x16x32_bf16 v[84:87], v[20:23], a[208:211], v[84:87]
  v_mfma_f32_16x16x32_bf16 v[88:91], v[24:27], a[208:211], v[88:91]
  v_mfma_f32_16x16x32_bf16 v[92:95], v[28:31], a[208:211], v[92:95]
  v_mfma_f32_16x16x32_bf16 v[80:83], v[32:35], a[212:215], v[80:83]
  v_mfma_f32_16x16x32_bf16 v[84:87], v[36:39], a[212:215], v[84:87]
  v_mfma_f32_16x16x32_bf16 v[88:91], v[40:43], a[212:215], v[88:91]
  v_mfma_f32_16x16x32_bf16 v[92:95], v[44:47], a[212:215], v[92:95]
  s_waitcnt lgkmcnt(0)
  v_mfma_f32_16x16x32_bf16 v[80:83], v[48:51], a[216:219], v[80:83]
  v_mfma_f32_16x16x32_bf16 v[84:87], v[52:55], a[216:219], v[84:87]
  v_mfma_f32_16x16x32_bf16 v[88:91], v[56:59], a[216:219], v[88:91]
  v_mfma_f32_16x16x32_bf16 v[92:95], v[60:63], a[216:219], v[92:95]
  v_mfma_f32_16x16x32_bf16 v[80:83], v[64:67], a[220:223], v[80:83]
  v_mfma_f32_16x16x32_bf16 v[84:87], v[68:71], a[220:223], v[84:87]
  v_mfma_f32_16x16x32_bf16 v[88:91], v[72:75], a[220:223], v[88:91]
  v_mfma_f32_16x16x32_bf16 v[92:95], v[76:79], a[220:223], v[92:95]
  s_waitcnt vmcnt(0)
  s_nop 7
  v_lshlrev_b32 v104, 16, v104
  v_lshlrev_b32 v10, 16, v96
  v_and_b32 v11, 0xffff0000, v96
  v_add_f32 v80, v80, v104
  v_add_f32 v81, v81, v104
  v_add_f32 v80, v80, v10
  v_add_f32 v81, v81, v11
  v_cvt_pk_bf16_f32 v106, v80, v81
  v_lshlrev_b32 v10, 16, v97
  v_and_b32 v11, 0xffff0000, v97
  v_add_f32 v82, v82, v104
  v_add_f32 v83, v83, v104
  v_add_f32 v82, v82, v10
  v_add_f32 v83, v83, v11
  v_cvt_pk_bf16_f32 v107, v82, v83
  v_lshlrev_b32 v10, 16, v98
  v_and_b32 v11, 0xffff0000, v98
  v_add_f32 v84, v84, v104
  v_add_f32 v85, v85, v104
  v_add_f32 v84, v84, v10
  v_add_f32 v85, v85, v11
  v_cvt_pk_bf16_f32 v108, v84, v85
  v_lshlrev_b32 v10, 16, v99
  v_and_b32 v11, 0xffff0000, v99
  v_add_f32 v86, v86, v104
  v_add_f32 v87, v87, v104
  v_add_f32 v86, v86, v10
  v_add_f32 v87, v87, v11
  v_cvt_pk_bf16_f32 v109, v86, v87
  global_store_dwordx4 v12, v[106:109], s[26:27] offset:0
  v_lshlrev_b32 v10, 16, v100
  v_and_b32 v11, 0xffff0000, v100
  v_add_f32 v88, v88, v104
  v_add_f32 v89, v89, v104
  v_add_f32 v88, v88, v10
  v_add_f32 v89, v89, v11
  v_cvt_pk_bf16_f32 v110, v88, v89
  v_lshlrev_b32 v10, 16, v101
  v_and_b32 v11, 0xffff0000, v101
  v_add_f32 v90, v90, v104
  v_add_f32 v91, v91, v104
  v_add_f32 v90, v90, v10
  v_add_f32 v91, v91, v11
  v_cvt_pk_bf16_f32 v111, v90, v91
  v_lshlrev_b32 v10, 16, v102
  v_and_b32 v11, 0xffff0000, v102
  v_add_f32 v92, v92, v104
  v_add_f32 v93, v93, v104
  v_add_f32 v92, v92, v10
  v_add_f32 v93, v93, v11
  v_cvt_pk_bf16_f32 v112, v92, v93
  v_lshlrev_b32 v10, 16, v103
  v_and_b32 v11, 0xffff0000, v103
  v_add_f32 v94, v94, v104
  v_add_f32 v95, v95, v104
  v_add_f32 v94, v94, v10
  v_add_f32 v95, v95, v11
  v_cvt_pk_bf16_f32 v113, v94, v95
  global_store_dwordx4 v12, v[110:113], s[26:27] offset:64
  s_waitcnt vmcnt(0)
L_fin:
L_sequential_preLN__memory_aug_recurrent_mem_tr__mixer_token_mlp__prompt_kernel_end:
  s_endpgm
.section .rodata,"a"
.p2align 6
.amdhsa_kernel sequential_preLN__memory_aug_recurrent_mem_tr__mixer_token_mlp__prompt_kernel
  .amdhsa_next_free_vgpr 512
  .amdhsa_next_free_sgpr 102
  .amdhsa_accum_offset 256
  .amdhsa_group_segment_fixed_size 0
  .amdhsa_kernarg_size 120
  .amdhsa_user_sgpr_count 2
  .amdhsa_user_sgpr_kernarg_segment_ptr 1
  .amdhsa_system_sgpr_workgroup_id_x 1
  .amdhsa_float_denorm_mode_32 3
  .amdhsa_float_denorm_mode_16_64 3
.end_amdhsa_kernel
```
